```python
import torch

def _softmax(x, axis=-1):
    return torch.softmax(x, dim=axis)
def _gelu(x):
    return torch.nn.functional.gelu(x, approximate="tanh")
def _silu(x):
    return torch.nn.functional.silu(x)
def _sigmoid(x):
    return torch.sigmoid(x)
def _layernorm(x, axis=-1, eps=1e-5):
    m = x.mean(dim=axis, keepdim=True)
    v = x.var(dim=axis, keepdim=True, unbiased=False)
    return (x - m) / torch.sqrt(v + eps)
def _scatter_add(tgt, idx, src, axis=0):
    return tgt.clone().index_add_(axis, idx, src)
def _segment_sum(src, seg, n):
    out = torch.zeros((n,) + src.shape[1:], dtype=src.dtype)
    return out.index_add_(0, seg, src)
def _pad(x, pw):
    flat = tuple(v for pair in reversed(pw) for v in pair)
    return torch.nn.functional.pad(x, flat)

kernel_name = 'standalone__gqa_softmax__near_ridge'

def setup_inputs():

    _w = (lambda a: (lambda t: t.to(torch.bfloat16) if t.is_floating_point() else t)(torch.as_tensor(a)))
    B, Hq, Hkv, Sq, Sk, D = 16, 32, 32, 384, 384, 192
    return {
        "q": _w((lambda *s: torch.randn(*s, dtype=torch.bfloat16) * 0.8)(B, Hq, Sq, D)),
        "k": _w((lambda *s: torch.randn(*s, dtype=torch.bfloat16) * 0.8)(B, Hkv, Sk, D)),
        "v": _w((lambda *s: torch.randn(*s, dtype=torch.bfloat16) * 0.05)(B, Hkv, Sk, D)),
    }

def reference(q, k, v):
    B, Hq, Sq, D = q.shape
    Hkv = k.shape[1]
    rep = Hq // Hkv
    k = (lambda x, n, axis: torch.repeat_interleave(x, n, dim=axis))(k, rep, axis=1)
    v = (lambda x, n, axis: torch.repeat_interleave(x, n, dim=axis))(v, rep, axis=1)
    scale = D ** -0.5
    scores = torch.einsum("bhqd,bhkd->bhqk", q, k) * scale
    p = _softmax(scores, axis=-1)
    return torch.einsum("bhqk,bhkd->bhqd", p, v)
```

```asm
; @launch grid=(256,1,1) block=(256,1,1) lds=163840
.amdgcn_target "amdgcn-amd-amdhsa--gfx950"
.text
.globl standalone__gqa_softmax__near_ridge_kernel
.p2align 8
.type standalone__gqa_softmax__near_ridge_kernel,@function
standalone__gqa_softmax__near_ridge_kernel:
s_cmp_ge_u32 s2, 256
s_cbranch_scc1 L_end
s_load_dwordx8 s[4:11], s[0:1], 0
v_lshrrev_b32 v1, 6, v0
s_nop 0
v_readfirstlane_b32 s3, v1
s_getpc_b64 s[60:61]
L_pc:
s_sub_u32 s60, s60, L_pc-standalone__gqa_softmax__near_ridge_kernel
s_subb_u32 s61, s61, 0
v_mbcnt_lo_u32_b32 v2, -1, 0
v_mbcnt_hi_u32_b32 v2, -1, v2
s_lshl_b32 s52, s3, 13
s_add_u32 s52, s52, 0
v_lshl_add_u32 v2, v2, 7, s52
v_min_u32 v2, L_end-standalone__gqa_softmax__near_ridge_kernel, v2
v_mov_b32 v3, 0
s_lshl_b32 m0, s3, 12
s_add_u32 m0, m0, 147456
v_lshl_add_u64 v[2:3], v[2:3], 0, s[60:61]
global_load_lds_dword v[2:3], off
s_mov_b32 s44, 0x3dd53b95
s_mov_b32 s45, 0xbdd53b95
s_mov_b32 s46, 0x4f800000
s_mov_b32 s56, 0x3dd53b95
s_mov_b32 s57, 0x3dd53b95
s_mul_i32 s47, s3, 3072
s_lshl_b32 s48, s3, 10
s_mul_i32 s49, s3, 33792
s_and_b32 s54, s3, 1
s_lshl_b32 s54, s54, 2
s_mov_b32 s52, s2
s_mul_i32 s52, s52, 147456
s_lshl_b32 s55, s3, 12
s_add_u32 s55, s55, 147456
s_mov_b32 s53, 0
s_add_u32 s84, s53, 0
s_and_b32 s84, s84, 3
s_mul_i32 s84, s84, 36864
s_add_u32 s85, s53, 1
s_and_b32 s85, s85, 3
s_mul_i32 s85, s85, 36864
s_add_u32 s86, s53, 2
s_and_b32 s86, s86, 3
s_mul_i32 s86, s86, 36864
s_add_u32 s87, s53, 3
s_and_b32 s87, s87, 3
s_mul_i32 s87, s87, 36864
v_mbcnt_lo_u32_b32 v2, -1, 0
v_mbcnt_hi_u32_b32 v2, -1, v2
v_lshrrev_b32 v1, 4, v2
v_or_b32 v1, s54, v1
v_and_b32 v18, 7, v2
v_xor_b32 v18, v1, v18
v_lshlrev_b32 v18, 4, v18
v_lshrrev_b32 v1, 3, v2
v_mul_u32_u24 v1, 384, v1
v_add3_u32 v18, v18, v1, s47
s_waitcnt lgkmcnt(0)
s_add_u32 s12, s4, s52
s_addc_u32 s13, s5, 0
s_mov_b32 s14, 147456
s_mov_b32 s15, 0x20000
s_add_u32 s16, s6, s52
s_addc_u32 s17, s7, 0
s_mov_b32 s18, 147456
s_mov_b32 s19, 0x20000
s_add_u32 m0, s47, 0
s_add_u32 s50, s84, 0
buffer_load_dwordx4 v18, s[16:19], s50 offen nt lds
s_add_u32 m0, s47, 896
s_nop 0
buffer_load_dwordx4 v18, s[16:19], s50 offen offset:128 nt lds
s_add_u32 m0, s47, 1792
s_nop 0
buffer_load_dwordx4 v18, s[16:19], s50 offen offset:256 nt lds
s_add_u32 s50, s49, 0
buffer_load_dwordx4 a[0:3], v18, s[12:15], s50 offen nt
s_add_u32 s50, s49, 3072
buffer_load_dwordx4 a[4:7], v18, s[12:15], s50 offen nt
s_add_u32 s50, s49, 6144
buffer_load_dwordx4 a[8:11], v18, s[12:15], s50 offen nt
s_add_u32 s50, s49, 9216
buffer_load_dwordx4 a[12:15], v18, s[12:15], s50 offen nt
s_add_u32 s50, s49, 128
buffer_load_dwordx4 a[16:19], v18, s[12:15], s50 offen nt
s_add_u32 s50, s49, 3200
buffer_load_dwordx4 a[20:23], v18, s[12:15], s50 offen nt
s_add_u32 s50, s49, 6272
buffer_load_dwordx4 a[24:27], v18, s[12:15], s50 offen nt
s_add_u32 s50, s49, 9344
buffer_load_dwordx4 a[28:31], v18, s[12:15], s50 offen nt
s_add_u32 s50, s49, 256
buffer_load_dwordx4 a[32:35], v18, s[12:15], s50 offen nt
s_add_u32 s50, s49, 3328
buffer_load_dwordx4 a[36:39], v18, s[12:15], s50 offen nt
s_add_u32 s50, s49, 6400
buffer_load_dwordx4 a[40:43], v18, s[12:15], s50 offen nt
s_add_u32 s50, s49, 9472
buffer_load_dwordx4 a[44:47], v18, s[12:15], s50 offen nt
s_add_u32 s53, s52, 37748736
s_add_u32 s20, s8, s52
s_addc_u32 s21, s9, 0
s_mov_b32 s22, 147456
s_mov_b32 s23, 0x20000
s_add_u32 s24, s10, s52
s_addc_u32 s25, s11, 0
s_mov_b32 s26, 147456
s_mov_b32 s27, 0x20000
s_add_u32 s28, s4, s53
s_addc_u32 s29, s5, 0
s_mov_b32 s30, 147456
s_mov_b32 s31, 0x20000
s_add_u32 s32, s6, s53
s_addc_u32 s33, s7, 0
s_mov_b32 s34, 147456
s_mov_b32 s35, 0x20000
s_add_u32 s36, s8, s53
s_addc_u32 s37, s9, 0
s_mov_b32 s38, 147456
s_mov_b32 s39, 0x20000
s_add_u32 s40, s10, s53
s_addc_u32 s41, s11, 0
s_mov_b32 s42, 147456
s_mov_b32 s43, 0x20000
v_mbcnt_lo_u32_b32 v2, -1, 0
v_mbcnt_hi_u32_b32 v2, -1, v2
v_bfe_u32 v1, v2, 1, 3
v_mul_u32_u24 v19, 384, v1
v_lshrrev_b32 v1, 4, v2
v_lshl_add_u32 v19, v1, 5, v19
v_and_b32 v1, 1, v2
v_lshl_add_u32 v19, v1, 4, v19
v_mov_b32 v1, s47
v_mad_u32_u24 v19, v1, 3, v19
v_mbcnt_lo_u32_b32 v2, -1, 0
v_mbcnt_hi_u32_b32 v2, -1, v2
v_bfe_u32 v1, v2, 1, 3
v_lshrrev_b32 v16, 4, v2
v_xor_b32 v16, v16, v1
v_lshlrev_b32 v16, 4, v16
v_and_b32 v1, 7, v2
v_lshl_add_u32 v16, v1, 7, v16
v_bfe_u32 v1, v2, 3, 1
v_mul_u32_u24 v1, 3072, v1
v_add_u32 v16, v16, v1
v_xor_b32 v17, 64, v16
v_mbcnt_lo_u32_b32 v235, -1, 0
v_mbcnt_hi_u32_b32 v235, -1, v235
v_bfe_u32 v233, v235, 1, 2
v_or_b32 v233, s54, v233
v_lshrrev_b32 v232, 4, v235
v_xor_b32 v232, v232, v233
v_lshlrev_b32 v232, 4, v232
v_and_b32 v233, 7, v235
v_lshl_add_u32 v232, v233, 7, v232
v_bfe_u32 v233, v235, 3, 1
v_lshl_add_u32 v232, v233, 10, v232
v_add_u32 v232, s55, v232
v_xor_b32 v233, 64, v232
v_lshlrev_b32 v234, 4, v235
v_add_u32 v234, s55, v234
s_add_u32 m0, s47, 12288
s_add_u32 s50, s84, 12288
buffer_load_dwordx4 v18, s[16:19], s50 offen nt lds
s_add_u32 m0, s47, 13184
s_nop 0
buffer_load_dwordx4 v18, s[16:19], s50 offen offset:128 nt lds
s_add_u32 m0, s47, 14080
s_nop 0
buffer_load_dwordx4 v18, s[16:19], s50 offen offset:256 nt lds
s_add_u32 m0, s47, 24576
s_add_u32 s50, s84, 24576
buffer_load_dwordx4 v18, s[16:19], s50 offen nt lds
s_add_u32 m0, s47, 25472
s_nop 0
buffer_load_dwordx4 v18, s[16:19], s50 offen offset:128 nt lds
s_add_u32 m0, s47, 26368
s_nop 0
buffer_load_dwordx4 v18, s[16:19], s50 offen offset:256 nt lds
s_waitcnt vmcnt(14)
ds_write_b128 v234, a[0:3] offset:0
ds_write_b128 v234, a[4:7] offset:1024
ds_write_b128 v234, a[8:11] offset:2048
ds_write_b128 v234, a[12:15] offset:3072
ds_read_b128 a[0:3], v232 offset:0
ds_read_b128 a[8:11], v232 offset:2048
ds_read_b128 a[4:7], v233 offset:0
ds_read_b128 a[12:15], v233 offset:2048
s_add_u32 m0, s47, 36864
s_add_u32 s50, s85, 0
buffer_load_dwordx4 v18, s[16:19], s50 offen nt lds
s_add_u32 m0, s47, 37760
s_nop 0
buffer_load_dwordx4 v18, s[16:19], s50 offen offset:128 nt lds
s_add_u32 m0, s47, 38656
s_nop 0
buffer_load_dwordx4 v18, s[16:19], s50 offen offset:256 nt lds
s_waitcnt vmcnt(13)
ds_write_b128 v234, a[16:19] offset:0
ds_write_b128 v234, a[20:23] offset:1024
ds_write_b128 v234, a[24:27] offset:2048
ds_write_b128 v234, a[28:31] offset:3072
ds_read_b128 a[16:19], v232 offset:0
ds_read_b128 a[24:27], v232 offset:2048
ds_read_b128 a[20:23], v233 offset:0
s_waitcnt lgkmcnt(14)
ds_read_b128 a[28:31], v233 offset:2048
s_add_u32 s50, s49, 12288
buffer_load_dwordx4 a[48:51], v18, s[12:15], s50 offen nt
s_add_u32 s50, s49, 15360
buffer_load_dwordx4 a[52:55], v18, s[12:15], s50 offen nt
s_add_u32 s50, s49, 18432
buffer_load_dwordx4 a[56:59], v18, s[12:15], s50 offen nt
s_waitcnt vmcnt(12)
s_waitcnt lgkmcnt(14)
ds_write_b128 v234, a[32:35] offset:0
s_waitcnt lgkmcnt(14)
ds_write_b128 v234, a[36:39] offset:1024
s_waitcnt lgkmcnt(14)
ds_write_b128 v234, a[40:43] offset:2048
s_waitcnt lgkmcnt(14)
ds_write_b128 v234, a[44:47] offset:3072
s_waitcnt lgkmcnt(14)
ds_read_b128 a[32:35], v232 offset:0
s_waitcnt lgkmcnt(14)
ds_read_b128 a[40:43], v232 offset:2048
s_waitcnt lgkmcnt(14)
ds_read_b128 a[36:39], v233 offset:0
s_waitcnt lgkmcnt(14)
ds_read_b128 a[44:47], v233 offset:2048
s_barrier
s_waitcnt lgkmcnt(14)
ds_read_b128 v[0:3], v16 offset:0
s_waitcnt lgkmcnt(14)
ds_read_b128 v[4:7], v17 offset:0
s_waitcnt lgkmcnt(14)
ds_read_b128 v[8:11], v16 offset:1024
s_waitcnt lgkmcnt(14)
ds_read_b128 v[12:15], v17 offset:1024
s_waitcnt lgkmcnt(14)
ds_read_b128 v[28:31], v16 offset:2048
s_waitcnt lgkmcnt(14)
ds_read_b128 v[88:91], v17 offset:2048
s_waitcnt lgkmcnt(14)
ds_read_b128 v[92:95], v16 offset:6144
s_waitcnt lgkmcnt(14)
ds_read_b128 v[112:115], v17 offset:6144
s_waitcnt lgkmcnt(14)
ds_read_b128 v[116:119], v16 offset:7168
s_waitcnt lgkmcnt(14)
ds_read_b128 v[136:139], v17 offset:7168
s_waitcnt lgkmcnt(14)
ds_read_b128 v[140:143], v16 offset:8192
s_waitcnt lgkmcnt(10)
v_mfma_f32_16x16x32_bf16 v[32:35], v[0:3], a[0:3], 0
s_waitcnt lgkmcnt(9)
ds_read_b128 v[152:155], v17 offset:8192
v_mfma_f32_16x16x32_bf16 v[32:35], v[4:7], a[4:7], v[32:35]
s_waitcnt lgkmcnt(9)
v_mfma_f32_16x16x32_bf16 v[32:35], v[8:11], a[16:19], v[32:35]
s_waitcnt lgkmcnt(8)
v_mfma_f32_16x16x32_bf16 v[32:35], v[12:15], a[20:23], v[32:35]
s_waitcnt lgkmcnt(7)
v_mfma_f32_16x16x32_bf16 v[32:35], v[28:31], a[32:35], v[32:35]
s_waitcnt lgkmcnt(6)
v_mfma_f32_16x16x32_bf16 v[32:35], v[88:91], a[36:39], v[32:35]
s_waitcnt vmcnt(9)
s_barrier
v_mfma_f32_16x16x32_bf16 v[40:43], v[0:3], a[8:11], 0
s_add_u32 s50, s49, 21504
buffer_load_dwordx4 a[60:63], v18, s[12:15], s50 offen nt
v_mfma_f32_16x16x32_bf16 v[40:43], v[4:7], a[12:15], v[40:43]
s_add_u32 s50, s49, 12416
ds_read_b128 v[0:3], v16 offset:12288
v_mfma_f32_16x16x32_bf16 v[40:43], v[8:11], a[24:27], v[40:43]
ds_read_b128 v[4:7], v17 offset:12288
v_mfma_f32_16x16x32_bf16 v[40:43], v[12:15], a[28:31], v[40:43]
ds_read_b128 v[8:11], v16 offset:13312
v_mfma_f32_16x16x32_bf16 v[40:43], v[28:31], a[40:43], v[40:43]
ds_read_b128 v[12:15], v17 offset:13312
v_mfma_f32_16x16x32_bf16 v[40:43], v[88:91], a[44:47], v[40:43]
s_waitcnt lgkmcnt(9)
ds_read_b128 v[28:31], v16 offset:14336
v_mfma_f32_16x16x32_bf16 v[36:39], v[92:95], a[0:3], 0
s_waitcnt lgkmcnt(9)
ds_read_b128 v[88:91], v17 offset:14336
v_mfma_f32_16x16x32_bf16 v[36:39], v[112:115], a[4:7], v[36:39]
s_waitcnt lgkmcnt(9)
buffer_load_dwordx4 a[64:67], v18, s[12:15], s50 offen nt
v_mfma_f32_16x16x32_bf16 v[36:39], v[116:119], a[16:19], v[36:39]
s_waitcnt lgkmcnt(8)
v_mfma_f32_16x16x32_bf16 v[36:39], v[136:139], a[20:23], v[36:39]
s_waitcnt lgkmcnt(7)
v_mfma_f32_16x16x32_bf16 v[36:39], v[140:143], a[32:35], v[36:39]
s_waitcnt lgkmcnt(6)
v_mfma_f32_16x16x32_bf16 v[36:39], v[152:155], a[36:39], v[36:39]
s_add_u32 s50, s49, 15488
buffer_load_dwordx4 a[68:71], v18, s[12:15], s50 offen nt
v_mfma_f32_16x16x32_bf16 v[44:47], v[92:95], a[8:11], 0
s_add_u32 s50, s49, 18560
buffer_load_dwordx4 a[72:75], v18, s[12:15], s50 offen nt
v_mfma_f32_16x16x32_bf16 v[44:47], v[112:115], a[12:15], v[44:47]
ds_read_b128 v[92:95], v16 offset:18432
v_mfma_f32_16x16x32_bf16 v[44:47], v[116:119], a[24:27], v[44:47]
ds_read_b128 v[112:115], v17 offset:18432
v_mfma_f32_16x16x32_bf16 v[44:47], v[136:139], a[28:31], v[44:47]
s_add_u32 s50, s49, 21632
ds_read_b128 v[116:119], v16 offset:19456
v_mfma_f32_16x16x32_bf16 v[44:47], v[140:143], a[40:43], v[44:47]
ds_read_b128 v[136:139], v17 offset:19456
v_mfma_f32_16x16x32_bf16 v[44:47], v[152:155], a[44:47], v[44:47]
s_waitcnt lgkmcnt(9)
ds_read_b128 v[140:143], v16 offset:20480
v_mfma_f32_16x16x32_bf16 v[48:51], v[0:3], a[0:3], 0
s_waitcnt lgkmcnt(9)
ds_read_b128 v[152:155], v17 offset:20480
v_mfma_f32_16x16x32_bf16 v[48:51], v[4:7], a[4:7], v[48:51]
s_waitcnt lgkmcnt(9)
buffer_load_dwordx4 a[76:79], v18, s[12:15], s50 offen nt
v_mfma_f32_16x16x32_bf16 v[48:51], v[8:11], a[16:19], v[48:51]
s_waitcnt lgkmcnt(8)
v_mfma_f32_16x16x32_bf16 v[48:51], v[12:15], a[20:23], v[48:51]
s_waitcnt lgkmcnt(7)
v_mfma_f32_16x16x32_bf16 v[48:51], v[28:31], a[32:35], v[48:51]
s_waitcnt lgkmcnt(6)
v_max3_f32 v148, v32, v33, v34
v_max3_f32 v149, v40, v41, v42
v_max3_f32 v148, v148, v35, v36
v_mfma_f32_16x16x32_bf16 v[48:51], v[88:91], a[36:39], v[48:51]
s_waitcnt vmcnt(11)
s_barrier
v_max3_f32 v149, v149, v43, v44
v_max3_f32 v148, v148, v37, v38
v_max3_f32 v149, v149, v45, v46
v_mfma_f32_16x16x32_bf16 v[56:59], v[0:3], a[8:11], 0
s_add_u32 s50, s49, 12544
buffer_load_dwordx4 a[80:83], v18, s[12:15], s50 offen nt
v_max_f32 v148, v148, v39
v_max_f32 v149, v149, v47
v_mov_b32 v20, v148
v_mov_b32 v21, v149
v_mfma_f32_16x16x32_bf16 v[56:59], v[4:7], a[12:15], v[56:59]
s_add_u32 s50, s49, 15616
ds_read_b128 v[0:3], v16 offset:24576
v_permlane16_swap_b32 v148, v20
v_permlane16_swap_b32 v149, v21
v_mfma_f32_16x16x32_bf16 v[56:59], v[8:11], a[24:27], v[56:59]
ds_read_b128 v[4:7], v17 offset:24576
v_max_f32 v148, v148, v20
v_max_f32 v149, v149, v21
v_mov_b32 v20, v148
v_mov_b32 v21, v149
v_mfma_f32_16x16x32_bf16 v[56:59], v[12:15], a[28:31], v[56:59]
ds_read_b128 v[8:11], v16 offset:25600
v_permlane32_swap_b32 v148, v20
v_permlane32_swap_b32 v149, v21
v_mfma_f32_16x16x32_bf16 v[56:59], v[28:31], a[40:43], v[56:59]
ds_read_b128 v[12:15], v17 offset:25600
v_max_f32 v148, v148, v20
v_max_f32 v149, v149, v21
v_mul_f32 v20, s45, v148
v_mfma_f32_16x16x32_bf16 v[56:59], v[88:91], a[44:47], v[56:59]
s_waitcnt lgkmcnt(9)
ds_read_b128 v[28:31], v16 offset:26624
v_mul_f32 v21, s45, v149
v_fma_f32 v32, v32, s44, v20
v_fma_f32 v33, v33, s44, v20
v_fma_f32 v34, v34, s44, v20
v_mfma_f32_16x16x32_bf16 v[52:55], v[92:95], a[0:3], 0
s_waitcnt lgkmcnt(9)
ds_read_b128 v[88:91], v17 offset:26624
v_exp_f32 v32, v32
v_fma_f32 v35, v35, s44, v20
v_exp_f32 v33, v33
v_mfma_f32_16x16x32_bf16 v[52:55], v[112:115], a[4:7], v[52:55]
s_waitcnt lgkmcnt(9)
buffer_load_dwordx4 a[84:87], v18, s[12:15], s50 offen nt
v_fma_f32 v36, v36, s44, v20
v_exp_f32 v34, v34
v_mfma_f32_16x16x32_bf16 v[52:55], v[116:119], a[16:19], v[52:55]
s_waitcnt lgkmcnt(8)
v_fma_f32 v37, v37, s44, v20
v_exp_f32 v35, v35
v_mfma_f32_16x16x32_bf16 v[52:55], v[136:139], a[20:23], v[52:55]
s_waitcnt lgkmcnt(7)
v_fma_f32 v38, v38, s44, v20
v_cvt_pk_bf16_f32 v32, v32, v33
v_exp_f32 v36, v36
v_mfma_f32_16x16x32_bf16 v[52:55], v[140:143], a[32:35], v[52:55]
s_waitcnt lgkmcnt(6)
v_fma_f32 v39, v39, s44, v20
v_exp_f32 v37, v37
v_fma_f32 v40, v40, s44, v21
v_mfma_f32_16x16x32_bf16 v[52:55], v[152:155], a[36:39], v[52:55]
s_add_u32 s50, s49, 18688
buffer_load_dwordx4 a[88:91], v18, s[12:15], s50 offen nt
v_cvt_pk_bf16_f32 v33, v34, v35
v_accvgpr_write_b32 a144, v32
v_exp_f32 v38, v38
v_mfma_f32_16x16x32_bf16 v[60:63], v[92:95], a[8:11], 0
s_add_u32 s50, s49, 21760
buffer_load_dwordx4 a[92:95], v18, s[12:15], s50 offen nt
v_fma_f32 v41, v41, s44, v21
v_exp_f32 v39, v39
v_mfma_f32_16x16x32_bf16 v[60:63], v[112:115], a[12:15], v[60:63]
ds_read_b128 v[92:95], v16 offset:30720
v_fma_f32 v42, v42, s44, v21
v_cvt_pk_bf16_f32 v34, v36, v37
v_accvgpr_write_b32 a145, v33
v_exp_f32 v40, v40
v_mfma_f32_16x16x32_bf16 v[60:63], v[116:119], a[24:27], v[60:63]
ds_read_b128 v[112:115], v17 offset:30720
v_fma_f32 v43, v43, s44, v21
v_exp_f32 v41, v41
v_mfma_f32_16x16x32_bf16 v[60:63], v[136:139], a[28:31], v[60:63]
ds_read_b128 v[116:119], v16 offset:31744
v_fma_f32 v44, v44, s44, v21
v_cvt_pk_bf16_f32 v35, v38, v39
v_accvgpr_write_b32 a146, v34
v_mfma_f32_16x16x32_bf16 v[60:63], v[140:143], a[40:43], v[60:63]
s_add_u32 s50, s49, 24576
ds_read_b128 v[136:139], v17 offset:31744
v_exp_f32 v42, v42
v_fma_f32 v45, v45, s44, v21
v_exp_f32 v43, v43
v_mfma_f32_16x16x32_bf16 v[60:63], v[152:155], a[44:47], v[60:63]
s_waitcnt lgkmcnt(9)
ds_read_b128 v[140:143], v16 offset:32768
v_fma_f32 v46, v46, s44, v21
v_cvt_pk_bf16_f32 v36, v40, v41
v_accvgpr_write_b32 a147, v35
v_mfma_f32_16x16x32_bf16 v[64:67], v[0:3], a[0:3], 0
s_waitcnt lgkmcnt(9)
ds_read_b128 v[152:155], v17 offset:32768
v_mbcnt_lo_u32_b32 v147, -1, 0
v_exp_f32 v44, v44
v_fma_f32 v47, v47, s44, v21
v_exp_f32 v45, v45
v_mfma_f32_16x16x32_bf16 v[64:67], v[4:7], a[4:7], v[64:67]
s_waitcnt lgkmcnt(9)
buffer_load_dwordx4 a[96:99], v18, s[12:15], s50 offen nt
v_mbcnt_hi_u32_b32 v147, -1, v147
v_cvt_pk_bf16_f32 v37, v42, v43
v_accvgpr_write_b32 a148, v36
v_mfma_f32_16x16x32_bf16 v[64:67], v[8:11], a[16:19], v[64:67]
s_waitcnt lgkmcnt(8)
v_exp_f32 v46, v46
v_bfe_u32 v145, v147, 1, 2
v_exp_f32 v47, v47
v_mfma_f32_16x16x32_bf16 v[64:67], v[12:15], a[20:23], v[64:67]
s_waitcnt lgkmcnt(7)
v_cvt_pk_bf16_f32 v38, v44, v45
v_or_b32 v145, s54, v145
v_accvgpr_write_b32 a149, v37
v_cvt_pk_bf16_f32 v39, v46, v47
v_accvgpr_write_b32 a150, v38
v_mfma_f32_16x16x32_bf16 v[64:67], v[28:31], a[32:35], v[64:67]
s_waitcnt lgkmcnt(6)
v_accvgpr_write_b32 a151, v39
v_lshrrev_b32 v144, 4, v147
v_fma_f32 v48, v48, s44, v20
v_fma_f32 v49, v49, s44, v20
v_mfma_f32_16x16x32_bf16 v[64:67], v[88:91], a[36:39], v[64:67]
s_waitcnt vmcnt(13)
s_barrier
v_fma_f32 v50, v50, s44, v20
v_xor_b32 v144, v144, v145
v_exp_f32 v48, v48
v_mfma_f32_16x16x32_bf16 v[72:75], v[0:3], a[8:11], 0
s_add_u32 s50, s49, 27648
buffer_load_dwordx4 a[100:103], v18, s[12:15], s50 offen nt
v_fma_f32 v51, v51, s44, v20
v_lshlrev_b32 v144, 4, v144
v_exp_f32 v49, v49
v_mfma_f32_16x16x32_bf16 v[72:75], v[4:7], a[12:15], v[72:75]
ds_read_b128 v[0:3], v16 offset:36864
v_fma_f32 v52, v52, s44, v20
v_and_b32 v145, 7, v147
v_exp_f32 v50, v50
v_mfma_f32_16x16x32_bf16 v[72:75], v[8:11], a[24:27], v[72:75]
s_add_u32 s50, s49, 30720
ds_read_b128 v[4:7], v17 offset:36864
v_fma_f32 v53, v53, s44, v20
v_lshl_add_u32 v144, v145, 7, v144
v_exp_f32 v51, v51
v_mfma_f32_16x16x32_bf16 v[72:75], v[12:15], a[28:31], v[72:75]
ds_read_b128 v[8:11], v16 offset:37888
v_bfe_u32 v145, v147, 3, 1
v_fma_f32 v54, v54, s44, v20
v_mfma_f32_16x16x32_bf16 v[72:75], v[28:31], a[40:43], v[72:75]
ds_read_b128 v[12:15], v17 offset:37888
v_cvt_pk_bf16_f32 v48, v48, v49
v_exp_f32 v52, v52
v_lshl_add_u32 v144, v145, 10, v144
v_mfma_f32_16x16x32_bf16 v[72:75], v[88:91], a[44:47], v[72:75]
s_waitcnt lgkmcnt(9)
ds_read_b128 v[28:31], v16 offset:38912
v_fma_f32 v55, v55, s44, v20
v_exp_f32 v53, v53
v_add_u32 v144, s55, v144
v_mfma_f32_16x16x32_bf16 v[68:71], v[92:95], a[0:3], 0
s_waitcnt lgkmcnt(9)
ds_read_b128 v[88:91], v17 offset:38912
v_fma_f32 v56, v56, s44, v21
v_cvt_pk_bf16_f32 v49, v50, v51
v_xor_b32 v145, 64, v144
v_mfma_f32_16x16x32_bf16 v[68:71], v[112:115], a[4:7], v[68:71]
s_waitcnt lgkmcnt(9)
buffer_load_dwordx4 a[104:107], v18, s[12:15], s50 offen nt
v_accvgpr_write_b32 a168, v48
v_exp_f32 v54, v54
v_lshlrev_b32 v146, 4, v147
v_mfma_f32_16x16x32_bf16 v[68:71], v[116:119], a[16:19], v[68:71]
s_waitcnt lgkmcnt(8)
v_fma_f32 v57, v57, s44, v21
v_exp_f32 v55, v55
v_add_u32 v146, s55, v146
v_mfma_f32_16x16x32_bf16 v[68:71], v[136:139], a[20:23], v[68:71]
s_waitcnt lgkmcnt(7)
v_fma_f32 v58, v58, s44, v21
v_cvt_pk_bf16_f32 v50, v52, v53
v_mfma_f32_16x16x32_bf16 v[68:71], v[140:143], a[32:35], v[68:71]
s_waitcnt lgkmcnt(6)
v_accvgpr_write_b32 a169, v49
v_exp_f32 v56, v56
v_mfma_f32_16x16x32_bf16 v[68:71], v[152:155], a[36:39], v[68:71]
s_add_u32 s50, s49, 33792
buffer_load_dwordx4 a[108:111], v18, s[12:15], s50 offen nt
v_fma_f32 v59, v59, s44, v21
v_exp_f32 v57, v57
v_mfma_f32_16x16x32_bf16 v[76:79], v[92:95], a[8:11], 0
s_add_u32 s50, s49, 24704
v_fma_f32 v60, v60, s44, v21
v_cvt_pk_bf16_f32 v51, v54, v55
v_mfma_f32_16x16x32_bf16 v[76:79], v[112:115], a[12:15], v[76:79]
ds_read_b128 v[92:95], v16 offset:43008
v_accvgpr_write_b32 a170, v50
v_exp_f32 v58, v58
v_mfma_f32_16x16x32_bf16 v[76:79], v[116:119], a[24:27], v[76:79]
s_waitcnt vmcnt(12)
ds_read_b128 v[112:115], v17 offset:43008
v_fma_f32 v61, v61, s44, v21
v_exp_f32 v59, v59
v_mfma_f32_16x16x32_bf16 v[76:79], v[136:139], a[28:31], v[76:79]
ds_read_b128 v[116:119], v16 offset:44032
v_fma_f32 v62, v62, s44, v21
v_cvt_pk_bf16_f32 v52, v56, v57
v_mfma_f32_16x16x32_bf16 v[76:79], v[140:143], a[40:43], v[76:79]
ds_read_b128 v[136:139], v17 offset:44032
v_accvgpr_write_b32 a171, v51
v_exp_f32 v60, v60
v_mfma_f32_16x16x32_bf16 v[76:79], v[152:155], a[44:47], v[76:79]
s_waitcnt lgkmcnt(9)
ds_read_b128 v[140:143], v16 offset:45056
v_fma_f32 v63, v63, s44, v21
v_exp_f32 v61, v61
v_mfma_f32_16x16x32_bf16 v[96:99], v[0:3], a[0:3], 0
s_waitcnt lgkmcnt(9)
ds_read_b128 v[152:155], v17 offset:45056
v_cvt_pk_bf16_f32 v53, v58, v59
v_accvgpr_write_b32 a172, v52
v_mfma_f32_16x16x32_bf16 v[96:99], v[4:7], a[4:7], v[96:99]
s_waitcnt lgkmcnt(9)
ds_write_b128 v146, a[48:51] offset:0
v_exp_f32 v62, v62
v_exp_f32 v63, v63
v_mfma_f32_16x16x32_bf16 v[96:99], v[8:11], a[16:19], v[96:99]
s_waitcnt lgkmcnt(9)
ds_write_b128 v146, a[52:55] offset:1024
buffer_load_dwordx4 a[112:115], v18, s[12:15], s50 offen nt
v_cvt_pk_bf16_f32 v54, v60, v61
v_accvgpr_write_b32 a173, v53
v_mfma_f32_16x16x32_bf16 v[96:99], v[12:15], a[20:23], v[96:99]
s_waitcnt lgkmcnt(9)
ds_write_b128 v146, a[56:59] offset:2048
v_cvt_pk_bf16_f32 v55, v62, v63
v_accvgpr_write_b32 a174, v54
v_mfma_f32_16x16x32_bf16 v[96:99], v[28:31], a[32:35], v[96:99]
s_waitcnt lgkmcnt(9)
ds_write_b128 v146, a[60:63] offset:3072
v_accvgpr_write_b32 a175, v55
v_fma_f32 v64, v64, s44, v20
v_fma_f32 v65, v65, s44, v20
v_mfma_f32_16x16x32_bf16 v[96:99], v[88:91], a[36:39], v[96:99]
s_add_u32 s50, s49, 27776
ds_read_b128 a[48:51], v144 offset:0
v_fma_f32 v66, v66, s44, v20
v_exp_f32 v64, v64
v_mfma_f32_16x16x32_bf16 v[104:107], v[0:3], a[8:11], 0
ds_read_b128 a[56:59], v144 offset:2048
v_fma_f32 v67, v67, s44, v20
v_exp_f32 v65, v65
v_mfma_f32_16x16x32_bf16 v[104:107], v[4:7], a[12:15], v[104:107]
ds_read_b128 v[0:3], v16 offset:0
buffer_load_dwordx4 a[116:119], v18, s[12:15], s50 offen nt
v_fma_f32 v68, v68, s44, v20
v_exp_f32 v66, v66
v_mfma_f32_16x16x32_bf16 v[104:107], v[8:11], a[24:27], v[104:107]
s_add_u32 s50, s49, 30848
ds_read_b128 v[4:7], v17 offset:0
ds_read_b128 a[52:55], v145 offset:0
v_fma_f32 v69, v69, s44, v20
v_exp_f32 v67, v67
v_mfma_f32_16x16x32_bf16 v[104:107], v[12:15], a[28:31], v[104:107]
s_waitcnt lgkmcnt(14)
ds_read_b128 v[8:11], v16 offset:1024
s_waitcnt lgkmcnt(14)
ds_read_b128 a[60:63], v145 offset:2048
v_fma_f32 v70, v70, s44, v20
v_mfma_f32_16x16x32_bf16 v[104:107], v[28:31], a[40:43], v[104:107]
s_waitcnt vmcnt(10)
s_waitcnt lgkmcnt(14)
ds_read_b128 v[12:15], v17 offset:1024
v_cvt_pk_bf16_f32 v64, v64, v65
v_exp_f32 v68, v68
v_mfma_f32_16x16x32_bf16 v[104:107], v[88:91], a[44:47], v[104:107]
s_waitcnt lgkmcnt(14)
ds_read_b128 v[28:31], v16 offset:2048
s_waitcnt lgkmcnt(14)
ds_write_b128 v146, a[64:67] offset:0
v_fma_f32 v71, v71, s44, v20
v_exp_f32 v69, v69
v_mfma_f32_16x16x32_bf16 v[100:103], v[92:95], a[0:3], 0
s_waitcnt lgkmcnt(14)
ds_read_b128 v[88:91], v17 offset:2048
s_waitcnt lgkmcnt(14)
ds_write_b128 v146, a[68:71] offset:1024
buffer_load_dwordx4 a[120:123], v18, s[12:15], s50 offen nt
v_fma_f32 v72, v72, s44, v21
v_cvt_pk_bf16_f32 v65, v66, v67
v_mfma_f32_16x16x32_bf16 v[100:103], v[112:115], a[4:7], v[100:103]
s_waitcnt lgkmcnt(14)
ds_write_b128 v146, a[72:75] offset:2048
v_accvgpr_write_b32 a192, v64
v_exp_f32 v70, v70
v_mfma_f32_16x16x32_bf16 v[100:103], v[116:119], a[16:19], v[100:103]
s_waitcnt lgkmcnt(14)
ds_write_b128 v146, a[76:79] offset:3072
v_fma_f32 v73, v73, s44, v21
v_exp_f32 v71, v71
v_mfma_f32_16x16x32_bf16 v[100:103], v[136:139], a[20:23], v[100:103]
s_waitcnt lgkmcnt(14)
ds_read_b128 a[64:67], v144 offset:0
s_waitcnt lgkmcnt(14)
ds_read_b128 a[72:75], v144 offset:2048
v_fma_f32 v74, v74, s44, v21
v_cvt_pk_bf16_f32 v66, v68, v69
v_mfma_f32_16x16x32_bf16 v[100:103], v[140:143], a[32:35], v[100:103]
s_add_u32 s50, s49, 33920
s_waitcnt lgkmcnt(14)
ds_read_b128 a[68:71], v145 offset:0
v_accvgpr_write_b32 a193, v65
v_exp_f32 v72, v72
v_mfma_f32_16x16x32_bf16 v[100:103], v[152:155], a[36:39], v[100:103]
s_waitcnt lgkmcnt(14)
ds_read_b128 a[76:79], v145 offset:2048
buffer_load_dwordx4 a[124:127], v18, s[12:15], s50 offen nt
v_fma_f32 v75, v75, s44, v21
v_exp_f32 v73, v73
v_mfma_f32_16x16x32_bf16 v[108:111], v[92:95], a[8:11], 0
s_waitcnt vmcnt(8)
s_waitcnt lgkmcnt(14)
ds_write_b128 v146, a[80:83] offset:0
v_fma_f32 v76, v76, s44, v21
v_cvt_pk_bf16_f32 v67, v70, v71
v_mfma_f32_16x16x32_bf16 v[108:111], v[112:115], a[12:15], v[108:111]
s_add_u32 s50, s49, 24832
s_waitcnt lgkmcnt(14)
ds_read_b128 v[92:95], v16 offset:6144
v_accvgpr_write_b32 a194, v66
v_exp_f32 v74, v74
v_mfma_f32_16x16x32_bf16 v[108:111], v[116:119], a[24:27], v[108:111]
s_waitcnt lgkmcnt(14)
ds_read_b128 v[112:115], v17 offset:6144
s_waitcnt lgkmcnt(14)
ds_write_b128 v146, a[84:87] offset:1024
v_fma_f32 v77, v77, s44, v21
v_exp_f32 v75, v75
v_mfma_f32_16x16x32_bf16 v[108:111], v[136:139], a[28:31], v[108:111]
s_waitcnt lgkmcnt(14)
ds_read_b128 v[116:119], v16 offset:7168
s_waitcnt lgkmcnt(14)
ds_write_b128 v146, a[88:91] offset:2048
v_fma_f32 v78, v78, s44, v21
v_cvt_pk_bf16_f32 v68, v72, v73
v_mfma_f32_16x16x32_bf16 v[108:111], v[140:143], a[40:43], v[108:111]
s_waitcnt lgkmcnt(14)
ds_read_b128 v[136:139], v17 offset:7168
s_waitcnt lgkmcnt(14)
ds_write_b128 v146, a[92:95] offset:3072
buffer_load_dwordx4 a[128:131], v18, s[12:15], s50 offen nt
v_accvgpr_write_b32 a195, v67
v_exp_f32 v76, v76
v_mfma_f32_16x16x32_bf16 v[108:111], v[152:155], a[44:47], v[108:111]
s_waitcnt lgkmcnt(14)
ds_read_b128 v[140:143], v16 offset:8192
s_waitcnt lgkmcnt(14)
ds_read_b128 a[80:83], v144 offset:0
s_waitcnt lgkmcnt(14)
ds_read_b128 a[88:91], v144 offset:2048
v_fma_f32 v79, v79, s44, v21
v_exp_f32 v77, v77
v_mfma_f32_16x16x32_bf16 v[120:123], v[0:3], a[48:51], 0
s_waitcnt lgkmcnt(14)
ds_read_b128 v[152:155], v17 offset:8192
s_waitcnt lgkmcnt(14)
ds_read_b128 a[84:87], v145 offset:0
v_cvt_pk_bf16_f32 v69, v74, v75
v_accvgpr_write_b32 a196, v68
v_mfma_f32_16x16x32_bf16 v[120:123], v[4:7], a[52:55], v[120:123]
s_waitcnt lgkmcnt(14)
ds_read_b128 a[92:95], v145 offset:2048
v_exp_f32 v78, v78
v_exp_f32 v79, v79
v_mfma_f32_16x16x32_bf16 v[120:123], v[8:11], a[64:67], v[120:123]
s_add_u32 s50, s49, 27904
buffer_load_dwordx4 a[132:135], v18, s[12:15], s50 offen nt
v_cvt_pk_bf16_f32 v70, v76, v77
v_accvgpr_write_b32 a197, v69
v_mfma_f32_16x16x32_bf16 v[120:123], v[12:15], a[68:71], v[120:123]
s_waitcnt lgkmcnt(4)
v_cvt_pk_bf16_f32 v71, v78, v79
v_accvgpr_write_b32 a198, v70
v_mfma_f32_16x16x32_bf16 v[120:123], v[28:31], a[80:83], v[120:123]
s_waitcnt lgkmcnt(1)
v_accvgpr_write_b32 a199, v71
v_fma_f32 v96, v96, s44, v20
v_fma_f32 v97, v97, s44, v20
v_mfma_f32_16x16x32_bf16 v[120:123], v[88:91], a[84:87], v[120:123]
s_add_u32 s50, s49, 30976
buffer_load_dwordx4 a[136:139], v18, s[12:15], s50 offen nt
v_fma_f32 v98, v98, s44, v20
v_exp_f32 v96, v96
v_mfma_f32_16x16x32_bf16 v[128:131], v[0:3], a[56:59], 0
s_add_u32 s50, s49, 34048
buffer_load_dwordx4 a[140:143], v18, s[12:15], s50 offen nt
v_fma_f32 v99, v99, s44, v20
v_exp_f32 v97, v97
v_mfma_f32_16x16x32_bf16 v[128:131], v[4:7], a[60:63], v[128:131]
ds_read_b128 v[0:3], v16 offset:12288
v_fma_f32 v100, v100, s44, v20
v_exp_f32 v98, v98
v_mfma_f32_16x16x32_bf16 v[128:131], v[8:11], a[72:75], v[128:131]
ds_read_b128 v[4:7], v17 offset:12288
v_fma_f32 v101, v101, s44, v20
v_exp_f32 v99, v99
v_mfma_f32_16x16x32_bf16 v[128:131], v[12:15], a[76:79], v[128:131]
s_add_u32 m0, s47, 49152
ds_read_b128 v[8:11], v16 offset:13312
v_fma_f32 v102, v102, s44, v20
v_mfma_f32_16x16x32_bf16 v[128:131], v[28:31], a[88:91], v[128:131]
s_waitcnt lgkmcnt(3)
s_add_u32 s50, s85, 12288
ds_read_b128 v[12:15], v17 offset:13312
v_cvt_pk_bf16_f32 v96, v96, v97
v_exp_f32 v100, v100
v_mfma_f32_16x16x32_bf16 v[128:131], v[88:91], a[92:95], v[128:131]
ds_read_b128 v[28:31], v16 offset:14336
v_fma_f32 v103, v103, s44, v20
v_exp_f32 v101, v101
v_mfma_f32_16x16x32_bf16 v[124:127], v[92:95], a[48:51], 0
ds_read_b128 v[88:91], v17 offset:14336
v_fma_f32 v104, v104, s44, v21
v_cvt_pk_bf16_f32 v97, v98, v99
v_mfma_f32_16x16x32_bf16 v[124:127], v[112:115], a[52:55], v[124:127]
buffer_load_dwordx4 v18, s[16:19], s50 offen nt lds
v_accvgpr_write_b32 a216, v96
v_exp_f32 v102, v102
v_mfma_f32_16x16x32_bf16 v[124:127], v[116:119], a[64:67], v[124:127]
v_fma_f32 v105, v105, s44, v21
v_exp_f32 v103, v103
v_mfma_f32_16x16x32_bf16 v[124:127], v[136:139], a[68:71], v[124:127]
v_fma_f32 v106, v106, s44, v21
v_cvt_pk_bf16_f32 v98, v100, v101
v_mfma_f32_16x16x32_bf16 v[124:127], v[140:143], a[80:83], v[124:127]
v_accvgpr_write_b32 a217, v97
v_exp_f32 v104, v104
v_mfma_f32_16x16x32_bf16 v[124:127], v[152:155], a[84:87], v[124:127]
v_fma_f32 v107, v107, s44, v21
v_exp_f32 v105, v105
v_mfma_f32_16x16x32_bf16 v[132:135], v[92:95], a[56:59], 0
v_fma_f32 v108, v108, s44, v21
v_cvt_pk_bf16_f32 v99, v102, v103
v_mfma_f32_16x16x32_bf16 v[132:135], v[112:115], a[60:63], v[132:135]
ds_read_b128 v[92:95], v16 offset:18432
v_accvgpr_write_b32 a218, v98
v_exp_f32 v106, v106
v_mfma_f32_16x16x32_bf16 v[132:135], v[116:119], a[72:75], v[132:135]
ds_read_b128 v[112:115], v17 offset:18432
v_fma_f32 v109, v109, s44, v21
v_exp_f32 v107, v107
v_mfma_f32_16x16x32_bf16 v[132:135], v[136:139], a[76:79], v[132:135]
ds_read_b128 v[116:119], v16 offset:19456
v_fma_f32 v110, v110, s44, v21
v_cvt_pk_bf16_f32 v100, v104, v105
v_mfma_f32_16x16x32_bf16 v[132:135], v[140:143], a[88:91], v[132:135]
s_add_u32 m0, s47, 50048
ds_read_b128 v[136:139], v17 offset:19456
v_accvgpr_write_b32 a219, v99
v_exp_f32 v108, v108
v_mfma_f32_16x16x32_bf16 v[132:135], v[152:155], a[92:95], v[132:135]
s_waitcnt lgkmcnt(9)
ds_read_b128 v[140:143], v16 offset:20480
v_fma_f32 v111, v111, s44, v21
v_exp_f32 v109, v109
v_mfma_f32_16x16x32_bf16 v[32:35], v[0:3], a[48:51], 0
s_waitcnt lgkmcnt(9)
ds_read_b128 v[152:155], v17 offset:20480
v_cvt_pk_bf16_f32 v101, v106, v107
v_accvgpr_write_b32 a220, v100
v_mfma_f32_16x16x32_bf16 v[32:35], v[4:7], a[52:55], v[32:35]
s_waitcnt lgkmcnt(9)
buffer_load_dwordx4 v18, s[16:19], s50 offen offset:128 nt lds
v_exp_f32 v110, v110
v_exp_f32 v111, v111
v_mfma_f32_16x16x32_bf16 v[32:35], v[8:11], a[64:67], v[32:35]
s_waitcnt lgkmcnt(8)
v_cvt_pk_bf16_f32 v102, v108, v109
v_accvgpr_write_b32 a221, v101
v_mfma_f32_16x16x32_bf16 v[32:35], v[12:15], a[68:71], v[32:35]
s_waitcnt lgkmcnt(7)
v_cvt_pk_bf16_f32 v103, v110, v111
v_accvgpr_write_b32 a222, v102
v_mfma_f32_16x16x32_bf16 v[32:35], v[28:31], a[80:83], v[32:35]
s_waitcnt lgkmcnt(6)
v_accvgpr_write_b32 a223, v103
v_max3_f32 v148, v120, v121, v122
v_max3_f32 v149, v128, v129, v130
v_max3_f32 v148, v148, v123, v124
v_mfma_f32_16x16x32_bf16 v[32:35], v[88:91], a[84:87], v[32:35]
v_max3_f32 v149, v149, v131, v132
v_max3_f32 v148, v148, v125, v126
v_max3_f32 v149, v149, v133, v134
v_mfma_f32_16x16x32_bf16 v[40:43], v[0:3], a[56:59], 0
v_max_f32 v148, v148, v127
v_max_f32 v149, v149, v135
v_mov_b32 v22, v148
v_mov_b32 v23, v149
v_mfma_f32_16x16x32_bf16 v[40:43], v[4:7], a[60:63], v[40:43]
ds_read_b128 v[0:3], v16 offset:24576
v_permlane16_swap_b32 v148, v22
v_permlane16_swap_b32 v149, v23
v_mfma_f32_16x16x32_bf16 v[40:43], v[8:11], a[72:75], v[40:43]
ds_read_b128 v[4:7], v17 offset:24576
v_max_f32 v148, v148, v22
v_max_f32 v149, v149, v23
v_mov_b32 v22, v148
v_mov_b32 v23, v149
v_mfma_f32_16x16x32_bf16 v[40:43], v[12:15], a[76:79], v[40:43]
ds_read_b128 v[8:11], v16 offset:25600
v_permlane32_swap_b32 v148, v22
v_permlane32_swap_b32 v149, v23
v_mfma_f32_16x16x32_bf16 v[40:43], v[28:31], a[88:91], v[40:43]
s_add_u32 m0, s47, 50944
ds_read_b128 v[12:15], v17 offset:25600
v_max_f32 v148, v148, v22
v_max_f32 v149, v149, v23
v_mul_f32 v22, s45, v148
v_mfma_f32_16x16x32_bf16 v[40:43], v[88:91], a[92:95], v[40:43]
s_waitcnt lgkmcnt(9)
ds_read_b128 v[28:31], v16 offset:26624
v_mul_f32 v23, s45, v149
v_fma_f32 v120, v120, s44, v22
v_fma_f32 v121, v121, s44, v22
v_fma_f32 v122, v122, s44, v22
v_mfma_f32_16x16x32_bf16 v[36:39], v[92:95], a[48:51], 0
s_waitcnt lgkmcnt(9)
ds_read_b128 v[88:91], v17 offset:26624
v_exp_f32 v120, v120
v_fma_f32 v123, v123, s44, v22
v_exp_f32 v121, v121
v_mfma_f32_16x16x32_bf16 v[36:39], v[112:115], a[52:55], v[36:39]
s_waitcnt lgkmcnt(9)
buffer_load_dwordx4 v18, s[16:19], s50 offen offset:256 nt lds
v_fma_f32 v124, v124, s44, v22
v_exp_f32 v122, v122
v_mfma_f32_16x16x32_bf16 v[36:39], v[116:119], a[64:67], v[36:39]
s_waitcnt lgkmcnt(8)
v_fma_f32 v125, v125, s44, v22
v_exp_f32 v123, v123
v_mfma_f32_16x16x32_bf16 v[36:39], v[136:139], a[68:71], v[36:39]
s_waitcnt lgkmcnt(7)
v_fma_f32 v126, v126, s44, v22
v_cvt_pk_bf16_f32 v120, v120, v121
v_exp_f32 v124, v124
v_mfma_f32_16x16x32_bf16 v[36:39], v[140:143], a[80:83], v[36:39]
s_waitcnt lgkmcnt(6)
v_fma_f32 v127, v127, s44, v22
v_exp_f32 v125, v125
v_fma_f32 v128, v128, s44, v23
v_mfma_f32_16x16x32_bf16 v[36:39], v[152:155], a[84:87], v[36:39]
v_cvt_pk_bf16_f32 v121, v122, v123
v_accvgpr_write_b32 a152, v120
v_exp_f32 v126, v126
v_mfma_f32_16x16x32_bf16 v[44:47], v[92:95], a[56:59], 0
v_fma_f32 v129, v129, s44, v23
v_exp_f32 v127, v127
v_mfma_f32_16x16x32_bf16 v[44:47], v[112:115], a[60:63], v[44:47]
ds_read_b128 v[92:95], v16 offset:30720
v_fma_f32 v130, v130, s44, v23
v_cvt_pk_bf16_f32 v122, v124, v125
v_accvgpr_write_b32 a153, v121
v_exp_f32 v128, v128
v_mfma_f32_16x16x32_bf16 v[44:47], v[116:119], a[72:75], v[44:47]
ds_read_b128 v[112:115], v17 offset:30720
v_fma_f32 v131, v131, s44, v23
v_exp_f32 v129, v129
v_mfma_f32_16x16x32_bf16 v[44:47], v[136:139], a[76:79], v[44:47]
s_add_u32 m0, s47, 61440
ds_read_b128 v[116:119], v16 offset:31744
v_fma_f32 v132, v132, s44, v23
v_cvt_pk_bf16_f32 v123, v126, v127
v_accvgpr_write_b32 a154, v122
v_mfma_f32_16x16x32_bf16 v[44:47], v[140:143], a[88:91], v[44:47]
s_add_u32 s50, s85, 24576
ds_read_b128 v[136:139], v17 offset:31744
v_exp_f32 v130, v130
v_fma_f32 v133, v133, s44, v23
v_exp_f32 v131, v131
v_mfma_f32_16x16x32_bf16 v[44:47], v[152:155], a[92:95], v[44:47]
s_waitcnt lgkmcnt(9)
ds_read_b128 v[140:143], v16 offset:32768
v_fma_f32 v134, v134, s44, v23
v_cvt_pk_bf16_f32 v124, v128, v129
v_accvgpr_write_b32 a155, v123
v_mfma_f32_16x16x32_bf16 v[48:51], v[0:3], a[48:51], 0
s_waitcnt lgkmcnt(9)
ds_read_b128 v[152:155], v17 offset:32768
v_mbcnt_lo_u32_b32 v147, -1, 0
v_exp_f32 v132, v132
v_fma_f32 v135, v135, s44, v23
v_exp_f32 v133, v133
v_mfma_f32_16x16x32_bf16 v[48:51], v[4:7], a[52:55], v[48:51]
s_waitcnt lgkmcnt(9)
buffer_load_dwordx4 v18, s[16:19], s50 offen nt lds
v_mbcnt_hi_u32_b32 v147, -1, v147
v_cvt_pk_bf16_f32 v125, v130, v131
v_accvgpr_write_b32 a156, v124
v_mfma_f32_16x16x32_bf16 v[48:51], v[8:11], a[64:67], v[48:51]
s_waitcnt lgkmcnt(8)
v_exp_f32 v134, v134
v_bfe_u32 v145, v147, 1, 2
v_exp_f32 v135, v135
v_mfma_f32_16x16x32_bf16 v[48:51], v[12:15], a[68:71], v[48:51]
s_waitcnt lgkmcnt(7)
v_cvt_pk_bf16_f32 v126, v132, v133
v_or_b32 v145, s54, v145
v_accvgpr_write_b32 a157, v125
v_cvt_pk_bf16_f32 v127, v134, v135
v_accvgpr_write_b32 a158, v126
v_mfma_f32_16x16x32_bf16 v[48:51], v[28:31], a[80:83], v[48:51]
s_waitcnt lgkmcnt(6)
v_accvgpr_write_b32 a159, v127
v_lshrrev_b32 v144, 4, v147
v_fma_f32 v32, v32, s44, v22
v_fma_f32 v33, v33, s44, v22
v_mfma_f32_16x16x32_bf16 v[48:51], v[88:91], a[84:87], v[48:51]
v_fma_f32 v34, v34, s44, v22
v_xor_b32 v144, v144, v145
v_exp_f32 v32, v32
v_mfma_f32_16x16x32_bf16 v[56:59], v[0:3], a[56:59], 0
v_fma_f32 v35, v35, s44, v22
v_lshlrev_b32 v144, 4, v144
v_exp_f32 v33, v33
v_mfma_f32_16x16x32_bf16 v[56:59], v[4:7], a[60:63], v[56:59]
ds_read_b128 v[0:3], v16 offset:36864
v_fma_f32 v36, v36, s44, v22
v_and_b32 v145, 7, v147
v_exp_f32 v34, v34
v_mfma_f32_16x16x32_bf16 v[56:59], v[8:11], a[72:75], v[56:59]
ds_read_b128 v[4:7], v17 offset:36864
v_fma_f32 v37, v37, s44, v22
v_lshl_add_u32 v144, v145, 7, v144
v_exp_f32 v35, v35
v_mfma_f32_16x16x32_bf16 v[56:59], v[12:15], a[76:79], v[56:59]
ds_read_b128 v[8:11], v16 offset:37888
v_bfe_u32 v145, v147, 3, 1
v_fma_f32 v38, v38, s44, v22
v_mfma_f32_16x16x32_bf16 v[56:59], v[28:31], a[88:91], v[56:59]
s_add_u32 m0, s47, 62336
ds_read_b128 v[12:15], v17 offset:37888
v_cvt_pk_bf16_f32 v32, v32, v33
v_exp_f32 v36, v36
v_lshl_add_u32 v144, v145, 10, v144
v_mfma_f32_16x16x32_bf16 v[56:59], v[88:91], a[92:95], v[56:59]
s_waitcnt lgkmcnt(9)
ds_read_b128 v[28:31], v16 offset:38912
v_fma_f32 v39, v39, s44, v22
v_exp_f32 v37, v37
v_add_u32 v144, s55, v144
v_mfma_f32_16x16x32_bf16 v[52:55], v[92:95], a[48:51], 0
s_waitcnt lgkmcnt(9)
ds_read_b128 v[88:91], v17 offset:38912
v_fma_f32 v40, v40, s44, v23
v_cvt_pk_bf16_f32 v33, v34, v35
v_xor_b32 v145, 64, v144
v_mfma_f32_16x16x32_bf16 v[52:55], v[112:115], a[52:55], v[52:55]
s_waitcnt lgkmcnt(9)
buffer_load_dwordx4 v18, s[16:19], s50 offen offset:128 nt lds
v_accvgpr_write_b32 a176, v32
v_exp_f32 v38, v38
v_lshlrev_b32 v146, 4, v147
v_mfma_f32_16x16x32_bf16 v[52:55], v[116:119], a[64:67], v[52:55]
s_waitcnt lgkmcnt(8)
v_fma_f32 v41, v41, s44, v23
v_exp_f32 v39, v39
v_add_u32 v146, s55, v146
v_mfma_f32_16x16x32_bf16 v[52:55], v[136:139], a[68:71], v[52:55]
s_waitcnt lgkmcnt(7)
v_fma_f32 v42, v42, s44, v23
v_cvt_pk_bf16_f32 v34, v36, v37
v_mfma_f32_16x16x32_bf16 v[52:55], v[140:143], a[80:83], v[52:55]
s_waitcnt lgkmcnt(6)
v_accvgpr_write_b32 a177, v33
v_exp_f32 v40, v40
v_mfma_f32_16x16x32_bf16 v[52:55], v[152:155], a[84:87], v[52:55]
v_fma_f32 v43, v43, s44, v23
v_exp_f32 v41, v41
v_mfma_f32_16x16x32_bf16 v[60:63], v[92:95], a[56:59], 0
v_fma_f32 v44, v44, s44, v23
v_cvt_pk_bf16_f32 v35, v38, v39
v_mfma_f32_16x16x32_bf16 v[60:63], v[112:115], a[60:63], v[60:63]
ds_read_b128 v[92:95], v16 offset:43008
v_accvgpr_write_b32 a178, v34
v_exp_f32 v42, v42
v_mfma_f32_16x16x32_bf16 v[60:63], v[116:119], a[72:75], v[60:63]
s_waitcnt vmcnt(13)
ds_read_b128 v[112:115], v17 offset:43008
v_fma_f32 v45, v45, s44, v23
v_exp_f32 v43, v43
v_mfma_f32_16x16x32_bf16 v[60:63], v[136:139], a[76:79], v[60:63]
ds_read_b128 v[116:119], v16 offset:44032
v_fma_f32 v46, v46, s44, v23
v_cvt_pk_bf16_f32 v36, v40, v41
v_mfma_f32_16x16x32_bf16 v[60:63], v[140:143], a[88:91], v[60:63]
s_add_u32 m0, s47, 63232
ds_read_b128 v[136:139], v17 offset:44032
v_accvgpr_write_b32 a179, v35
v_exp_f32 v44, v44
v_mfma_f32_16x16x32_bf16 v[60:63], v[152:155], a[92:95], v[60:63]
s_waitcnt lgkmcnt(9)
ds_read_b128 v[140:143], v16 offset:45056
v_fma_f32 v47, v47, s44, v23
v_exp_f32 v45, v45
v_mfma_f32_16x16x32_bf16 v[64:67], v[0:3], a[48:51], 0
s_waitcnt lgkmcnt(9)
ds_read_b128 v[152:155], v17 offset:45056
v_cvt_pk_bf16_f32 v37, v42, v43
v_accvgpr_write_b32 a180, v36
v_mfma_f32_16x16x32_bf16 v[64:67], v[4:7], a[52:55], v[64:67]
s_waitcnt lgkmcnt(9)
ds_write_b128 v146, a[96:99] offset:0
v_exp_f32 v46, v46
v_exp_f32 v47, v47
v_mfma_f32_16x16x32_bf16 v[64:67], v[8:11], a[64:67], v[64:67]
s_waitcnt lgkmcnt(9)
ds_write_b128 v146, a[100:103] offset:1024
v_cvt_pk_bf16_f32 v38, v44, v45
v_accvgpr_write_b32 a181, v37
v_mfma_f32_16x16x32_bf16 v[64:67], v[12:15], a[68:71], v[64:67]
s_waitcnt lgkmcnt(9)
ds_write_b128 v146, a[104:107] offset:2048
v_cvt_pk_bf16_f32 v39, v46, v47
v_accvgpr_write_b32 a182, v38
v_mfma_f32_16x16x32_bf16 v[64:67], v[28:31], a[80:83], v[64:67]
s_waitcnt lgkmcnt(9)
ds_write_b128 v146, a[108:111] offset:3072
v_accvgpr_write_b32 a183, v39
v_fma_f32 v48, v48, s44, v22
v_fma_f32 v49, v49, s44, v22
v_mfma_f32_16x16x32_bf16 v[64:67], v[88:91], a[84:87], v[64:67]
ds_read_b128 a[96:99], v144 offset:0
v_fma_f32 v50, v50, s44, v22
v_exp_f32 v48, v48
v_mfma_f32_16x16x32_bf16 v[72:75], v[0:3], a[56:59], 0
ds_read_b128 a[104:107], v144 offset:2048
buffer_load_dwordx4 v18, s[16:19], s50 offen offset:256 nt lds
v_fma_f32 v51, v51, s44, v22
v_exp_f32 v49, v49
v_mfma_f32_16x16x32_bf16 v[72:75], v[4:7], a[60:63], v[72:75]
ds_read_b128 v[0:3], v16 offset:0
v_fma_f32 v52, v52, s44, v22
v_exp_f32 v50, v50
v_mfma_f32_16x16x32_bf16 v[72:75], v[8:11], a[72:75], v[72:75]
ds_read_b128 v[4:7], v17 offset:0
ds_read_b128 a[100:103], v145 offset:0
v_fma_f32 v53, v53, s44, v22
v_exp_f32 v51, v51
v_mfma_f32_16x16x32_bf16 v[72:75], v[12:15], a[76:79], v[72:75]
s_add_u32 m0, s47, 73728
s_waitcnt lgkmcnt(14)
ds_read_b128 v[8:11], v16 offset:1024
s_waitcnt lgkmcnt(14)
ds_read_b128 a[108:111], v145 offset:2048
v_fma_f32 v54, v54, s44, v22
v_mfma_f32_16x16x32_bf16 v[72:75], v[28:31], a[88:91], v[72:75]
s_waitcnt vmcnt(10)
s_waitcnt lgkmcnt(14)
ds_read_b128 v[12:15], v17 offset:1024
v_cvt_pk_bf16_f32 v48, v48, v49
v_exp_f32 v52, v52
v_mfma_f32_16x16x32_bf16 v[72:75], v[88:91], a[92:95], v[72:75]
s_waitcnt lgkmcnt(14)
ds_read_b128 v[28:31], v16 offset:2048
s_waitcnt lgkmcnt(14)
ds_write_b128 v146, a[112:115] offset:0
v_fma_f32 v55, v55, s44, v22
v_exp_f32 v53, v53
v_mfma_f32_16x16x32_bf16 v[68:71], v[92:95], a[48:51], 0
s_waitcnt lgkmcnt(14)
ds_read_b128 v[88:91], v17 offset:2048
s_waitcnt lgkmcnt(14)
ds_write_b128 v146, a[116:119] offset:1024
v_fma_f32 v56, v56, s44, v23
v_cvt_pk_bf16_f32 v49, v50, v51
v_mfma_f32_16x16x32_bf16 v[68:71], v[112:115], a[52:55], v[68:71]
s_waitcnt lgkmcnt(14)
ds_write_b128 v146, a[120:123] offset:2048
v_accvgpr_write_b32 a200, v48
v_exp_f32 v54, v54
v_mfma_f32_16x16x32_bf16 v[68:71], v[116:119], a[64:67], v[68:71]
s_waitcnt lgkmcnt(14)
ds_write_b128 v146, a[124:127] offset:3072
v_fma_f32 v57, v57, s44, v23
v_exp_f32 v55, v55
v_mfma_f32_16x16x32_bf16 v[68:71], v[136:139], a[68:71], v[68:71]
s_waitcnt lgkmcnt(14)
ds_read_b128 a[112:115], v144 offset:0
s_waitcnt lgkmcnt(14)
ds_read_b128 a[120:123], v144 offset:2048
v_fma_f32 v58, v58, s44, v23
v_cvt_pk_bf16_f32 v50, v52, v53
v_mfma_f32_16x16x32_bf16 v[68:71], v[140:143], a[80:83], v[68:71]
s_waitcnt lgkmcnt(14)
ds_read_b128 a[116:119], v145 offset:0
v_accvgpr_write_b32 a201, v49
v_exp_f32 v56, v56
v_mfma_f32_16x16x32_bf16 v[68:71], v[152:155], a[84:87], v[68:71]
s_add_u32 s50, s86, 0
s_waitcnt lgkmcnt(14)
ds_read_b128 a[124:127], v145 offset:2048
v_fma_f32 v59, v59, s44, v23
v_exp_f32 v57, v57
v_mfma_f32_16x16x32_bf16 v[76:79], v[92:95], a[56:59], 0
s_waitcnt vmcnt(6)
s_waitcnt lgkmcnt(14)
ds_write_b128 v146, a[128:131] offset:0
buffer_load_dwordx4 v18, s[16:19], s50 offen nt lds
v_fma_f32 v60, v60, s44, v23
v_cvt_pk_bf16_f32 v51, v54, v55
v_mfma_f32_16x16x32_bf16 v[76:79], v[112:115], a[60:63], v[76:79]
s_waitcnt lgkmcnt(14)
ds_read_b128 v[92:95], v16 offset:6144
v_accvgpr_write_b32 a202, v50
v_exp_f32 v58, v58
v_mfma_f32_16x16x32_bf16 v[76:79], v[116:119], a[72:75], v[76:79]
s_waitcnt lgkmcnt(14)
ds_read_b128 v[112:115], v17 offset:6144
s_waitcnt lgkmcnt(14)
ds_write_b128 v146, a[132:135] offset:1024
v_fma_f32 v61, v61, s44, v23
v_exp_f32 v59, v59
v_mfma_f32_16x16x32_bf16 v[76:79], v[136:139], a[76:79], v[76:79]
s_waitcnt lgkmcnt(14)
ds_read_b128 v[116:119], v16 offset:7168
s_waitcnt lgkmcnt(14)
ds_write_b128 v146, a[136:139] offset:2048
v_fma_f32 v62, v62, s44, v23
v_cvt_pk_bf16_f32 v52, v56, v57
v_mfma_f32_16x16x32_bf16 v[76:79], v[140:143], a[88:91], v[76:79]
s_add_u32 m0, s47, 74624
s_waitcnt lgkmcnt(14)
ds_read_b128 v[136:139], v17 offset:7168
s_waitcnt lgkmcnt(14)
ds_write_b128 v146, a[140:143] offset:3072
v_accvgpr_write_b32 a203, v51
v_exp_f32 v60, v60
v_mfma_f32_16x16x32_bf16 v[76:79], v[152:155], a[92:95], v[76:79]
s_waitcnt lgkmcnt(14)
ds_read_b128 v[140:143], v16 offset:8192
s_waitcnt lgkmcnt(14)
ds_read_b128 a[128:131], v144 offset:0
s_waitcnt lgkmcnt(14)
ds_read_b128 a[136:139], v144 offset:2048
v_fma_f32 v63, v63, s44, v23
v_exp_f32 v61, v61
v_mfma_f32_16x16x32_bf16 v[96:99], v[0:3], a[96:99], 0
s_waitcnt lgkmcnt(14)
ds_read_b128 v[152:155], v17 offset:8192
s_waitcnt lgkmcnt(14)
ds_read_b128 a[132:135], v145 offset:0
v_cvt_pk_bf16_f32 v53, v58, v59
v_accvgpr_write_b32 a204, v52
v_mfma_f32_16x16x32_bf16 v[96:99], v[4:7], a[100:103], v[96:99]
s_waitcnt lgkmcnt(14)
ds_read_b128 a[140:143], v145 offset:2048
v_exp_f32 v62, v62
v_exp_f32 v63, v63
v_mfma_f32_16x16x32_bf16 v[96:99], v[8:11], a[112:115], v[96:99]
buffer_load_dwordx4 v18, s[16:19], s50 offen offset:128 nt lds
v_cvt_pk_bf16_f32 v54, v60, v61
v_accvgpr_write_b32 a205, v53
v_mfma_f32_16x16x32_bf16 v[96:99], v[12:15], a[116:119], v[96:99]
s_waitcnt lgkmcnt(4)
v_cvt_pk_bf16_f32 v55, v62, v63
v_accvgpr_write_b32 a206, v54
v_mfma_f32_16x16x32_bf16 v[96:99], v[28:31], a[128:131], v[96:99]
s_waitcnt lgkmcnt(1)
v_accvgpr_write_b32 a207, v55
v_fma_f32 v64, v64, s44, v22
v_fma_f32 v65, v65, s44, v22
v_mfma_f32_16x16x32_bf16 v[96:99], v[88:91], a[132:135], v[96:99]
v_fma_f32 v66, v66, s44, v22
v_exp_f32 v64, v64
v_mfma_f32_16x16x32_bf16 v[104:107], v[0:3], a[104:107], 0
v_fma_f32 v67, v67, s44, v22
v_exp_f32 v65, v65
v_mfma_f32_16x16x32_bf16 v[104:107], v[4:7], a[108:111], v[104:107]
ds_read_b128 v[0:3], v16 offset:12288
v_fma_f32 v68, v68, s44, v22
v_exp_f32 v66, v66
v_mfma_f32_16x16x32_bf16 v[104:107], v[8:11], a[120:123], v[104:107]
ds_read_b128 v[4:7], v17 offset:12288
v_fma_f32 v69, v69, s44, v22
v_exp_f32 v67, v67
v_mfma_f32_16x16x32_bf16 v[104:107], v[12:15], a[124:127], v[104:107]
ds_read_b128 v[8:11], v16 offset:13312
v_fma_f32 v70, v70, s44, v22
v_mfma_f32_16x16x32_bf16 v[104:107], v[28:31], a[136:139], v[104:107]
s_waitcnt lgkmcnt(3)
s_add_u32 m0, s47, 75520
ds_read_b128 v[12:15], v17 offset:13312
v_cvt_pk_bf16_f32 v64, v64, v65
v_exp_f32 v68, v68
v_mfma_f32_16x16x32_bf16 v[104:107], v[88:91], a[140:143], v[104:107]
ds_read_b128 v[28:31], v16 offset:14336
v_fma_f32 v71, v71, s44, v22
v_exp_f32 v69, v69
v_mfma_f32_16x16x32_bf16 v[100:103], v[92:95], a[96:99], 0
ds_read_b128 v[88:91], v17 offset:14336
v_fma_f32 v72, v72, s44, v23
v_cvt_pk_bf16_f32 v65, v66, v67
v_mfma_f32_16x16x32_bf16 v[100:103], v[112:115], a[100:103], v[100:103]
buffer_load_dwordx4 v18, s[16:19], s50 offen offset:256 nt lds
v_accvgpr_write_b32 a224, v64
v_exp_f32 v70, v70
v_mfma_f32_16x16x32_bf16 v[100:103], v[116:119], a[112:115], v[100:103]
v_fma_f32 v73, v73, s44, v23
v_exp_f32 v71, v71
v_mfma_f32_16x16x32_bf16 v[100:103], v[136:139], a[116:119], v[100:103]
v_fma_f32 v74, v74, s44, v23
v_cvt_pk_bf16_f32 v66, v68, v69
v_mfma_f32_16x16x32_bf16 v[100:103], v[140:143], a[128:131], v[100:103]
v_accvgpr_write_b32 a225, v65
v_exp_f32 v72, v72
v_mfma_f32_16x16x32_bf16 v[100:103], v[152:155], a[132:135], v[100:103]
v_fma_f32 v75, v75, s44, v23
v_exp_f32 v73, v73
v_mfma_f32_16x16x32_bf16 v[108:111], v[92:95], a[104:107], 0
v_fma_f32 v76, v76, s44, v23
v_cvt_pk_bf16_f32 v67, v70, v71
v_mfma_f32_16x16x32_bf16 v[108:111], v[112:115], a[108:111], v[108:111]
ds_read_b128 v[92:95], v16 offset:18432
v_accvgpr_write_b32 a226, v66
v_exp_f32 v74, v74
v_mfma_f32_16x16x32_bf16 v[108:111], v[116:119], a[120:123], v[108:111]
ds_read_b128 v[112:115], v17 offset:18432
v_fma_f32 v77, v77, s44, v23
v_exp_f32 v75, v75
v_mfma_f32_16x16x32_bf16 v[108:111], v[136:139], a[124:127], v[108:111]
s_add_u32 m0, s47, 86016
ds_read_b128 v[116:119], v16 offset:19456
v_fma_f32 v78, v78, s44, v23
v_cvt_pk_bf16_f32 v68, v72, v73
v_mfma_f32_16x16x32_bf16 v[108:111], v[140:143], a[136:139], v[108:111]
s_add_u32 s50, s86, 12288
ds_read_b128 v[136:139], v17 offset:19456
v_accvgpr_write_b32 a227, v67
v_exp_f32 v76, v76
v_mfma_f32_16x16x32_bf16 v[108:111], v[152:155], a[140:143], v[108:111]
s_waitcnt lgkmcnt(9)
ds_read_b128 v[140:143], v16 offset:20480
v_fma_f32 v79, v79, s44, v23
v_exp_f32 v77, v77
v_mfma_f32_16x16x32_bf16 v[120:123], v[0:3], a[96:99], 0
s_waitcnt lgkmcnt(9)
ds_read_b128 v[152:155], v17 offset:20480
v_cvt_pk_bf16_f32 v69, v74, v75
v_accvgpr_write_b32 a228, v68
v_mfma_f32_16x16x32_bf16 v[120:123], v[4:7], a[100:103], v[120:123]
s_waitcnt lgkmcnt(9)
buffer_load_dwordx4 v18, s[16:19], s50 offen nt lds
v_exp_f32 v78, v78
v_exp_f32 v79, v79
v_mfma_f32_16x16x32_bf16 v[120:123], v[8:11], a[112:115], v[120:123]
s_waitcnt lgkmcnt(8)
v_cvt_pk_bf16_f32 v70, v76, v77
v_accvgpr_write_b32 a229, v69
v_mfma_f32_16x16x32_bf16 v[120:123], v[12:15], a[116:119], v[120:123]
s_waitcnt lgkmcnt(7)
v_cvt_pk_bf16_f32 v71, v78, v79
v_accvgpr_write_b32 a230, v70
v_mfma_f32_16x16x32_bf16 v[120:123], v[28:31], a[128:131], v[120:123]
s_waitcnt lgkmcnt(6)
v_accvgpr_write_b32 a231, v71
v_max3_f32 v148, v96, v97, v98
v_max3_f32 v149, v104, v105, v106
v_max3_f32 v148, v148, v99, v100
v_mfma_f32_16x16x32_bf16 v[120:123], v[88:91], a[132:135], v[120:123]
v_max3_f32 v149, v149, v107, v108
v_max3_f32 v148, v148, v101, v102
v_max3_f32 v149, v149, v109, v110
v_mfma_f32_16x16x32_bf16 v[128:131], v[0:3], a[104:107], 0
v_max_f32 v148, v148, v103
v_max_f32 v149, v149, v111
v_mov_b32 v24, v148
v_mov_b32 v25, v149
v_mfma_f32_16x16x32_bf16 v[128:131], v[4:7], a[108:111], v[128:131]
ds_read_b128 v[0:3], v16 offset:24576
v_permlane16_swap_b32 v148, v24
v_permlane16_swap_b32 v149, v25
v_mfma_f32_16x16x32_bf16 v[128:131], v[8:11], a[120:123], v[128:131]
ds_read_b128 v[4:7], v17 offset:24576
v_max_f32 v148, v148, v24
v_max_f32 v149, v149, v25
v_mov_b32 v24, v148
v_mov_b32 v25, v149
v_mfma_f32_16x16x32_bf16 v[128:131], v[12:15], a[124:127], v[128:131]
ds_read_b128 v[8:11], v16 offset:25600
v_permlane32_swap_b32 v148, v24
v_permlane32_swap_b32 v149, v25
v_mfma_f32_16x16x32_bf16 v[128:131], v[28:31], a[136:139], v[128:131]
s_add_u32 m0, s47, 86912
ds_read_b128 v[12:15], v17 offset:25600
v_max_f32 v148, v148, v24
v_max_f32 v149, v149, v25
v_mul_f32 v24, s45, v148
v_mfma_f32_16x16x32_bf16 v[128:131], v[88:91], a[140:143], v[128:131]
s_waitcnt lgkmcnt(9)
ds_read_b128 v[28:31], v16 offset:26624
v_mul_f32 v25, s45, v149
v_fma_f32 v96, v96, s44, v24
v_fma_f32 v97, v97, s44, v24
v_fma_f32 v98, v98, s44, v24
v_mfma_f32_16x16x32_bf16 v[124:127], v[92:95], a[96:99], 0
s_waitcnt lgkmcnt(9)
ds_read_b128 v[88:91], v17 offset:26624
v_exp_f32 v96, v96
v_fma_f32 v99, v99, s44, v24
v_exp_f32 v97, v97
v_mfma_f32_16x16x32_bf16 v[124:127], v[112:115], a[100:103], v[124:127]
s_waitcnt lgkmcnt(9)
buffer_load_dwordx4 v18, s[16:19], s50 offen offset:128 nt lds
v_fma_f32 v100, v100, s44, v24
v_exp_f32 v98, v98
v_mfma_f32_16x16x32_bf16 v[124:127], v[116:119], a[112:115], v[124:127]
s_waitcnt lgkmcnt(8)
v_fma_f32 v101, v101, s44, v24
v_exp_f32 v99, v99
v_mfma_f32_16x16x32_bf16 v[124:127], v[136:139], a[116:119], v[124:127]
s_waitcnt lgkmcnt(7)
v_fma_f32 v102, v102, s44, v24
v_cvt_pk_bf16_f32 v96, v96, v97
v_exp_f32 v100, v100
v_mfma_f32_16x16x32_bf16 v[124:127], v[140:143], a[128:131], v[124:127]
s_waitcnt lgkmcnt(6)
v_fma_f32 v103, v103, s44, v24
v_exp_f32 v101, v101
v_fma_f32 v104, v104, s44, v25
v_mfma_f32_16x16x32_bf16 v[124:127], v[152:155], a[132:135], v[124:127]
v_cvt_pk_bf16_f32 v97, v98, v99
v_accvgpr_write_b32 a160, v96
v_exp_f32 v102, v102
v_mfma_f32_16x16x32_bf16 v[132:135], v[92:95], a[104:107], 0
v_fma_f32 v105, v105, s44, v25
v_exp_f32 v103, v103
v_mfma_f32_16x16x32_bf16 v[132:135], v[112:115], a[108:111], v[132:135]
ds_read_b128 v[92:95], v16 offset:30720
v_fma_f32 v106, v106, s44, v25
v_cvt_pk_bf16_f32 v98, v100, v101
v_accvgpr_write_b32 a161, v97
v_exp_f32 v104, v104
v_mfma_f32_16x16x32_bf16 v[132:135], v[116:119], a[120:123], v[132:135]
ds_read_b128 v[112:115], v17 offset:30720
v_fma_f32 v107, v107, s44, v25
v_exp_f32 v105, v105
v_mfma_f32_16x16x32_bf16 v[132:135], v[136:139], a[124:127], v[132:135]
ds_read_b128 v[116:119], v16 offset:31744
v_fma_f32 v108, v108, s44, v25
v_cvt_pk_bf16_f32 v99, v102, v103
v_accvgpr_write_b32 a162, v98
v_mfma_f32_16x16x32_bf16 v[132:135], v[140:143], a[136:139], v[132:135]
s_add_u32 m0, s47, 87808
ds_read_b128 v[136:139], v17 offset:31744
v_exp_f32 v106, v106
v_fma_f32 v109, v109, s44, v25
v_exp_f32 v107, v107
v_mfma_f32_16x16x32_bf16 v[132:135], v[152:155], a[140:143], v[132:135]
s_waitcnt lgkmcnt(9)
ds_read_b128 v[140:143], v16 offset:32768
v_fma_f32 v110, v110, s44, v25
v_cvt_pk_bf16_f32 v100, v104, v105
v_accvgpr_write_b32 a163, v99
v_mfma_f32_16x16x32_bf16 v[32:35], v[0:3], a[96:99], 0
s_waitcnt lgkmcnt(9)
ds_read_b128 v[152:155], v17 offset:32768
v_exp_f32 v108, v108
v_fma_f32 v111, v111, s44, v25
v_exp_f32 v109, v109
v_mfma_f32_16x16x32_bf16 v[32:35], v[4:7], a[100:103], v[32:35]
s_waitcnt lgkmcnt(9)
buffer_load_dwordx4 v18, s[16:19], s50 offen offset:256 nt lds
v_cvt_pk_bf16_f32 v101, v106, v107
v_accvgpr_write_b32 a164, v100
v_mfma_f32_16x16x32_bf16 v[32:35], v[8:11], a[112:115], v[32:35]
s_waitcnt lgkmcnt(8)
v_exp_f32 v110, v110
v_exp_f32 v111, v111
v_mfma_f32_16x16x32_bf16 v[32:35], v[12:15], a[116:119], v[32:35]
s_waitcnt lgkmcnt(7)
v_cvt_pk_bf16_f32 v102, v108, v109
v_accvgpr_write_b32 a165, v101
v_cvt_pk_bf16_f32 v103, v110, v111
v_accvgpr_write_b32 a166, v102
v_mfma_f32_16x16x32_bf16 v[32:35], v[28:31], a[128:131], v[32:35]
s_waitcnt lgkmcnt(6)
v_accvgpr_write_b32 a167, v103
v_fma_f32 v120, v120, s44, v24
v_fma_f32 v121, v121, s44, v24
v_mfma_f32_16x16x32_bf16 v[32:35], v[88:91], a[132:135], v[32:35]
v_fma_f32 v122, v122, s44, v24
v_exp_f32 v120, v120
v_mfma_f32_16x16x32_bf16 v[40:43], v[0:3], a[104:107], 0
v_fma_f32 v123, v123, s44, v24
v_exp_f32 v121, v121
v_mfma_f32_16x16x32_bf16 v[40:43], v[4:7], a[108:111], v[40:43]
ds_read_b128 v[0:3], v16 offset:36864
v_fma_f32 v124, v124, s44, v24
v_exp_f32 v122, v122
v_mfma_f32_16x16x32_bf16 v[40:43], v[8:11], a[120:123], v[40:43]
ds_read_b128 v[4:7], v17 offset:36864
v_fma_f32 v125, v125, s44, v24
v_exp_f32 v123, v123
v_mfma_f32_16x16x32_bf16 v[40:43], v[12:15], a[124:127], v[40:43]
s_add_u32 m0, s47, 98304
ds_read_b128 v[8:11], v16 offset:37888
v_fma_f32 v126, v126, s44, v24
v_mfma_f32_16x16x32_bf16 v[40:43], v[28:31], a[136:139], v[40:43]
s_add_u32 s50, s86, 24576
ds_read_b128 v[12:15], v17 offset:37888
v_cvt_pk_bf16_f32 v120, v120, v121
v_exp_f32 v124, v124
v_mfma_f32_16x16x32_bf16 v[40:43], v[88:91], a[140:143], v[40:43]
s_waitcnt lgkmcnt(9)
ds_read_b128 v[28:31], v16 offset:38912
v_fma_f32 v127, v127, s44, v24
v_exp_f32 v125, v125
v_mfma_f32_16x16x32_bf16 v[36:39], v[92:95], a[96:99], 0
s_waitcnt lgkmcnt(9)
ds_read_b128 v[88:91], v17 offset:38912
v_fma_f32 v128, v128, s44, v25
v_cvt_pk_bf16_f32 v121, v122, v123
v_mfma_f32_16x16x32_bf16 v[36:39], v[112:115], a[100:103], v[36:39]
s_waitcnt lgkmcnt(9)
buffer_load_dwordx4 v18, s[16:19], s50 offen nt lds
v_accvgpr_write_b32 a184, v120
v_exp_f32 v126, v126
v_mfma_f32_16x16x32_bf16 v[36:39], v[116:119], a[112:115], v[36:39]
s_waitcnt lgkmcnt(8)
v_fma_f32 v129, v129, s44, v25
v_exp_f32 v127, v127
v_mfma_f32_16x16x32_bf16 v[36:39], v[136:139], a[116:119], v[36:39]
s_waitcnt lgkmcnt(7)
v_fma_f32 v130, v130, s44, v25
v_cvt_pk_bf16_f32 v122, v124, v125
v_mfma_f32_16x16x32_bf16 v[36:39], v[140:143], a[128:131], v[36:39]
s_waitcnt lgkmcnt(6)
v_accvgpr_write_b32 a185, v121
v_exp_f32 v128, v128
v_mfma_f32_16x16x32_bf16 v[36:39], v[152:155], a[132:135], v[36:39]
v_fma_f32 v131, v131, s44, v25
v_exp_f32 v129, v129
v_mfma_f32_16x16x32_bf16 v[44:47], v[92:95], a[104:107], 0
v_fma_f32 v132, v132, s44, v25
v_cvt_pk_bf16_f32 v123, v126, v127
v_mfma_f32_16x16x32_bf16 v[44:47], v[112:115], a[108:111], v[44:47]
ds_read_b128 v[92:95], v16 offset:43008
v_accvgpr_write_b32 a186, v122
v_exp_f32 v130, v130
v_mfma_f32_16x16x32_bf16 v[44:47], v[116:119], a[120:123], v[44:47]
ds_read_b128 v[112:115], v17 offset:43008
v_fma_f32 v133, v133, s44, v25
v_exp_f32 v131, v131
v_mfma_f32_16x16x32_bf16 v[44:47], v[136:139], a[124:127], v[44:47]
ds_read_b128 v[116:119], v16 offset:44032
v_fma_f32 v134, v134, s44, v25
v_cvt_pk_bf16_f32 v124, v128, v129
v_mfma_f32_16x16x32_bf16 v[44:47], v[140:143], a[136:139], v[44:47]
s_add_u32 m0, s47, 99200
ds_read_b128 v[136:139], v17 offset:44032
v_accvgpr_write_b32 a187, v123
v_exp_f32 v132, v132
v_mfma_f32_16x16x32_bf16 v[44:47], v[152:155], a[140:143], v[44:47]
s_waitcnt lgkmcnt(9)
ds_read_b128 v[140:143], v16 offset:45056
v_fma_f32 v135, v135, s44, v25
v_exp_f32 v133, v133
v_mfma_f32_16x16x32_bf16 v[48:51], v[0:3], a[96:99], 0
s_waitcnt lgkmcnt(9)
ds_read_b128 v[152:155], v17 offset:45056
s_waitcnt vmcnt(10)
s_barrier
v_add_u32 v16, 0xc000, v16
v_cvt_pk_bf16_f32 v125, v130, v131
v_accvgpr_write_b32 a188, v124
v_mfma_f32_16x16x32_bf16 v[48:51], v[4:7], a[100:103], v[48:51]
s_waitcnt lgkmcnt(9)
buffer_load_dwordx4 v18, s[16:19], s50 offen offset:128 nt lds
v_exp_f32 v134, v134
v_exp_f32 v135, v135
v_mfma_f32_16x16x32_bf16 v[48:51], v[8:11], a[112:115], v[48:51]
s_waitcnt lgkmcnt(8)
ds_read_b128 v[156:159], v16 offset:0
v_cvt_pk_bf16_f32 v126, v132, v133
v_accvgpr_write_b32 a189, v125
v_mfma_f32_16x16x32_bf16 v[48:51], v[12:15], a[116:119], v[48:51]
s_waitcnt lgkmcnt(8)
v_cvt_pk_bf16_f32 v127, v134, v135
v_accvgpr_write_b32 a190, v126
v_mfma_f32_16x16x32_bf16 v[48:51], v[28:31], a[128:131], v[48:51]
s_waitcnt lgkmcnt(7)
v_accvgpr_write_b32 a191, v127
v_add_u32 v17, 0xc000, v17
v_fma_f32 v32, v32, s44, v24
v_fma_f32 v33, v33, s44, v24
v_mfma_f32_16x16x32_bf16 v[48:51], v[88:91], a[132:135], v[48:51]
v_fma_f32 v34, v34, s44, v24
v_exp_f32 v32, v32
v_mfma_f32_16x16x32_bf16 v[56:59], v[0:3], a[104:107], 0
ds_read_b128 v[0:3], v17 offset:0
v_fma_f32 v35, v35, s44, v24
v_exp_f32 v33, v33
v_mfma_f32_16x16x32_bf16 v[56:59], v[4:7], a[108:111], v[56:59]
v_fma_f32 v36, v36, s44, v24
v_exp_f32 v34, v34
v_mfma_f32_16x16x32_bf16 v[56:59], v[8:11], a[120:123], v[56:59]
ds_read_b128 v[8:11], v16 offset:1024
v_fma_f32 v37, v37, s44, v24
v_exp_f32 v35, v35
v_mfma_f32_16x16x32_bf16 v[56:59], v[12:15], a[124:127], v[56:59]
v_fma_f32 v38, v38, s44, v24
v_mfma_f32_16x16x32_bf16 v[56:59], v[28:31], a[136:139], v[56:59]
s_add_u32 m0, s47, 100096
ds_read_b128 v[28:31], v17 offset:1024
v_cvt_pk_bf16_f32 v32, v32, v33
v_exp_f32 v36, v36
v_mfma_f32_16x16x32_bf16 v[56:59], v[88:91], a[140:143], v[56:59]
s_waitcnt lgkmcnt(9)
buffer_load_dwordx4 v18, s[16:19], s50 offen offset:256 nt lds
v_fma_f32 v39, v39, s44, v24
v_exp_f32 v37, v37
v_mfma_f32_16x16x32_bf16 v[52:55], v[92:95], a[96:99], 0
s_waitcnt lgkmcnt(8)
ds_read_b128 v[12:15], v16 offset:2048
v_fma_f32 v40, v40, s44, v25
v_cvt_pk_bf16_f32 v33, v34, v35
v_mfma_f32_16x16x32_bf16 v[52:55], v[112:115], a[100:103], v[52:55]
s_waitcnt lgkmcnt(8)
v_accvgpr_write_b32 a208, v32
v_exp_f32 v38, v38
v_mfma_f32_16x16x32_bf16 v[52:55], v[116:119], a[112:115], v[52:55]
s_waitcnt lgkmcnt(7)
ds_read_b128 v[4:7], v17 offset:2048
v_fma_f32 v41, v41, s44, v25
v_exp_f32 v39, v39
v_mfma_f32_16x16x32_bf16 v[52:55], v[136:139], a[116:119], v[52:55]
s_waitcnt lgkmcnt(7)
v_fma_f32 v42, v42, s44, v25
v_cvt_pk_bf16_f32 v34, v36, v37
v_mfma_f32_16x16x32_bf16 v[52:55], v[140:143], a[128:131], v[52:55]
s_waitcnt lgkmcnt(6)
v_accvgpr_write_b32 a209, v33
v_exp_f32 v40, v40
v_mfma_f32_16x16x32_bf16 v[52:55], v[152:155], a[132:135], v[52:55]
v_fma_f32 v43, v43, s44, v25
v_exp_f32 v41, v41
v_mfma_f32_16x16x32_bf16 v[60:63], v[92:95], a[104:107], 0
v_fma_f32 v44, v44, s44, v25
v_cvt_pk_bf16_f32 v35, v38, v39
v_mfma_f32_16x16x32_bf16 v[60:63], v[112:115], a[108:111], v[60:63]
v_accvgpr_write_b32 a210, v34
v_exp_f32 v42, v42
v_mfma_f32_16x16x32_bf16 v[60:63], v[116:119], a[120:123], v[60:63]
v_fma_f32 v45, v45, s44, v25
v_exp_f32 v43, v43
v_mfma_f32_16x16x32_bf16 v[60:63], v[136:139], a[124:127], v[60:63]
s_add_u32 m0, s47, 110592
v_fma_f32 v46, v46, s44, v25
v_cvt_pk_bf16_f32 v36, v40, v41
v_mfma_f32_16x16x32_bf16 v[60:63], v[140:143], a[136:139], v[60:63]
s_add_u32 s50, s87, 0
v_accvgpr_write_b32 a211, v35
v_exp_f32 v44, v44
v_mfma_f32_16x16x32_bf16 v[60:63], v[152:155], a[140:143], v[60:63]
s_waitcnt lgkmcnt(5)
buffer_load_dwordx4 v18, s[16:19], s50 offen nt lds
v_fma_f32 v47, v47, s44, v25
v_exp_f32 v45, v45
v_mfma_f32_16x16x32_bf16 v[160:163], v[156:159], a[0:3], 0
s_waitcnt lgkmcnt(4)
v_cvt_pk_bf16_f32 v37, v42, v43
v_accvgpr_write_b32 a212, v36
v_mfma_f32_16x16x32_bf16 v[160:163], v[0:3], a[4:7], v[160:163]
s_waitcnt lgkmcnt(3)
v_exp_f32 v46, v46
v_exp_f32 v47, v47
v_mfma_f32_16x16x32_bf16 v[160:163], v[8:11], a[16:19], v[160:163]
s_waitcnt lgkmcnt(2)
v_cvt_pk_bf16_f32 v38, v44, v45
v_accvgpr_write_b32 a213, v37
v_mfma_f32_16x16x32_bf16 v[160:163], v[28:31], a[20:23], v[160:163]
s_waitcnt lgkmcnt(1)
v_cvt_pk_bf16_f32 v39, v46, v47
v_accvgpr_write_b32 a214, v38
v_mfma_f32_16x16x32_bf16 v[160:163], v[12:15], a[32:35], v[160:163]
s_waitcnt lgkmcnt(0)
v_accvgpr_write_b32 a215, v39
v_fma_f32 v48, v48, s44, v24
v_mfma_f32_16x16x32_bf16 v[160:163], v[4:7], a[36:39], v[160:163]
v_fma_f32 v49, v49, s44, v24
v_fma_f32 v50, v50, s44, v24
v_mfma_f32_16x16x32_bf16 v[168:171], v[156:159], a[8:11], 0
v_exp_f32 v48, v48
v_mfma_f32_16x16x32_bf16 v[168:171], v[0:3], a[12:15], v[168:171]
v_mfma_f32_16x16x32_bf16 v[168:171], v[8:11], a[24:27], v[168:171]
v_fma_f32 v51, v51, s44, v24
v_exp_f32 v49, v49
v_mfma_f32_16x16x32_bf16 v[168:171], v[28:31], a[28:31], v[168:171]
v_mfma_f32_16x16x32_bf16 v[168:171], v[12:15], a[40:43], v[168:171]
s_add_u32 m0, s47, 111488
v_fma_f32 v52, v52, s44, v24
v_mfma_f32_16x16x32_bf16 v[168:171], v[4:7], a[44:47], v[168:171]
ds_read_b128 v[152:155], v16 offset:6144
v_exp_f32 v50, v50
v_mfma_f32_16x16x32_bf16 v[176:179], v[156:159], a[48:51], 0
buffer_load_dwordx4 v18, s[16:19], s50 offen offset:128 nt lds
v_fma_f32 v53, v53, s44, v24
v_mfma_f32_16x16x32_bf16 v[176:179], v[0:3], a[52:55], v[176:179]
v_exp_f32 v51, v51
v_mfma_f32_16x16x32_bf16 v[176:179], v[8:11], a[64:67], v[176:179]
v_fma_f32 v54, v54, s44, v24
v_mfma_f32_16x16x32_bf16 v[176:179], v[28:31], a[68:71], v[176:179]
v_cvt_pk_bf16_f32 v48, v48, v49
v_mfma_f32_16x16x32_bf16 v[176:179], v[12:15], a[80:83], v[176:179]
v_exp_f32 v52, v52
v_mfma_f32_16x16x32_bf16 v[176:179], v[4:7], a[84:87], v[176:179]
v_fma_f32 v55, v55, s44, v24
v_mfma_f32_16x16x32_bf16 v[184:187], v[156:159], a[56:59], 0
v_exp_f32 v53, v53
v_mfma_f32_16x16x32_bf16 v[184:187], v[0:3], a[60:63], v[184:187]
v_mfma_f32_16x16x32_bf16 v[184:187], v[8:11], a[72:75], v[184:187]
ds_read_b128 v[112:115], v17 offset:6144
v_fma_f32 v56, v56, s44, v25
v_cvt_pk_bf16_f32 v49, v50, v51
v_mfma_f32_16x16x32_bf16 v[184:187], v[28:31], a[76:79], v[184:187]
v_accvgpr_write_b32 a232, v48
v_mfma_f32_16x16x32_bf16 v[184:187], v[12:15], a[88:91], v[184:187]
s_add_u32 m0, s47, 112384
ds_read_b128 v[140:143], v16 offset:7168
v_exp_f32 v54, v54
v_mfma_f32_16x16x32_bf16 v[184:187], v[4:7], a[92:95], v[184:187]
buffer_load_dwordx4 v18, s[16:19], s50 offen offset:256 nt lds
v_fma_f32 v57, v57, s44, v25
v_mfma_f32_16x16x32_bf16 v[192:195], v[156:159], a[96:99], 0
ds_read_b128 v[136:139], v17 offset:7168
v_exp_f32 v55, v55
v_mfma_f32_16x16x32_bf16 v[192:195], v[0:3], a[100:103], v[192:195]
v_mbcnt_lo_u32_b32 v150, -1, 0
v_mbcnt_hi_u32_b32 v150, -1, v150
s_lshl_b32 s52, s3, 13
s_add_u32 s52, s52, 32768
v_lshl_add_u32 v150, v150, 7, s52
v_min_u32 v150, L_end-standalone__gqa_softmax__near_ridge_kernel, v150
v_mov_b32 v151, 0
s_lshl_b32 m0, s3, 12
s_add_u32 m0, m0, 147456
v_lshl_add_u64 v[150:151], v[150:151], 0, s[60:61]
global_load_lds_dword v[150:151], off
v_fma_f32 v58, v58, s44, v25
v_mfma_f32_16x16x32_bf16 v[192:195], v[8:11], a[112:115], v[192:195]
ds_read_b128 v[116:119], v16 offset:8192
v_cvt_pk_bf16_f32 v50, v52, v53
v_mfma_f32_16x16x32_bf16 v[192:195], v[28:31], a[116:119], v[192:195]
v_accvgpr_write_b32 a233, v49
v_mfma_f32_16x16x32_bf16 v[192:195], v[12:15], a[128:131], v[192:195]
v_exp_f32 v56, v56
v_mfma_f32_16x16x32_bf16 v[192:195], v[4:7], a[132:135], v[192:195]
v_fma_f32 v59, v59, s44, v25
v_mfma_f32_16x16x32_bf16 v[200:203], v[156:159], a[104:107], 0
ds_read_b128 v[156:159], v17 offset:8192
v_exp_f32 v57, v57
v_mfma_f32_16x16x32_bf16 v[200:203], v[0:3], a[108:111], v[200:203]
v_fma_f32 v60, v60, s44, v25
v_mfma_f32_16x16x32_bf16 v[200:203], v[8:11], a[120:123], v[200:203]
v_cvt_pk_bf16_f32 v51, v54, v55
v_mfma_f32_16x16x32_bf16 v[200:203], v[28:31], a[124:127], v[200:203]
s_add_u32 m0, s47, 122880
v_accvgpr_write_b32 a234, v50
v_mfma_f32_16x16x32_bf16 v[200:203], v[12:15], a[136:139], v[200:203]
s_add_u32 s50, s87, 12288
v_exp_f32 v58, v58
v_mfma_f32_16x16x32_bf16 v[200:203], v[4:7], a[140:143], v[200:203]
s_waitcnt lgkmcnt(5)
buffer_load_dwordx4 v18, s[16:19], s50 offen nt lds
v_fma_f32 v61, v61, s44, v25
v_mfma_f32_16x16x32_bf16 v[164:167], v[152:155], a[0:3], 0
s_waitcnt lgkmcnt(4)
v_exp_f32 v59, v59
v_mfma_f32_16x16x32_bf16 v[164:167], v[112:115], a[4:7], v[164:167]
s_waitcnt lgkmcnt(3)
v_fma_f32 v62, v62, s44, v25
v_mfma_f32_16x16x32_bf16 v[164:167], v[140:143], a[16:19], v[164:167]
s_waitcnt lgkmcnt(2)
v_cvt_pk_bf16_f32 v52, v56, v57
v_mfma_f32_16x16x32_bf16 v[164:167], v[136:139], a[20:23], v[164:167]
s_waitcnt lgkmcnt(1)
v_accvgpr_write_b32 a235, v51
v_mfma_f32_16x16x32_bf16 v[164:167], v[116:119], a[32:35], v[164:167]
s_waitcnt lgkmcnt(0)
v_exp_f32 v60, v60
v_mfma_f32_16x16x32_bf16 v[164:167], v[156:159], a[36:39], v[164:167]
v_fma_f32 v63, v63, s44, v25
v_mfma_f32_16x16x32_bf16 v[172:175], v[152:155], a[8:11], 0
v_exp_f32 v61, v61
v_mfma_f32_16x16x32_bf16 v[172:175], v[112:115], a[12:15], v[172:175]
v_cvt_pk_bf16_f32 v53, v58, v59
v_mfma_f32_16x16x32_bf16 v[172:175], v[140:143], a[24:27], v[172:175]
v_accvgpr_write_b32 a236, v52
v_mfma_f32_16x16x32_bf16 v[172:175], v[136:139], a[28:31], v[172:175]
s_waitcnt vmcnt(14)
s_barrier
v_exp_f32 v62, v62
v_mfma_f32_16x16x32_bf16 v[172:175], v[116:119], a[40:43], v[172:175]
s_add_u32 m0, s47, 123776
v_exp_f32 v63, v63
v_mfma_f32_16x16x32_bf16 v[172:175], v[156:159], a[44:47], v[172:175]
ds_read_b128 v[4:7], v16 offset:12288
v_mfma_f32_16x16x32_bf16 v[180:183], v[152:155], a[48:51], 0
buffer_load_dwordx4 v18, s[16:19], s50 offen offset:128 nt lds
v_cvt_pk_bf16_f32 v54, v60, v61
v_mfma_f32_16x16x32_bf16 v[180:183], v[112:115], a[52:55], v[180:183]
ds_read_b128 v[12:15], v17 offset:12288
v_accvgpr_write_b32 a237, v53
v_cvt_pk_bf16_f32 v55, v62, v63
v_mfma_f32_16x16x32_bf16 v[180:183], v[140:143], a[64:67], v[180:183]
v_accvgpr_write_b32 a238, v54
v_mfma_f32_16x16x32_bf16 v[180:183], v[136:139], a[68:71], v[180:183]
ds_read_b128 v[28:31], v16 offset:13312
v_accvgpr_write_b32 a239, v55
v_mfma_f32_16x16x32_bf16 v[180:183], v[116:119], a[80:83], v[180:183]
v_mfma_f32_16x16x32_bf16 v[180:183], v[156:159], a[84:87], v[180:183]
ds_read_b128 v[8:11], v17 offset:13312
v_mfma_f32_16x16x32_bf16 v[188:191], v[152:155], a[56:59], 0
v_mfma_f32_16x16x32_bf16 v[188:191], v[112:115], a[60:63], v[188:191]
ds_read_b128 v[0:3], v16 offset:14336
v_mfma_f32_16x16x32_bf16 v[188:191], v[140:143], a[72:75], v[188:191]
v_mfma_f32_16x16x32_bf16 v[188:191], v[136:139], a[76:79], v[188:191]
ds_read_b128 v[120:123], v17 offset:14336
v_mfma_f32_16x16x32_bf16 v[188:191], v[116:119], a[88:91], v[188:191]
s_add_u32 m0, s47, 124672
v_mfma_f32_16x16x32_bf16 v[188:191], v[156:159], a[92:95], v[188:191]
buffer_load_dwordx4 v18, s[16:19], s50 offen offset:256 nt lds
v_mfma_f32_16x16x32_bf16 v[196:199], v[152:155], a[96:99], 0
v_mfma_f32_16x16x32_bf16 v[196:199], v[112:115], a[100:103], v[196:199]
v_mfma_f32_16x16x32_bf16 v[196:199], v[140:143], a[112:115], v[196:199]
v_mfma_f32_16x16x32_bf16 v[196:199], v[136:139], a[116:119], v[196:199]
v_mfma_f32_16x16x32_bf16 v[196:199], v[116:119], a[128:131], v[196:199]
v_mfma_f32_16x16x32_bf16 v[196:199], v[156:159], a[132:135], v[196:199]
v_mfma_f32_16x16x32_bf16 v[204:207], v[152:155], a[104:107], 0
v_mfma_f32_16x16x32_bf16 v[204:207], v[112:115], a[108:111], v[204:207]
v_mfma_f32_16x16x32_bf16 v[204:207], v[140:143], a[120:123], v[204:207]
v_mfma_f32_16x16x32_bf16 v[204:207], v[136:139], a[124:127], v[204:207]
s_add_u32 m0, s47, 135168
v_mfma_f32_16x16x32_bf16 v[204:207], v[116:119], a[136:139], v[204:207]
s_add_u32 s50, s87, 24576
v_mfma_f32_16x16x32_bf16 v[204:207], v[156:159], a[140:143], v[204:207]
s_waitcnt lgkmcnt(5)
buffer_load_dwordx4 v18, s[16:19], s50 offen nt lds
v_mfma_f32_16x16x32_bf16 v[208:211], v[4:7], a[0:3], 0
s_waitcnt lgkmcnt(4)
v_mfma_f32_16x16x32_bf16 v[208:211], v[12:15], a[4:7], v[208:211]
s_waitcnt lgkmcnt(3)
v_mfma_f32_16x16x32_bf16 v[208:211], v[28:31], a[16:19], v[208:211]
s_waitcnt lgkmcnt(2)
v_fma_f32 v160, v160, s44, v20
v_fma_f32 v161, v161, s44, v20
v_mfma_f32_16x16x32_bf16 v[208:211], v[8:11], a[20:23], v[208:211]
s_waitcnt lgkmcnt(1)
v_fma_f32 v162, v162, s44, v20
v_exp_f32 v160, v160
v_mfma_f32_16x16x32_bf16 v[208:211], v[0:3], a[32:35], v[208:211]
s_waitcnt lgkmcnt(0)
v_fma_f32 v163, v163, s44, v20
v_exp_f32 v161, v161
v_mfma_f32_16x16x32_bf16 v[208:211], v[120:123], a[36:39], v[208:211]
v_fma_f32 v164, v164, s44, v20
v_exp_f32 v162, v162
v_mfma_f32_16x16x32_bf16 v[216:219], v[4:7], a[8:11], 0
v_fma_f32 v165, v165, s44, v20
v_mfma_f32_16x16x32_bf16 v[216:219], v[12:15], a[12:15], v[216:219]
v_exp_f32 v163, v163
v_fma_f32 v166, v166, s44, v20
v_mfma_f32_16x16x32_bf16 v[216:219], v[28:31], a[24:27], v[216:219]
v_cvt_pk_bf16_f32 v160, v160, v161
v_exp_f32 v164, v164
v_mfma_f32_16x16x32_bf16 v[216:219], v[8:11], a[28:31], v[216:219]
v_fma_f32 v167, v167, s44, v20
v_exp_f32 v165, v165
v_mfma_f32_16x16x32_bf16 v[216:219], v[0:3], a[40:43], v[216:219]
s_add_u32 m0, s47, 136064
v_fma_f32 v168, v168, s44, v21
v_mfma_f32_16x16x32_bf16 v[216:219], v[120:123], a[44:47], v[216:219]
ds_read_b128 v[156:159], v16 offset:18432
v_cvt_pk_bf16_f32 v161, v162, v163
v_accvgpr_write_b32 a240, v160
v_exp_f32 v166, v166
v_mfma_f32_16x16x32_bf16 v[224:227], v[4:7], a[48:51], 0
buffer_load_dwordx4 v18, s[16:19], s50 offen offset:128 nt lds
v_fma_f32 v169, v169, s44, v21
v_exp_f32 v167, v167
v_mfma_f32_16x16x32_bf16 v[224:227], v[12:15], a[52:55], v[224:227]
ds_read_b128 v[116:119], v17 offset:18432
v_fma_f32 v170, v170, s44, v21
v_mfma_f32_16x16x32_bf16 v[224:227], v[28:31], a[64:67], v[224:227]
v_cvt_pk_bf16_f32 v162, v164, v165
v_accvgpr_write_b32 a241, v161
v_exp_f32 v168, v168
v_mfma_f32_16x16x32_bf16 v[224:227], v[8:11], a[68:71], v[224:227]
ds_read_b128 v[136:139], v16 offset:19456
v_fma_f32 v171, v171, s44, v21
v_mfma_f32_16x16x32_bf16 v[224:227], v[0:3], a[80:83], v[224:227]
v_exp_f32 v169, v169
v_fma_f32 v172, v172, s44, v21
v_mfma_f32_16x16x32_bf16 v[224:227], v[120:123], a[84:87], v[224:227]
ds_read_b128 v[140:143], v17 offset:19456
v_cvt_pk_bf16_f32 v163, v166, v167
v_accvgpr_write_b32 a242, v162
v_mfma_f32_16x16x32_bf16 v[232:235], v[4:7], a[56:59], 0
v_exp_f32 v170, v170
v_fma_f32 v173, v173, s44, v21
v_mfma_f32_16x16x32_bf16 v[232:235], v[12:15], a[60:63], v[232:235]
ds_read_b128 v[112:115], v16 offset:20480
v_exp_f32 v171, v171
v_mfma_f32_16x16x32_bf16 v[232:235], v[28:31], a[72:75], v[232:235]
v_fma_f32 v174, v174, s44, v21
v_cvt_pk_bf16_f32 v164, v168, v169
v_accvgpr_write_b32 a243, v163
v_mfma_f32_16x16x32_bf16 v[232:235], v[8:11], a[76:79], v[232:235]
ds_read_b128 v[152:155], v17 offset:20480
v_exp_f32 v172, v172
v_fma_f32 v175, v175, s44, v21
v_mfma_f32_16x16x32_bf16 v[232:235], v[0:3], a[88:91], v[232:235]
s_add_u32 m0, s47, 136960
v_exp_f32 v173, v173
v_mfma_f32_16x16x32_bf16 v[232:235], v[120:123], a[92:95], v[232:235]
buffer_load_dwordx4 v18, s[16:19], s50 offen offset:256 nt lds
v_cvt_pk_bf16_f32 v165, v170, v171
v_accvgpr_write_b32 a244, v164
v_exp_f32 v174, v174
v_mfma_f32_16x16x32_bf16 v[240:243], v[4:7], a[96:99], 0
v_exp_f32 v175, v175
v_mfma_f32_16x16x32_bf16 v[240:243], v[12:15], a[100:103], v[240:243]
v_cvt_pk_bf16_f32 v166, v172, v173
v_accvgpr_write_b32 a245, v165
v_mfma_f32_16x16x32_bf16 v[240:243], v[28:31], a[112:115], v[240:243]
v_cvt_pk_bf16_f32 v167, v174, v175
v_accvgpr_write_b32 a246, v166
v_mfma_f32_16x16x32_bf16 v[240:243], v[8:11], a[116:119], v[240:243]
v_accvgpr_write_b32 a247, v167
v_fma_f32 v176, v176, s44, v22
v_fma_f32 v177, v177, s44, v22
v_mfma_f32_16x16x32_bf16 v[240:243], v[0:3], a[128:131], v[240:243]
v_fma_f32 v178, v178, s44, v22
v_exp_f32 v176, v176
v_mfma_f32_16x16x32_bf16 v[240:243], v[120:123], a[132:135], v[240:243]
v_fma_f32 v179, v179, s44, v22
v_exp_f32 v177, v177
v_mfma_f32_16x16x32_bf16 v[248:251], v[4:7], a[104:107], 0
v_fma_f32 v180, v180, s44, v22
v_exp_f32 v178, v178
v_mfma_f32_16x16x32_bf16 v[248:251], v[12:15], a[108:111], v[248:251]
v_fma_f32 v181, v181, s44, v22
v_mfma_f32_16x16x32_bf16 v[248:251], v[28:31], a[120:123], v[248:251]
v_exp_f32 v179, v179
v_fma_f32 v182, v182, s44, v22
v_mfma_f32_16x16x32_bf16 v[248:251], v[8:11], a[124:127], v[248:251]
s_add_u32 m0, s47, 12288
v_cvt_pk_bf16_f32 v176, v176, v177
v_exp_f32 v180, v180
v_mfma_f32_16x16x32_bf16 v[248:251], v[0:3], a[136:139], v[248:251]
s_add_u32 s50, s85, 0
v_fma_f32 v183, v183, s44, v22
v_exp_f32 v181, v181
v_mfma_f32_16x16x32_bf16 v[248:251], v[120:123], a[140:143], v[248:251]
s_waitcnt lgkmcnt(5)
buffer_load_dwordx4 v19, s[20:23], s50 offen nt lds
v_fma_f32 v184, v184, s44, v23
v_mfma_f32_16x16x32_bf16 v[212:215], v[156:159], a[0:3], 0
s_waitcnt lgkmcnt(4)
v_cvt_pk_bf16_f32 v177, v178, v179
v_accvgpr_write_b32 a248, v176
v_exp_f32 v182, v182
v_mfma_f32_16x16x32_bf16 v[212:215], v[116:119], a[4:7], v[212:215]
s_waitcnt lgkmcnt(3)
v_fma_f32 v185, v185, s44, v23
v_mfma_f32_16x16x32_bf16 v[212:215], v[136:139], a[16:19], v[212:215]
s_waitcnt lgkmcnt(2)
v_exp_f32 v183, v183
v_fma_f32 v186, v186, s44, v23
v_mfma_f32_16x16x32_bf16 v[212:215], v[140:143], a[20:23], v[212:215]
s_waitcnt lgkmcnt(1)
v_cvt_pk_bf16_f32 v178, v180, v181
v_accvgpr_write_b32 a249, v177
v_exp_f32 v184, v184
v_mfma_f32_16x16x32_bf16 v[212:215], v[112:115], a[32:35], v[212:215]
s_waitcnt lgkmcnt(0)
v_fma_f32 v187, v187, s44, v23
v_mfma_f32_16x16x32_bf16 v[212:215], v[152:155], a[36:39], v[212:215]
v_exp_f32 v185, v185
v_fma_f32 v188, v188, s44, v23
v_mfma_f32_16x16x32_bf16 v[220:223], v[156:159], a[8:11], 0
v_cvt_pk_bf16_f32 v179, v182, v183
v_accvgpr_write_b32 a250, v178
v_mfma_f32_16x16x32_bf16 v[220:223], v[116:119], a[12:15], v[220:223]
v_exp_f32 v186, v186
v_fma_f32 v189, v189, s44, v23
v_mfma_f32_16x16x32_bf16 v[220:223], v[136:139], a[24:27], v[220:223]
v_exp_f32 v187, v187
v_mfma_f32_16x16x32_bf16 v[220:223], v[140:143], a[28:31], v[220:223]
s_waitcnt vmcnt(17)
s_barrier
v_fma_f32 v190, v190, s44, v23
v_cvt_pk_bf16_f32 v180, v184, v185
v_accvgpr_write_b32 a251, v179
v_mfma_f32_16x16x32_bf16 v[220:223], v[112:115], a[40:43], v[220:223]
s_add_u32 m0, s47, 13312
v_exp_f32 v188, v188
v_mfma_f32_16x16x32_bf16 v[220:223], v[152:155], a[44:47], v[220:223]
s_add_u32 s50, s85, 3072
ds_read_b128 v[120:123], v16 offset:24576
v_fma_f32 v191, v191, s44, v23
v_exp_f32 v189, v189
v_mfma_f32_16x16x32_bf16 v[228:231], v[156:159], a[48:51], 0
buffer_load_dwordx4 v19, s[20:23], s50 offen nt lds
v_cvt_pk_bf16_f32 v181, v186, v187
v_accvgpr_write_b32 a252, v180
v_exp_f32 v190, v190
v_mfma_f32_16x16x32_bf16 v[228:231], v[116:119], a[52:55], v[228:231]
ds_read_b128 v[0:3], v17 offset:24576
v_exp_f32 v191, v191
v_mfma_f32_16x16x32_bf16 v[228:231], v[136:139], a[64:67], v[228:231]
v_cvt_pk_bf16_f32 v182, v188, v189
v_accvgpr_write_b32 a253, v181
v_mfma_f32_16x16x32_bf16 v[228:231], v[140:143], a[68:71], v[228:231]
ds_read_b128 v[8:11], v16 offset:25600
v_cvt_pk_bf16_f32 v183, v190, v191
v_accvgpr_write_b32 a254, v182
v_mfma_f32_16x16x32_bf16 v[228:231], v[112:115], a[80:83], v[228:231]
v_accvgpr_write_b32 a255, v183
v_fma_f32 v192, v192, s44, v24
v_fma_f32 v193, v193, s44, v24
v_mfma_f32_16x16x32_bf16 v[228:231], v[152:155], a[84:87], v[228:231]
ds_read_b128 v[28:31], v17 offset:25600
v_fma_f32 v194, v194, s44, v24
v_exp_f32 v192, v192
v_mfma_f32_16x16x32_bf16 v[236:239], v[156:159], a[56:59], 0
v_fma_f32 v195, v195, s44, v24
v_exp_f32 v193, v193
v_mfma_f32_16x16x32_bf16 v[236:239], v[116:119], a[60:63], v[236:239]
ds_read_b128 v[12:15], v16 offset:26624
v_fma_f32 v196, v196, s44, v24
v_mfma_f32_16x16x32_bf16 v[236:239], v[136:139], a[72:75], v[236:239]
v_exp_f32 v194, v194
v_fma_f32 v197, v197, s44, v24
v_mfma_f32_16x16x32_bf16 v[236:239], v[140:143], a[76:79], v[236:239]
s_add_u32 m0, s47, 14336
ds_read_b128 v[4:7], v17 offset:26624
v_exp_f32 v195, v195
v_fma_f32 v198, v198, s44, v24
v_mfma_f32_16x16x32_bf16 v[236:239], v[112:115], a[88:91], v[236:239]
s_add_u32 s50, s85, 6144
v_cvt_pk_bf16_f32 v32, v192, v193
v_exp_f32 v196, v196
v_mfma_f32_16x16x32_bf16 v[236:239], v[152:155], a[92:95], v[236:239]
buffer_load_dwordx4 v19, s[20:23], s50 offen nt lds
v_fma_f32 v199, v199, s44, v24
v_exp_f32 v197, v197
v_mfma_f32_16x16x32_bf16 v[244:247], v[156:159], a[96:99], 0
v_fma_f32 v200, v200, s44, v25
v_mfma_f32_16x16x32_bf16 v[244:247], v[116:119], a[100:103], v[244:247]
v_cvt_pk_bf16_f32 v33, v194, v195
v_exp_f32 v198, v198
v_mfma_f32_16x16x32_bf16 v[244:247], v[136:139], a[112:115], v[244:247]
v_fma_f32 v201, v201, s44, v25
v_exp_f32 v199, v199
v_mfma_f32_16x16x32_bf16 v[244:247], v[140:143], a[116:119], v[244:247]
v_fma_f32 v202, v202, s44, v25
v_cvt_pk_bf16_f32 v34, v196, v197
v_mfma_f32_16x16x32_bf16 v[244:247], v[112:115], a[128:131], v[244:247]
v_exp_f32 v200, v200
v_mfma_f32_16x16x32_bf16 v[244:247], v[152:155], a[132:135], v[244:247]
v_fma_f32 v203, v203, s44, v25
v_exp_f32 v201, v201
v_mfma_f32_16x16x32_bf16 v[252:255], v[156:159], a[104:107], 0
v_fma_f32 v204, v204, s44, v25
v_cvt_pk_bf16_f32 v35, v198, v199
v_exp_f32 v202, v202
v_mfma_f32_16x16x32_bf16 v[252:255], v[116:119], a[108:111], v[252:255]
v_fma_f32 v205, v205, s44, v25
v_mfma_f32_16x16x32_bf16 v[252:255], v[136:139], a[120:123], v[252:255]
v_exp_f32 v203, v203
v_fma_f32 v206, v206, s44, v25
v_mfma_f32_16x16x32_bf16 v[252:255], v[140:143], a[124:127], v[252:255]
s_add_u32 m0, s47, 0
v_cvt_pk_bf16_f32 v36, v200, v201
v_exp_f32 v204, v204
v_mfma_f32_16x16x32_bf16 v[252:255], v[112:115], a[136:139], v[252:255]
s_add_u32 s50, s84, 0
v_fma_f32 v207, v207, s44, v25
v_exp_f32 v205, v205
v_mfma_f32_16x16x32_bf16 v[252:255], v[152:155], a[140:143], v[252:255]
s_waitcnt lgkmcnt(5)
buffer_load_dwordx4 v19, s[20:23], s50 offen nt lds
v_cvt_pk_bf16_f32 v37, v202, v203
v_mfma_f32_16x16x32_bf16 v[160:163], v[120:123], a[0:3], 0
s_waitcnt lgkmcnt(4)
v_exp_f32 v206, v206
v_exp_f32 v207, v207
v_mfma_f32_16x16x32_bf16 v[160:163], v[0:3], a[4:7], v[160:163]
s_waitcnt lgkmcnt(3)
v_cvt_pk_bf16_f32 v38, v204, v205
v_mfma_f32_16x16x32_bf16 v[160:163], v[8:11], a[16:19], v[160:163]
s_waitcnt lgkmcnt(2)
v_cvt_pk_bf16_f32 v39, v206, v207
v_fma_f32 v208, v208, s44, v20
v_fma_f32 v209, v209, s44, v20
v_mfma_f32_16x16x32_bf16 v[160:163], v[28:31], a[20:23], v[160:163]
s_waitcnt lgkmcnt(1)
v_fma_f32 v210, v210, s44, v20
v_exp_f32 v208, v208
v_mfma_f32_16x16x32_bf16 v[160:163], v[12:15], a[32:35], v[160:163]
s_waitcnt lgkmcnt(0)
v_fma_f32 v211, v211, s44, v20
v_exp_f32 v209, v209
v_mfma_f32_16x16x32_bf16 v[160:163], v[4:7], a[36:39], v[160:163]
v_fma_f32 v212, v212, s44, v20
v_mfma_f32_16x16x32_bf16 v[168:171], v[120:123], a[8:11], 0
v_exp_f32 v210, v210
v_mfma_f32_16x16x32_bf16 v[168:171], v[0:3], a[12:15], v[168:171]
v_fma_f32 v213, v213, s44, v20
v_exp_f32 v211, v211
v_mfma_f32_16x16x32_bf16 v[168:171], v[8:11], a[24:27], v[168:171]
v_fma_f32 v214, v214, s44, v20
v_cvt_pk_bf16_f32 v40, v208, v209
v_mfma_f32_16x16x32_bf16 v[168:171], v[28:31], a[28:31], v[168:171]
s_add_u32 m0, s47, 1024
v_exp_f32 v212, v212
v_mfma_f32_16x16x32_bf16 v[168:171], v[12:15], a[40:43], v[168:171]
s_add_u32 s50, s84, 3072
v_fma_f32 v215, v215, s44, v20
v_exp_f32 v213, v213
v_mfma_f32_16x16x32_bf16 v[168:171], v[4:7], a[44:47], v[168:171]
ds_read_b128 v[152:155], v16 offset:30720
v_fma_f32 v216, v216, s44, v21
v_cvt_pk_bf16_f32 v41, v210, v211
v_mfma_f32_16x16x32_bf16 v[176:179], v[120:123], a[48:51], 0
buffer_load_dwordx4 v19, s[20:23], s50 offen nt lds
v_exp_f32 v214, v214
v_mfma_f32_16x16x32_bf16 v[176:179], v[0:3], a[52:55], v[176:179]
ds_read_b128 v[112:115], v17 offset:30720
v_fma_f32 v217, v217, s44, v21
v_exp_f32 v215, v215
v_mfma_f32_16x16x32_bf16 v[176:179], v[8:11], a[64:67], v[176:179]
v_fma_f32 v218, v218, s44, v21
v_cvt_pk_bf16_f32 v42, v212, v213
v_mfma_f32_16x16x32_bf16 v[176:179], v[28:31], a[68:71], v[176:179]
ds_read_b128 v[140:143], v16 offset:31744
v_exp_f32 v216, v216
v_mfma_f32_16x16x32_bf16 v[176:179], v[12:15], a[80:83], v[176:179]
v_fma_f32 v219, v219, s44, v21
v_exp_f32 v217, v217
v_mfma_f32_16x16x32_bf16 v[176:179], v[4:7], a[84:87], v[176:179]
ds_read_b128 v[136:139], v17 offset:31744
v_fma_f32 v220, v220, s44, v21
v_cvt_pk_bf16_f32 v43, v214, v215
v_mfma_f32_16x16x32_bf16 v[184:187], v[120:123], a[56:59], 0
v_exp_f32 v218, v218
v_mfma_f32_16x16x32_bf16 v[184:187], v[0:3], a[60:63], v[184:187]
ds_read_b128 v[116:119], v16 offset:32768
v_fma_f32 v221, v221, s44, v21
v_exp_f32 v219, v219
v_mfma_f32_16x16x32_bf16 v[184:187], v[8:11], a[72:75], v[184:187]
v_fma_f32 v222, v222, s44, v21
v_cvt_pk_bf16_f32 v44, v216, v217
v_mfma_f32_16x16x32_bf16 v[184:187], v[28:31], a[76:79], v[184:187]
s_add_u32 m0, s47, 2048
ds_read_b128 v[156:159], v17 offset:32768
v_exp_f32 v220, v220
v_mfma_f32_16x16x32_bf16 v[184:187], v[12:15], a[88:91], v[184:187]
s_add_u32 s50, s84, 6144
v_fma_f32 v223, v223, s44, v21
v_exp_f32 v221, v221
v_mfma_f32_16x16x32_bf16 v[184:187], v[4:7], a[92:95], v[184:187]
buffer_load_dwordx4 v19, s[20:23], s50 offen nt lds
v_cvt_pk_bf16_f32 v45, v218, v219
v_exp_f32 v222, v222
v_mfma_f32_16x16x32_bf16 v[192:195], v[120:123], a[96:99], 0
v_exp_f32 v223, v223
v_mfma_f32_16x16x32_bf16 v[192:195], v[0:3], a[100:103], v[192:195]
v_cvt_pk_bf16_f32 v46, v220, v221
v_cvt_pk_bf16_f32 v47, v222, v223
v_mfma_f32_16x16x32_bf16 v[192:195], v[8:11], a[112:115], v[192:195]
v_fma_f32 v224, v224, s44, v22
v_fma_f32 v225, v225, s44, v22
v_mfma_f32_16x16x32_bf16 v[192:195], v[28:31], a[116:119], v[192:195]
v_fma_f32 v226, v226, s44, v22
v_exp_f32 v224, v224
v_mfma_f32_16x16x32_bf16 v[192:195], v[12:15], a[128:131], v[192:195]
v_fma_f32 v227, v227, s44, v22
v_exp_f32 v225, v225
v_mfma_f32_16x16x32_bf16 v[192:195], v[4:7], a[132:135], v[192:195]
v_fma_f32 v228, v228, s44, v22
v_mfma_f32_16x16x32_bf16 v[200:203], v[120:123], a[104:107], 0
v_exp_f32 v226, v226
v_mfma_f32_16x16x32_bf16 v[200:203], v[0:3], a[108:111], v[200:203]
v_fma_f32 v229, v229, s44, v22
v_exp_f32 v227, v227
v_mfma_f32_16x16x32_bf16 v[200:203], v[8:11], a[120:123], v[200:203]
v_fma_f32 v230, v230, s44, v22
v_cvt_pk_bf16_f32 v48, v224, v225
v_mfma_f32_16x16x32_bf16 v[200:203], v[28:31], a[124:127], v[200:203]
s_add_u32 m0, s47, 36864
v_exp_f32 v228, v228
v_mfma_f32_16x16x32_bf16 v[200:203], v[12:15], a[136:139], v[200:203]
s_add_u32 s50, s87, 0
v_fma_f32 v231, v231, s44, v22
v_exp_f32 v229, v229
v_mfma_f32_16x16x32_bf16 v[200:203], v[4:7], a[140:143], v[200:203]
s_waitcnt lgkmcnt(5)
buffer_load_dwordx4 v19, s[20:23], s50 offen nt lds
v_fma_f32 v232, v232, s44, v23
v_cvt_pk_bf16_f32 v49, v226, v227
v_mfma_f32_16x16x32_bf16 v[164:167], v[152:155], a[0:3], 0
s_waitcnt lgkmcnt(4)
v_exp_f32 v230, v230
v_mfma_f32_16x16x32_bf16 v[164:167], v[112:115], a[4:7], v[164:167]
s_waitcnt lgkmcnt(3)
v_fma_f32 v233, v233, s44, v23
v_exp_f32 v231, v231
v_mfma_f32_16x16x32_bf16 v[164:167], v[140:143], a[16:19], v[164:167]
s_waitcnt lgkmcnt(2)
v_fma_f32 v234, v234, s44, v23
v_cvt_pk_bf16_f32 v50, v228, v229
v_mfma_f32_16x16x32_bf16 v[164:167], v[136:139], a[20:23], v[164:167]
s_waitcnt lgkmcnt(1)
v_exp_f32 v232, v232
v_mfma_f32_16x16x32_bf16 v[164:167], v[116:119], a[32:35], v[164:167]
s_waitcnt lgkmcnt(0)
v_fma_f32 v235, v235, s44, v23
v_exp_f32 v233, v233
v_mfma_f32_16x16x32_bf16 v[164:167], v[156:159], a[36:39], v[164:167]
v_fma_f32 v236, v236, s44, v23
v_cvt_pk_bf16_f32 v51, v230, v231
v_mfma_f32_16x16x32_bf16 v[172:175], v[152:155], a[8:11], 0
v_exp_f32 v234, v234
v_mfma_f32_16x16x32_bf16 v[172:175], v[112:115], a[12:15], v[172:175]
v_fma_f32 v237, v237, s44, v23
v_exp_f32 v235, v235
v_mfma_f32_16x16x32_bf16 v[172:175], v[140:143], a[24:27], v[172:175]
v_fma_f32 v238, v238, s44, v23
v_cvt_pk_bf16_f32 v52, v232, v233
v_mfma_f32_16x16x32_bf16 v[172:175], v[136:139], a[28:31], v[172:175]
s_waitcnt vmcnt(20)
s_barrier
v_exp_f32 v236, v236
v_mfma_f32_16x16x32_bf16 v[172:175], v[116:119], a[40:43], v[172:175]
s_add_u32 m0, s47, 37888
v_fma_f32 v239, v239, s44, v23
v_exp_f32 v237, v237
v_mfma_f32_16x16x32_bf16 v[172:175], v[156:159], a[44:47], v[172:175]
s_add_u32 s50, s87, 3072
ds_read_b128 v[4:7], v16 offset:36864
v_cvt_pk_bf16_f32 v53, v234, v235
v_exp_f32 v238, v238
v_mfma_f32_16x16x32_bf16 v[180:183], v[152:155], a[48:51], 0
buffer_load_dwordx4 v19, s[20:23], s50 offen nt lds
v_exp_f32 v239, v239
v_mfma_f32_16x16x32_bf16 v[180:183], v[112:115], a[52:55], v[180:183]
ds_read_b128 v[12:15], v17 offset:36864
v_cvt_pk_bf16_f32 v54, v236, v237
v_cvt_pk_bf16_f32 v55, v238, v239
v_mfma_f32_16x16x32_bf16 v[180:183], v[140:143], a[64:67], v[180:183]
v_fma_f32 v240, v240, s44, v24
v_fma_f32 v241, v241, s44, v24
v_mfma_f32_16x16x32_bf16 v[180:183], v[136:139], a[68:71], v[180:183]
ds_read_b128 v[28:31], v16 offset:37888
v_fma_f32 v242, v242, s44, v24
v_exp_f32 v240, v240
v_mfma_f32_16x16x32_bf16 v[180:183], v[116:119], a[80:83], v[180:183]
v_fma_f32 v243, v243, s44, v24
v_exp_f32 v241, v241
v_mfma_f32_16x16x32_bf16 v[180:183], v[156:159], a[84:87], v[180:183]
ds_read_b128 v[8:11], v17 offset:37888
v_fma_f32 v244, v244, s44, v24
v_mfma_f32_16x16x32_bf16 v[188:191], v[152:155], a[56:59], 0
v_exp_f32 v242, v242
v_mfma_f32_16x16x32_bf16 v[188:191], v[112:115], a[60:63], v[188:191]
ds_read_b128 v[0:3], v16 offset:38912
v_fma_f32 v245, v245, s44, v24
v_exp_f32 v243, v243
v_mfma_f32_16x16x32_bf16 v[188:191], v[140:143], a[72:75], v[188:191]
v_fma_f32 v246, v246, s44, v24
v_cvt_pk_bf16_f32 v56, v240, v241
v_mfma_f32_16x16x32_bf16 v[188:191], v[136:139], a[76:79], v[188:191]
s_add_u32 m0, s47, 38912
ds_read_b128 v[120:123], v17 offset:38912
v_exp_f32 v244, v244
v_mfma_f32_16x16x32_bf16 v[188:191], v[116:119], a[88:91], v[188:191]
s_add_u32 s50, s87, 6144
v_fma_f32 v247, v247, s44, v24
v_exp_f32 v245, v245
v_mfma_f32_16x16x32_bf16 v[188:191], v[156:159], a[92:95], v[188:191]
buffer_load_dwordx4 v19, s[20:23], s50 offen nt lds
v_fma_f32 v248, v248, s44, v25
v_cvt_pk_bf16_f32 v57, v242, v243
v_mfma_f32_16x16x32_bf16 v[196:199], v[152:155], a[96:99], 0
v_exp_f32 v246, v246
v_mfma_f32_16x16x32_bf16 v[196:199], v[112:115], a[100:103], v[196:199]
v_fma_f32 v249, v249, s44, v25
v_exp_f32 v247, v247
v_mfma_f32_16x16x32_bf16 v[196:199], v[140:143], a[112:115], v[196:199]
v_fma_f32 v250, v250, s44, v25
v_cvt_pk_bf16_f32 v58, v244, v245
v_mfma_f32_16x16x32_bf16 v[196:199], v[136:139], a[116:119], v[196:199]
v_exp_f32 v248, v248
v_mfma_f32_16x16x32_bf16 v[196:199], v[116:119], a[128:131], v[196:199]
v_fma_f32 v251, v251, s44, v25
v_exp_f32 v249, v249
v_mfma_f32_16x16x32_bf16 v[196:199], v[156:159], a[132:135], v[196:199]
v_fma_f32 v252, v252, s44, v25
v_cvt_pk_bf16_f32 v59, v246, v247
v_mfma_f32_16x16x32_bf16 v[204:207], v[152:155], a[104:107], 0
v_exp_f32 v250, v250
v_mfma_f32_16x16x32_bf16 v[204:207], v[112:115], a[108:111], v[204:207]
v_fma_f32 v253, v253, s44, v25
v_exp_f32 v251, v251
v_mfma_f32_16x16x32_bf16 v[204:207], v[140:143], a[120:123], v[204:207]
v_fma_f32 v254, v254, s44, v25
v_cvt_pk_bf16_f32 v60, v248, v249
v_mfma_f32_16x16x32_bf16 v[204:207], v[136:139], a[124:127], v[204:207]
s_add_u32 m0, s47, 24576
v_exp_f32 v252, v252
v_mfma_f32_16x16x32_bf16 v[204:207], v[116:119], a[136:139], v[204:207]
s_add_u32 s50, s86, 0
v_fma_f32 v255, v255, s44, v25
v_exp_f32 v253, v253
v_mfma_f32_16x16x32_bf16 v[204:207], v[156:159], a[140:143], v[204:207]
s_waitcnt lgkmcnt(5)
buffer_load_dwordx4 v19, s[20:23], s50 offen nt lds
v_cvt_pk_bf16_f32 v61, v250, v251
v_exp_f32 v254, v254
v_mfma_f32_16x16x32_bf16 v[208:211], v[4:7], a[0:3], 0
s_waitcnt lgkmcnt(4)
v_exp_f32 v255, v255
v_mfma_f32_16x16x32_bf16 v[208:211], v[12:15], a[4:7], v[208:211]
s_waitcnt lgkmcnt(3)
v_cvt_pk_bf16_f32 v62, v252, v253
v_cvt_pk_bf16_f32 v63, v254, v255
v_mfma_f32_16x16x32_bf16 v[208:211], v[28:31], a[16:19], v[208:211]
s_waitcnt lgkmcnt(2)
v_fma_f32 v160, v160, s44, v20
v_fma_f32 v161, v161, s44, v20
v_mfma_f32_16x16x32_bf16 v[208:211], v[8:11], a[20:23], v[208:211]
s_waitcnt lgkmcnt(1)
v_fma_f32 v162, v162, s44, v20
v_exp_f32 v160, v160
v_mfma_f32_16x16x32_bf16 v[208:211], v[0:3], a[32:35], v[208:211]
s_waitcnt lgkmcnt(0)
v_fma_f32 v163, v163, s44, v20
v_exp_f32 v161, v161
v_mfma_f32_16x16x32_bf16 v[208:211], v[120:123], a[36:39], v[208:211]
v_fma_f32 v164, v164, s44, v20
v_mfma_f32_16x16x32_bf16 v[216:219], v[4:7], a[8:11], 0
v_exp_f32 v162, v162
v_mfma_f32_16x16x32_bf16 v[216:219], v[12:15], a[12:15], v[216:219]
v_fma_f32 v165, v165, s44, v20
v_exp_f32 v163, v163
v_mfma_f32_16x16x32_bf16 v[216:219], v[28:31], a[24:27], v[216:219]
v_fma_f32 v166, v166, s44, v20
v_cvt_pk_bf16_f32 v64, v160, v161
v_mfma_f32_16x16x32_bf16 v[216:219], v[8:11], a[28:31], v[216:219]
s_add_u32 m0, s47, 25600
v_exp_f32 v164, v164
v_mfma_f32_16x16x32_bf16 v[216:219], v[0:3], a[40:43], v[216:219]
s_add_u32 s50, s86, 3072
v_fma_f32 v167, v167, s44, v20
v_exp_f32 v165, v165
v_mfma_f32_16x16x32_bf16 v[216:219], v[120:123], a[44:47], v[216:219]
ds_read_b128 v[156:159], v16 offset:43008
v_fma_f32 v168, v168, s44, v21
v_cvt_pk_bf16_f32 v65, v162, v163
v_mfma_f32_16x16x32_bf16 v[224:227], v[4:7], a[48:51], 0
buffer_load_dwordx4 v19, s[20:23], s50 offen nt lds
v_exp_f32 v166, v166
v_mfma_f32_16x16x32_bf16 v[224:227], v[12:15], a[52:55], v[224:227]
ds_read_b128 v[116:119], v17 offset:43008
v_fma_f32 v169, v169, s44, v21
v_exp_f32 v167, v167
v_mfma_f32_16x16x32_bf16 v[224:227], v[28:31], a[64:67], v[224:227]
v_fma_f32 v170, v170, s44, v21
v_cvt_pk_bf16_f32 v66, v164, v165
v_mfma_f32_16x16x32_bf16 v[224:227], v[8:11], a[68:71], v[224:227]
ds_read_b128 v[136:139], v16 offset:44032
v_exp_f32 v168, v168
v_mfma_f32_16x16x32_bf16 v[224:227], v[0:3], a[80:83], v[224:227]
v_fma_f32 v171, v171, s44, v21
v_exp_f32 v169, v169
v_mfma_f32_16x16x32_bf16 v[224:227], v[120:123], a[84:87], v[224:227]
ds_read_b128 v[140:143], v17 offset:44032
v_fma_f32 v172, v172, s44, v21
v_cvt_pk_bf16_f32 v67, v166, v167
v_mfma_f32_16x16x32_bf16 v[232:235], v[4:7], a[56:59], 0
v_exp_f32 v170, v170
v_mfma_f32_16x16x32_bf16 v[232:235], v[12:15], a[60:63], v[232:235]
ds_read_b128 v[112:115], v16 offset:45056
v_fma_f32 v173, v173, s44, v21
v_exp_f32 v171, v171
v_mfma_f32_16x16x32_bf16 v[232:235], v[28:31], a[72:75], v[232:235]
v_fma_f32 v174, v174, s44, v21
v_cvt_pk_bf16_f32 v68, v168, v169
v_mfma_f32_16x16x32_bf16 v[232:235], v[8:11], a[76:79], v[232:235]
s_add_u32 m0, s47, 26624
ds_read_b128 v[152:155], v17 offset:45056
v_exp_f32 v172, v172
v_mfma_f32_16x16x32_bf16 v[232:235], v[0:3], a[88:91], v[232:235]
s_add_u32 s50, s86, 6144
v_fma_f32 v175, v175, s44, v21
v_exp_f32 v173, v173
v_mfma_f32_16x16x32_bf16 v[232:235], v[120:123], a[92:95], v[232:235]
buffer_load_dwordx4 v19, s[20:23], s50 offen nt lds
v_cvt_pk_bf16_f32 v69, v170, v171
v_exp_f32 v174, v174
v_mfma_f32_16x16x32_bf16 v[240:243], v[4:7], a[96:99], 0
v_exp_f32 v175, v175
v_mfma_f32_16x16x32_bf16 v[240:243], v[12:15], a[100:103], v[240:243]
v_cvt_pk_bf16_f32 v70, v172, v173
v_cvt_pk_bf16_f32 v71, v174, v175
v_mfma_f32_16x16x32_bf16 v[240:243], v[28:31], a[112:115], v[240:243]
v_fma_f32 v176, v176, s44, v22
v_fma_f32 v177, v177, s44, v22
v_mfma_f32_16x16x32_bf16 v[240:243], v[8:11], a[116:119], v[240:243]
v_fma_f32 v178, v178, s44, v22
v_exp_f32 v176, v176
v_mfma_f32_16x16x32_bf16 v[240:243], v[0:3], a[128:131], v[240:243]
v_fma_f32 v179, v179, s44, v22
v_exp_f32 v177, v177
v_mfma_f32_16x16x32_bf16 v[240:243], v[120:123], a[132:135], v[240:243]
v_fma_f32 v180, v180, s44, v22
v_mfma_f32_16x16x32_bf16 v[248:251], v[4:7], a[104:107], 0
v_exp_f32 v178, v178
v_mfma_f32_16x16x32_bf16 v[248:251], v[12:15], a[108:111], v[248:251]
v_fma_f32 v181, v181, s44, v22
v_exp_f32 v179, v179
v_mfma_f32_16x16x32_bf16 v[248:251], v[28:31], a[120:123], v[248:251]
v_fma_f32 v182, v182, s44, v22
v_cvt_pk_bf16_f32 v72, v176, v177
v_mfma_f32_16x16x32_bf16 v[248:251], v[8:11], a[124:127], v[248:251]
s_add_u32 m0, s47, 73728
v_exp_f32 v180, v180
v_mfma_f32_16x16x32_bf16 v[248:251], v[0:3], a[136:139], v[248:251]
s_add_u32 s50, s86, 128
v_fma_f32 v183, v183, s44, v22
v_exp_f32 v181, v181
v_mfma_f32_16x16x32_bf16 v[248:251], v[120:123], a[140:143], v[248:251]
s_waitcnt lgkmcnt(5)
buffer_load_dwordx4 v19, s[20:23], s50 offen nt lds
v_fma_f32 v184, v184, s44, v23
v_cvt_pk_bf16_f32 v73, v178, v179
v_mfma_f32_16x16x32_bf16 v[212:215], v[156:159], a[0:3], 0
s_waitcnt lgkmcnt(4)
v_exp_f32 v182, v182
v_mfma_f32_16x16x32_bf16 v[212:215], v[116:119], a[4:7], v[212:215]
s_waitcnt lgkmcnt(3)
v_fma_f32 v185, v185, s44, v23
v_exp_f32 v183, v183
v_mfma_f32_16x16x32_bf16 v[212:215], v[136:139], a[16:19], v[212:215]
s_waitcnt lgkmcnt(2)
v_fma_f32 v186, v186, s44, v23
v_cvt_pk_bf16_f32 v74, v180, v181
v_mfma_f32_16x16x32_bf16 v[212:215], v[140:143], a[20:23], v[212:215]
s_waitcnt lgkmcnt(1)
v_exp_f32 v184, v184
v_mfma_f32_16x16x32_bf16 v[212:215], v[112:115], a[32:35], v[212:215]
s_waitcnt lgkmcnt(0)
v_fma_f32 v187, v187, s44, v23
v_exp_f32 v185, v185
v_mfma_f32_16x16x32_bf16 v[212:215], v[152:155], a[36:39], v[212:215]
v_fma_f32 v188, v188, s44, v23
v_cvt_pk_bf16_f32 v75, v182, v183
v_mfma_f32_16x16x32_bf16 v[220:223], v[156:159], a[8:11], 0
v_exp_f32 v186, v186
v_mfma_f32_16x16x32_bf16 v[220:223], v[116:119], a[12:15], v[220:223]
v_fma_f32 v189, v189, s44, v23
v_exp_f32 v187, v187
v_mfma_f32_16x16x32_bf16 v[220:223], v[136:139], a[24:27], v[220:223]
v_fma_f32 v190, v190, s44, v23
v_cvt_pk_bf16_f32 v76, v184, v185
v_mfma_f32_16x16x32_bf16 v[220:223], v[140:143], a[28:31], v[220:223]
s_waitcnt vmcnt(23)
s_barrier
v_add_u32 v16, 0xc000, v16
v_exp_f32 v188, v188
v_mfma_f32_16x16x32_bf16 v[220:223], v[112:115], a[40:43], v[220:223]
s_add_u32 m0, s47, 74752
v_fma_f32 v191, v191, s44, v23
v_exp_f32 v189, v189
v_mfma_f32_16x16x32_bf16 v[220:223], v[152:155], a[44:47], v[220:223]
s_add_u32 s50, s86, 3200
ds_read_b128 v[120:123], v16 offset:0
v_add_u32 v17, 0xc000, v17
v_cvt_pk_bf16_f32 v77, v186, v187
v_exp_f32 v190, v190
v_mfma_f32_16x16x32_bf16 v[228:231], v[156:159], a[48:51], 0
buffer_load_dwordx4 v19, s[20:23], s50 offen nt lds
v_exp_f32 v191, v191
v_mfma_f32_16x16x32_bf16 v[228:231], v[116:119], a[52:55], v[228:231]
ds_read_b128 v[0:3], v17 offset:0
v_cvt_pk_bf16_f32 v78, v188, v189
v_cvt_pk_bf16_f32 v79, v190, v191
v_mfma_f32_16x16x32_bf16 v[228:231], v[136:139], a[64:67], v[228:231]
v_fma_f32 v192, v192, s44, v24
v_fma_f32 v193, v193, s44, v24
v_mfma_f32_16x16x32_bf16 v[228:231], v[140:143], a[68:71], v[228:231]
ds_read_b128 v[8:11], v16 offset:1024
v_fma_f32 v194, v194, s44, v24
v_exp_f32 v192, v192
v_mfma_f32_16x16x32_bf16 v[228:231], v[112:115], a[80:83], v[228:231]
v_fma_f32 v195, v195, s44, v24
v_exp_f32 v193, v193
v_mfma_f32_16x16x32_bf16 v[228:231], v[152:155], a[84:87], v[228:231]
ds_read_b128 v[28:31], v17 offset:1024
v_fma_f32 v196, v196, s44, v24
v_mfma_f32_16x16x32_bf16 v[236:239], v[156:159], a[56:59], 0
v_exp_f32 v194, v194
v_mfma_f32_16x16x32_bf16 v[236:239], v[116:119], a[60:63], v[236:239]
ds_read_b128 v[12:15], v16 offset:2048
v_fma_f32 v197, v197, s44, v24
v_exp_f32 v195, v195
v_mfma_f32_16x16x32_bf16 v[236:239], v[136:139], a[72:75], v[236:239]
v_fma_f32 v198, v198, s44, v24
v_cvt_pk_bf16_f32 v80, v192, v193
v_mfma_f32_16x16x32_bf16 v[236:239], v[140:143], a[76:79], v[236:239]
s_add_u32 m0, s47, 75776
ds_read_b128 v[4:7], v17 offset:2048
v_exp_f32 v196, v196
v_mfma_f32_16x16x32_bf16 v[236:239], v[112:115], a[88:91], v[236:239]
s_add_u32 s50, s86, 6272
v_fma_f32 v199, v199, s44, v24
v_exp_f32 v197, v197
v_mfma_f32_16x16x32_bf16 v[236:239], v[152:155], a[92:95], v[236:239]
buffer_load_dwordx4 v19, s[20:23], s50 offen nt lds
v_fma_f32 v200, v200, s44, v25
v_cvt_pk_bf16_f32 v81, v194, v195
v_mfma_f32_16x16x32_bf16 v[244:247], v[156:159], a[96:99], 0
v_exp_f32 v198, v198
v_mfma_f32_16x16x32_bf16 v[244:247], v[116:119], a[100:103], v[244:247]
v_fma_f32 v201, v201, s44, v25
v_exp_f32 v199, v199
v_mfma_f32_16x16x32_bf16 v[244:247], v[136:139], a[112:115], v[244:247]
v_fma_f32 v202, v202, s44, v25
v_cvt_pk_bf16_f32 v82, v196, v197
v_mfma_f32_16x16x32_bf16 v[244:247], v[140:143], a[116:119], v[244:247]
v_exp_f32 v200, v200
v_mfma_f32_16x16x32_bf16 v[244:247], v[112:115], a[128:131], v[244:247]
v_fma_f32 v203, v203, s44, v25
v_exp_f32 v201, v201
v_mfma_f32_16x16x32_bf16 v[244:247], v[152:155], a[132:135], v[244:247]
v_fma_f32 v204, v204, s44, v25
v_cvt_pk_bf16_f32 v83, v198, v199
v_mfma_f32_16x16x32_bf16 v[252:255], v[156:159], a[104:107], 0
v_exp_f32 v202, v202
v_mfma_f32_16x16x32_bf16 v[252:255], v[116:119], a[108:111], v[252:255]
v_fma_f32 v205, v205, s44, v25
v_exp_f32 v203, v203
v_mfma_f32_16x16x32_bf16 v[252:255], v[136:139], a[120:123], v[252:255]
v_fma_f32 v206, v206, s44, v25
v_cvt_pk_bf16_f32 v84, v200, v201
v_mfma_f32_16x16x32_bf16 v[252:255], v[140:143], a[124:127], v[252:255]
s_add_u32 m0, s47, 86016
v_exp_f32 v204, v204
v_mfma_f32_16x16x32_bf16 v[252:255], v[112:115], a[136:139], v[252:255]
s_add_u32 s50, s87, 128
v_fma_f32 v207, v207, s44, v25
v_exp_f32 v205, v205
v_mfma_f32_16x16x32_bf16 v[252:255], v[152:155], a[140:143], v[252:255]
s_waitcnt lgkmcnt(5)
buffer_load_dwordx4 v19, s[20:23], s50 offen nt lds
v_cvt_pk_bf16_f32 v85, v202, v203
v_exp_f32 v206, v206
v_mfma_f32_16x16x32_bf16 v[160:163], v[120:123], a[0:3], 0
s_waitcnt lgkmcnt(4)
v_exp_f32 v207, v207
v_mfma_f32_16x16x32_bf16 v[160:163], v[0:3], a[4:7], v[160:163]
s_waitcnt lgkmcnt(3)
v_cvt_pk_bf16_f32 v86, v204, v205
v_cvt_pk_bf16_f32 v87, v206, v207
v_mfma_f32_16x16x32_bf16 v[160:163], v[8:11], a[16:19], v[160:163]
s_waitcnt lgkmcnt(2)
v_fma_f32 v208, v208, s44, v20
v_fma_f32 v209, v209, s44, v20
v_mfma_f32_16x16x32_bf16 v[160:163], v[28:31], a[20:23], v[160:163]
s_waitcnt lgkmcnt(1)
v_fma_f32 v210, v210, s44, v20
v_exp_f32 v208, v208
v_mfma_f32_16x16x32_bf16 v[160:163], v[12:15], a[32:35], v[160:163]
s_waitcnt lgkmcnt(0)
v_fma_f32 v211, v211, s44, v20
v_exp_f32 v209, v209
v_mfma_f32_16x16x32_bf16 v[160:163], v[4:7], a[36:39], v[160:163]
v_fma_f32 v212, v212, s44, v20
v_mfma_f32_16x16x32_bf16 v[168:171], v[120:123], a[8:11], 0
v_exp_f32 v210, v210
v_mfma_f32_16x16x32_bf16 v[168:171], v[0:3], a[12:15], v[168:171]
v_fma_f32 v213, v213, s44, v20
v_exp_f32 v211, v211
v_mfma_f32_16x16x32_bf16 v[168:171], v[8:11], a[24:27], v[168:171]
v_fma_f32 v214, v214, s44, v20
v_cvt_pk_bf16_f32 v88, v208, v209
v_mfma_f32_16x16x32_bf16 v[168:171], v[28:31], a[28:31], v[168:171]
s_add_u32 m0, s47, 87040
v_exp_f32 v212, v212
v_mfma_f32_16x16x32_bf16 v[168:171], v[12:15], a[40:43], v[168:171]
s_add_u32 s50, s87, 3200
v_fma_f32 v215, v215, s44, v20
v_exp_f32 v213, v213
v_mfma_f32_16x16x32_bf16 v[168:171], v[4:7], a[44:47], v[168:171]
ds_read_b128 v[152:155], v16 offset:6144
v_fma_f32 v216, v216, s44, v21
v_cvt_pk_bf16_f32 v89, v210, v211
v_mfma_f32_16x16x32_bf16 v[176:179], v[120:123], a[48:51], 0
buffer_load_dwordx4 v19, s[20:23], s50 offen nt lds
v_exp_f32 v214, v214
v_mfma_f32_16x16x32_bf16 v[176:179], v[0:3], a[52:55], v[176:179]
ds_read_b128 v[112:115], v17 offset:6144
v_fma_f32 v217, v217, s44, v21
v_exp_f32 v215, v215
v_mfma_f32_16x16x32_bf16 v[176:179], v[8:11], a[64:67], v[176:179]
v_fma_f32 v218, v218, s44, v21
v_cvt_pk_bf16_f32 v90, v212, v213
v_mfma_f32_16x16x32_bf16 v[176:179], v[28:31], a[68:71], v[176:179]
ds_read_b128 v[140:143], v16 offset:7168
v_exp_f32 v216, v216
v_mfma_f32_16x16x32_bf16 v[176:179], v[12:15], a[80:83], v[176:179]
v_fma_f32 v219, v219, s44, v21
v_exp_f32 v217, v217
v_mfma_f32_16x16x32_bf16 v[176:179], v[4:7], a[84:87], v[176:179]
ds_read_b128 v[136:139], v17 offset:7168
v_fma_f32 v220, v220, s44, v21
v_cvt_pk_bf16_f32 v91, v214, v215
v_mfma_f32_16x16x32_bf16 v[184:187], v[120:123], a[56:59], 0
v_exp_f32 v218, v218
v_mfma_f32_16x16x32_bf16 v[184:187], v[0:3], a[60:63], v[184:187]
ds_read_b128 v[116:119], v16 offset:8192
v_fma_f32 v221, v221, s44, v21
v_exp_f32 v219, v219
v_mfma_f32_16x16x32_bf16 v[184:187], v[8:11], a[72:75], v[184:187]
v_fma_f32 v222, v222, s44, v21
v_cvt_pk_bf16_f32 v92, v216, v217
v_mfma_f32_16x16x32_bf16 v[184:187], v[28:31], a[76:79], v[184:187]
s_add_u32 m0, s47, 88064
ds_read_b128 v[156:159], v17 offset:8192
v_exp_f32 v220, v220
v_mfma_f32_16x16x32_bf16 v[184:187], v[12:15], a[88:91], v[184:187]
s_add_u32 s50, s87, 6272
v_fma_f32 v223, v223, s44, v21
v_exp_f32 v221, v221
v_mfma_f32_16x16x32_bf16 v[184:187], v[4:7], a[92:95], v[184:187]
buffer_load_dwordx4 v19, s[20:23], s50 offen nt lds
v_cvt_pk_bf16_f32 v93, v218, v219
v_exp_f32 v222, v222
v_mfma_f32_16x16x32_bf16 v[192:195], v[120:123], a[96:99], 0
v_exp_f32 v223, v223
v_mfma_f32_16x16x32_bf16 v[192:195], v[0:3], a[100:103], v[192:195]
v_cvt_pk_bf16_f32 v94, v220, v221
v_cvt_pk_bf16_f32 v95, v222, v223
v_mfma_f32_16x16x32_bf16 v[192:195], v[8:11], a[112:115], v[192:195]
v_fma_f32 v224, v224, s44, v22
v_fma_f32 v225, v225, s44, v22
v_mfma_f32_16x16x32_bf16 v[192:195], v[28:31], a[116:119], v[192:195]
v_fma_f32 v226, v226, s44, v22
v_exp_f32 v224, v224
v_mfma_f32_16x16x32_bf16 v[192:195], v[12:15], a[128:131], v[192:195]
v_fma_f32 v227, v227, s44, v22
v_exp_f32 v225, v225
v_mfma_f32_16x16x32_bf16 v[192:195], v[4:7], a[132:135], v[192:195]
v_fma_f32 v228, v228, s44, v22
v_mfma_f32_16x16x32_bf16 v[200:203], v[120:123], a[104:107], 0
v_exp_f32 v226, v226
v_mfma_f32_16x16x32_bf16 v[200:203], v[0:3], a[108:111], v[200:203]
v_fma_f32 v229, v229, s44, v22
v_exp_f32 v227, v227
v_mfma_f32_16x16x32_bf16 v[200:203], v[8:11], a[120:123], v[200:203]
v_fma_f32 v230, v230, s44, v22
v_cvt_pk_bf16_f32 v96, v224, v225
v_mfma_f32_16x16x32_bf16 v[200:203], v[28:31], a[124:127], v[200:203]
s_add_u32 m0, s47, 61440
v_exp_f32 v228, v228
v_mfma_f32_16x16x32_bf16 v[200:203], v[12:15], a[136:139], v[200:203]
s_add_u32 s50, s85, 128
v_fma_f32 v231, v231, s44, v22
v_exp_f32 v229, v229
v_mfma_f32_16x16x32_bf16 v[200:203], v[4:7], a[140:143], v[200:203]
s_waitcnt lgkmcnt(5)
buffer_load_dwordx4 v19, s[20:23], s50 offen nt lds
v_fma_f32 v232, v232, s44, v23
v_cvt_pk_bf16_f32 v97, v226, v227
v_mfma_f32_16x16x32_bf16 v[164:167], v[152:155], a[0:3], 0
s_waitcnt lgkmcnt(4)
v_exp_f32 v230, v230
v_mfma_f32_16x16x32_bf16 v[164:167], v[112:115], a[4:7], v[164:167]
s_waitcnt lgkmcnt(3)
v_fma_f32 v233, v233, s44, v23
v_exp_f32 v231, v231
v_mfma_f32_16x16x32_bf16 v[164:167], v[140:143], a[16:19], v[164:167]
s_waitcnt lgkmcnt(2)
v_fma_f32 v234, v234, s44, v23
v_cvt_pk_bf16_f32 v98, v228, v229
v_mfma_f32_16x16x32_bf16 v[164:167], v[136:139], a[20:23], v[164:167]
s_waitcnt lgkmcnt(1)
v_exp_f32 v232, v232
v_mfma_f32_16x16x32_bf16 v[164:167], v[116:119], a[32:35], v[164:167]
s_waitcnt lgkmcnt(0)
v_fma_f32 v235, v235, s44, v23
v_exp_f32 v233, v233
v_mfma_f32_16x16x32_bf16 v[164:167], v[156:159], a[36:39], v[164:167]
v_fma_f32 v236, v236, s44, v23
v_cvt_pk_bf16_f32 v99, v230, v231
v_mfma_f32_16x16x32_bf16 v[172:175], v[152:155], a[8:11], 0
v_exp_f32 v234, v234
v_mfma_f32_16x16x32_bf16 v[172:175], v[112:115], a[12:15], v[172:175]
v_fma_f32 v237, v237, s44, v23
v_exp_f32 v235, v235
v_mfma_f32_16x16x32_bf16 v[172:175], v[140:143], a[24:27], v[172:175]
v_fma_f32 v238, v238, s44, v23
v_cvt_pk_bf16_f32 v100, v232, v233
v_mfma_f32_16x16x32_bf16 v[172:175], v[136:139], a[28:31], v[172:175]
s_add_u32 m0, s47, 62464
v_exp_f32 v236, v236
v_mfma_f32_16x16x32_bf16 v[172:175], v[116:119], a[40:43], v[172:175]
s_add_u32 s50, s85, 3200
v_fma_f32 v239, v239, s44, v23
v_exp_f32 v237, v237
v_mfma_f32_16x16x32_bf16 v[172:175], v[156:159], a[44:47], v[172:175]
buffer_load_dwordx4 v19, s[20:23], s50 offen nt lds
v_cvt_pk_bf16_f32 v101, v234, v235
v_exp_f32 v238, v238
v_mfma_f32_16x16x32_bf16 v[180:183], v[152:155], a[48:51], 0
v_exp_f32 v239, v239
v_mfma_f32_16x16x32_bf16 v[180:183], v[112:115], a[52:55], v[180:183]
v_cvt_pk_bf16_f32 v102, v236, v237
v_cvt_pk_bf16_f32 v103, v238, v239
v_mfma_f32_16x16x32_bf16 v[180:183], v[140:143], a[64:67], v[180:183]
v_fma_f32 v240, v240, s44, v24
v_fma_f32 v241, v241, s44, v24
v_mfma_f32_16x16x32_bf16 v[180:183], v[136:139], a[68:71], v[180:183]
s_waitcnt vmcnt(27)
s_barrier
v_fma_f32 v242, v242, s44, v24
v_exp_f32 v240, v240
v_mfma_f32_16x16x32_bf16 v[180:183], v[116:119], a[80:83], v[180:183]
v_fma_f32 v243, v243, s44, v24
v_exp_f32 v241, v241
v_mfma_f32_16x16x32_bf16 v[180:183], v[156:159], a[84:87], v[180:183]
ds_read_b128 v[4:7], v16 offset:12288
v_fma_f32 v244, v244, s44, v24
v_mfma_f32_16x16x32_bf16 v[188:191], v[152:155], a[56:59], 0
v_exp_f32 v242, v242
v_mfma_f32_16x16x32_bf16 v[188:191], v[112:115], a[60:63], v[188:191]
ds_read_b128 v[12:15], v17 offset:12288
v_fma_f32 v245, v245, s44, v24
v_exp_f32 v243, v243
v_mfma_f32_16x16x32_bf16 v[188:191], v[140:143], a[72:75], v[188:191]
v_fma_f32 v246, v246, s44, v24
v_cvt_pk_bf16_f32 v104, v240, v241
v_mfma_f32_16x16x32_bf16 v[188:191], v[136:139], a[76:79], v[188:191]
s_add_u32 m0, s47, 63488
ds_read_b128 v[28:31], v16 offset:13312
v_exp_f32 v244, v244
v_mfma_f32_16x16x32_bf16 v[188:191], v[116:119], a[88:91], v[188:191]
s_add_u32 s50, s85, 6272
v_fma_f32 v247, v247, s44, v24
v_exp_f32 v245, v245
v_mfma_f32_16x16x32_bf16 v[188:191], v[156:159], a[92:95], v[188:191]
buffer_load_dwordx4 v19, s[20:23], s50 offen nt lds
v_fma_f32 v248, v248, s44, v25
v_cvt_pk_bf16_f32 v105, v242, v243
v_mfma_f32_16x16x32_bf16 v[196:199], v[152:155], a[96:99], 0
v_exp_f32 v246, v246
v_mfma_f32_16x16x32_bf16 v[196:199], v[112:115], a[100:103], v[196:199]
v_fma_f32 v249, v249, s44, v25
v_exp_f32 v247, v247
v_mfma_f32_16x16x32_bf16 v[196:199], v[140:143], a[112:115], v[196:199]
v_fma_f32 v250, v250, s44, v25
v_cvt_pk_bf16_f32 v106, v244, v245
v_mfma_f32_16x16x32_bf16 v[196:199], v[136:139], a[116:119], v[196:199]
v_exp_f32 v248, v248
v_mfma_f32_16x16x32_bf16 v[196:199], v[116:119], a[128:131], v[196:199]
v_fma_f32 v251, v251, s44, v25
v_exp_f32 v249, v249
v_mfma_f32_16x16x32_bf16 v[196:199], v[156:159], a[132:135], v[196:199]
v_fma_f32 v252, v252, s44, v25
v_cvt_pk_bf16_f32 v107, v246, v247
v_mfma_f32_16x16x32_bf16 v[204:207], v[152:155], a[104:107], 0
v_exp_f32 v250, v250
v_mfma_f32_16x16x32_bf16 v[204:207], v[112:115], a[108:111], v[204:207]
v_fma_f32 v253, v253, s44, v25
v_exp_f32 v251, v251
v_mfma_f32_16x16x32_bf16 v[204:207], v[140:143], a[120:123], v[204:207]
v_fma_f32 v254, v254, s44, v25
v_cvt_pk_bf16_f32 v108, v248, v249
v_mfma_f32_16x16x32_bf16 v[204:207], v[136:139], a[124:127], v[204:207]
s_add_u32 m0, s47, 49152
v_exp_f32 v252, v252
v_mfma_f32_16x16x32_bf16 v[204:207], v[116:119], a[136:139], v[204:207]
s_add_u32 s50, s84, 128
v_fma_f32 v255, v255, s44, v25
v_exp_f32 v253, v253
v_mfma_f32_16x16x32_bf16 v[204:207], v[156:159], a[140:143], v[204:207]
s_waitcnt lgkmcnt(2)
ds_read_b128 v[136:139], v16 offset:18432
v_cvt_pk_bf16_f32 v109, v250, v251
v_exp_f32 v254, v254
v_mfma_f32_16x16x32_bf16 v[208:211], v[4:7], a[0:3], 0
s_waitcnt lgkmcnt(2)
buffer_load_dwordx4 v19, s[20:23], s50 offen nt lds
v_exp_f32 v255, v255
v_mfma_f32_16x16x32_bf16 v[208:211], v[12:15], a[4:7], v[208:211]
s_waitcnt lgkmcnt(1)
ds_read_b128 v[156:159], v17 offset:18432
v_cvt_pk_bf16_f32 v110, v252, v253
v_cvt_pk_bf16_f32 v111, v254, v255
v_mfma_f32_16x16x32_bf16 v[208:211], v[28:31], a[16:19], v[208:211]
v_fma_f32 v160, v160, s44, v20
v_fma_f32 v161, v161, s44, v20
v_mfma_f32_16x16x32_bf16 v[216:219], v[4:7], a[8:11], 0
ds_read_b128 v[140:143], v16 offset:19456
v_fma_f32 v162, v162, s44, v20
v_exp_f32 v160, v160
v_mfma_f32_16x16x32_bf16 v[216:219], v[12:15], a[12:15], v[216:219]
v_fma_f32 v163, v163, s44, v20
v_exp_f32 v161, v161
v_mfma_f32_16x16x32_bf16 v[216:219], v[28:31], a[24:27], v[216:219]
v_fma_f32 v164, v164, s44, v20
v_mfma_f32_16x16x32_bf16 v[224:227], v[4:7], a[48:51], 0
v_exp_f32 v162, v162
v_mfma_f32_16x16x32_bf16 v[224:227], v[12:15], a[52:55], v[224:227]
v_fma_f32 v165, v165, s44, v20
v_exp_f32 v163, v163
v_mfma_f32_16x16x32_bf16 v[224:227], v[28:31], a[64:67], v[224:227]
v_fma_f32 v166, v166, s44, v20
v_cvt_pk_bf16_f32 v112, v160, v161
v_mfma_f32_16x16x32_bf16 v[232:235], v[4:7], a[56:59], 0
s_add_u32 m0, s47, 50176
v_exp_f32 v164, v164
v_mfma_f32_16x16x32_bf16 v[232:235], v[12:15], a[60:63], v[232:235]
s_add_u32 s50, s84, 3200
v_fma_f32 v167, v167, s44, v20
v_exp_f32 v165, v165
v_mfma_f32_16x16x32_bf16 v[232:235], v[28:31], a[72:75], v[232:235]
buffer_load_dwordx4 v19, s[20:23], s50 offen nt lds
v_fma_f32 v168, v168, s44, v21
v_cvt_pk_bf16_f32 v113, v162, v163
v_mfma_f32_16x16x32_bf16 v[240:243], v[4:7], a[96:99], 0
v_exp_f32 v166, v166
v_mfma_f32_16x16x32_bf16 v[240:243], v[12:15], a[100:103], v[240:243]
v_fma_f32 v169, v169, s44, v21
v_exp_f32 v167, v167
v_mfma_f32_16x16x32_bf16 v[240:243], v[28:31], a[112:115], v[240:243]
v_fma_f32 v170, v170, s44, v21
v_cvt_pk_bf16_f32 v114, v164, v165
v_mfma_f32_16x16x32_bf16 v[248:251], v[4:7], a[104:107], 0
v_exp_f32 v168, v168
v_mfma_f32_16x16x32_bf16 v[248:251], v[12:15], a[108:111], v[248:251]
v_fma_f32 v171, v171, s44, v21
v_exp_f32 v169, v169
v_mfma_f32_16x16x32_bf16 v[248:251], v[28:31], a[120:123], v[248:251]
s_waitcnt lgkmcnt(2)
ds_read_b128 v[12:15], v17 offset:13312
v_fma_f32 v172, v172, s44, v21
v_cvt_pk_bf16_f32 v115, v166, v167
v_mfma_f32_16x16x32_bf16 v[212:215], v[136:139], a[0:3], 0
s_waitcnt lgkmcnt(2)
v_exp_f32 v170, v170
v_mfma_f32_16x16x32_bf16 v[212:215], v[156:159], a[4:7], v[212:215]
s_waitcnt lgkmcnt(1)
ds_read_b128 v[28:31], v16 offset:14336
v_fma_f32 v173, v173, s44, v21
v_exp_f32 v171, v171
v_mfma_f32_16x16x32_bf16 v[212:215], v[140:143], a[16:19], v[212:215]
v_fma_f32 v174, v174, s44, v21
v_cvt_pk_bf16_f32 v116, v168, v169
v_mfma_f32_16x16x32_bf16 v[220:223], v[136:139], a[8:11], 0
s_add_u32 m0, s47, 51200
ds_read_b128 v[4:7], v17 offset:14336
v_exp_f32 v172, v172
v_mfma_f32_16x16x32_bf16 v[220:223], v[156:159], a[12:15], v[220:223]
s_add_u32 s50, s84, 6272
v_fma_f32 v175, v175, s44, v21
v_exp_f32 v173, v173
v_mfma_f32_16x16x32_bf16 v[220:223], v[140:143], a[24:27], v[220:223]
buffer_load_dwordx4 v19, s[20:23], s50 offen nt lds
v_cvt_pk_bf16_f32 v117, v170, v171
v_exp_f32 v174, v174
v_mfma_f32_16x16x32_bf16 v[228:231], v[136:139], a[48:51], 0
v_exp_f32 v175, v175
v_mfma_f32_16x16x32_bf16 v[228:231], v[156:159], a[52:55], v[228:231]
v_cvt_pk_bf16_f32 v118, v172, v173
v_cvt_pk_bf16_f32 v119, v174, v175
v_mfma_f32_16x16x32_bf16 v[228:231], v[140:143], a[64:67], v[228:231]
v_fma_f32 v176, v176, s44, v22
v_fma_f32 v177, v177, s44, v22
v_mfma_f32_16x16x32_bf16 v[236:239], v[136:139], a[56:59], 0
v_fma_f32 v178, v178, s44, v22
v_exp_f32 v176, v176
v_mfma_f32_16x16x32_bf16 v[236:239], v[156:159], a[60:63], v[236:239]
v_fma_f32 v179, v179, s44, v22
v_exp_f32 v177, v177
v_mfma_f32_16x16x32_bf16 v[236:239], v[140:143], a[72:75], v[236:239]
v_fma_f32 v180, v180, s44, v22
v_mfma_f32_16x16x32_bf16 v[244:247], v[136:139], a[96:99], 0
v_exp_f32 v178, v178
v_mfma_f32_16x16x32_bf16 v[244:247], v[156:159], a[100:103], v[244:247]
v_fma_f32 v181, v181, s44, v22
v_exp_f32 v179, v179
v_mfma_f32_16x16x32_bf16 v[244:247], v[140:143], a[112:115], v[244:247]
v_fma_f32 v182, v182, s44, v22
v_cvt_pk_bf16_f32 v120, v176, v177
v_mfma_f32_16x16x32_bf16 v[252:255], v[136:139], a[104:107], 0
s_add_u32 m0, s47, 98304
v_exp_f32 v180, v180
v_mfma_f32_16x16x32_bf16 v[252:255], v[156:159], a[108:111], v[252:255]
s_add_u32 s50, s84, 256
v_fma_f32 v183, v183, s44, v22
v_exp_f32 v181, v181
v_mfma_f32_16x16x32_bf16 v[252:255], v[140:143], a[120:123], v[252:255]
s_waitcnt lgkmcnt(2)
ds_read_b128 v[156:159], v17 offset:19456
v_fma_f32 v184, v184, s44, v23
v_cvt_pk_bf16_f32 v121, v178, v179
v_mfma_f32_16x16x32_bf16 v[208:211], v[12:15], a[20:23], v[208:211]
s_waitcnt lgkmcnt(2)
buffer_load_dwordx4 v19, s[20:23], s50 offen nt lds
v_exp_f32 v182, v182
v_mfma_f32_16x16x32_bf16 v[208:211], v[28:31], a[32:35], v[208:211]
s_waitcnt lgkmcnt(1)
ds_read_b128 v[140:143], v16 offset:20480
v_fma_f32 v185, v185, s44, v23
v_exp_f32 v183, v183
v_mfma_f32_16x16x32_bf16 v[208:211], v[4:7], a[36:39], v[208:211]
v_fma_f32 v186, v186, s44, v23
v_cvt_pk_bf16_f32 v122, v180, v181
v_mfma_f32_16x16x32_bf16 v[216:219], v[12:15], a[28:31], v[216:219]
ds_read_b128 v[152:155], v17 offset:20480
v_exp_f32 v184, v184
v_mfma_f32_16x16x32_bf16 v[216:219], v[28:31], a[40:43], v[216:219]
v_fma_f32 v187, v187, s44, v23
v_exp_f32 v185, v185
v_mfma_f32_16x16x32_bf16 v[216:219], v[4:7], a[44:47], v[216:219]
v_fma_f32 v188, v188, s44, v23
v_cvt_pk_bf16_f32 v123, v182, v183
v_mfma_f32_16x16x32_bf16 v[224:227], v[12:15], a[68:71], v[224:227]
v_exp_f32 v186, v186
v_mfma_f32_16x16x32_bf16 v[224:227], v[28:31], a[80:83], v[224:227]
v_fma_f32 v189, v189, s44, v23
v_exp_f32 v187, v187
v_mfma_f32_16x16x32_bf16 v[224:227], v[4:7], a[84:87], v[224:227]
v_fma_f32 v190, v190, s44, v23
v_cvt_pk_bf16_f32 v124, v184, v185
v_mfma_f32_16x16x32_bf16 v[232:235], v[12:15], a[76:79], v[232:235]
s_add_u32 m0, s47, 99328
v_exp_f32 v188, v188
v_mfma_f32_16x16x32_bf16 v[232:235], v[28:31], a[88:91], v[232:235]
s_add_u32 s50, s84, 3328
v_fma_f32 v191, v191, s44, v23
v_exp_f32 v189, v189
v_mfma_f32_16x16x32_bf16 v[232:235], v[4:7], a[92:95], v[232:235]
buffer_load_dwordx4 v19, s[20:23], s50 offen nt lds
v_cvt_pk_bf16_f32 v125, v186, v187
v_exp_f32 v190, v190
v_mfma_f32_16x16x32_bf16 v[240:243], v[12:15], a[116:119], v[240:243]
v_exp_f32 v191, v191
v_mfma_f32_16x16x32_bf16 v[240:243], v[28:31], a[128:131], v[240:243]
v_cvt_pk_bf16_f32 v126, v188, v189
v_cvt_pk_bf16_f32 v127, v190, v191
v_mfma_f32_16x16x32_bf16 v[240:243], v[4:7], a[132:135], v[240:243]
v_fma_f32 v192, v192, s44, v24
v_fma_f32 v193, v193, s44, v24
v_mfma_f32_16x16x32_bf16 v[248:251], v[12:15], a[124:127], v[248:251]
v_fma_f32 v194, v194, s44, v24
v_exp_f32 v192, v192
v_mfma_f32_16x16x32_bf16 v[248:251], v[28:31], a[136:139], v[248:251]
v_fma_f32 v195, v195, s44, v24
v_exp_f32 v193, v193
v_mfma_f32_16x16x32_bf16 v[248:251], v[4:7], a[140:143], v[248:251]
s_waitcnt vmcnt(29) lgkmcnt(0)
s_barrier
v_fma_f32 v196, v196, s44, v24
v_mfma_f32_16x16x32_bf16 v[212:215], v[156:159], a[20:23], v[212:215]
v_exp_f32 v194, v194
v_mfma_f32_16x16x32_bf16 v[212:215], v[140:143], a[32:35], v[212:215]
ds_read_b128 v[4:7], v16 offset:24576
v_fma_f32 v197, v197, s44, v24
v_exp_f32 v195, v195
v_mfma_f32_16x16x32_bf16 v[212:215], v[152:155], a[36:39], v[212:215]
ds_read_b128 v[28:31], v17 offset:24576
v_fma_f32 v198, v198, s44, v24
v_cvt_pk_bf16_f32 v128, v192, v193
v_mfma_f32_16x16x32_bf16 v[220:223], v[156:159], a[28:31], v[220:223]
s_add_u32 m0, s47, 100352
v_exp_f32 v196, v196
v_mfma_f32_16x16x32_bf16 v[220:223], v[140:143], a[40:43], v[220:223]
s_add_u32 s50, s84, 6400
v_fma_f32 v199, v199, s44, v24
v_exp_f32 v197, v197
v_mfma_f32_16x16x32_bf16 v[220:223], v[152:155], a[44:47], v[220:223]
buffer_load_dwordx4 v19, s[20:23], s50 offen nt lds
v_fma_f32 v200, v200, s44, v25
v_cvt_pk_bf16_f32 v129, v194, v195
v_mfma_f32_16x16x32_bf16 v[228:231], v[156:159], a[68:71], v[228:231]
v_exp_f32 v198, v198
v_mfma_f32_16x16x32_bf16 v[228:231], v[140:143], a[80:83], v[228:231]
v_fma_f32 v201, v201, s44, v25
v_exp_f32 v199, v199
v_mfma_f32_16x16x32_bf16 v[228:231], v[152:155], a[84:87], v[228:231]
v_fma_f32 v202, v202, s44, v25
v_cvt_pk_bf16_f32 v130, v196, v197
v_mfma_f32_16x16x32_bf16 v[236:239], v[156:159], a[76:79], v[236:239]
v_exp_f32 v200, v200
v_mfma_f32_16x16x32_bf16 v[236:239], v[140:143], a[88:91], v[236:239]
v_fma_f32 v203, v203, s44, v25
v_exp_f32 v201, v201
v_mfma_f32_16x16x32_bf16 v[236:239], v[152:155], a[92:95], v[236:239]
v_fma_f32 v204, v204, s44, v25
v_cvt_pk_bf16_f32 v131, v198, v199
v_mfma_f32_16x16x32_bf16 v[244:247], v[156:159], a[116:119], v[244:247]
v_exp_f32 v202, v202
v_mfma_f32_16x16x32_bf16 v[244:247], v[140:143], a[128:131], v[244:247]
ds_read_b128 v[12:15], v16 offset:30720
v_fma_f32 v205, v205, s44, v25
v_exp_f32 v203, v203
v_mfma_f32_16x16x32_bf16 v[244:247], v[152:155], a[132:135], v[244:247]
ds_read_b128 v[8:11], v17 offset:30720
v_fma_f32 v206, v206, s44, v25
v_cvt_pk_bf16_f32 v132, v200, v201
v_mfma_f32_16x16x32_bf16 v[252:255], v[156:159], a[124:127], v[252:255]
s_add_u32 m0, s47, 110592
v_exp_f32 v204, v204
v_mfma_f32_16x16x32_bf16 v[252:255], v[140:143], a[136:139], v[252:255]
s_add_u32 s50, s85, 256
v_fma_f32 v207, v207, s44, v25
v_exp_f32 v205, v205
v_mfma_f32_16x16x32_bf16 v[252:255], v[152:155], a[140:143], v[252:255]
s_waitcnt lgkmcnt(3)
buffer_load_dwordx4 v19, s[20:23], s50 offen nt lds
v_cvt_pk_bf16_f32 v133, v202, v203
v_exp_f32 v206, v206
v_mfma_f32_16x16x32_bf16 v[160:163], v[4:7], a[0:3], 0
s_waitcnt lgkmcnt(2)
v_exp_f32 v207, v207
v_mfma_f32_16x16x32_bf16 v[160:163], v[28:31], a[4:7], v[160:163]
v_cvt_pk_bf16_f32 v134, v204, v205
v_cvt_pk_bf16_f32 v135, v206, v207
v_mfma_f32_16x16x32_bf16 v[168:171], v[4:7], a[8:11], 0
v_fma_f32 v208, v208, s44, v20
v_fma_f32 v209, v209, s44, v20
v_mfma_f32_16x16x32_bf16 v[168:171], v[28:31], a[12:15], v[168:171]
v_fma_f32 v210, v210, s44, v20
v_exp_f32 v208, v208
v_mfma_f32_16x16x32_bf16 v[176:179], v[4:7], a[48:51], 0
v_fma_f32 v211, v211, s44, v20
v_exp_f32 v209, v209
v_mfma_f32_16x16x32_bf16 v[176:179], v[28:31], a[52:55], v[176:179]
v_fma_f32 v212, v212, s44, v20
v_mfma_f32_16x16x32_bf16 v[184:187], v[4:7], a[56:59], 0
v_exp_f32 v210, v210
v_mfma_f32_16x16x32_bf16 v[184:187], v[28:31], a[60:63], v[184:187]
ds_read_b128 v[152:155], v16 offset:25600
v_fma_f32 v213, v213, s44, v20
v_exp_f32 v211, v211
v_mfma_f32_16x16x32_bf16 v[192:195], v[4:7], a[96:99], 0
ds_read_b128 v[156:159], v17 offset:25600
v_fma_f32 v214, v214, s44, v20
v_cvt_pk_bf16_f32 v136, v208, v209
v_mfma_f32_16x16x32_bf16 v[192:195], v[28:31], a[100:103], v[192:195]
s_add_u32 m0, s47, 111616
v_exp_f32 v212, v212
v_mfma_f32_16x16x32_bf16 v[200:203], v[4:7], a[104:107], 0
s_add_u32 s50, s85, 3328
v_fma_f32 v215, v215, s44, v20
v_exp_f32 v213, v213
v_mfma_f32_16x16x32_bf16 v[200:203], v[28:31], a[108:111], v[200:203]
s_waitcnt lgkmcnt(3)
buffer_load_dwordx4 v19, s[20:23], s50 offen nt lds
v_fma_f32 v216, v216, s44, v21
v_cvt_pk_bf16_f32 v137, v210, v211
v_mfma_f32_16x16x32_bf16 v[164:167], v[12:15], a[0:3], 0
s_waitcnt lgkmcnt(2)
v_exp_f32 v214, v214
v_mfma_f32_16x16x32_bf16 v[164:167], v[8:11], a[4:7], v[164:167]
v_fma_f32 v217, v217, s44, v21
v_exp_f32 v215, v215
v_mfma_f32_16x16x32_bf16 v[172:175], v[12:15], a[8:11], 0
v_fma_f32 v218, v218, s44, v21
v_cvt_pk_bf16_f32 v138, v212, v213
v_mfma_f32_16x16x32_bf16 v[172:175], v[8:11], a[12:15], v[172:175]
v_exp_f32 v216, v216
v_mfma_f32_16x16x32_bf16 v[180:183], v[12:15], a[48:51], 0
v_fma_f32 v219, v219, s44, v21
v_exp_f32 v217, v217
v_mfma_f32_16x16x32_bf16 v[180:183], v[8:11], a[52:55], v[180:183]
v_fma_f32 v220, v220, s44, v21
v_cvt_pk_bf16_f32 v139, v214, v215
v_mfma_f32_16x16x32_bf16 v[188:191], v[12:15], a[56:59], 0
v_exp_f32 v218, v218
v_mfma_f32_16x16x32_bf16 v[188:191], v[8:11], a[60:63], v[188:191]
ds_read_b128 v[28:31], v16 offset:31744
v_fma_f32 v221, v221, s44, v21
v_exp_f32 v219, v219
v_mfma_f32_16x16x32_bf16 v[196:199], v[12:15], a[96:99], 0
ds_read_b128 v[4:7], v17 offset:31744
v_fma_f32 v222, v222, s44, v21
v_cvt_pk_bf16_f32 v140, v216, v217
v_mfma_f32_16x16x32_bf16 v[196:199], v[8:11], a[100:103], v[196:199]
s_add_u32 m0, s47, 112640
v_exp_f32 v220, v220
v_mfma_f32_16x16x32_bf16 v[204:207], v[12:15], a[104:107], 0
s_add_u32 s50, s85, 6400
v_fma_f32 v223, v223, s44, v21
v_exp_f32 v221, v221
v_mfma_f32_16x16x32_bf16 v[204:207], v[8:11], a[108:111], v[204:207]
s_waitcnt lgkmcnt(3)
buffer_load_dwordx4 v19, s[20:23], s50 offen nt lds
v_cvt_pk_bf16_f32 v141, v218, v219
v_exp_f32 v222, v222
v_mfma_f32_16x16x32_bf16 v[160:163], v[152:155], a[16:19], v[160:163]
s_waitcnt lgkmcnt(2)
v_exp_f32 v223, v223
v_mfma_f32_16x16x32_bf16 v[160:163], v[156:159], a[20:23], v[160:163]
v_cvt_pk_bf16_f32 v142, v220, v221
v_cvt_pk_bf16_f32 v143, v222, v223
v_mfma_f32_16x16x32_bf16 v[168:171], v[152:155], a[24:27], v[168:171]
v_fma_f32 v224, v224, s44, v22
v_fma_f32 v225, v225, s44, v22
v_mfma_f32_16x16x32_bf16 v[168:171], v[156:159], a[28:31], v[168:171]
v_fma_f32 v226, v226, s44, v22
v_exp_f32 v224, v224
v_mfma_f32_16x16x32_bf16 v[176:179], v[152:155], a[64:67], v[176:179]
v_fma_f32 v227, v227, s44, v22
v_exp_f32 v225, v225
v_mfma_f32_16x16x32_bf16 v[176:179], v[156:159], a[68:71], v[176:179]
v_fma_f32 v228, v228, s44, v22
v_mfma_f32_16x16x32_bf16 v[184:187], v[152:155], a[72:75], v[184:187]
v_exp_f32 v226, v226
v_mfma_f32_16x16x32_bf16 v[184:187], v[156:159], a[76:79], v[184:187]
ds_read_b128 v[8:11], v16 offset:26624
v_fma_f32 v229, v229, s44, v22
v_exp_f32 v227, v227
v_mfma_f32_16x16x32_bf16 v[192:195], v[152:155], a[112:115], v[192:195]
ds_read_b128 v[12:15], v17 offset:26624
v_fma_f32 v230, v230, s44, v22
v_cvt_pk_bf16_f32 v144, v224, v225
v_mfma_f32_16x16x32_bf16 v[192:195], v[156:159], a[116:119], v[192:195]
v_exp_f32 v228, v228
v_mfma_f32_16x16x32_bf16 v[200:203], v[152:155], a[120:123], v[200:203]
v_fma_f32 v231, v231, s44, v22
v_exp_f32 v229, v229
v_mfma_f32_16x16x32_bf16 v[200:203], v[156:159], a[124:127], v[200:203]
s_waitcnt lgkmcnt(3)
v_fma_f32 v232, v232, s44, v23
v_cvt_pk_bf16_f32 v145, v226, v227
v_mfma_f32_16x16x32_bf16 v[164:167], v[28:31], a[16:19], v[164:167]
s_waitcnt lgkmcnt(2)
v_exp_f32 v230, v230
v_mfma_f32_16x16x32_bf16 v[164:167], v[4:7], a[20:23], v[164:167]
v_fma_f32 v233, v233, s44, v23
v_exp_f32 v231, v231
v_mfma_f32_16x16x32_bf16 v[172:175], v[28:31], a[24:27], v[172:175]
v_fma_f32 v234, v234, s44, v23
v_cvt_pk_bf16_f32 v146, v228, v229
v_mfma_f32_16x16x32_bf16 v[172:175], v[4:7], a[28:31], v[172:175]
v_exp_f32 v232, v232
v_mfma_f32_16x16x32_bf16 v[180:183], v[28:31], a[64:67], v[180:183]
v_fma_f32 v235, v235, s44, v23
v_exp_f32 v233, v233
v_mfma_f32_16x16x32_bf16 v[180:183], v[4:7], a[68:71], v[180:183]
v_fma_f32 v236, v236, s44, v23
v_cvt_pk_bf16_f32 v147, v230, v231
v_mfma_f32_16x16x32_bf16 v[188:191], v[28:31], a[72:75], v[188:191]
v_exp_f32 v234, v234
v_mfma_f32_16x16x32_bf16 v[188:191], v[4:7], a[76:79], v[188:191]
ds_read_b128 v[0:3], v16 offset:32768
v_fma_f32 v237, v237, s44, v23
v_exp_f32 v235, v235
v_mfma_f32_16x16x32_bf16 v[196:199], v[28:31], a[112:115], v[196:199]
v_fma_f32 v238, v238, s44, v23
v_cvt_pk_bf16_f32 v148, v232, v233
v_mfma_f32_16x16x32_bf16 v[196:199], v[4:7], a[116:119], v[196:199]
v_exp_f32 v236, v236
v_mfma_f32_16x16x32_bf16 v[204:207], v[28:31], a[120:123], v[204:207]
ds_read_b128 v[28:31], v17 offset:32768
v_fma_f32 v239, v239, s44, v23
v_exp_f32 v237, v237
v_mfma_f32_16x16x32_bf16 v[204:207], v[4:7], a[124:127], v[204:207]
s_waitcnt lgkmcnt(3)
v_cvt_pk_bf16_f32 v149, v234, v235
v_exp_f32 v238, v238
v_mfma_f32_16x16x32_bf16 v[160:163], v[8:11], a[32:35], v[160:163]
s_waitcnt lgkmcnt(2)
v_exp_f32 v239, v239
v_mfma_f32_16x16x32_bf16 v[160:163], v[12:15], a[36:39], v[160:163]
v_cvt_pk_bf16_f32 v150, v236, v237
v_cvt_pk_bf16_f32 v151, v238, v239
v_mfma_f32_16x16x32_bf16 v[168:171], v[8:11], a[40:43], v[168:171]
v_fma_f32 v240, v240, s44, v24
v_fma_f32 v241, v241, s44, v24
v_mfma_f32_16x16x32_bf16 v[168:171], v[12:15], a[44:47], v[168:171]
v_fma_f32 v242, v242, s44, v24
v_exp_f32 v240, v240
v_mfma_f32_16x16x32_bf16 v[176:179], v[8:11], a[80:83], v[176:179]
v_fma_f32 v243, v243, s44, v24
v_exp_f32 v241, v241
v_mfma_f32_16x16x32_bf16 v[176:179], v[12:15], a[84:87], v[176:179]
s_waitcnt vmcnt(30) lgkmcnt(0)
s_barrier
v_fma_f32 v244, v244, s44, v24
v_mfma_f32_16x16x32_bf16 v[184:187], v[8:11], a[88:91], v[184:187]
v_exp_f32 v242, v242
v_mfma_f32_16x16x32_bf16 v[184:187], v[12:15], a[92:95], v[184:187]
s_add_u32 m0, s47, 122880
ds_read_b128 v[4:7], v16 offset:36864
v_fma_f32 v245, v245, s44, v24
v_exp_f32 v243, v243
v_mfma_f32_16x16x32_bf16 v[192:195], v[8:11], a[128:131], v[192:195]
s_add_u32 s50, s86, 256
v_fma_f32 v246, v246, s44, v24
v_cvt_pk_bf16_f32 v152, v240, v241
v_mfma_f32_16x16x32_bf16 v[192:195], v[12:15], a[132:135], v[192:195]
buffer_load_dwordx4 v19, s[20:23], s50 offen nt lds
v_exp_f32 v244, v244
v_mfma_f32_16x16x32_bf16 v[200:203], v[8:11], a[136:139], v[200:203]
ds_read_b128 v[8:11], v17 offset:36864
v_fma_f32 v247, v247, s44, v24
v_exp_f32 v245, v245
v_mfma_f32_16x16x32_bf16 v[200:203], v[12:15], a[140:143], v[200:203]
v_fma_f32 v248, v248, s44, v25
v_cvt_pk_bf16_f32 v153, v242, v243
v_mfma_f32_16x16x32_bf16 v[164:167], v[0:3], a[32:35], v[164:167]
v_exp_f32 v246, v246
v_mfma_f32_16x16x32_bf16 v[164:167], v[28:31], a[36:39], v[164:167]
v_fma_f32 v249, v249, s44, v25
v_exp_f32 v247, v247
v_mfma_f32_16x16x32_bf16 v[172:175], v[0:3], a[40:43], v[172:175]
v_fma_f32 v250, v250, s44, v25
v_cvt_pk_bf16_f32 v154, v244, v245
v_mfma_f32_16x16x32_bf16 v[172:175], v[28:31], a[44:47], v[172:175]
v_exp_f32 v248, v248
v_mfma_f32_16x16x32_bf16 v[180:183], v[0:3], a[80:83], v[180:183]
v_fma_f32 v251, v251, s44, v25
v_exp_f32 v249, v249
v_mfma_f32_16x16x32_bf16 v[180:183], v[28:31], a[84:87], v[180:183]
v_fma_f32 v252, v252, s44, v25
v_cvt_pk_bf16_f32 v155, v246, v247
v_mfma_f32_16x16x32_bf16 v[188:191], v[0:3], a[88:91], v[188:191]
v_exp_f32 v250, v250
v_mfma_f32_16x16x32_bf16 v[188:191], v[28:31], a[92:95], v[188:191]
s_add_u32 m0, s47, 123904
ds_read_b128 v[12:15], v16 offset:43008
v_fma_f32 v253, v253, s44, v25
v_exp_f32 v251, v251
v_mfma_f32_16x16x32_bf16 v[196:199], v[0:3], a[128:131], v[196:199]
s_add_u32 s50, s86, 3328
v_fma_f32 v254, v254, s44, v25
v_cvt_pk_bf16_f32 v156, v248, v249
v_mfma_f32_16x16x32_bf16 v[196:199], v[28:31], a[132:135], v[196:199]
buffer_load_dwordx4 v19, s[20:23], s50 offen nt lds
v_exp_f32 v252, v252
v_mfma_f32_16x16x32_bf16 v[204:207], v[0:3], a[136:139], v[204:207]
ds_read_b128 v[0:3], v17 offset:43008
v_fma_f32 v255, v255, s44, v25
v_exp_f32 v253, v253
v_mfma_f32_16x16x32_bf16 v[204:207], v[28:31], a[140:143], v[204:207]
s_waitcnt lgkmcnt(3)
v_cvt_pk_bf16_f32 v157, v250, v251
v_exp_f32 v254, v254
v_mfma_f32_16x16x32_bf16 v[208:211], v[4:7], a[0:3], 0
s_waitcnt lgkmcnt(2)
v_exp_f32 v255, v255
v_mfma_f32_16x16x32_bf16 v[208:211], v[8:11], a[4:7], v[208:211]
v_cvt_pk_bf16_f32 v158, v252, v253
v_cvt_pk_bf16_f32 v159, v254, v255
v_mfma_f32_16x16x32_bf16 v[216:219], v[4:7], a[8:11], 0
v_fma_f32 v160, v160, s44, v20
v_mfma_f32_16x16x32_bf16 v[216:219], v[8:11], a[12:15], v[216:219]
v_fma_f32 v161, v161, s44, v20
v_fma_f32 v162, v162, s44, v20
v_mfma_f32_16x16x32_bf16 v[224:227], v[4:7], a[48:51], 0
v_exp_f32 v160, v160
v_mfma_f32_16x16x32_bf16 v[224:227], v[8:11], a[52:55], v[224:227]
v_fma_f32 v163, v163, s44, v20
v_mfma_f32_16x16x32_bf16 v[232:235], v[4:7], a[56:59], 0
v_exp_f32 v161, v161
v_mfma_f32_16x16x32_bf16 v[232:235], v[8:11], a[60:63], v[232:235]
s_add_u32 m0, s47, 124928
ds_read_b128 v[28:31], v16 offset:37888
v_fma_f32 v164, v164, s44, v20
v_mfma_f32_16x16x32_bf16 v[240:243], v[4:7], a[96:99], 0
s_add_u32 s50, s86, 6400
v_exp_f32 v162, v162
v_mfma_f32_16x16x32_bf16 v[240:243], v[8:11], a[100:103], v[240:243]
buffer_load_dwordx4 v19, s[20:23], s50 offen nt lds
v_fma_f32 v165, v165, s44, v20
v_mfma_f32_16x16x32_bf16 v[248:251], v[4:7], a[104:107], 0
ds_read_b128 v[4:7], v17 offset:37888
v_exp_f32 v163, v163
v_mfma_f32_16x16x32_bf16 v[248:251], v[8:11], a[108:111], v[248:251]
s_waitcnt lgkmcnt(3)
v_fma_f32 v166, v166, s44, v20
v_mfma_f32_16x16x32_bf16 v[212:215], v[12:15], a[0:3], 0
s_waitcnt lgkmcnt(2)
v_cvt_pk_bf16_f32 v160, v160, v161
v_exp_f32 v164, v164
v_mfma_f32_16x16x32_bf16 v[212:215], v[0:3], a[4:7], v[212:215]
v_mfma_f32_16x16x32_bf16 v[220:223], v[12:15], a[8:11], 0
v_fma_f32 v167, v167, s44, v20
v_exp_f32 v165, v165
v_mfma_f32_16x16x32_bf16 v[220:223], v[0:3], a[12:15], v[220:223]
v_mfma_f32_16x16x32_bf16 v[228:231], v[12:15], a[48:51], 0
v_fma_f32 v168, v168, s44, v21
v_cvt_pk_bf16_f32 v161, v162, v163
v_mfma_f32_16x16x32_bf16 v[228:231], v[0:3], a[52:55], v[228:231]
v_exp_f32 v166, v166
v_mfma_f32_16x16x32_bf16 v[236:239], v[12:15], a[56:59], 0
v_fma_f32 v169, v169, s44, v21
v_mfma_f32_16x16x32_bf16 v[236:239], v[0:3], a[60:63], v[236:239]
ds_read_b128 v[8:11], v16 offset:44032
v_exp_f32 v167, v167
v_mfma_f32_16x16x32_bf16 v[244:247], v[12:15], a[96:99], 0
v_fma_f32 v170, v170, s44, v21
v_mfma_f32_16x16x32_bf16 v[244:247], v[0:3], a[100:103], v[244:247]
v_cvt_pk_bf16_f32 v162, v164, v165
v_exp_f32 v168, v168
v_mfma_f32_16x16x32_bf16 v[252:255], v[12:15], a[104:107], 0
ds_read_b128 v[12:15], v17 offset:44032
v_mfma_f32_16x16x32_bf16 v[252:255], v[0:3], a[108:111], v[252:255]
s_waitcnt lgkmcnt(3)
v_fma_f32 v171, v171, s44, v21
v_exp_f32 v169, v169
v_mfma_f32_16x16x32_bf16 v[208:211], v[28:31], a[16:19], v[208:211]
s_waitcnt lgkmcnt(2)
v_mfma_f32_16x16x32_bf16 v[208:211], v[4:7], a[20:23], v[208:211]
v_fma_f32 v172, v172, s44, v21
v_cvt_pk_bf16_f32 v163, v166, v167
v_mfma_f32_16x16x32_bf16 v[216:219], v[28:31], a[24:27], v[216:219]
v_exp_f32 v170, v170
v_mfma_f32_16x16x32_bf16 v[216:219], v[4:7], a[28:31], v[216:219]
v_fma_f32 v173, v173, s44, v21
v_mfma_f32_16x16x32_bf16 v[224:227], v[28:31], a[64:67], v[224:227]
v_exp_f32 v171, v171
v_mfma_f32_16x16x32_bf16 v[224:227], v[4:7], a[68:71], v[224:227]
v_fma_f32 v174, v174, s44, v21
v_mfma_f32_16x16x32_bf16 v[232:235], v[28:31], a[72:75], v[232:235]
v_cvt_pk_bf16_f32 v164, v168, v169
v_mfma_f32_16x16x32_bf16 v[232:235], v[4:7], a[76:79], v[232:235]
ds_read_b128 v[0:3], v16 offset:38912
v_exp_f32 v172, v172
v_mfma_f32_16x16x32_bf16 v[240:243], v[28:31], a[112:115], v[240:243]
v_fma_f32 v175, v175, s44, v21
v_mfma_f32_16x16x32_bf16 v[240:243], v[4:7], a[116:119], v[240:243]
v_exp_f32 v173, v173
v_mfma_f32_16x16x32_bf16 v[248:251], v[28:31], a[120:123], v[248:251]
ds_read_b128 v[28:31], v17 offset:38912
v_cvt_pk_bf16_f32 v165, v170, v171
v_mfma_f32_16x16x32_bf16 v[248:251], v[4:7], a[124:127], v[248:251]
s_waitcnt lgkmcnt(3)
v_exp_f32 v174, v174
v_mfma_f32_16x16x32_bf16 v[212:215], v[8:11], a[16:19], v[212:215]
s_waitcnt lgkmcnt(2)
v_exp_f32 v175, v175
v_mfma_f32_16x16x32_bf16 v[212:215], v[12:15], a[20:23], v[212:215]
v_cvt_pk_bf16_f32 v166, v172, v173
v_mfma_f32_16x16x32_bf16 v[220:223], v[8:11], a[24:27], v[220:223]
v_cvt_pk_bf16_f32 v167, v174, v175
v_fma_f32 v176, v176, s44, v22
v_mfma_f32_16x16x32_bf16 v[220:223], v[12:15], a[28:31], v[220:223]
v_fma_f32 v177, v177, s44, v22
v_mfma_f32_16x16x32_bf16 v[228:231], v[8:11], a[64:67], v[228:231]
v_fma_f32 v178, v178, s44, v22
v_exp_f32 v176, v176
v_mfma_f32_16x16x32_bf16 v[228:231], v[12:15], a[68:71], v[228:231]
v_mfma_f32_16x16x32_bf16 v[236:239], v[8:11], a[72:75], v[236:239]
v_fma_f32 v179, v179, s44, v22
v_exp_f32 v177, v177
v_mfma_f32_16x16x32_bf16 v[236:239], v[12:15], a[76:79], v[236:239]
ds_read_b128 v[4:7], v16 offset:45056
v_mfma_f32_16x16x32_bf16 v[244:247], v[8:11], a[112:115], v[244:247]
v_fma_f32 v180, v180, s44, v22
v_exp_f32 v178, v178
v_mfma_f32_16x16x32_bf16 v[244:247], v[12:15], a[116:119], v[244:247]
v_mfma_f32_16x16x32_bf16 v[252:255], v[8:11], a[120:123], v[252:255]
ds_read_b128 v[8:11], v17 offset:45056
v_fma_f32 v181, v181, s44, v22
v_exp_f32 v179, v179
v_mfma_f32_16x16x32_bf16 v[252:255], v[12:15], a[124:127], v[252:255]
s_waitcnt lgkmcnt(3)
v_mfma_f32_16x16x32_bf16 v[208:211], v[0:3], a[32:35], v[208:211]
s_waitcnt lgkmcnt(2)
v_fma_f32 v182, v182, s44, v22
v_cvt_pk_bf16_f32 v168, v176, v177
v_mfma_f32_16x16x32_bf16 v[208:211], v[28:31], a[36:39], v[208:211]
v_exp_f32 v180, v180
v_mfma_f32_16x16x32_bf16 v[216:219], v[0:3], a[40:43], v[216:219]
v_fma_f32 v183, v183, s44, v22
v_mfma_f32_16x16x32_bf16 v[216:219], v[28:31], a[44:47], v[216:219]
v_exp_f32 v181, v181
v_mfma_f32_16x16x32_bf16 v[224:227], v[0:3], a[80:83], v[224:227]
v_fma_f32 v184, v184, s44, v23
v_mfma_f32_16x16x32_bf16 v[224:227], v[28:31], a[84:87], v[224:227]
v_cvt_pk_bf16_f32 v169, v178, v179
v_exp_f32 v182, v182
v_mfma_f32_16x16x32_bf16 v[232:235], v[0:3], a[88:91], v[232:235]
v_mfma_f32_16x16x32_bf16 v[232:235], v[28:31], a[92:95], v[232:235]
v_fma_f32 v185, v185, s44, v23
v_exp_f32 v183, v183
v_mfma_f32_16x16x32_bf16 v[240:243], v[0:3], a[128:131], v[240:243]
v_mfma_f32_16x16x32_bf16 v[240:243], v[28:31], a[132:135], v[240:243]
v_fma_f32 v186, v186, s44, v23
v_cvt_pk_bf16_f32 v170, v180, v181
v_mfma_f32_16x16x32_bf16 v[248:251], v[0:3], a[136:139], v[248:251]
v_exp_f32 v184, v184
v_mfma_f32_16x16x32_bf16 v[248:251], v[28:31], a[140:143], v[248:251]
s_waitcnt lgkmcnt(1)
v_fma_f32 v187, v187, s44, v23
v_mfma_f32_16x16x32_bf16 v[212:215], v[4:7], a[32:35], v[212:215]
s_waitcnt lgkmcnt(0)
v_exp_f32 v185, v185
v_mfma_f32_16x16x32_bf16 v[212:215], v[8:11], a[36:39], v[212:215]
v_fma_f32 v188, v188, s44, v23
v_mfma_f32_16x16x32_bf16 v[220:223], v[4:7], a[40:43], v[220:223]
v_cvt_pk_bf16_f32 v171, v182, v183
v_mfma_f32_16x16x32_bf16 v[220:223], v[8:11], a[44:47], v[220:223]
v_mbcnt_lo_u32_b32 v27, -1, 0
v_exp_f32 v186, v186
v_mfma_f32_16x16x32_bf16 v[228:231], v[4:7], a[80:83], v[228:231]
v_mbcnt_hi_u32_b32 v27, -1, v27
v_mov_b32 v28, 0x3f803f80
v_fma_f32 v189, v189, s44, v23
v_mfma_f32_16x16x32_bf16 v[228:231], v[8:11], a[84:87], v[228:231]
v_lshrrev_b32 v26, 5, v27
v_mov_b32 v29, 0x3f803f80
v_exp_f32 v187, v187
v_mfma_f32_16x16x32_bf16 v[236:239], v[4:7], a[88:91], v[236:239]
v_lshlrev_b32 v26, 10, v26
v_mov_b32 v30, 0x3f803f80
v_fma_f32 v190, v190, s44, v23
v_cvt_pk_bf16_f32 v172, v184, v185
v_mfma_f32_16x16x32_bf16 v[236:239], v[8:11], a[92:95], v[236:239]
v_and_b32 v27, 31, v27
v_mov_b32 v31, 0x3f803f80
v_exp_f32 v188, v188
v_mfma_f32_16x16x32_bf16 v[244:247], v[4:7], a[128:131], v[244:247]
v_lshl_add_u32 v26, v27, 3, v26
v_fma_f32 v191, v191, s44, v23
v_mfma_f32_16x16x32_bf16 v[244:247], v[8:11], a[132:135], v[244:247]
v_exp_f32 v189, v189
v_mfma_f32_16x16x32_bf16 v[252:255], v[4:7], a[136:139], v[252:255]
s_waitcnt vmcnt(27)
s_barrier
v_cvt_pk_bf16_f32 v173, v186, v187
v_mfma_f32_16x16x32_bf16 v[252:255], v[8:11], a[140:143], v[252:255]
v_exp_f32 v190, v190
v_mfma_f32_16x16x32_bf16 a[120:123], v[28:31], a[144:147], 0
ds_read_b64_tr_b16 v[8:9], v26 offset:0
v_mfma_f32_16x16x32_bf16 a[120:123], v[28:31], a[168:171], a[120:123]
s_add_u32 s50, s49, 0
ds_read_b64_tr_b16 v[10:11], v26 offset:2048
v_mfma_f32_16x16x32_bf16 a[124:127], v[28:31], a[148:151], 0
ds_read_b64_tr_b16 v[4:5], v26 offset:4096
v_mfma_f32_16x16x32_bf16 a[124:127], v[28:31], a[172:175], a[124:127]
ds_read_b64_tr_b16 v[6:7], v26 offset:6144
v_mfma_f32_16x16x32_bf16 a[128:131], v[28:31], a[152:155], 0
buffer_load_dwordx4 a[0:3], v18, s[28:31], s50 offen nt
v_mfma_f32_16x16x32_bf16 a[128:131], v[28:31], a[176:179], a[128:131]
v_exp_f32 v191, v191
v_mfma_f32_16x16x32_bf16 a[132:135], v[28:31], a[156:159], 0
v_cvt_pk_bf16_f32 v174, v188, v189
v_cvt_pk_bf16_f32 v175, v190, v191
v_mfma_f32_16x16x32_bf16 a[132:135], v[28:31], a[180:183], a[132:135]
v_fma_f32 v192, v192, s44, v24
v_fma_f32 v193, v193, s44, v24
v_mfma_f32_16x16x32_bf16 a[136:139], v[28:31], a[160:163], 0
v_fma_f32 v194, v194, s44, v24
v_mfma_f32_16x16x32_bf16 a[136:139], v[28:31], a[184:187], a[136:139]
v_exp_f32 v192, v192
v_mfma_f32_16x16x32_bf16 a[140:143], v[28:31], a[164:167], 0
v_fma_f32 v195, v195, s44, v24
v_mfma_f32_16x16x32_bf16 a[140:143], v[28:31], a[188:191], a[140:143]
s_waitcnt lgkmcnt(2)
v_exp_f32 v193, v193
v_mfma_f32_16x16x32_bf16 a[48:51], v[8:11], a[144:147], 0
s_waitcnt lgkmcnt(0)
ds_read_b64_tr_b16 v[0:1], v26 offset:256
v_fma_f32 v196, v196, s44, v24
v_mfma_f32_16x16x32_bf16 a[48:51], v[4:7], a[168:171], a[48:51]
s_add_u32 s50, s49, 3072
ds_read_b64_tr_b16 v[2:3], v26 offset:2304
v_mfma_f32_16x16x32_bf16 a[56:59], v[8:11], a[148:151], 0
ds_read_b64_tr_b16 v[12:13], v26 offset:4352
v_mfma_f32_16x16x32_bf16 a[56:59], v[4:7], a[172:175], a[56:59]
ds_read_b64_tr_b16 v[14:15], v26 offset:6400
v_mfma_f32_16x16x32_bf16 a[64:67], v[8:11], a[152:155], 0
buffer_load_dwordx4 a[4:7], v18, s[28:31], s50 offen nt
v_exp_f32 v194, v194
v_mfma_f32_16x16x32_bf16 a[64:67], v[4:7], a[176:179], a[64:67]
v_fma_f32 v197, v197, s44, v24
v_mfma_f32_16x16x32_bf16 a[72:75], v[8:11], a[156:159], 0
v_exp_f32 v195, v195
v_mfma_f32_16x16x32_bf16 a[72:75], v[4:7], a[180:183], a[72:75]
v_fma_f32 v198, v198, s44, v24
v_cvt_pk_bf16_f32 v176, v192, v193
v_mfma_f32_16x16x32_bf16 a[80:83], v[8:11], a[160:163], 0
v_exp_f32 v196, v196
v_mfma_f32_16x16x32_bf16 a[80:83], v[4:7], a[184:187], a[80:83]
s_add_u32 s50, s49, 6144
v_fma_f32 v199, v199, s44, v24
v_mfma_f32_16x16x32_bf16 a[88:91], v[8:11], a[164:167], 0
buffer_load_dwordx4 a[8:11], v18, s[28:31], s50 offen nt
v_exp_f32 v197, v197
v_mfma_f32_16x16x32_bf16 a[88:91], v[4:7], a[188:191], a[88:91]
s_waitcnt lgkmcnt(2)
v_fma_f32 v200, v200, s44, v25
v_cvt_pk_bf16_f32 v177, v194, v195
v_mfma_f32_16x16x32_bf16 a[52:55], v[0:3], a[144:147], 0
s_waitcnt lgkmcnt(0)
v_exp_f32 v198, v198
v_mfma_f32_16x16x32_bf16 a[52:55], v[12:15], a[168:171], a[52:55]
v_fma_f32 v201, v201, s44, v25
v_mfma_f32_16x16x32_bf16 a[60:63], v[0:3], a[148:151], 0
v_exp_f32 v199, v199
v_mfma_f32_16x16x32_bf16 a[60:63], v[12:15], a[172:175], a[60:63]
v_fma_f32 v202, v202, s44, v25
v_cvt_pk_bf16_f32 v178, v196, v197
v_mfma_f32_16x16x32_bf16 a[68:71], v[0:3], a[152:155], 0
v_exp_f32 v200, v200
v_mfma_f32_16x16x32_bf16 a[68:71], v[12:15], a[176:179], a[68:71]
v_fma_f32 v203, v203, s44, v25
v_mfma_f32_16x16x32_bf16 a[76:79], v[0:3], a[156:159], 0
v_exp_f32 v201, v201
v_mfma_f32_16x16x32_bf16 a[76:79], v[12:15], a[180:183], a[76:79]
s_add_u32 s50, s49, 9216
v_fma_f32 v204, v204, s44, v25
v_cvt_pk_bf16_f32 v179, v198, v199
v_mfma_f32_16x16x32_bf16 a[84:87], v[0:3], a[160:163], 0
buffer_load_dwordx4 a[12:15], v18, s[28:31], s50 offen nt
v_mfma_f32_16x16x32_bf16 a[84:87], v[12:15], a[184:187], a[84:87]
v_exp_f32 v202, v202
v_mfma_f32_16x16x32_bf16 a[92:95], v[0:3], a[164:167], 0
v_fma_f32 v205, v205, s44, v25
v_mfma_f32_16x16x32_bf16 a[92:95], v[12:15], a[188:191], a[92:95]
v_exp_f32 v203, v203
v_mfma_f32_16x16x32_bf16 a[120:123], v[28:31], a[192:195], a[120:123]
ds_read_b64_tr_b16 v[12:13], v26 offset:8192
v_fma_f32 v206, v206, s44, v25
v_mfma_f32_16x16x32_bf16 a[120:123], v[28:31], a[216:219], a[120:123]
ds_read_b64_tr_b16 v[14:15], v26 offset:10240
v_cvt_pk_bf16_f32 v180, v200, v201
v_mfma_f32_16x16x32_bf16 a[124:127], v[28:31], a[196:199], a[124:127]
ds_read_b64_tr_b16 v[0:1], v26 offset:12288
v_mfma_f32_16x16x32_bf16 a[124:127], v[28:31], a[220:223], a[124:127]
ds_read_b64_tr_b16 v[2:3], v26 offset:14336
v_exp_f32 v204, v204
v_mfma_f32_16x16x32_bf16 a[128:131], v[28:31], a[200:203], a[128:131]
v_fma_f32 v207, v207, s44, v25
v_mfma_f32_16x16x32_bf16 a[128:131], v[28:31], a[224:227], a[128:131]
s_add_u32 s50, s49, 128
v_exp_f32 v205, v205
v_mfma_f32_16x16x32_bf16 a[132:135], v[28:31], a[204:207], a[132:135]
buffer_load_dwordx4 a[16:19], v18, s[28:31], s50 offen nt
v_cvt_pk_bf16_f32 v181, v202, v203
v_mfma_f32_16x16x32_bf16 a[132:135], v[28:31], a[228:231], a[132:135]
v_exp_f32 v206, v206
v_mfma_f32_16x16x32_bf16 a[136:139], v[28:31], a[208:211], a[136:139]
v_exp_f32 v207, v207
v_mov_b32 v184, v26
v_mov_b32 v185, v26
v_mfma_f32_16x16x32_bf16 a[136:139], v[28:31], a[232:235], a[136:139]
v_cvt_pk_bf16_f32 v182, v204, v205
v_cvt_pk_bf16_f32 v183, v206, v207
v_mfma_f32_16x16x32_bf16 a[140:143], v[28:31], a[212:215], a[140:143]
v_fma_f32 v208, v208, s44, v20
v_fma_f32 v209, v209, s44, v20
v_mfma_f32_16x16x32_bf16 a[140:143], v[28:31], a[236:239], a[140:143]
s_waitcnt lgkmcnt(2)
v_fma_f32 v210, v210, s44, v20
v_mfma_f32_16x16x32_bf16 a[48:51], v[12:15], a[192:195], a[48:51]
s_waitcnt lgkmcnt(0)
ds_read_b64_tr_b16 v[4:5], v184 offset:8448
v_mfma_f32_16x16x32_bf16 a[48:51], v[0:3], a[216:219], a[48:51]
ds_read_b64_tr_b16 v[6:7], v184 offset:10496
v_exp_f32 v208, v208
v_mfma_f32_16x16x32_bf16 a[56:59], v[12:15], a[196:199], a[56:59]
ds_read_b64_tr_b16 v[8:9], v184 offset:12544
v_fma_f32 v211, v211, s44, v20
v_mfma_f32_16x16x32_bf16 a[56:59], v[0:3], a[220:223], a[56:59]
s_add_u32 s50, s49, 3200
ds_read_b64_tr_b16 v[10:11], v184 offset:14592
v_exp_f32 v209, v209
v_mfma_f32_16x16x32_bf16 a[64:67], v[12:15], a[200:203], a[64:67]
buffer_load_dwordx4 a[20:23], v18, s[28:31], s50 offen nt
v_fma_f32 v212, v212, s44, v20
v_mfma_f32_16x16x32_bf16 a[64:67], v[0:3], a[224:227], a[64:67]
v_exp_f32 v210, v210
v_mfma_f32_16x16x32_bf16 a[72:75], v[12:15], a[204:207], a[72:75]
v_fma_f32 v213, v213, s44, v20
v_mfma_f32_16x16x32_bf16 a[72:75], v[0:3], a[228:231], a[72:75]
v_exp_f32 v211, v211
v_mfma_f32_16x16x32_bf16 a[80:83], v[12:15], a[208:211], a[80:83]
v_fma_f32 v214, v214, s44, v20
v_cvt_pk_bf16_f32 v208, v208, v209
v_mfma_f32_16x16x32_bf16 a[80:83], v[0:3], a[232:235], a[80:83]
v_exp_f32 v212, v212
v_mfma_f32_16x16x32_bf16 a[88:91], v[12:15], a[212:215], a[88:91]
v_fma_f32 v215, v215, s44, v20
v_mfma_f32_16x16x32_bf16 a[88:91], v[0:3], a[236:239], a[88:91]
s_waitcnt lgkmcnt(2)
v_exp_f32 v213, v213
v_mfma_f32_16x16x32_bf16 a[52:55], v[4:7], a[192:195], a[52:55]
s_waitcnt lgkmcnt(0)
v_fma_f32 v216, v216, s44, v21
v_cvt_pk_bf16_f32 v209, v210, v211
v_mfma_f32_16x16x32_bf16 a[52:55], v[8:11], a[216:219], a[52:55]
s_add_u32 s50, s49, 6272
v_exp_f32 v214, v214
v_mfma_f32_16x16x32_bf16 a[60:63], v[4:7], a[196:199], a[60:63]
buffer_load_dwordx4 a[24:27], v18, s[28:31], s50 offen nt
v_mfma_f32_16x16x32_bf16 a[60:63], v[8:11], a[220:223], a[60:63]
v_fma_f32 v217, v217, s44, v21
v_mfma_f32_16x16x32_bf16 a[68:71], v[4:7], a[200:203], a[68:71]
v_exp_f32 v215, v215
v_mfma_f32_16x16x32_bf16 a[68:71], v[8:11], a[224:227], a[68:71]
v_fma_f32 v218, v218, s44, v21
v_cvt_pk_bf16_f32 v210, v212, v213
v_mfma_f32_16x16x32_bf16 a[76:79], v[4:7], a[204:207], a[76:79]
v_exp_f32 v216, v216
v_mfma_f32_16x16x32_bf16 a[76:79], v[8:11], a[228:231], a[76:79]
v_fma_f32 v219, v219, s44, v21
v_mfma_f32_16x16x32_bf16 a[84:87], v[4:7], a[208:211], a[84:87]
v_exp_f32 v217, v217
v_mfma_f32_16x16x32_bf16 a[84:87], v[8:11], a[232:235], a[84:87]
v_fma_f32 v220, v220, s44, v21
v_cvt_pk_bf16_f32 v211, v214, v215
v_mfma_f32_16x16x32_bf16 a[92:95], v[4:7], a[212:215], a[92:95]
v_exp_f32 v218, v218
v_mfma_f32_16x16x32_bf16 a[92:95], v[8:11], a[236:239], a[92:95]
s_add_u32 s50, s49, 9344
v_fma_f32 v221, v221, s44, v21
v_mfma_f32_16x16x32_bf16 a[120:123], v[28:31], a[240:243], a[120:123]
ds_read_b64_tr_b16 v[8:9], v184 offset:16384
v_mfma_f32_16x16x32_bf16 a[120:123], v[28:31], v[40:43], a[120:123]
ds_read_b64_tr_b16 v[10:11], v184 offset:18432
v_mfma_f32_16x16x32_bf16 a[124:127], v[28:31], a[244:247], a[124:127]
ds_read_b64_tr_b16 v[4:5], v184 offset:20480
v_mfma_f32_16x16x32_bf16 a[124:127], v[28:31], v[44:47], a[124:127]
ds_read_b64_tr_b16 v[6:7], v184 offset:22528
v_mfma_f32_16x16x32_bf16 a[128:131], v[28:31], a[248:251], a[128:131]
buffer_load_dwordx4 a[28:31], v18, s[28:31], s50 offen nt
v_exp_f32 v219, v219
v_mfma_f32_16x16x32_bf16 a[128:131], v[28:31], v[48:51], a[128:131]
v_fma_f32 v222, v222, s44, v21
v_cvt_pk_bf16_f32 v212, v216, v217
v_mfma_f32_16x16x32_bf16 a[132:135], v[28:31], a[252:255], a[132:135]
v_exp_f32 v220, v220
v_mfma_f32_16x16x32_bf16 a[132:135], v[28:31], v[52:55], a[132:135]
v_fma_f32 v223, v223, s44, v21
v_mfma_f32_16x16x32_bf16 a[136:139], v[28:31], v[32:35], a[136:139]
v_exp_f32 v221, v221
v_mfma_f32_16x16x32_bf16 a[136:139], v[28:31], v[56:59], a[136:139]
s_add_u32 s50, s49, 256
v_cvt_pk_bf16_f32 v213, v218, v219
v_mfma_f32_16x16x32_bf16 a[140:143], v[28:31], v[36:39], a[140:143]
buffer_load_dwordx4 a[32:35], v18, s[28:31], s50 offen nt
v_mfma_f32_16x16x32_bf16 a[140:143], v[28:31], v[60:63], a[140:143]
s_waitcnt lgkmcnt(2)
v_exp_f32 v222, v222
v_mfma_f32_16x16x32_bf16 a[48:51], v[8:11], a[240:243], a[48:51]
s_waitcnt lgkmcnt(0)
ds_read_b64_tr_b16 v[0:1], v184 offset:16640
v_mfma_f32_16x16x32_bf16 a[48:51], v[4:7], v[40:43], a[48:51]
ds_read_b64_tr_b16 v[2:3], v184 offset:18688
v_exp_f32 v223, v223
v_mfma_f32_16x16x32_bf16 a[56:59], v[8:11], a[244:247], a[56:59]
ds_read_b64_tr_b16 v[12:13], v184 offset:20736
v_cvt_pk_bf16_f32 v214, v220, v221
v_mfma_f32_16x16x32_bf16 a[56:59], v[4:7], v[44:47], a[56:59]
ds_read_b64_tr_b16 v[14:15], v184 offset:22784
v_cvt_pk_bf16_f32 v215, v222, v223
v_mfma_f32_16x16x32_bf16 a[64:67], v[8:11], a[248:251], a[64:67]
v_fma_f32 v224, v224, s44, v22
v_fma_f32 v225, v225, s44, v22
v_mfma_f32_16x16x32_bf16 a[64:67], v[4:7], v[48:51], a[64:67]
v_fma_f32 v226, v226, s44, v22
v_mfma_f32_16x16x32_bf16 a[72:75], v[8:11], a[252:255], a[72:75]
v_exp_f32 v224, v224
v_mfma_f32_16x16x32_bf16 a[72:75], v[4:7], v[52:55], a[72:75]
s_add_u32 s50, s49, 3328
v_fma_f32 v227, v227, s44, v22
v_mfma_f32_16x16x32_bf16 a[80:83], v[8:11], v[32:35], a[80:83]
buffer_load_dwordx4 a[36:39], v18, s[28:31], s50 offen nt
v_exp_f32 v225, v225
v_mfma_f32_16x16x32_bf16 a[80:83], v[4:7], v[56:59], a[80:83]
v_fma_f32 v228, v228, s44, v22
v_mfma_f32_16x16x32_bf16 a[88:91], v[8:11], v[36:39], a[88:91]
v_exp_f32 v226, v226
v_mfma_f32_16x16x32_bf16 a[88:91], v[4:7], v[60:63], a[88:91]
s_waitcnt lgkmcnt(2)
v_fma_f32 v229, v229, s44, v22
v_mfma_f32_16x16x32_bf16 a[52:55], v[0:3], a[240:243], a[52:55]
s_waitcnt lgkmcnt(0)
v_exp_f32 v227, v227
v_mfma_f32_16x16x32_bf16 a[52:55], v[12:15], v[40:43], a[52:55]
v_fma_f32 v230, v230, s44, v22
v_cvt_pk_bf16_f32 v216, v224, v225
v_mfma_f32_16x16x32_bf16 a[60:63], v[0:3], a[244:247], a[60:63]
v_exp_f32 v228, v228
v_mfma_f32_16x16x32_bf16 a[60:63], v[12:15], v[44:47], a[60:63]
v_fma_f32 v231, v231, s44, v22
v_mfma_f32_16x16x32_bf16 a[68:71], v[0:3], a[248:251], a[68:71]
v_exp_f32 v229, v229
v_mfma_f32_16x16x32_bf16 a[68:71], v[12:15], v[48:51], a[68:71]
s_add_u32 s50, s49, 6400
v_fma_f32 v232, v232, s44, v23
v_cvt_pk_bf16_f32 v217, v226, v227
v_mfma_f32_16x16x32_bf16 a[76:79], v[0:3], a[252:255], a[76:79]
buffer_load_dwordx4 a[40:43], v18, s[28:31], s50 offen nt
v_mfma_f32_16x16x32_bf16 a[76:79], v[12:15], v[52:55], a[76:79]
v_exp_f32 v230, v230
v_mfma_f32_16x16x32_bf16 a[84:87], v[0:3], v[32:35], a[84:87]
v_fma_f32 v233, v233, s44, v23
v_mfma_f32_16x16x32_bf16 a[84:87], v[12:15], v[56:59], a[84:87]
v_exp_f32 v231, v231
v_mfma_f32_16x16x32_bf16 a[92:95], v[0:3], v[36:39], a[92:95]
s_waitcnt vmcnt(32)
s_barrier
v_mfma_f32_16x16x32_bf16 a[92:95], v[12:15], v[60:63], a[92:95]
v_fma_f32 v234, v234, s44, v23
v_cvt_pk_bf16_f32 v218, v228, v229
v_mfma_f32_16x16x32_bf16 a[120:123], v[28:31], v[64:67], a[120:123]
ds_read_b64_tr_b16 v[12:13], v184 offset:24576
v_mfma_f32_16x16x32_bf16 a[120:123], v[28:31], v[88:91], a[120:123]
ds_read_b64_tr_b16 v[14:15], v184 offset:26624
v_mfma_f32_16x16x32_bf16 a[124:127], v[28:31], v[68:71], a[124:127]
ds_read_b64_tr_b16 v[0:1], v184 offset:28672
v_exp_f32 v232, v232
v_mfma_f32_16x16x32_bf16 a[124:127], v[28:31], v[92:95], a[124:127]
s_add_u32 s50, s49, 9472
ds_read_b64_tr_b16 v[2:3], v184 offset:30720
v_fma_f32 v235, v235, s44, v23
v_mfma_f32_16x16x32_bf16 a[128:131], v[28:31], v[72:75], a[128:131]
buffer_load_dwordx4 a[44:47], v18, s[28:31], s50 offen nt
v_exp_f32 v233, v233
v_mfma_f32_16x16x32_bf16 a[128:131], v[28:31], v[96:99], a[128:131]
v_fma_f32 v236, v236, s44, v23
v_cvt_pk_bf16_f32 v219, v230, v231
v_mfma_f32_16x16x32_bf16 a[132:135], v[28:31], v[76:79], a[132:135]
v_exp_f32 v234, v234
v_mfma_f32_16x16x32_bf16 a[132:135], v[28:31], v[100:103], a[132:135]
v_fma_f32 v237, v237, s44, v23
v_mfma_f32_16x16x32_bf16 a[136:139], v[28:31], v[80:83], a[136:139]
v_exp_f32 v235, v235
v_mfma_f32_16x16x32_bf16 a[136:139], v[28:31], v[104:107], a[136:139]
v_fma_f32 v238, v238, s44, v23
v_cvt_pk_bf16_f32 v220, v232, v233
v_mfma_f32_16x16x32_bf16 a[140:143], v[28:31], v[84:87], a[140:143]
v_exp_f32 v236, v236
v_mfma_f32_16x16x32_bf16 a[140:143], v[28:31], v[108:111], a[140:143]
s_waitcnt lgkmcnt(2)
v_fma_f32 v239, v239, s44, v23
v_mfma_f32_16x16x32_bf16 a[48:51], v[12:15], v[64:67], a[48:51]
s_waitcnt lgkmcnt(0)
ds_read_b64_tr_b16 v[4:5], v184 offset:24832
v_mfma_f32_16x16x32_bf16 a[48:51], v[0:3], v[88:91], a[48:51]
s_add_u32 m0, s47, 135168
ds_read_b64_tr_b16 v[6:7], v184 offset:26880
v_mfma_f32_16x16x32_bf16 a[56:59], v[12:15], v[68:71], a[56:59]
s_add_u32 s50, s87, 256
ds_read_b64_tr_b16 v[8:9], v184 offset:28928
v_mfma_f32_16x16x32_bf16 a[56:59], v[0:3], v[92:95], a[56:59]
ds_read_b64_tr_b16 v[10:11], v184 offset:30976
v_exp_f32 v237, v237
v_mfma_f32_16x16x32_bf16 a[64:67], v[12:15], v[72:75], a[64:67]
buffer_load_dwordx4 v19, s[20:23], s50 offen nt lds
v_cvt_pk_bf16_f32 v221, v234, v235
v_mfma_f32_16x16x32_bf16 a[64:67], v[0:3], v[96:99], a[64:67]
v_exp_f32 v238, v238
v_mfma_f32_16x16x32_bf16 a[72:75], v[12:15], v[76:79], a[72:75]
v_exp_f32 v239, v239
v_mfma_f32_16x16x32_bf16 a[72:75], v[0:3], v[100:103], a[72:75]
v_cvt_pk_bf16_f32 v222, v236, v237
v_cvt_pk_bf16_f32 v223, v238, v239
v_mfma_f32_16x16x32_bf16 a[80:83], v[12:15], v[80:83], a[80:83]
v_fma_f32 v240, v240, s44, v24
v_fma_f32 v241, v241, s44, v24
v_mfma_f32_16x16x32_bf16 a[80:83], v[0:3], v[104:107], a[80:83]
v_fma_f32 v242, v242, s44, v24
v_mfma_f32_16x16x32_bf16 a[88:91], v[12:15], v[84:87], a[88:91]
s_add_u32 m0, s47, 136192
v_exp_f32 v240, v240
v_mfma_f32_16x16x32_bf16 a[88:91], v[0:3], v[108:111], a[88:91]
s_waitcnt lgkmcnt(2)
v_fma_f32 v243, v243, s44, v24
v_mfma_f32_16x16x32_bf16 a[52:55], v[4:7], v[64:67], a[52:55]
s_waitcnt lgkmcnt(0)
v_exp_f32 v241, v241
v_mfma_f32_16x16x32_bf16 a[52:55], v[8:11], v[88:91], a[52:55]
s_add_u32 s50, s87, 3328
buffer_load_dwordx4 v19, s[20:23], s50 offen nt lds
v_mfma_f32_16x16x32_bf16 a[60:63], v[4:7], v[68:71], a[60:63]
v_fma_f32 v244, v244, s44, v24
v_mfma_f32_16x16x32_bf16 a[60:63], v[8:11], v[92:95], a[60:63]
v_exp_f32 v242, v242
v_mfma_f32_16x16x32_bf16 a[68:71], v[4:7], v[72:75], a[68:71]
v_fma_f32 v245, v245, s44, v24
v_mfma_f32_16x16x32_bf16 a[68:71], v[8:11], v[96:99], a[68:71]
v_exp_f32 v243, v243
v_mfma_f32_16x16x32_bf16 a[76:79], v[4:7], v[76:79], a[76:79]
v_fma_f32 v246, v246, s44, v24
v_cvt_pk_bf16_f32 v224, v240, v241
v_mfma_f32_16x16x32_bf16 a[76:79], v[8:11], v[100:103], a[76:79]
v_exp_f32 v244, v244
v_mfma_f32_16x16x32_bf16 a[84:87], v[4:7], v[80:83], a[84:87]
s_add_u32 m0, s47, 137216
v_fma_f32 v247, v247, s44, v24
v_mfma_f32_16x16x32_bf16 a[84:87], v[8:11], v[104:107], a[84:87]
s_add_u32 s50, s87, 6400
v_exp_f32 v245, v245
v_mfma_f32_16x16x32_bf16 a[92:95], v[4:7], v[84:87], a[92:95]
buffer_load_dwordx4 v19, s[20:23], s50 offen nt lds
v_mfma_f32_16x16x32_bf16 a[92:95], v[8:11], v[108:111], a[92:95]
v_fma_f32 v248, v248, s44, v25
v_cvt_pk_bf16_f32 v225, v242, v243
v_mfma_f32_16x16x32_bf16 a[120:123], v[28:31], v[112:115], a[120:123]
ds_read_b64_tr_b16 v[8:9], v184 offset:32768
v_mfma_f32_16x16x32_bf16 a[120:123], v[28:31], v[136:139], a[120:123]
ds_read_b64_tr_b16 v[10:11], v184 offset:34816
v_mfma_f32_16x16x32_bf16 a[124:127], v[28:31], v[116:119], a[124:127]
ds_read_b64_tr_b16 v[4:5], v184 offset:36864
v_exp_f32 v246, v246
v_mfma_f32_16x16x32_bf16 a[124:127], v[28:31], v[140:143], a[124:127]
ds_read_b64_tr_b16 v[6:7], v184 offset:38912
v_fma_f32 v249, v249, s44, v25
v_mfma_f32_16x16x32_bf16 a[128:131], v[28:31], v[120:123], a[128:131]
v_exp_f32 v247, v247
v_mfma_f32_16x16x32_bf16 a[128:131], v[28:31], v[144:147], a[128:131]
v_fma_f32 v250, v250, s44, v25
v_cvt_pk_bf16_f32 v226, v244, v245
v_mfma_f32_16x16x32_bf16 a[132:135], v[28:31], v[124:127], a[132:135]
v_exp_f32 v248, v248
v_mfma_f32_16x16x32_bf16 a[132:135], v[28:31], v[148:151], a[132:135]
v_fma_f32 v251, v251, s44, v25
v_mfma_f32_16x16x32_bf16 a[136:139], v[28:31], v[128:131], a[136:139]
v_exp_f32 v249, v249
v_mfma_f32_16x16x32_bf16 a[136:139], v[28:31], v[152:155], a[136:139]
v_fma_f32 v252, v252, s44, v25
v_cvt_pk_bf16_f32 v227, v246, v247
v_mfma_f32_16x16x32_bf16 a[140:143], v[28:31], v[132:135], a[140:143]
v_exp_f32 v250, v250
v_mfma_f32_16x16x32_bf16 a[140:143], v[28:31], v[156:159], a[140:143]
s_waitcnt lgkmcnt(2)
v_fma_f32 v253, v253, s44, v25
v_mfma_f32_16x16x32_bf16 a[48:51], v[8:11], v[112:115], a[48:51]
s_waitcnt lgkmcnt(0)
ds_read_b64_tr_b16 v[0:1], v184 offset:33024
v_mfma_f32_16x16x32_bf16 a[48:51], v[4:7], v[136:139], a[48:51]
ds_read_b64_tr_b16 v[2:3], v184 offset:35072
v_mfma_f32_16x16x32_bf16 a[56:59], v[8:11], v[116:119], a[56:59]
ds_read_b64_tr_b16 v[12:13], v184 offset:37120
v_mfma_f32_16x16x32_bf16 a[56:59], v[4:7], v[140:143], a[56:59]
ds_read_b64_tr_b16 v[14:15], v184 offset:39168
v_exp_f32 v251, v251
v_mfma_f32_16x16x32_bf16 a[64:67], v[8:11], v[120:123], a[64:67]
v_fma_f32 v254, v254, s44, v25
v_cvt_pk_bf16_f32 v228, v248, v249
v_mfma_f32_16x16x32_bf16 a[64:67], v[4:7], v[144:147], a[64:67]
v_exp_f32 v252, v252
v_mfma_f32_16x16x32_bf16 a[72:75], v[8:11], v[124:127], a[72:75]
v_fma_f32 v255, v255, s44, v25
v_mfma_f32_16x16x32_bf16 a[72:75], v[4:7], v[148:151], a[72:75]
v_exp_f32 v253, v253
v_mfma_f32_16x16x32_bf16 a[80:83], v[8:11], v[128:131], a[80:83]
v_cvt_pk_bf16_f32 v229, v250, v251
v_mbcnt_lo_u32_b32 v238, -1, 0
v_mfma_f32_16x16x32_bf16 a[80:83], v[4:7], v[152:155], a[80:83]
v_exp_f32 v254, v254
v_mfma_f32_16x16x32_bf16 a[88:91], v[8:11], v[132:135], a[88:91]
v_exp_f32 v255, v255
v_mfma_f32_16x16x32_bf16 a[88:91], v[4:7], v[156:159], a[88:91]
s_waitcnt lgkmcnt(2)
v_cvt_pk_bf16_f32 v230, v252, v253
v_cvt_pk_bf16_f32 v231, v254, v255
v_mfma_f32_16x16x32_bf16 a[52:55], v[0:3], v[112:115], a[52:55]
s_waitcnt lgkmcnt(0)
v_mbcnt_hi_u32_b32 v238, -1, v238
v_lshrrev_b32 v237, 5, v238
v_mfma_f32_16x16x32_bf16 a[52:55], v[12:15], v[136:139], a[52:55]
v_and_b32 v236, 7, v238
v_xor_b32 v236, v237, v236
v_mfma_f32_16x16x32_bf16 a[60:63], v[0:3], v[116:119], a[60:63]
v_lshlrev_b32 v236, 4, v236
v_mfma_f32_16x16x32_bf16 a[60:63], v[12:15], v[140:143], a[60:63]
v_and_b32 v237, 15, v238
v_mfma_f32_16x16x32_bf16 a[68:71], v[0:3], v[120:123], a[68:71]
v_lshl_add_u32 v236, v237, 7, v236
v_mfma_f32_16x16x32_bf16 a[68:71], v[12:15], v[144:147], a[68:71]
v_mfma_f32_16x16x32_bf16 a[76:79], v[0:3], v[124:127], a[76:79]
v_bfe_u32 v237, v238, 4, 1
v_mfma_f32_16x16x32_bf16 a[76:79], v[12:15], v[148:151], a[76:79]
v_lshl_add_u32 v236, v237, 3, v236
v_mfma_f32_16x16x32_bf16 a[84:87], v[0:3], v[128:131], a[84:87]
v_add_u32 v236, s55, v236
v_mfma_f32_16x16x32_bf16 a[84:87], v[12:15], v[152:155], a[84:87]
v_lshrrev_b32 v186, 3, v238
v_mfma_f32_16x16x32_bf16 a[92:95], v[0:3], v[132:135], a[92:95]
v_mfma_f32_16x16x32_bf16 a[92:95], v[12:15], v[156:159], a[92:95]
v_mul_u32_u24 v186, 0x90, v186
v_mfma_f32_16x16x32_bf16 a[120:123], v[28:31], v[160:163], a[120:123]
ds_read_b64_tr_b16 v[12:13], v184 offset:40960
v_and_b32 v237, 0x70, v18
v_mfma_f32_16x16x32_bf16 a[120:123], v[28:31], v[208:211], a[120:123]
ds_read_b64_tr_b16 v[14:15], v184 offset:43008
v_xor_b32 v186, v186, v237
v_mfma_f32_16x16x32_bf16 a[124:127], v[28:31], v[164:167], a[124:127]
ds_read_b64_tr_b16 v[0:1], v184 offset:45056
v_add_u32 v186, s55, v186
v_mfma_f32_16x16x32_bf16 a[124:127], v[28:31], v[212:215], a[124:127]
ds_read_b64_tr_b16 v[2:3], v184 offset:47104
v_mfma_f32_16x16x32_bf16 a[128:131], v[28:31], v[168:171], a[128:131]
v_xor_b32 v237, 32, v236
v_mfma_f32_16x16x32_bf16 a[128:131], v[28:31], v[216:219], a[128:131]
v_xor_b32 v238, 64, v236
v_mfma_f32_16x16x32_bf16 a[132:135], v[28:31], v[172:175], a[132:135]
v_xor_b32 v239, 96, v236
v_mfma_f32_16x16x32_bf16 a[132:135], v[28:31], v[220:223], a[132:135]
v_mfma_f32_16x16x32_bf16 a[136:139], v[28:31], v[176:179], a[136:139]
v_mfma_f32_16x16x32_bf16 a[136:139], v[28:31], v[224:227], a[136:139]
v_mfma_f32_16x16x32_bf16 a[140:143], v[28:31], v[180:183], a[140:143]
v_mfma_f32_16x16x32_bf16 a[140:143], v[28:31], v[228:231], a[140:143]
s_waitcnt lgkmcnt(2)
v_mfma_f32_16x16x32_bf16 a[48:51], v[12:15], v[160:163], a[48:51]
s_waitcnt lgkmcnt(0)
ds_read_b64_tr_b16 v[4:5], v184 offset:41216
v_mfma_f32_16x16x32_bf16 a[48:51], v[0:3], v[208:211], a[48:51]
ds_read_b64_tr_b16 v[6:7], v184 offset:43264
v_mfma_f32_16x16x32_bf16 a[56:59], v[12:15], v[164:167], a[56:59]
ds_read_b64_tr_b16 v[8:9], v184 offset:45312
v_mfma_f32_16x16x32_bf16 a[56:59], v[0:3], v[212:215], a[56:59]
ds_read_b64_tr_b16 v[10:11], v184 offset:47360
v_mfma_f32_16x16x32_bf16 a[64:67], v[12:15], v[168:171], a[64:67]
v_mfma_f32_16x16x32_bf16 a[64:67], v[0:3], v[216:219], a[64:67]
v_mfma_f32_16x16x32_bf16 a[72:75], v[12:15], v[172:175], a[72:75]
v_accvgpr_read_b32 v26, a120
v_accvgpr_read_b32 v27, a124
v_mfma_f32_16x16x32_bf16 a[72:75], v[0:3], v[220:223], a[72:75]
v_accvgpr_read_b32 v28, a128
v_mfma_f32_16x16x32_bf16 a[80:83], v[12:15], v[176:179], a[80:83]
v_accvgpr_read_b32 v29, a132
v_accvgpr_read_b32 v30, a136
v_mfma_f32_16x16x32_bf16 a[80:83], v[0:3], v[224:227], a[80:83]
v_accvgpr_read_b32 v31, a140
v_mfma_f32_16x16x32_bf16 a[88:91], v[12:15], v[180:183], a[88:91]
v_add_f32 v20, v26, v27
v_min_f32 v21, v26, v27
v_mfma_f32_16x16x32_bf16 a[88:91], v[0:3], v[228:231], a[88:91]
s_waitcnt lgkmcnt(2)
v_cmp_nle_f32 s[90:91], v20, s46
v_mfma_f32_16x16x32_bf16 a[52:55], v[4:7], v[160:163], a[52:55]
s_waitcnt lgkmcnt(0)
ds_read_b64_tr_b16 v[0:1], v184 offset:512
v_cmp_nle_f32 vcc, 0.5, v21
v_mfma_f32_16x16x32_bf16 a[52:55], v[8:11], v[208:211], a[52:55]
s_or_b64 s[90:91], s[90:91], vcc
ds_read_b64_tr_b16 v[2:3], v184 offset:2560
v_mfma_f32_16x16x32_bf16 a[60:63], v[4:7], v[164:167], a[60:63]
ds_read_b64_tr_b16 v[12:13], v184 offset:4608
v_mfma_f32_16x16x32_bf16 a[60:63], v[8:11], v[212:215], a[60:63]
ds_read_b64_tr_b16 v[14:15], v184 offset:6656
v_mfma_f32_16x16x32_bf16 a[68:71], v[4:7], v[168:171], a[68:71]
v_rcp_f32 v26, v26
v_mfma_f32_16x16x32_bf16 a[68:71], v[8:11], v[216:219], a[68:71]
v_rcp_f32 v27, v27
v_mfma_f32_16x16x32_bf16 a[76:79], v[4:7], v[172:175], a[76:79]
v_add_f32 v20, v28, v29
v_min_f32 v21, v28, v29
v_mfma_f32_16x16x32_bf16 a[76:79], v[8:11], v[220:223], a[76:79]
v_cmp_nle_f32 s[92:93], v20, s46
v_cmp_nle_f32 vcc, 0.5, v21
v_mfma_f32_16x16x32_bf16 a[84:87], v[4:7], v[176:179], a[84:87]
s_or_b64 s[92:93], s[92:93], vcc
v_rcp_f32 v28, v28
v_mfma_f32_16x16x32_bf16 a[84:87], v[8:11], v[224:227], a[84:87]
v_rcp_f32 v29, v29
v_mfma_f32_16x16x32_bf16 a[92:95], v[4:7], v[180:183], a[92:95]
v_add_f32 v20, v30, v31
v_min_f32 v21, v30, v31
v_mfma_f32_16x16x32_bf16 a[92:95], v[8:11], v[228:231], a[92:95]
s_waitcnt lgkmcnt(2)
v_cmp_nle_f32 s[94:95], v20, s46
v_cmp_nle_f32 vcc, 0.5, v21
v_mfma_f32_16x16x32_bf16 a[96:99], v[0:3], a[144:147], 0
s_waitcnt lgkmcnt(0)
ds_read_b64_tr_b16 v[8:9], v184 offset:768
v_mfma_f32_16x16x32_bf16 a[96:99], v[12:15], a[168:171], a[96:99]
s_or_b64 s[94:95], s[94:95], vcc
ds_read_b64_tr_b16 v[10:11], v184 offset:2816
v_mfma_f32_16x16x32_bf16 a[104:107], v[0:3], a[148:151], 0
ds_read_b64_tr_b16 v[4:5], v184 offset:4864
v_mfma_f32_16x16x32_bf16 a[104:107], v[12:15], a[172:175], a[104:107]
ds_read_b64_tr_b16 v[6:7], v184 offset:6912
v_mfma_f32_16x16x32_bf16 a[112:115], v[0:3], a[152:155], 0
v_rcp_f32 v30, v30
v_mfma_f32_16x16x32_bf16 a[112:115], v[12:15], a[176:179], a[112:115]
v_rcp_f32 v31, v31
v_mfma_f32_16x16x32_bf16 a[120:123], v[0:3], a[156:159], 0
v_accvgpr_read_b32 v188, a48
v_accvgpr_read_b32 v189, a49
v_mfma_f32_16x16x32_bf16 a[120:123], v[12:15], a[180:183], a[120:123]
v_accvgpr_read_b32 v190, a50
v_mfma_f32_16x16x32_bf16 a[128:131], v[0:3], a[160:163], 0
v_accvgpr_read_b32 v191, a51
v_mfma_f32_16x16x32_bf16 a[128:131], v[12:15], a[184:187], a[128:131]
v_mul_f32 v188, v188, v26
v_mfma_f32_16x16x32_bf16 a[136:139], v[0:3], a[164:167], 0
v_mul_f32 v189, v189, v26
v_mfma_f32_16x16x32_bf16 a[136:139], v[12:15], a[188:191], a[136:139]
s_waitcnt lgkmcnt(2)
v_cvt_pk_bf16_f32 v240, v188, v189
v_mfma_f32_16x16x32_bf16 a[100:103], v[8:11], a[144:147], 0
s_waitcnt lgkmcnt(0)
ds_read_b64_tr_b16 v[12:13], v184 offset:8704
v_accvgpr_read_b32 v188, a52
v_mfma_f32_16x16x32_bf16 a[100:103], v[4:7], a[168:171], a[100:103]
ds_read_b64_tr_b16 v[14:15], v184 offset:10752
v_accvgpr_read_b32 v189, a53
v_mfma_f32_16x16x32_bf16 a[108:111], v[8:11], a[148:151], 0
ds_read_b64_tr_b16 v[0:1], v184 offset:12800
v_mul_f32 v190, v190, v26
v_mfma_f32_16x16x32_bf16 a[108:111], v[4:7], a[172:175], a[108:111]
ds_read_b64_tr_b16 v[2:3], v184 offset:14848
v_mfma_f32_16x16x32_bf16 a[116:119], v[8:11], a[152:155], 0
v_mul_f32 v191, v191, v26
v_mfma_f32_16x16x32_bf16 a[116:119], v[4:7], a[176:179], a[116:119]
v_cvt_pk_bf16_f32 v241, v190, v191
v_mfma_f32_16x16x32_bf16 a[124:127], v[8:11], a[156:159], 0
v_accvgpr_read_b32 v190, a54
v_mfma_f32_16x16x32_bf16 a[124:127], v[4:7], a[180:183], a[124:127]
v_accvgpr_read_b32 v191, a55
v_mfma_f32_16x16x32_bf16 a[132:135], v[8:11], a[160:163], 0
v_mul_f32 v188, v188, v26
v_mfma_f32_16x16x32_bf16 a[132:135], v[4:7], a[184:187], a[132:135]
v_mul_f32 v189, v189, v26
v_mfma_f32_16x16x32_bf16 a[140:143], v[8:11], a[164:167], 0
v_cvt_pk_bf16_f32 v242, v188, v189
v_mfma_f32_16x16x32_bf16 a[140:143], v[4:7], a[188:191], a[140:143]
s_waitcnt lgkmcnt(2)
v_mul_f32 v190, v190, v26
v_mfma_f32_16x16x32_bf16 a[96:99], v[12:15], a[192:195], a[96:99]
s_waitcnt lgkmcnt(0)
ds_read_b64_tr_b16 v[4:5], v184 offset:8960
v_mul_f32 v191, v191, v26
v_mfma_f32_16x16x32_bf16 a[96:99], v[0:3], a[216:219], a[96:99]
ds_read_b64_tr_b16 v[6:7], v184 offset:11008
v_cvt_pk_bf16_f32 v243, v190, v191
v_mfma_f32_16x16x32_bf16 a[104:107], v[12:15], a[196:199], a[104:107]
ds_read_b64_tr_b16 v[8:9], v184 offset:13056
v_mfma_f32_16x16x32_bf16 a[104:107], v[0:3], a[220:223], a[104:107]
ds_read_b64_tr_b16 v[10:11], v184 offset:15104
v_accvgpr_read_b32 v188, a72
v_mfma_f32_16x16x32_bf16 a[112:115], v[12:15], a[200:203], a[112:115]
v_accvgpr_read_b32 v189, a73
v_mfma_f32_16x16x32_bf16 a[112:115], v[0:3], a[224:227], a[112:115]
v_accvgpr_read_b32 v190, a74
v_mfma_f32_16x16x32_bf16 a[120:123], v[12:15], a[204:207], a[120:123]
v_accvgpr_read_b32 v191, a75
v_mfma_f32_16x16x32_bf16 a[120:123], v[0:3], a[228:231], a[120:123]
s_waitcnt lgkmcnt(2)
s_barrier
v_mfma_f32_16x16x32_bf16 a[128:131], v[12:15], a[208:211], a[128:131]
v_mul_f32 v188, v188, v29
v_mul_f32 v189, v189, v29
v_mfma_f32_16x16x32_bf16 a[128:131], v[0:3], a[232:235], a[128:131]
s_add_u32 m0, s47, 0
v_cvt_pk_bf16_f32 v252, v188, v189
v_mfma_f32_16x16x32_bf16 a[136:139], v[12:15], a[212:215], a[136:139]
s_add_u32 s50, s84, 0
v_accvgpr_read_b32 v188, a76
v_mfma_f32_16x16x32_bf16 a[136:139], v[0:3], a[236:239], a[136:139]
buffer_load_dwordx4 v18, s[32:35], s50 offen nt lds
v_mfma_f32_16x16x32_bf16 a[100:103], v[4:7], a[192:195], a[100:103]
s_waitcnt lgkmcnt(0)
ds_read_b64_tr_b16 v[0:1], v184 offset:16896
v_accvgpr_read_b32 v189, a77
v_mfma_f32_16x16x32_bf16 a[100:103], v[8:11], a[216:219], a[100:103]
ds_read_b64_tr_b16 v[2:3], v184 offset:18944
v_mul_f32 v190, v190, v29
v_mfma_f32_16x16x32_bf16 a[108:111], v[4:7], a[196:199], a[108:111]
ds_read_b64_tr_b16 v[12:13], v184 offset:20992
v_mul_f32 v191, v191, v29
v_mfma_f32_16x16x32_bf16 a[108:111], v[8:11], a[220:223], a[108:111]
ds_read_b64_tr_b16 v[14:15], v184 offset:23040
v_cvt_pk_bf16_f32 v253, v190, v191
v_mfma_f32_16x16x32_bf16 a[116:119], v[4:7], a[200:203], a[116:119]
v_accvgpr_read_b32 v190, a78
v_mfma_f32_16x16x32_bf16 a[116:119], v[8:11], a[224:227], a[116:119]
v_accvgpr_read_b32 v191, a79
v_mfma_f32_16x16x32_bf16 a[124:127], v[4:7], a[204:207], a[124:127]
v_mul_f32 v188, v188, v29
v_mfma_f32_16x16x32_bf16 a[124:127], v[8:11], a[228:231], a[124:127]
v_mul_f32 v189, v189, v29
v_mfma_f32_16x16x32_bf16 a[132:135], v[4:7], a[208:211], a[132:135]
s_add_u32 m0, s47, 896
v_cvt_pk_bf16_f32 v254, v188, v189
v_mfma_f32_16x16x32_bf16 a[132:135], v[8:11], a[232:235], a[132:135]
buffer_load_dwordx4 v18, s[32:35], s50 offen offset:128 nt lds
v_mfma_f32_16x16x32_bf16 a[140:143], v[4:7], a[212:215], a[140:143]
v_mul_f32 v190, v190, v29
v_mul_f32 v191, v191, v29
v_mfma_f32_16x16x32_bf16 a[140:143], v[8:11], a[236:239], a[140:143]
s_waitcnt lgkmcnt(2)
v_mfma_f32_16x16x32_bf16 a[96:99], v[0:3], a[240:243], a[96:99]
s_waitcnt lgkmcnt(0)
ds_read_b64_tr_b16 v[8:9], v184 offset:17152
v_cvt_pk_bf16_f32 v255, v190, v191
v_mfma_f32_16x16x32_bf16 a[96:99], v[12:15], v[40:43], a[96:99]
ds_read_b64_tr_b16 v[10:11], v184 offset:19200
v_accvgpr_read_b32 v188, a56
v_mfma_f32_16x16x32_bf16 a[104:107], v[0:3], a[244:247], a[104:107]
ds_read_b64_tr_b16 v[4:5], v184 offset:21248
v_accvgpr_read_b32 v189, a57
v_mfma_f32_16x16x32_bf16 a[104:107], v[12:15], v[44:47], a[104:107]
ds_read_b64_tr_b16 v[6:7], v184 offset:23296
v_accvgpr_read_b32 v190, a58
v_mfma_f32_16x16x32_bf16 a[112:115], v[0:3], a[248:251], a[112:115]
v_accvgpr_read_b32 v191, a59
v_mfma_f32_16x16x32_bf16 a[112:115], v[12:15], v[48:51], a[112:115]
v_mul_f32 v188, v188, v27
v_mfma_f32_16x16x32_bf16 a[120:123], v[0:3], a[252:255], a[120:123]
s_add_u32 m0, s47, 1792
v_mul_f32 v189, v189, v27
v_mfma_f32_16x16x32_bf16 a[120:123], v[12:15], v[52:55], a[120:123]
buffer_load_dwordx4 v18, s[32:35], s50 offen offset:256 nt lds
v_mfma_f32_16x16x32_bf16 a[128:131], v[0:3], v[32:35], a[128:131]
v_cvt_pk_bf16_f32 v244, v188, v189
v_accvgpr_read_b32 v188, a60
v_mfma_f32_16x16x32_bf16 a[128:131], v[12:15], v[56:59], a[128:131]
s_waitcnt lgkmcnt(0)
s_barrier
v_mfma_f32_16x16x32_bf16 a[136:139], v[0:3], v[36:39], a[136:139]
v_accvgpr_read_b32 v189, a61
v_mfma_f32_16x16x32_bf16 a[136:139], v[12:15], v[60:63], a[136:139]
v_mul_f32 v190, v190, v27
v_mfma_f32_16x16x32_bf16 a[100:103], v[8:11], a[240:243], a[100:103]
ds_read_b64_tr_b16 v[12:13], v184 offset:25088
v_mul_f32 v191, v191, v27
v_mfma_f32_16x16x32_bf16 a[100:103], v[4:7], v[40:43], a[100:103]
ds_read_b64_tr_b16 v[14:15], v184 offset:27136
v_cvt_pk_bf16_f32 v245, v190, v191
v_mfma_f32_16x16x32_bf16 a[108:111], v[8:11], a[244:247], a[108:111]
ds_read_b64_tr_b16 v[0:1], v184 offset:29184
v_accvgpr_read_b32 v190, a62
v_mfma_f32_16x16x32_bf16 a[108:111], v[4:7], v[44:47], a[108:111]
s_add_u32 m0, s47, 12288
ds_read_b64_tr_b16 v[2:3], v184 offset:31232
v_accvgpr_read_b32 v191, a63
v_mfma_f32_16x16x32_bf16 a[116:119], v[8:11], a[248:251], a[116:119]
s_add_u32 s50, s84, 12288
v_mul_f32 v188, v188, v27
v_mfma_f32_16x16x32_bf16 a[116:119], v[4:7], v[48:51], a[116:119]
buffer_load_dwordx4 v18, s[32:35], s50 offen nt lds
v_mfma_f32_16x16x32_bf16 a[124:127], v[8:11], a[252:255], a[124:127]
v_mul_f32 v189, v189, v27
v_cvt_pk_bf16_f32 v246, v188, v189
v_mfma_f32_16x16x32_bf16 a[124:127], v[4:7], v[52:55], a[124:127]
v_mul_f32 v190, v190, v27
v_mfma_f32_16x16x32_bf16 a[132:135], v[8:11], v[32:35], a[132:135]
v_mfma_f32_16x16x32_bf16 a[132:135], v[4:7], v[56:59], a[132:135]
v_mul_f32 v191, v191, v27
v_mfma_f32_16x16x32_bf16 a[140:143], v[8:11], v[36:39], a[140:143]
v_cvt_pk_bf16_f32 v247, v190, v191
v_mfma_f32_16x16x32_bf16 a[140:143], v[4:7], v[60:63], a[140:143]
s_waitcnt lgkmcnt(2)
v_accvgpr_read_b32 v188, a80
v_mfma_f32_16x16x32_bf16 a[96:99], v[12:15], v[64:67], a[96:99]
s_waitcnt lgkmcnt(0)
ds_read_b64_tr_b16 v[4:5], v184 offset:25344
v_accvgpr_read_b32 v189, a81
v_mfma_f32_16x16x32_bf16 a[96:99], v[0:3], v[88:91], a[96:99]
ds_read_b64_tr_b16 v[6:7], v184 offset:27392
v_accvgpr_read_b32 v190, a82
v_mfma_f32_16x16x32_bf16 a[104:107], v[12:15], v[68:71], a[104:107]
s_add_u32 m0, s47, 13184
ds_read_b64_tr_b16 v[8:9], v184 offset:29440
v_accvgpr_read_b32 v191, a83
v_mfma_f32_16x16x32_bf16 a[104:107], v[0:3], v[92:95], a[104:107]
ds_read_b64_tr_b16 v[10:11], v184 offset:31488
v_mul_f32 v188, v188, v30
v_mfma_f32_16x16x32_bf16 a[112:115], v[12:15], v[72:75], a[112:115]
buffer_load_dwordx4 v18, s[32:35], s50 offen offset:128 nt lds
v_mfma_f32_16x16x32_bf16 a[112:115], v[0:3], v[96:99], a[112:115]
v_mul_f32 v189, v189, v30
v_cvt_pk_bf16_f32 v192, v188, v189
v_mfma_f32_16x16x32_bf16 a[120:123], v[12:15], v[76:79], a[120:123]
v_accvgpr_read_b32 v188, a84
v_mfma_f32_16x16x32_bf16 a[120:123], v[0:3], v[100:103], a[120:123]
v_mfma_f32_16x16x32_bf16 a[128:131], v[12:15], v[80:83], a[128:131]
v_accvgpr_read_b32 v189, a85
v_mfma_f32_16x16x32_bf16 a[128:131], v[0:3], v[104:107], a[128:131]
v_mul_f32 v190, v190, v30
v_mfma_f32_16x16x32_bf16 a[136:139], v[12:15], v[84:87], a[136:139]
v_mul_f32 v191, v191, v30
v_mfma_f32_16x16x32_bf16 a[136:139], v[0:3], v[108:111], a[136:139]
s_waitcnt lgkmcnt(2)
v_cvt_pk_bf16_f32 v193, v190, v191
v_mfma_f32_16x16x32_bf16 a[100:103], v[4:7], v[64:67], a[100:103]
s_waitcnt lgkmcnt(0)
ds_read_b64_tr_b16 v[0:1], v184 offset:33280
v_accvgpr_read_b32 v190, a86
v_mfma_f32_16x16x32_bf16 a[100:103], v[8:11], v[88:91], a[100:103]
s_add_u32 m0, s47, 14080
ds_read_b64_tr_b16 v[2:3], v184 offset:35328
v_accvgpr_read_b32 v191, a87
v_mfma_f32_16x16x32_bf16 a[108:111], v[4:7], v[68:71], a[108:111]
ds_read_b64_tr_b16 v[12:13], v184 offset:37376
v_mul_f32 v188, v188, v30
v_mfma_f32_16x16x32_bf16 a[108:111], v[8:11], v[92:95], a[108:111]
ds_read_b64_tr_b16 v[14:15], v184 offset:39424
v_mul_f32 v189, v189, v30
v_mfma_f32_16x16x32_bf16 a[116:119], v[4:7], v[72:75], a[116:119]
buffer_load_dwordx4 v18, s[32:35], s50 offen offset:256 nt lds
v_mfma_f32_16x16x32_bf16 a[116:119], v[8:11], v[96:99], a[116:119]
v_cvt_pk_bf16_f32 v194, v188, v189
v_mfma_f32_16x16x32_bf16 a[124:127], v[4:7], v[76:79], a[124:127]
v_mul_f32 v190, v190, v30
v_mfma_f32_16x16x32_bf16 a[124:127], v[8:11], v[100:103], a[124:127]
v_mul_f32 v191, v191, v30
v_mfma_f32_16x16x32_bf16 a[132:135], v[4:7], v[80:83], a[132:135]
v_cvt_pk_bf16_f32 v195, v190, v191
v_mfma_f32_16x16x32_bf16 a[132:135], v[8:11], v[104:107], a[132:135]
v_accvgpr_read_b32 v188, a64
v_mfma_f32_16x16x32_bf16 a[140:143], v[4:7], v[84:87], a[140:143]
v_accvgpr_read_b32 v189, a65
v_mfma_f32_16x16x32_bf16 a[140:143], v[8:11], v[108:111], a[140:143]
s_waitcnt lgkmcnt(2)
v_accvgpr_read_b32 v190, a66
v_mfma_f32_16x16x32_bf16 a[96:99], v[0:3], v[112:115], a[96:99]
s_waitcnt lgkmcnt(0)
ds_read_b64_tr_b16 v[8:9], v184 offset:33536
v_accvgpr_read_b32 v191, a67
v_mfma_f32_16x16x32_bf16 a[96:99], v[12:15], v[136:139], a[96:99]
ds_read_b64_tr_b16 v[10:11], v184 offset:35584
v_mul_f32 v188, v188, v28
v_mfma_f32_16x16x32_bf16 a[104:107], v[0:3], v[116:119], a[104:107]
ds_read_b64_tr_b16 v[4:5], v184 offset:37632
v_mul_f32 v189, v189, v28
v_mfma_f32_16x16x32_bf16 a[104:107], v[12:15], v[140:143], a[104:107]
ds_read_b64_tr_b16 v[6:7], v184 offset:39680
v_cvt_pk_bf16_f32 v248, v188, v189
v_mfma_f32_16x16x32_bf16 a[112:115], v[0:3], v[120:123], a[112:115]
v_mfma_f32_16x16x32_bf16 a[112:115], v[12:15], v[144:147], a[112:115]
v_accvgpr_read_b32 v188, a68
v_mfma_f32_16x16x32_bf16 a[120:123], v[0:3], v[124:127], a[120:123]
v_accvgpr_read_b32 v189, a69
v_mfma_f32_16x16x32_bf16 a[120:123], v[12:15], v[148:151], a[120:123]
s_waitcnt lgkmcnt(2)
s_barrier
v_mfma_f32_16x16x32_bf16 a[128:131], v[0:3], v[128:131], a[128:131]
v_mul_f32 v190, v190, v28
v_mul_f32 v191, v191, v28
v_mfma_f32_16x16x32_bf16 a[128:131], v[12:15], v[152:155], a[128:131]
s_add_u32 m0, s47, 24576
v_cvt_pk_bf16_f32 v249, v190, v191
v_mbcnt_lo_u32_b32 v235, -1, 0
v_mfma_f32_16x16x32_bf16 a[136:139], v[0:3], v[132:135], a[136:139]
s_add_u32 s50, s84, 24576
v_accvgpr_read_b32 v190, a70
v_mbcnt_hi_u32_b32 v235, -1, v235
v_mfma_f32_16x16x32_bf16 a[136:139], v[12:15], v[156:159], a[136:139]
buffer_load_dwordx4 v18, s[32:35], s50 offen nt lds
v_mfma_f32_16x16x32_bf16 a[100:103], v[8:11], v[112:115], a[100:103]
s_waitcnt lgkmcnt(0)
ds_read_b64_tr_b16 v[12:13], v184 offset:41472
v_accvgpr_read_b32 v191, a71
v_mfma_f32_16x16x32_bf16 a[100:103], v[4:7], v[136:139], a[100:103]
ds_read_b64_tr_b16 v[14:15], v184 offset:43520
v_bfe_u32 v233, v235, 1, 2
v_mfma_f32_16x16x32_bf16 a[108:111], v[8:11], v[116:119], a[108:111]
ds_read_b64_tr_b16 v[0:1], v184 offset:45568
v_mul_f32 v188, v188, v28
v_mfma_f32_16x16x32_bf16 a[108:111], v[4:7], v[140:143], a[108:111]
ds_read_b64_tr_b16 v[2:3], v184 offset:47616
v_or_b32 v233, s54, v233
v_mfma_f32_16x16x32_bf16 a[116:119], v[8:11], v[120:123], a[116:119]
v_mul_f32 v189, v189, v28
v_lshrrev_b32 v232, 4, v235
v_mfma_f32_16x16x32_bf16 a[116:119], v[4:7], v[144:147], a[116:119]
v_cvt_pk_bf16_f32 v250, v188, v189
v_mul_f32 v190, v190, v28
v_mfma_f32_16x16x32_bf16 a[124:127], v[8:11], v[124:127], a[124:127]
v_xor_b32 v232, v232, v233
v_mul_f32 v191, v191, v28
v_mfma_f32_16x16x32_bf16 a[124:127], v[4:7], v[148:151], a[124:127]
v_lshlrev_b32 v232, 4, v232
v_cvt_pk_bf16_f32 v251, v190, v191
v_mfma_f32_16x16x32_bf16 a[132:135], v[8:11], v[128:131], a[132:135]
s_add_u32 m0, s47, 25472
v_and_b32 v233, 7, v235
v_accvgpr_read_b32 v188, a88
v_mfma_f32_16x16x32_bf16 a[132:135], v[4:7], v[152:155], a[132:135]
buffer_load_dwordx4 v18, s[32:35], s50 offen offset:128 nt lds
v_mfma_f32_16x16x32_bf16 a[140:143], v[8:11], v[132:135], a[140:143]
v_lshl_add_u32 v232, v233, 7, v232
v_accvgpr_read_b32 v189, a89
v_mfma_f32_16x16x32_bf16 a[140:143], v[4:7], v[156:159], a[140:143]
s_waitcnt lgkmcnt(2)
v_bfe_u32 v233, v235, 3, 1
v_accvgpr_read_b32 v190, a90
v_mfma_f32_16x16x32_bf16 a[96:99], v[12:15], v[160:163], a[96:99]
s_waitcnt lgkmcnt(0)
ds_read_b64_tr_b16 v[4:5], v184 offset:41728
v_accvgpr_read_b32 v191, a91
v_mfma_f32_16x16x32_bf16 a[96:99], v[0:3], v[208:211], a[96:99]
ds_read_b64_tr_b16 v[6:7], v184 offset:43776
v_lshl_add_u32 v232, v233, 10, v232
v_mfma_f32_16x16x32_bf16 a[104:107], v[12:15], v[164:167], a[104:107]
ds_read_b64_tr_b16 v[8:9], v184 offset:45824
v_mul_f32 v188, v188, v31
v_mfma_f32_16x16x32_bf16 a[104:107], v[0:3], v[212:215], a[104:107]
ds_read_b64_tr_b16 v[10:11], v184 offset:47872
v_add_u32 v232, s55, v232
v_mfma_f32_16x16x32_bf16 a[112:115], v[12:15], v[168:171], a[112:115]
v_mul_f32 v189, v189, v31
v_xor_b32 v233, 64, v232
v_add_u32 v185, 0xc000, v185
v_mfma_f32_16x16x32_bf16 a[112:115], v[0:3], v[216:219], a[112:115]
v_cvt_pk_bf16_f32 v196, v188, v189
v_lshlrev_b32 v234, 4, v235
v_mfma_f32_16x16x32_bf16 a[120:123], v[12:15], v[172:175], a[120:123]
s_add_u32 m0, s47, 26368
v_accvgpr_read_b32 v188, a92
v_accvgpr_read_b32 v189, a93
v_mfma_f32_16x16x32_bf16 a[120:123], v[0:3], v[220:223], a[120:123]
buffer_load_dwordx4 v18, s[32:35], s50 offen offset:256 nt lds
v_mfma_f32_16x16x32_bf16 a[128:131], v[12:15], v[176:179], a[128:131]
v_add_u32 v234, s55, v234
v_mul_f32 v190, v190, v31
v_mfma_f32_16x16x32_bf16 a[128:131], v[0:3], v[224:227], a[128:131]
v_mul_f32 v191, v191, v31
v_cvt_pk_bf16_f32 v197, v190, v191
v_mfma_f32_16x16x32_bf16 a[136:139], v[12:15], v[180:183], a[136:139]
s_waitcnt vmcnt(33) lgkmcnt(0)
s_barrier
v_mfma_f32_16x16x32_bf16 a[136:139], v[0:3], v[228:231], a[136:139]
v_accvgpr_read_b32 v190, a94
v_accvgpr_read_b32 v191, a95
v_mfma_f32_16x16x32_bf16 a[100:103], v[4:7], v[160:163], a[100:103]
ds_read_b64_tr_b16 v[0:1], v185 offset:0
v_mul_f32 v188, v188, v31
v_mfma_f32_16x16x32_bf16 a[100:103], v[8:11], v[208:211], a[100:103]
ds_read_b64_tr_b16 v[2:3], v185 offset:2048
v_mul_f32 v189, v189, v31
v_mfma_f32_16x16x32_bf16 a[108:111], v[4:7], v[164:167], a[108:111]
ds_read_b64_tr_b16 v[12:13], v185 offset:4096
v_cvt_pk_bf16_f32 v198, v188, v189
v_mfma_f32_16x16x32_bf16 a[108:111], v[8:11], v[212:215], a[108:111]
s_add_u32 m0, s47, 36864
ds_read_b64_tr_b16 v[14:15], v185 offset:6144
v_mul_f32 v190, v190, v31
v_mfma_f32_16x16x32_bf16 a[116:119], v[4:7], v[168:171], a[116:119]
s_add_u32 s50, s85, 0
v_mul_f32 v191, v191, v31
v_cvt_pk_bf16_f32 v199, v190, v191
v_mfma_f32_16x16x32_bf16 a[116:119], v[8:11], v[216:219], a[116:119]
buffer_load_dwordx4 v18, s[32:35], s50 offen nt lds
v_mfma_f32_16x16x32_bf16 a[124:127], v[4:7], v[172:175], a[124:127]
v_mfma_f32_16x16x32_bf16 a[124:127], v[8:11], v[220:223], a[124:127]
v_mfma_f32_16x16x32_bf16 a[132:135], v[4:7], v[176:179], a[132:135]
v_mfma_f32_16x16x32_bf16 a[132:135], v[8:11], v[224:227], a[132:135]
v_mfma_f32_16x16x32_bf16 a[140:143], v[4:7], v[180:183], a[140:143]
v_mfma_f32_16x16x32_bf16 a[140:143], v[8:11], v[228:231], a[140:143]
s_waitcnt lgkmcnt(2)
v_mfma_f32_16x16x32_bf16 a[48:51], v[0:3], a[144:147], 0
s_waitcnt lgkmcnt(0)
ds_read_b64_tr_b16 v[8:9], v185 offset:256
v_mfma_f32_16x16x32_bf16 a[48:51], v[12:15], a[168:171], a[48:51]
ds_read_b64_tr_b16 v[10:11], v185 offset:2304
v_mfma_f32_16x16x32_bf16 a[56:59], v[0:3], a[148:151], 0
s_add_u32 m0, s47, 37760
ds_read_b64_tr_b16 v[4:5], v185 offset:4352
v_mfma_f32_16x16x32_bf16 a[56:59], v[12:15], a[172:175], a[56:59]
ds_read_b64_tr_b16 v[6:7], v185 offset:6400
v_mfma_f32_16x16x32_bf16 a[64:67], v[0:3], a[152:155], 0
buffer_load_dwordx4 v18, s[32:35], s50 offen offset:128 nt lds
v_mfma_f32_16x16x32_bf16 a[64:67], v[12:15], a[176:179], a[64:67]
v_accvgpr_read_b32 v188, a96
v_accvgpr_read_b32 v189, a97
v_mfma_f32_16x16x32_bf16 a[72:75], v[0:3], a[156:159], 0
v_accvgpr_read_b32 v190, a98
v_mfma_f32_16x16x32_bf16 a[72:75], v[12:15], a[180:183], a[72:75]
v_accvgpr_read_b32 v191, a99
v_mul_f32 v188, v188, v26
v_mfma_f32_16x16x32_bf16 a[80:83], v[0:3], a[160:163], 0
v_mul_f32 v189, v189, v26
v_mfma_f32_16x16x32_bf16 a[80:83], v[12:15], a[184:187], a[80:83]
v_cvt_pk_bf16_f32 v22, v188, v189
v_mfma_f32_16x16x32_bf16 a[88:91], v[0:3], a[164:167], 0
ds_write_b64 v236, v[240:241]
v_mfma_f32_16x16x32_bf16 a[88:91], v[12:15], a[188:191], a[88:91]
s_waitcnt lgkmcnt(3)
v_accvgpr_read_b32 v188, a100
v_accvgpr_read_b32 v189, a101
v_mfma_f32_16x16x32_bf16 a[52:55], v[8:11], a[144:147], 0
s_waitcnt lgkmcnt(1)
ds_read_b64_tr_b16 v[12:13], v185 offset:8192
v_mul_f32 v190, v190, v26
v_mfma_f32_16x16x32_bf16 a[52:55], v[4:7], a[168:171], a[52:55]
s_add_u32 m0, s47, 38656
ds_read_b64_tr_b16 v[14:15], v185 offset:10240
v_mul_f32 v191, v191, v26
v_mfma_f32_16x16x32_bf16 a[60:63], v[8:11], a[148:151], 0
ds_read_b64_tr_b16 v[0:1], v185 offset:12288
v_cvt_pk_bf16_f32 v23, v190, v191
v_mfma_f32_16x16x32_bf16 a[60:63], v[4:7], a[172:175], a[60:63]
ds_read_b64_tr_b16 v[2:3], v185 offset:14336
v_accvgpr_read_b32 v190, a102
v_mfma_f32_16x16x32_bf16 a[68:71], v[8:11], a[152:155], 0
ds_write_b64 v238, v[22:23]
v_mfma_f32_16x16x32_bf16 a[68:71], v[4:7], a[176:179], a[68:71]
buffer_load_dwordx4 v18, s[32:35], s50 offen offset:256 nt lds
v_mfma_f32_16x16x32_bf16 a[76:79], v[8:11], a[156:159], 0
v_accvgpr_read_b32 v191, a103
v_mul_f32 v188, v188, v26
v_mfma_f32_16x16x32_bf16 a[76:79], v[4:7], a[180:183], a[76:79]
v_mul_f32 v189, v189, v26
v_cvt_pk_bf16_f32 v24, v188, v189
v_mfma_f32_16x16x32_bf16 a[84:87], v[8:11], a[160:163], 0
ds_write_b64 v237, v[242:243]
v_mfma_f32_16x16x32_bf16 a[84:87], v[4:7], a[184:187], a[84:87]
v_mul_f32 v190, v190, v26
v_mul_f32 v191, v191, v26
v_mfma_f32_16x16x32_bf16 a[92:95], v[8:11], a[164:167], 0
v_cvt_pk_bf16_f32 v25, v190, v191
v_mfma_f32_16x16x32_bf16 a[92:95], v[4:7], a[188:191], a[92:95]
s_waitcnt lgkmcnt(4)
ds_write_b64 v239, v[24:25]
v_mfma_f32_16x16x32_bf16 a[48:51], v[12:15], a[192:195], a[48:51]
s_waitcnt lgkmcnt(3)
ds_read_b64_tr_b16 v[4:5], v185 offset:8448
v_mfma_f32_16x16x32_bf16 a[48:51], v[0:3], a[216:219], a[48:51]
ds_read_b64_tr_b16 v[6:7], v185 offset:10496
v_mfma_f32_16x16x32_bf16 a[56:59], v[12:15], a[196:199], a[56:59]
ds_read_b64_tr_b16 v[8:9], v185 offset:12544
v_mfma_f32_16x16x32_bf16 a[56:59], v[0:3], a[220:223], a[56:59]
ds_read_b64_tr_b16 v[10:11], v185 offset:14592
v_mfma_f32_16x16x32_bf16 a[64:67], v[12:15], a[200:203], a[64:67]
ds_read_b128 v[200:203], v186 offset:0
v_mfma_f32_16x16x32_bf16 a[64:67], v[0:3], a[224:227], a[64:67]
ds_read_b128 v[204:207], v186 offset:1024
v_mfma_f32_16x16x32_bf16 a[72:75], v[12:15], a[204:207], a[72:75]
s_waitcnt vmcnt(23)
ds_write_b128 v234, a[0:3] offset:0
v_mfma_f32_16x16x32_bf16 a[72:75], v[0:3], a[228:231], a[72:75]
ds_write_b128 v234, a[4:7] offset:1024
v_mfma_f32_16x16x32_bf16 a[80:83], v[12:15], a[208:211], a[80:83]
ds_write_b128 v234, a[8:11] offset:2048
v_mfma_f32_16x16x32_bf16 a[80:83], v[0:3], a[232:235], a[80:83]
ds_write_b128 v234, a[12:15] offset:3072
v_mfma_f32_16x16x32_bf16 a[88:91], v[12:15], a[212:215], a[88:91]
ds_read_b128 a[0:3], v232 offset:0
v_accvgpr_read_b32 v188, a120
v_mfma_f32_16x16x32_bf16 a[88:91], v[0:3], a[236:239], a[88:91]
s_waitcnt lgkmcnt(9)
ds_read_b128 a[8:11], v232 offset:2048
v_accvgpr_read_b32 v189, a121
v_mfma_f32_16x16x32_bf16 a[52:55], v[4:7], a[192:195], a[52:55]
s_waitcnt lgkmcnt(8)
ds_read_b64_tr_b16 v[0:1], v185 offset:16384
v_accvgpr_read_b32 v190, a122
v_mfma_f32_16x16x32_bf16 a[52:55], v[8:11], a[216:219], a[52:55]
ds_read_b64_tr_b16 v[2:3], v185 offset:18432
ds_read_b128 a[4:7], v233 offset:0
v_mfma_f32_16x16x32_bf16 a[60:63], v[4:7], a[196:199], a[60:63]
ds_read_b64_tr_b16 v[12:13], v185 offset:20480
ds_read_b128 a[12:15], v233 offset:2048
v_mfma_f32_16x16x32_bf16 a[60:63], v[8:11], a[220:223], a[60:63]
ds_read_b64_tr_b16 v[14:15], v185 offset:22528
v_accvgpr_read_b32 v191, a123
v_mfma_f32_16x16x32_bf16 a[68:71], v[4:7], a[200:203], a[68:71]
v_mul_f32 v188, v188, v29
v_mul_f32 v189, v189, v29
v_mfma_f32_16x16x32_bf16 a[68:71], v[8:11], a[224:227], a[68:71]
s_add_u32 s51, s49, 0
v_cvt_pk_bf16_f32 v240, v188, v189
v_accvgpr_read_b32 v188, a124
v_mfma_f32_16x16x32_bf16 a[76:79], v[4:7], a[204:207], a[76:79]
v_accvgpr_read_b32 v189, a125
v_mul_f32 v190, v190, v29
v_mfma_f32_16x16x32_bf16 a[76:79], v[8:11], a[228:231], a[76:79]
v_mul_f32 v191, v191, v29
v_cvt_pk_bf16_f32 v241, v190, v191
v_mfma_f32_16x16x32_bf16 a[84:87], v[4:7], a[208:211], a[84:87]
s_waitcnt lgkmcnt(13)
buffer_store_dwordx4 v[200:203], v18, s[24:27], s51 offen sc1
v_mfma_f32_16x16x32_bf16 a[84:87], v[8:11], a[232:235], a[84:87]
v_accvgpr_read_b32 v190, a126
v_accvgpr_read_b32 v191, a127
v_mfma_f32_16x16x32_bf16 a[92:95], v[4:7], a[212:215], a[92:95]
v_mul_f32 v188, v188, v29
v_mul_f32 v189, v189, v29
v_mfma_f32_16x16x32_bf16 a[92:95], v[8:11], a[236:239], a[92:95]
s_waitcnt lgkmcnt(4)
v_cvt_pk_bf16_f32 v242, v188, v189
v_mul_f32 v190, v190, v29
v_mfma_f32_16x16x32_bf16 a[48:51], v[0:3], a[240:243], a[48:51]
s_waitcnt lgkmcnt(0)
ds_read_b64_tr_b16 v[8:9], v185 offset:16640
v_mul_f32 v191, v191, v29
v_mfma_f32_16x16x32_bf16 a[48:51], v[12:15], v[40:43], a[48:51]
s_add_u32 s51, s49, 3072
ds_read_b64_tr_b16 v[10:11], v185 offset:18688
v_cvt_pk_bf16_f32 v243, v190, v191
v_mfma_f32_16x16x32_bf16 a[56:59], v[0:3], a[244:247], a[56:59]
s_waitcnt vmcnt(20)
ds_read_b64_tr_b16 v[4:5], v185 offset:20736
v_mfma_f32_16x16x32_bf16 a[56:59], v[12:15], v[44:47], a[56:59]
ds_read_b64_tr_b16 v[6:7], v185 offset:22784
v_mfma_f32_16x16x32_bf16 a[64:67], v[0:3], a[248:251], a[64:67]
ds_write_b128 v234, a[16:19] offset:0
v_mfma_f32_16x16x32_bf16 a[64:67], v[12:15], v[48:51], a[64:67]
ds_write_b128 v234, a[20:23] offset:1024
v_mfma_f32_16x16x32_bf16 a[72:75], v[0:3], a[252:255], a[72:75]
ds_write_b128 v234, a[24:27] offset:2048
v_mfma_f32_16x16x32_bf16 a[72:75], v[12:15], v[52:55], a[72:75]
ds_write_b128 v234, a[28:31] offset:3072
v_mfma_f32_16x16x32_bf16 a[80:83], v[0:3], v[32:35], a[80:83]
ds_read_b128 a[16:19], v232 offset:0
v_accvgpr_read_b32 v188, a104
v_mfma_f32_16x16x32_bf16 a[80:83], v[12:15], v[56:59], a[80:83]
ds_read_b128 a[24:27], v232 offset:2048
v_accvgpr_read_b32 v189, a105
v_mfma_f32_16x16x32_bf16 a[88:91], v[0:3], v[36:39], a[88:91]
ds_read_b128 a[20:23], v233 offset:0
v_accvgpr_read_b32 v190, a106
v_mfma_f32_16x16x32_bf16 a[88:91], v[12:15], v[60:63], a[88:91]
s_waitcnt lgkmcnt(9)
ds_read_b128 a[28:31], v233 offset:2048
v_accvgpr_read_b32 v191, a107
v_mfma_f32_16x16x32_bf16 a[52:55], v[8:11], a[240:243], a[52:55]
s_waitcnt lgkmcnt(8)
ds_read_b64_tr_b16 v[12:13], v185 offset:24576
v_mul_f32 v188, v188, v27
v_mfma_f32_16x16x32_bf16 a[52:55], v[4:7], v[40:43], a[52:55]
ds_read_b64_tr_b16 v[14:15], v185 offset:26624
v_mul_f32 v189, v189, v27
v_mfma_f32_16x16x32_bf16 a[60:63], v[8:11], a[244:247], a[60:63]
ds_read_b64_tr_b16 v[0:1], v185 offset:28672
v_cvt_pk_bf16_f32 v22, v188, v189
v_mfma_f32_16x16x32_bf16 a[60:63], v[4:7], v[44:47], a[60:63]
ds_read_b64_tr_b16 v[2:3], v185 offset:30720
v_accvgpr_read_b32 v188, a108
v_mfma_f32_16x16x32_bf16 a[68:71], v[8:11], a[248:251], a[68:71]
buffer_store_dwordx4 v[204:207], v18, s[24:27], s51 offen sc1
v_mfma_f32_16x16x32_bf16 a[68:71], v[4:7], v[48:51], a[68:71]
ds_write_b64 v236, v[244:245] offset:2048
v_mfma_f32_16x16x32_bf16 a[76:79], v[8:11], a[252:255], a[76:79]
v_accvgpr_read_b32 v189, a109
v_mul_f32 v190, v190, v27
v_mfma_f32_16x16x32_bf16 a[76:79], v[4:7], v[52:55], a[76:79]
v_mul_f32 v191, v191, v27
v_cvt_pk_bf16_f32 v23, v190, v191
v_mfma_f32_16x16x32_bf16 a[84:87], v[8:11], v[32:35], a[84:87]
ds_write_b64 v238, v[22:23] offset:2048
v_mfma_f32_16x16x32_bf16 a[84:87], v[4:7], v[56:59], a[84:87]
v_accvgpr_read_b32 v190, a110
v_accvgpr_read_b32 v191, a111
v_mfma_f32_16x16x32_bf16 a[92:95], v[8:11], v[36:39], a[92:95]
v_mul_f32 v188, v188, v27
v_mul_f32 v189, v189, v27
v_mfma_f32_16x16x32_bf16 a[92:95], v[4:7], v[60:63], a[92:95]
s_waitcnt lgkmcnt(4)
v_cvt_pk_bf16_f32 v24, v188, v189
v_mfma_f32_16x16x32_bf16 a[48:51], v[12:15], v[64:67], a[48:51]
s_waitcnt lgkmcnt(2)
ds_read_b64_tr_b16 v[4:5], v185 offset:24832
v_mul_f32 v190, v190, v27
v_mfma_f32_16x16x32_bf16 a[48:51], v[0:3], v[88:91], a[48:51]
ds_read_b64_tr_b16 v[6:7], v185 offset:26880
v_mul_f32 v191, v191, v27
v_mfma_f32_16x16x32_bf16 a[56:59], v[12:15], v[68:71], a[56:59]
ds_read_b64_tr_b16 v[8:9], v185 offset:28928
v_cvt_pk_bf16_f32 v25, v190, v191
v_mfma_f32_16x16x32_bf16 a[56:59], v[0:3], v[92:95], a[56:59]
ds_read_b64_tr_b16 v[10:11], v185 offset:30976
v_mfma_f32_16x16x32_bf16 a[64:67], v[12:15], v[72:75], a[64:67]
ds_write_b64 v237, v[246:247] offset:2048
v_mfma_f32_16x16x32_bf16 a[64:67], v[0:3], v[96:99], a[64:67]
ds_write_b64 v239, v[24:25] offset:2048
v_mfma_f32_16x16x32_bf16 a[72:75], v[12:15], v[76:79], a[72:75]
ds_read_b128 v[200:203], v186 offset:2048
v_mfma_f32_16x16x32_bf16 a[72:75], v[0:3], v[100:103], a[72:75]
ds_read_b128 v[204:207], v186 offset:3072
v_mfma_f32_16x16x32_bf16 a[80:83], v[12:15], v[80:83], a[80:83]
s_waitcnt vmcnt(17)
ds_write_b128 v234, a[32:35] offset:0
v_mfma_f32_16x16x32_bf16 a[80:83], v[0:3], v[104:107], a[80:83]
ds_write_b128 v234, a[36:39] offset:1024
v_mfma_f32_16x16x32_bf16 a[88:91], v[12:15], v[84:87], a[88:91]
ds_write_b128 v234, a[40:43] offset:2048
v_mfma_f32_16x16x32_bf16 a[88:91], v[0:3], v[108:111], a[88:91]
s_waitcnt lgkmcnt(9)
ds_write_b128 v234, a[44:47] offset:3072
v_mfma_f32_16x16x32_bf16 a[52:55], v[4:7], v[64:67], a[52:55]
s_waitcnt lgkmcnt(8)
ds_read_b64_tr_b16 v[0:1], v185 offset:32768
v_accvgpr_read_b32 v188, a128
v_mfma_f32_16x16x32_bf16 a[52:55], v[8:11], v[88:91], a[52:55]
ds_read_b64_tr_b16 v[2:3], v185 offset:34816
v_accvgpr_read_b32 v189, a129
v_mfma_f32_16x16x32_bf16 a[60:63], v[4:7], v[68:71], a[60:63]
ds_read_b64_tr_b16 v[12:13], v185 offset:36864
v_accvgpr_read_b32 v190, a130
v_mfma_f32_16x16x32_bf16 a[60:63], v[8:11], v[92:95], a[60:63]
ds_read_b64_tr_b16 v[14:15], v185 offset:38912
v_accvgpr_read_b32 v191, a131
v_mfma_f32_16x16x32_bf16 a[68:71], v[4:7], v[72:75], a[68:71]
ds_read_b128 a[32:35], v232 offset:0
ds_read_b128 a[40:43], v232 offset:2048
v_mfma_f32_16x16x32_bf16 a[68:71], v[8:11], v[96:99], a[68:71]
ds_read_b128 a[36:39], v233 offset:0
v_mul_f32 v188, v188, v30
v_mfma_f32_16x16x32_bf16 a[76:79], v[4:7], v[76:79], a[76:79]
s_waitcnt lgkmcnt(14)
ds_read_b128 a[44:47], v233 offset:2048
v_mul_f32 v189, v189, v30
v_mfma_f32_16x16x32_bf16 a[76:79], v[8:11], v[100:103], a[76:79]
s_add_u32 s51, s49, 6144
v_cvt_pk_bf16_f32 v244, v188, v189
v_accvgpr_read_b32 v188, a132
v_mfma_f32_16x16x32_bf16 a[84:87], v[4:7], v[80:83], a[84:87]
v_accvgpr_read_b32 v189, a133
v_mul_f32 v190, v190, v30
v_mfma_f32_16x16x32_bf16 a[84:87], v[8:11], v[104:107], a[84:87]
v_mul_f32 v191, v191, v30
v_cvt_pk_bf16_f32 v245, v190, v191
v_mfma_f32_16x16x32_bf16 a[92:95], v[4:7], v[84:87], a[92:95]
s_waitcnt lgkmcnt(13)
buffer_store_dwordx4 v[200:203], v18, s[24:27], s51 offen sc1
v_mfma_f32_16x16x32_bf16 a[92:95], v[8:11], v[108:111], a[92:95]
s_waitcnt lgkmcnt(6)
v_accvgpr_read_b32 v190, a134
v_accvgpr_read_b32 v191, a135
v_mfma_f32_16x16x32_bf16 a[48:51], v[0:3], v[112:115], a[48:51]
s_waitcnt lgkmcnt(4)
ds_read_b64_tr_b16 v[8:9], v185 offset:33024
v_mul_f32 v188, v188, v30
v_mfma_f32_16x16x32_bf16 a[48:51], v[12:15], v[136:139], a[48:51]
ds_read_b64_tr_b16 v[10:11], v185 offset:35072
v_mul_f32 v189, v189, v30
v_mfma_f32_16x16x32_bf16 a[56:59], v[0:3], v[116:119], a[56:59]
ds_read_b64_tr_b16 v[4:5], v185 offset:37120
v_cvt_pk_bf16_f32 v246, v188, v189
v_mfma_f32_16x16x32_bf16 a[56:59], v[12:15], v[140:143], a[56:59]
ds_read_b64_tr_b16 v[6:7], v185 offset:39168
v_mul_f32 v190, v190, v30
v_mfma_f32_16x16x32_bf16 a[64:67], v[0:3], v[120:123], a[64:67]
s_add_u32 s51, s49, 9216
v_mul_f32 v191, v191, v30
v_cvt_pk_bf16_f32 v247, v190, v191
v_mfma_f32_16x16x32_bf16 a[64:67], v[12:15], v[144:147], a[64:67]
v_accvgpr_read_b32 v188, a112
v_accvgpr_read_b32 v189, a113
v_mfma_f32_16x16x32_bf16 a[72:75], v[0:3], v[124:127], a[72:75]
v_accvgpr_read_b32 v190, a114
v_accvgpr_read_b32 v191, a115
v_mfma_f32_16x16x32_bf16 a[72:75], v[12:15], v[148:151], a[72:75]
buffer_store_dwordx4 v[204:207], v18, s[24:27], s51 offen sc1
v_mfma_f32_16x16x32_bf16 a[80:83], v[0:3], v[128:131], a[80:83]
v_mul_f32 v188, v188, v28
v_mfma_f32_16x16x32_bf16 a[80:83], v[12:15], v[152:155], a[80:83]
v_mul_f32 v189, v189, v28
v_cvt_pk_bf16_f32 v22, v188, v189
v_mfma_f32_16x16x32_bf16 a[88:91], v[0:3], v[132:135], a[88:91]
ds_write_b64 v236, v[248:249]
v_mfma_f32_16x16x32_bf16 a[88:91], v[12:15], v[156:159], a[88:91]
s_waitcnt lgkmcnt(3)
v_accvgpr_read_b32 v188, a116
v_mfma_f32_16x16x32_bf16 a[52:55], v[8:11], v[112:115], a[52:55]
s_waitcnt lgkmcnt(1)
ds_read_b64_tr_b16 v[12:13], v185 offset:40960
v_accvgpr_read_b32 v189, a117
v_mfma_f32_16x16x32_bf16 a[52:55], v[4:7], v[136:139], a[52:55]
ds_read_b64_tr_b16 v[14:15], v185 offset:43008
v_mul_f32 v190, v190, v28
v_mfma_f32_16x16x32_bf16 a[60:63], v[8:11], v[116:119], a[60:63]
ds_read_b64_tr_b16 v[0:1], v185 offset:45056
v_mul_f32 v191, v191, v28
v_mfma_f32_16x16x32_bf16 a[60:63], v[4:7], v[140:143], a[60:63]
ds_read_b64_tr_b16 v[2:3], v185 offset:47104
v_cvt_pk_bf16_f32 v23, v190, v191
v_mfma_f32_16x16x32_bf16 a[68:71], v[8:11], v[120:123], a[68:71]
ds_write_b64 v238, v[22:23]
v_mfma_f32_16x16x32_bf16 a[68:71], v[4:7], v[144:147], a[68:71]
v_accvgpr_read_b32 v190, a118
v_accvgpr_read_b32 v191, a119
v_mfma_f32_16x16x32_bf16 a[76:79], v[8:11], v[124:127], a[76:79]
v_mul_f32 v188, v188, v28
v_mul_f32 v189, v189, v28
v_mfma_f32_16x16x32_bf16 a[76:79], v[4:7], v[148:151], a[76:79]
v_cvt_pk_bf16_f32 v24, v188, v189
v_mfma_f32_16x16x32_bf16 a[84:87], v[8:11], v[128:131], a[84:87]
ds_write_b64 v237, v[250:251]
v_mfma_f32_16x16x32_bf16 a[84:87], v[4:7], v[152:155], a[84:87]
v_mul_f32 v190, v190, v28
v_mul_f32 v191, v191, v28
v_mfma_f32_16x16x32_bf16 a[92:95], v[8:11], v[132:135], a[92:95]
v_cvt_pk_bf16_f32 v25, v190, v191
v_mfma_f32_16x16x32_bf16 a[92:95], v[4:7], v[156:159], a[92:95]
s_waitcnt lgkmcnt(4)
ds_write_b64 v239, v[24:25]
v_mfma_f32_16x16x32_bf16 a[48:51], v[12:15], v[160:163], a[48:51]
s_waitcnt lgkmcnt(3)
ds_read_b64_tr_b16 v[4:5], v185 offset:41216
v_mfma_f32_16x16x32_bf16 a[48:51], v[0:3], v[208:211], a[48:51]
ds_read_b64_tr_b16 v[6:7], v185 offset:43264
v_accvgpr_read_b32 v188, a136
v_mfma_f32_16x16x32_bf16 a[56:59], v[12:15], v[164:167], a[56:59]
ds_read_b64_tr_b16 v[8:9], v185 offset:45312
v_accvgpr_read_b32 v189, a137
v_mfma_f32_16x16x32_bf16 a[56:59], v[0:3], v[212:215], a[56:59]
ds_read_b64_tr_b16 v[10:11], v185 offset:47360
v_accvgpr_read_b32 v190, a138
v_mfma_f32_16x16x32_bf16 a[64:67], v[12:15], v[168:171], a[64:67]
ds_read_b128 v[200:203], v186 offset:0
v_accvgpr_read_b32 v191, a139
v_mfma_f32_16x16x32_bf16 a[64:67], v[0:3], v[216:219], a[64:67]
ds_read_b128 v[204:207], v186 offset:1024
v_mul_f32 v188, v188, v31
v_mfma_f32_16x16x32_bf16 a[72:75], v[12:15], v[172:175], a[72:75]
v_mul_f32 v189, v189, v31
v_cvt_pk_bf16_f32 v248, v188, v189
v_mfma_f32_16x16x32_bf16 a[72:75], v[0:3], v[220:223], a[72:75]
s_add_u32 s51, s49, 12288
v_accvgpr_read_b32 v188, a140
v_accvgpr_read_b32 v189, a141
v_mfma_f32_16x16x32_bf16 a[80:83], v[12:15], v[176:179], a[80:83]
v_mul_f32 v190, v190, v31
v_mul_f32 v191, v191, v31
v_mfma_f32_16x16x32_bf16 a[80:83], v[0:3], v[224:227], a[80:83]
v_cvt_pk_bf16_f32 v249, v190, v191
v_mfma_f32_16x16x32_bf16 a[88:91], v[12:15], v[180:183], a[88:91]
s_waitcnt lgkmcnt(1)
buffer_store_dwordx4 v[200:203], v18, s[24:27], s51 offen sc1
v_mfma_f32_16x16x32_bf16 a[88:91], v[0:3], v[228:231], a[88:91]
v_accvgpr_read_b32 v190, a142
v_mfma_f32_16x16x32_bf16 a[52:55], v[4:7], v[160:163], a[52:55]
ds_read_b64_tr_b16 v[0:1], v185 offset:512
v_accvgpr_read_b32 v191, a143
v_mfma_f32_16x16x32_bf16 a[52:55], v[8:11], v[208:211], a[52:55]
ds_read_b64_tr_b16 v[2:3], v185 offset:2560
v_mul_f32 v188, v188, v31
v_mfma_f32_16x16x32_bf16 a[60:63], v[4:7], v[164:167], a[60:63]
ds_read_b64_tr_b16 v[12:13], v185 offset:4608
v_mul_f32 v189, v189, v31
v_mfma_f32_16x16x32_bf16 a[60:63], v[8:11], v[212:215], a[60:63]
ds_read_b64_tr_b16 v[14:15], v185 offset:6656
v_cvt_pk_bf16_f32 v250, v188, v189
v_mfma_f32_16x16x32_bf16 a[68:71], v[4:7], v[168:171], a[68:71]
v_mul_f32 v190, v190, v31
v_mul_f32 v191, v191, v31
v_mfma_f32_16x16x32_bf16 a[68:71], v[8:11], v[216:219], a[68:71]
s_add_u32 s51, s49, 15360
v_cvt_pk_bf16_f32 v251, v190, v191
v_mfma_f32_16x16x32_bf16 a[76:79], v[4:7], v[172:175], a[76:79]
v_mfma_f32_16x16x32_bf16 a[76:79], v[8:11], v[220:223], a[76:79]
v_mfma_f32_16x16x32_bf16 a[84:87], v[4:7], v[176:179], a[84:87]
v_mfma_f32_16x16x32_bf16 a[84:87], v[8:11], v[224:227], a[84:87]
s_waitcnt lgkmcnt(4)
buffer_store_dwordx4 v[204:207], v18, s[24:27], s51 offen sc1
v_mfma_f32_16x16x32_bf16 a[92:95], v[4:7], v[180:183], a[92:95]
v_mfma_f32_16x16x32_bf16 a[92:95], v[8:11], v[228:231], a[92:95]
s_waitcnt lgkmcnt(2)
v_mfma_f32_16x16x32_bf16 a[96:99], v[0:3], a[144:147], 0
s_waitcnt lgkmcnt(0)
ds_read_b64_tr_b16 v[8:9], v185 offset:768
v_mfma_f32_16x16x32_bf16 a[96:99], v[12:15], a[168:171], a[96:99]
ds_read_b64_tr_b16 v[10:11], v185 offset:2816
v_mfma_f32_16x16x32_bf16 a[104:107], v[0:3], a[148:151], 0
ds_read_b64_tr_b16 v[4:5], v185 offset:4864
v_mfma_f32_16x16x32_bf16 a[104:107], v[12:15], a[172:175], a[104:107]
ds_read_b64_tr_b16 v[6:7], v185 offset:6912
v_mfma_f32_16x16x32_bf16 a[112:115], v[0:3], a[152:155], 0
v_mfma_f32_16x16x32_bf16 a[112:115], v[12:15], a[176:179], a[112:115]
ds_write_b64 v236, v[252:253] offset:2048
v_mfma_f32_16x16x32_bf16 a[120:123], v[0:3], a[156:159], 0
ds_write_b64 v237, v[254:255] offset:2048
v_mfma_f32_16x16x32_bf16 a[120:123], v[12:15], a[180:183], a[120:123]
ds_write_b64 v238, v[240:241] offset:2048
v_mfma_f32_16x16x32_bf16 a[128:131], v[0:3], a[160:163], 0
ds_write_b64 v239, v[242:243] offset:2048
v_mfma_f32_16x16x32_bf16 a[128:131], v[12:15], a[184:187], a[128:131]
v_mfma_f32_16x16x32_bf16 a[136:139], v[0:3], a[164:167], 0
ds_read_b128 v[200:203], v186 offset:2048
v_mfma_f32_16x16x32_bf16 a[136:139], v[12:15], a[188:191], a[136:139]
s_waitcnt lgkmcnt(7)
ds_read_b128 v[204:207], v186 offset:3072
v_accvgpr_read_b32 v188, a48
v_mfma_f32_16x16x32_bf16 a[100:103], v[8:11], a[144:147], 0
s_waitcnt lgkmcnt(6)
ds_read_b64_tr_b16 v[12:13], v185 offset:8704
v_accvgpr_read_b32 v189, a49
v_mfma_f32_16x16x32_bf16 a[100:103], v[4:7], a[168:171], a[100:103]
ds_read_b64_tr_b16 v[14:15], v185 offset:10752
v_accvgpr_read_b32 v190, a50
v_mfma_f32_16x16x32_bf16 a[108:111], v[8:11], a[148:151], 0
ds_read_b64_tr_b16 v[0:1], v185 offset:12800
v_accvgpr_read_b32 v191, a51
v_mfma_f32_16x16x32_bf16 a[108:111], v[4:7], a[172:175], a[108:111]
ds_read_b64_tr_b16 v[2:3], v185 offset:14848
v_mul_f32 v188, v188, v26
v_mfma_f32_16x16x32_bf16 a[116:119], v[8:11], a[152:155], 0
v_mul_f32 v189, v189, v26
v_mfma_f32_16x16x32_bf16 a[116:119], v[4:7], a[176:179], a[116:119]
s_add_u32 s51, s49, 18432
v_cvt_pk_bf16_f32 v240, v188, v189
v_accvgpr_read_b32 v188, a52
v_mfma_f32_16x16x32_bf16 a[124:127], v[8:11], a[156:159], 0
v_accvgpr_read_b32 v189, a53
v_mfma_f32_16x16x32_bf16 a[124:127], v[4:7], a[180:183], a[124:127]
v_mul_f32 v190, v190, v26
v_mfma_f32_16x16x32_bf16 a[132:135], v[8:11], a[160:163], 0
v_mul_f32 v191, v191, v26
v_mfma_f32_16x16x32_bf16 a[132:135], v[4:7], a[184:187], a[132:135]
v_cvt_pk_bf16_f32 v241, v190, v191
v_mfma_f32_16x16x32_bf16 a[140:143], v[8:11], a[164:167], 0
s_waitcnt lgkmcnt(5)
buffer_store_dwordx4 v[200:203], v18, s[24:27], s51 offen sc1
v_mfma_f32_16x16x32_bf16 a[140:143], v[4:7], a[188:191], a[140:143]
s_waitcnt lgkmcnt(2)
v_accvgpr_read_b32 v190, a54
v_mfma_f32_16x16x32_bf16 a[96:99], v[12:15], a[192:195], a[96:99]
s_waitcnt lgkmcnt(0)
ds_read_b64_tr_b16 v[4:5], v185 offset:8960
v_accvgpr_read_b32 v191, a55
v_mfma_f32_16x16x32_bf16 a[96:99], v[0:3], a[216:219], a[96:99]
ds_read_b64_tr_b16 v[6:7], v185 offset:11008
v_mul_f32 v188, v188, v26
v_mfma_f32_16x16x32_bf16 a[104:107], v[12:15], a[196:199], a[104:107]
ds_read_b64_tr_b16 v[8:9], v185 offset:13056
v_mul_f32 v189, v189, v26
v_mfma_f32_16x16x32_bf16 a[104:107], v[0:3], a[220:223], a[104:107]
ds_read_b64_tr_b16 v[10:11], v185 offset:15104
v_cvt_pk_bf16_f32 v242, v188, v189
v_mfma_f32_16x16x32_bf16 a[112:115], v[12:15], a[200:203], a[112:115]
v_mul_f32 v190, v190, v26
v_mfma_f32_16x16x32_bf16 a[112:115], v[0:3], a[224:227], a[112:115]
s_add_u32 s51, s49, 21504
v_mul_f32 v191, v191, v26
v_cvt_pk_bf16_f32 v243, v190, v191
v_mfma_f32_16x16x32_bf16 a[120:123], v[12:15], a[204:207], a[120:123]
v_accvgpr_read_b32 v188, a72
v_mfma_f32_16x16x32_bf16 a[120:123], v[0:3], a[228:231], a[120:123]
s_waitcnt lgkmcnt(2)
s_barrier
v_mfma_f32_16x16x32_bf16 a[128:131], v[12:15], a[208:211], a[128:131]
v_accvgpr_read_b32 v189, a73
v_accvgpr_read_b32 v190, a74
v_mfma_f32_16x16x32_bf16 a[128:131], v[0:3], a[232:235], a[128:131]
s_add_u32 m0, s48, 49152
v_accvgpr_read_b32 v191, a75
v_mfma_f32_16x16x32_bf16 a[136:139], v[12:15], a[212:215], a[136:139]
s_add_u32 s50, s49, 12288
v_mul_f32 v188, v188, v29
v_mul_f32 v189, v189, v29
v_mfma_f32_16x16x32_bf16 a[136:139], v[0:3], a[236:239], a[136:139]
buffer_store_dwordx4 v[204:207], v18, s[24:27], s51 offen sc1
v_mfma_f32_16x16x32_bf16 a[100:103], v[4:7], a[192:195], a[100:103]
s_waitcnt lgkmcnt(0)
ds_read_b64_tr_b16 v[0:1], v185 offset:16896
v_mfma_f32_16x16x32_bf16 a[100:103], v[8:11], a[216:219], a[100:103]
ds_read_b64_tr_b16 v[2:3], v185 offset:18944
v_cvt_pk_bf16_f32 v252, v188, v189
v_mfma_f32_16x16x32_bf16 a[108:111], v[4:7], a[196:199], a[108:111]
ds_read_b64_tr_b16 v[12:13], v185 offset:20992
v_accvgpr_read_b32 v188, a76
v_mfma_f32_16x16x32_bf16 a[108:111], v[8:11], a[220:223], a[108:111]
ds_read_b64_tr_b16 v[14:15], v185 offset:23040
v_accvgpr_read_b32 v189, a77
v_mfma_f32_16x16x32_bf16 a[116:119], v[4:7], a[200:203], a[116:119]
buffer_load_dwordx4 v18, s[28:31], s50 offen nt lds
v_mfma_f32_16x16x32_bf16 a[116:119], v[8:11], a[224:227], a[116:119]
v_mul_f32 v190, v190, v29
v_mul_f32 v191, v191, v29
v_mfma_f32_16x16x32_bf16 a[124:127], v[4:7], a[204:207], a[124:127]
v_cvt_pk_bf16_f32 v253, v190, v191
v_accvgpr_read_b32 v190, a78
v_mfma_f32_16x16x32_bf16 a[124:127], v[8:11], a[228:231], a[124:127]
s_add_u32 m0, s48, 53248
v_accvgpr_read_b32 v191, a79
v_mfma_f32_16x16x32_bf16 a[132:135], v[4:7], a[208:211], a[132:135]
s_add_u32 s50, s49, 15360
v_mul_f32 v188, v188, v29
v_mul_f32 v189, v189, v29
v_mfma_f32_16x16x32_bf16 a[132:135], v[8:11], a[232:235], a[132:135]
buffer_load_dwordx4 v18, s[28:31], s50 offen nt lds
v_mfma_f32_16x16x32_bf16 a[140:143], v[4:7], a[212:215], a[140:143]
v_cvt_pk_bf16_f32 v254, v188, v189
v_mul_f32 v190, v190, v29
v_mfma_f32_16x16x32_bf16 a[140:143], v[8:11], a[236:239], a[140:143]
s_waitcnt lgkmcnt(2)
v_mul_f32 v191, v191, v29
v_mfma_f32_16x16x32_bf16 a[96:99], v[0:3], a[240:243], a[96:99]
s_waitcnt lgkmcnt(0)
ds_read_b64_tr_b16 v[8:9], v185 offset:17152
v_cvt_pk_bf16_f32 v255, v190, v191
v_mfma_f32_16x16x32_bf16 a[96:99], v[12:15], v[40:43], a[96:99]
ds_read_b64_tr_b16 v[10:11], v185 offset:19200
v_mfma_f32_16x16x32_bf16 a[104:107], v[0:3], a[244:247], a[104:107]
ds_read_b64_tr_b16 v[4:5], v185 offset:21248
v_mfma_f32_16x16x32_bf16 a[104:107], v[12:15], v[44:47], a[104:107]
ds_read_b64_tr_b16 v[6:7], v185 offset:23296
v_mfma_f32_16x16x32_bf16 a[112:115], v[0:3], a[248:251], a[112:115]
ds_write_b64 v236, v[192:193]
v_mfma_f32_16x16x32_bf16 a[112:115], v[12:15], v[48:51], a[112:115]
s_add_u32 m0, s48, 57344
ds_write_b64 v237, v[194:195]
v_mfma_f32_16x16x32_bf16 a[120:123], v[0:3], a[252:255], a[120:123]
s_add_u32 s50, s49, 18432
ds_write_b64 v238, v[244:245]
v_mfma_f32_16x16x32_bf16 a[120:123], v[12:15], v[52:55], a[120:123]
ds_write_b64 v239, v[246:247]
v_mfma_f32_16x16x32_bf16 a[128:131], v[0:3], v[32:35], a[128:131]
ds_read_b128 v[200:203], v186 offset:0
v_accvgpr_read_b32 v188, a56
v_mfma_f32_16x16x32_bf16 a[128:131], v[12:15], v[56:59], a[128:131]
s_waitcnt lgkmcnt(5)
s_barrier
ds_read_b128 v[204:207], v186 offset:1024
v_mfma_f32_16x16x32_bf16 a[136:139], v[0:3], v[36:39], a[136:139]
buffer_load_dwordx4 v18, s[28:31], s50 offen nt lds
v_mfma_f32_16x16x32_bf16 a[136:139], v[12:15], v[60:63], a[136:139]
v_accvgpr_read_b32 v189, a57
v_accvgpr_read_b32 v190, a58
v_mfma_f32_16x16x32_bf16 a[100:103], v[8:11], a[240:243], a[100:103]
ds_read_b64_tr_b16 v[12:13], v185 offset:25088
v_accvgpr_read_b32 v191, a59
v_mfma_f32_16x16x32_bf16 a[100:103], v[4:7], v[40:43], a[100:103]
ds_read_b64_tr_b16 v[14:15], v185 offset:27136
v_mul_f32 v188, v188, v27
v_mfma_f32_16x16x32_bf16 a[108:111], v[8:11], a[244:247], a[108:111]
ds_read_b64_tr_b16 v[0:1], v185 offset:29184
v_mul_f32 v189, v189, v27
v_mfma_f32_16x16x32_bf16 a[108:111], v[4:7], v[44:47], a[108:111]
s_add_u32 s51, s49, 24576
ds_read_b64_tr_b16 v[2:3], v185 offset:31232
v_cvt_pk_bf16_f32 v244, v188, v189
v_mfma_f32_16x16x32_bf16 a[116:119], v[8:11], a[248:251], a[116:119]
s_add_u32 m0, s48, 61440
v_accvgpr_read_b32 v188, a60
v_accvgpr_read_b32 v189, a61
v_mfma_f32_16x16x32_bf16 a[116:119], v[4:7], v[48:51], a[116:119]
s_add_u32 s50, s49, 21504
buffer_load_dwordx4 v18, s[28:31], s50 offen nt lds
v_mfma_f32_16x16x32_bf16 a[124:127], v[8:11], a[252:255], a[124:127]
v_mul_f32 v190, v190, v27
v_mul_f32 v191, v191, v27
v_mfma_f32_16x16x32_bf16 a[124:127], v[4:7], v[52:55], a[124:127]
v_cvt_pk_bf16_f32 v245, v190, v191
v_accvgpr_read_b32 v190, a62
v_mfma_f32_16x16x32_bf16 a[132:135], v[8:11], v[32:35], a[132:135]
s_waitcnt lgkmcnt(5)
buffer_store_dwordx4 v[200:203], v18, s[24:27], s51 offen sc1
v_mfma_f32_16x16x32_bf16 a[132:135], v[4:7], v[56:59], a[132:135]
v_accvgpr_read_b32 v191, a63
v_mul_f32 v188, v188, v27
v_mfma_f32_16x16x32_bf16 a[140:143], v[8:11], v[36:39], a[140:143]
v_mul_f32 v189, v189, v27
v_mfma_f32_16x16x32_bf16 a[140:143], v[4:7], v[60:63], a[140:143]
s_waitcnt lgkmcnt(2)
v_cvt_pk_bf16_f32 v246, v188, v189
v_mfma_f32_16x16x32_bf16 a[96:99], v[12:15], v[64:67], a[96:99]
s_waitcnt lgkmcnt(0)
ds_read_b64_tr_b16 v[4:5], v185 offset:25344
v_mul_f32 v190, v190, v27
v_mfma_f32_16x16x32_bf16 a[96:99], v[0:3], v[88:91], a[96:99]
s_add_u32 s51, s49, 27648
ds_read_b64_tr_b16 v[6:7], v185 offset:27392
v_mul_f32 v191, v191, v27
v_mfma_f32_16x16x32_bf16 a[104:107], v[12:15], v[68:71], a[104:107]
s_add_u32 m0, s48, 65536
ds_read_b64_tr_b16 v[8:9], v185 offset:29440
v_cvt_pk_bf16_f32 v247, v190, v191
v_mfma_f32_16x16x32_bf16 a[104:107], v[0:3], v[92:95], a[104:107]
s_add_u32 s50, s49, 12416
ds_read_b64_tr_b16 v[10:11], v185 offset:31488
v_accvgpr_read_b32 v188, a80
v_mfma_f32_16x16x32_bf16 a[112:115], v[12:15], v[72:75], a[112:115]
buffer_load_dwordx4 v18, s[28:31], s50 offen nt lds
v_mfma_f32_16x16x32_bf16 a[112:115], v[0:3], v[96:99], a[112:115]
v_accvgpr_read_b32 v189, a81
v_accvgpr_read_b32 v190, a82
v_mfma_f32_16x16x32_bf16 a[120:123], v[12:15], v[76:79], a[120:123]
v_accvgpr_read_b32 v191, a83
v_mul_f32 v188, v188, v30
v_mfma_f32_16x16x32_bf16 a[120:123], v[0:3], v[100:103], a[120:123]
v_mul_f32 v189, v189, v30
v_mfma_f32_16x16x32_bf16 a[128:131], v[12:15], v[80:83], a[128:131]
buffer_store_dwordx4 v[204:207], v18, s[24:27], s51 offen sc1
v_mfma_f32_16x16x32_bf16 a[128:131], v[0:3], v[104:107], a[128:131]
v_cvt_pk_bf16_f32 v192, v188, v189
v_mfma_f32_16x16x32_bf16 a[136:139], v[12:15], v[84:87], a[136:139]
v_accvgpr_read_b32 v188, a84
v_mfma_f32_16x16x32_bf16 a[136:139], v[0:3], v[108:111], a[136:139]
s_waitcnt lgkmcnt(2)
v_accvgpr_read_b32 v189, a85
v_mfma_f32_16x16x32_bf16 a[100:103], v[4:7], v[64:67], a[100:103]
s_waitcnt lgkmcnt(0)
ds_read_b64_tr_b16 v[0:1], v185 offset:33280
v_mul_f32 v190, v190, v30
v_mfma_f32_16x16x32_bf16 a[100:103], v[8:11], v[88:91], a[100:103]
s_add_u32 m0, s48, 69632
ds_read_b64_tr_b16 v[2:3], v185 offset:35328
v_mul_f32 v191, v191, v30
v_mfma_f32_16x16x32_bf16 a[108:111], v[4:7], v[68:71], a[108:111]
s_add_u32 s50, s49, 15488
ds_read_b64_tr_b16 v[12:13], v185 offset:37376
v_cvt_pk_bf16_f32 v193, v190, v191
v_mfma_f32_16x16x32_bf16 a[108:111], v[8:11], v[92:95], a[108:111]
ds_read_b64_tr_b16 v[14:15], v185 offset:39424
v_accvgpr_read_b32 v190, a86
v_mfma_f32_16x16x32_bf16 a[116:119], v[4:7], v[72:75], a[116:119]
buffer_load_dwordx4 v18, s[28:31], s50 offen nt lds
v_mfma_f32_16x16x32_bf16 a[116:119], v[8:11], v[96:99], a[116:119]
v_accvgpr_read_b32 v191, a87
v_mul_f32 v188, v188, v30
v_mfma_f32_16x16x32_bf16 a[124:127], v[4:7], v[76:79], a[124:127]
v_mul_f32 v189, v189, v30
v_cvt_pk_bf16_f32 v194, v188, v189
v_mfma_f32_16x16x32_bf16 a[124:127], v[8:11], v[100:103], a[124:127]
v_mul_f32 v190, v190, v30
v_mul_f32 v191, v191, v30
v_mfma_f32_16x16x32_bf16 a[132:135], v[4:7], v[80:83], a[132:135]
v_cvt_pk_bf16_f32 v195, v190, v191
v_mfma_f32_16x16x32_bf16 a[132:135], v[8:11], v[104:107], a[132:135]
ds_write_b64 v236, v[196:197] offset:2048
v_mfma_f32_16x16x32_bf16 a[140:143], v[4:7], v[84:87], a[140:143]
ds_write_b64 v237, v[198:199] offset:2048
v_mfma_f32_16x16x32_bf16 a[140:143], v[8:11], v[108:111], a[140:143]
s_waitcnt lgkmcnt(4)
ds_write_b64 v238, v[248:249] offset:2048
v_mfma_f32_16x16x32_bf16 a[96:99], v[0:3], v[112:115], a[96:99]
s_waitcnt lgkmcnt(3)
ds_read_b64_tr_b16 v[8:9], v185 offset:33536
v_mfma_f32_16x16x32_bf16 a[96:99], v[12:15], v[136:139], a[96:99]
ds_read_b64_tr_b16 v[10:11], v185 offset:35584
v_mfma_f32_16x16x32_bf16 a[104:107], v[0:3], v[116:119], a[104:107]
ds_read_b64_tr_b16 v[4:5], v185 offset:37632
v_mfma_f32_16x16x32_bf16 a[104:107], v[12:15], v[140:143], a[104:107]
ds_read_b64_tr_b16 v[6:7], v185 offset:39680
v_accvgpr_read_b32 v188, a64
v_mfma_f32_16x16x32_bf16 a[112:115], v[0:3], v[120:123], a[112:115]
ds_write_b64 v239, v[250:251] offset:2048
v_mfma_f32_16x16x32_bf16 a[112:115], v[12:15], v[144:147], a[112:115]
ds_read_b128 v[200:203], v186 offset:2048
v_accvgpr_read_b32 v189, a65
v_mfma_f32_16x16x32_bf16 a[120:123], v[0:3], v[124:127], a[120:123]
ds_read_b128 v[204:207], v186 offset:3072
v_accvgpr_read_b32 v190, a66
v_mfma_f32_16x16x32_bf16 a[120:123], v[12:15], v[148:151], a[120:123]
s_waitcnt lgkmcnt(5)
s_barrier
v_mfma_f32_16x16x32_bf16 a[128:131], v[0:3], v[128:131], a[128:131]
v_accvgpr_read_b32 v191, a67
v_mul_f32 v188, v188, v28
v_mfma_f32_16x16x32_bf16 a[128:131], v[12:15], v[152:155], a[128:131]
s_add_u32 m0, s48, 73728
v_mul_f32 v189, v189, v28
v_cvt_pk_bf16_f32 v248, v188, v189
v_mfma_f32_16x16x32_bf16 a[136:139], v[0:3], v[132:135], a[136:139]
s_add_u32 s51, s49, 30720
v_accvgpr_read_b32 v188, a68
v_mfma_f32_16x16x32_bf16 a[136:139], v[12:15], v[156:159], a[136:139]
v_accvgpr_read_b32 v189, a69
v_mul_f32 v190, v190, v28
v_mfma_f32_16x16x32_bf16 a[100:103], v[8:11], v[112:115], a[100:103]
s_waitcnt lgkmcnt(3)
ds_read_b64_tr_b16 v[12:13], v185 offset:41472
v_mul_f32 v191, v191, v28
v_mfma_f32_16x16x32_bf16 a[100:103], v[4:7], v[136:139], a[100:103]
s_add_u32 s50, s49, 18560
ds_read_b64_tr_b16 v[14:15], v185 offset:43520
v_cvt_pk_bf16_f32 v249, v190, v191
v_mfma_f32_16x16x32_bf16 a[108:111], v[8:11], v[116:119], a[108:111]
ds_read_b64_tr_b16 v[0:1], v185 offset:45568
v_mfma_f32_16x16x32_bf16 a[108:111], v[4:7], v[140:143], a[108:111]
ds_read_b64_tr_b16 v[2:3], v185 offset:47616
v_mfma_f32_16x16x32_bf16 a[116:119], v[8:11], v[120:123], a[116:119]
s_waitcnt lgkmcnt(5)
buffer_store_dwordx4 v[200:203], v18, s[24:27], s51 offen sc1
v_mfma_f32_16x16x32_bf16 a[116:119], v[4:7], v[144:147], a[116:119]
buffer_load_dwordx4 v18, s[28:31], s50 offen nt lds
v_mfma_f32_16x16x32_bf16 a[124:127], v[8:11], v[124:127], a[124:127]
v_accvgpr_read_b32 v190, a70
v_accvgpr_read_b32 v191, a71
v_mfma_f32_16x16x32_bf16 a[124:127], v[4:7], v[148:151], a[124:127]
s_add_u32 m0, s48, 77824
v_mul_f32 v188, v188, v28
v_mul_f32 v189, v189, v28
v_mfma_f32_16x16x32_bf16 a[132:135], v[8:11], v[128:131], a[132:135]
s_add_u32 s50, s49, 21632
v_cvt_pk_bf16_f32 v250, v188, v189
v_mul_f32 v190, v190, v28
v_mfma_f32_16x16x32_bf16 a[132:135], v[4:7], v[152:155], a[132:135]
s_add_u32 s51, s49, 33792
buffer_load_dwordx4 v18, s[28:31], s50 offen nt lds
v_mfma_f32_16x16x32_bf16 a[140:143], v[8:11], v[132:135], a[140:143]
v_mul_f32 v191, v191, v28
v_cvt_pk_bf16_f32 v251, v190, v191
v_mfma_f32_16x16x32_bf16 a[140:143], v[4:7], v[156:159], a[140:143]
s_waitcnt lgkmcnt(2)
v_accvgpr_read_b32 v188, a88
v_accvgpr_read_b32 v189, a89
v_mfma_f32_16x16x32_bf16 a[96:99], v[12:15], v[160:163], a[96:99]
s_waitcnt lgkmcnt(0)
ds_read_b64_tr_b16 v[4:5], v185 offset:41728
v_accvgpr_read_b32 v190, a90
v_mfma_f32_16x16x32_bf16 a[96:99], v[0:3], v[208:211], a[96:99]
ds_read_b64_tr_b16 v[6:7], v185 offset:43776
v_accvgpr_read_b32 v191, a91
v_mfma_f32_16x16x32_bf16 a[104:107], v[12:15], v[164:167], a[104:107]
ds_read_b64_tr_b16 v[8:9], v185 offset:45824
v_mul_f32 v188, v188, v31
v_mfma_f32_16x16x32_bf16 a[104:107], v[0:3], v[212:215], a[104:107]
ds_read_b64_tr_b16 v[10:11], v185 offset:47872
v_mul_f32 v189, v189, v31
v_mfma_f32_16x16x32_bf16 a[112:115], v[12:15], v[168:171], a[112:115]
buffer_store_dwordx4 v[204:207], v18, s[24:27], s51 offen sc1
v_add_u32 v184, 0x18000, v184
v_mfma_f32_16x16x32_bf16 a[112:115], v[0:3], v[216:219], a[112:115]
s_add_u32 m0, s48, 81920
v_cvt_pk_bf16_f32 v196, v188, v189
v_mfma_f32_16x16x32_bf16 a[120:123], v[12:15], v[172:175], a[120:123]
s_add_u32 s50, s49, 12544
v_accvgpr_read_b32 v188, a92
v_mfma_f32_16x16x32_bf16 a[120:123], v[0:3], v[220:223], a[120:123]
buffer_load_dwordx4 v18, s[28:31], s50 offen nt lds
v_mfma_f32_16x16x32_bf16 a[128:131], v[12:15], v[176:179], a[128:131]
v_accvgpr_read_b32 v189, a93
v_mul_f32 v190, v190, v31
v_mfma_f32_16x16x32_bf16 a[128:131], v[0:3], v[224:227], a[128:131]
v_mul_f32 v191, v191, v31
v_cvt_pk_bf16_f32 v197, v190, v191
v_mfma_f32_16x16x32_bf16 a[136:139], v[12:15], v[180:183], a[136:139]
s_waitcnt vmcnt(33) lgkmcnt(0)
s_barrier
v_mfma_f32_16x16x32_bf16 a[136:139], v[0:3], v[228:231], a[136:139]
v_accvgpr_read_b32 v190, a94
v_accvgpr_read_b32 v191, a95
v_mfma_f32_16x16x32_bf16 a[100:103], v[4:7], v[160:163], a[100:103]
ds_read_b64_tr_b16 v[0:1], v184 offset:0
v_mul_f32 v188, v188, v31
v_mfma_f32_16x16x32_bf16 a[100:103], v[8:11], v[208:211], a[100:103]
ds_read_b64_tr_b16 v[2:3], v184 offset:2048
v_mul_f32 v189, v189, v31
v_mfma_f32_16x16x32_bf16 a[108:111], v[4:7], v[164:167], a[108:111]
ds_read_b64_tr_b16 v[12:13], v184 offset:4096
v_cvt_pk_bf16_f32 v198, v188, v189
v_mfma_f32_16x16x32_bf16 a[108:111], v[8:11], v[212:215], a[108:111]
s_add_u32 m0, s48, 86016
ds_read_b64_tr_b16 v[14:15], v184 offset:6144
v_mul_f32 v190, v190, v31
v_mfma_f32_16x16x32_bf16 a[116:119], v[4:7], v[168:171], a[116:119]
s_add_u32 s50, s49, 15616
v_mul_f32 v191, v191, v31
v_cvt_pk_bf16_f32 v199, v190, v191
v_mfma_f32_16x16x32_bf16 a[116:119], v[8:11], v[216:219], a[116:119]
buffer_load_dwordx4 v18, s[28:31], s50 offen nt lds
v_mfma_f32_16x16x32_bf16 a[124:127], v[4:7], v[172:175], a[124:127]
v_mfma_f32_16x16x32_bf16 a[124:127], v[8:11], v[220:223], a[124:127]
v_mfma_f32_16x16x32_bf16 a[132:135], v[4:7], v[176:179], a[132:135]
v_mfma_f32_16x16x32_bf16 a[132:135], v[8:11], v[224:227], a[132:135]
v_mfma_f32_16x16x32_bf16 a[140:143], v[4:7], v[180:183], a[140:143]
v_mfma_f32_16x16x32_bf16 a[140:143], v[8:11], v[228:231], a[140:143]
s_waitcnt lgkmcnt(2)
v_mfma_f32_16x16x32_bf16 a[48:51], v[0:3], a[144:147], 0
s_waitcnt lgkmcnt(0)
ds_read_b64_tr_b16 v[8:9], v184 offset:256
v_mfma_f32_16x16x32_bf16 a[48:51], v[12:15], a[168:171], a[48:51]
s_add_u32 m0, s48, 90112
ds_read_b64_tr_b16 v[10:11], v184 offset:2304
v_mfma_f32_16x16x32_bf16 a[56:59], v[0:3], a[148:151], 0
s_add_u32 s50, s49, 18688
ds_read_b64_tr_b16 v[4:5], v184 offset:4352
v_mfma_f32_16x16x32_bf16 a[56:59], v[12:15], a[172:175], a[56:59]
ds_read_b64_tr_b16 v[6:7], v184 offset:6400
v_mfma_f32_16x16x32_bf16 a[64:67], v[0:3], a[152:155], 0
buffer_load_dwordx4 v18, s[28:31], s50 offen nt lds
v_mfma_f32_16x16x32_bf16 a[64:67], v[12:15], a[176:179], a[64:67]
v_accvgpr_read_b32 v188, a96
v_accvgpr_read_b32 v189, a97
v_mfma_f32_16x16x32_bf16 a[72:75], v[0:3], a[156:159], 0
v_accvgpr_read_b32 v190, a98
v_mfma_f32_16x16x32_bf16 a[72:75], v[12:15], a[180:183], a[72:75]
v_accvgpr_read_b32 v191, a99
v_mfma_f32_16x16x32_bf16 a[80:83], v[0:3], a[160:163], 0
v_mul_f32 v188, v188, v26
v_mfma_f32_16x16x32_bf16 a[80:83], v[12:15], a[184:187], a[80:83]
v_mul_f32 v189, v189, v26
v_mfma_f32_16x16x32_bf16 a[88:91], v[0:3], a[164:167], 0
v_cvt_pk_bf16_f32 v22, v188, v189
v_mfma_f32_16x16x32_bf16 a[88:91], v[12:15], a[188:191], a[88:91]
s_waitcnt lgkmcnt(2)
ds_write_b64 v236, v[240:241]
v_mfma_f32_16x16x32_bf16 a[52:55], v[8:11], a[144:147], 0
s_waitcnt lgkmcnt(1)
ds_read_b64_tr_b16 v[12:13], v184 offset:8192
v_accvgpr_read_b32 v188, a100
v_mfma_f32_16x16x32_bf16 a[52:55], v[4:7], a[168:171], a[52:55]
s_add_u32 m0, s48, 94208
ds_read_b64_tr_b16 v[14:15], v184 offset:10240
v_accvgpr_read_b32 v189, a101
v_mfma_f32_16x16x32_bf16 a[60:63], v[8:11], a[148:151], 0
s_add_u32 s50, s49, 21760
ds_read_b64_tr_b16 v[0:1], v184 offset:12288
v_mul_f32 v190, v190, v26
v_mfma_f32_16x16x32_bf16 a[60:63], v[4:7], a[172:175], a[60:63]
ds_read_b64_tr_b16 v[2:3], v184 offset:14336
v_mul_f32 v191, v191, v26
v_mfma_f32_16x16x32_bf16 a[68:71], v[8:11], a[152:155], 0
buffer_load_dwordx4 v18, s[28:31], s50 offen nt lds
v_mfma_f32_16x16x32_bf16 a[68:71], v[4:7], a[176:179], a[68:71]
v_cvt_pk_bf16_f32 v23, v190, v191
v_accvgpr_read_b32 v190, a102
v_mfma_f32_16x16x32_bf16 a[76:79], v[8:11], a[156:159], 0
ds_write_b64 v238, v[22:23]
v_mfma_f32_16x16x32_bf16 a[76:79], v[4:7], a[180:183], a[76:79]
v_accvgpr_read_b32 v191, a103
v_mul_f32 v188, v188, v26
v_mfma_f32_16x16x32_bf16 a[84:87], v[8:11], a[160:163], 0
v_mul_f32 v189, v189, v26
v_mfma_f32_16x16x32_bf16 a[84:87], v[4:7], a[184:187], a[84:87]
v_cvt_pk_bf16_f32 v24, v188, v189
v_mfma_f32_16x16x32_bf16 a[92:95], v[8:11], a[164:167], 0
ds_write_b64 v237, v[242:243]
v_mfma_f32_16x16x32_bf16 a[92:95], v[4:7], a[188:191], a[92:95]
s_waitcnt lgkmcnt(4)
v_mul_f32 v190, v190, v26
v_mul_f32 v191, v191, v26
v_mfma_f32_16x16x32_bf16 a[48:51], v[12:15], a[192:195], a[48:51]
s_waitcnt lgkmcnt(2)
ds_read_b64_tr_b16 v[4:5], v184 offset:8448
v_cvt_pk_bf16_f32 v25, v190, v191
v_mfma_f32_16x16x32_bf16 a[48:51], v[0:3], a[216:219], a[48:51]
ds_read_b64_tr_b16 v[6:7], v184 offset:10496
v_mfma_f32_16x16x32_bf16 a[56:59], v[12:15], a[196:199], a[56:59]
ds_read_b64_tr_b16 v[8:9], v184 offset:12544
v_mfma_f32_16x16x32_bf16 a[56:59], v[0:3], a[220:223], a[56:59]
ds_read_b64_tr_b16 v[10:11], v184 offset:14592
v_mfma_f32_16x16x32_bf16 a[64:67], v[12:15], a[200:203], a[64:67]
ds_write_b64 v239, v[24:25]
v_mfma_f32_16x16x32_bf16 a[64:67], v[0:3], a[224:227], a[64:67]
ds_read_b128 v[200:203], v186 offset:0
v_accvgpr_read_b32 v188, a120
v_mfma_f32_16x16x32_bf16 a[72:75], v[12:15], a[204:207], a[72:75]
ds_read_b128 v[204:207], v186 offset:1024
v_accvgpr_read_b32 v189, a121
v_mfma_f32_16x16x32_bf16 a[72:75], v[0:3], a[228:231], a[72:75]
v_accvgpr_read_b32 v190, a122
v_accvgpr_read_b32 v191, a123
v_mfma_f32_16x16x32_bf16 a[80:83], v[12:15], a[208:211], a[80:83]
v_mul_f32 v188, v188, v29
v_mul_f32 v189, v189, v29
v_mfma_f32_16x16x32_bf16 a[80:83], v[0:3], a[232:235], a[80:83]
s_add_u32 s51, s49, 128
v_mfma_f32_16x16x32_bf16 a[88:91], v[12:15], a[212:215], a[88:91]
v_cvt_pk_bf16_f32 v240, v188, v189
v_accvgpr_read_b32 v188, a124
v_mfma_f32_16x16x32_bf16 a[88:91], v[0:3], a[236:239], a[88:91]
s_waitcnt lgkmcnt(5)
v_accvgpr_read_b32 v189, a125
v_mfma_f32_16x16x32_bf16 a[52:55], v[4:7], a[192:195], a[52:55]
s_waitcnt lgkmcnt(3)
ds_read_b64_tr_b16 v[0:1], v184 offset:16384
v_mul_f32 v190, v190, v29
v_mfma_f32_16x16x32_bf16 a[52:55], v[8:11], a[216:219], a[52:55]
ds_read_b64_tr_b16 v[2:3], v184 offset:18432
v_mul_f32 v191, v191, v29
v_mfma_f32_16x16x32_bf16 a[60:63], v[4:7], a[196:199], a[60:63]
ds_read_b64_tr_b16 v[12:13], v184 offset:20480
v_cvt_pk_bf16_f32 v241, v190, v191
v_mfma_f32_16x16x32_bf16 a[60:63], v[8:11], a[220:223], a[60:63]
ds_read_b64_tr_b16 v[14:15], v184 offset:22528
v_mfma_f32_16x16x32_bf16 a[68:71], v[4:7], a[200:203], a[68:71]
s_waitcnt lgkmcnt(5)
buffer_store_dwordx4 v[200:203], v18, s[24:27], s51 offen sc1
v_mfma_f32_16x16x32_bf16 a[68:71], v[8:11], a[224:227], a[68:71]
v_accvgpr_read_b32 v190, a126
v_accvgpr_read_b32 v191, a127
v_mfma_f32_16x16x32_bf16 a[76:79], v[4:7], a[204:207], a[76:79]
v_mul_f32 v188, v188, v29
v_mfma_f32_16x16x32_bf16 a[76:79], v[8:11], a[228:231], a[76:79]
v_mul_f32 v189, v189, v29
v_mfma_f32_16x16x32_bf16 a[84:87], v[4:7], a[208:211], a[84:87]
v_cvt_pk_bf16_f32 v242, v188, v189
v_mfma_f32_16x16x32_bf16 a[84:87], v[8:11], a[232:235], a[84:87]
v_mul_f32 v190, v190, v29
v_mfma_f32_16x16x32_bf16 a[92:95], v[4:7], a[212:215], a[92:95]
s_add_u32 s51, s49, 3200
v_mul_f32 v191, v191, v29
v_mfma_f32_16x16x32_bf16 a[92:95], v[8:11], a[236:239], a[92:95]
s_waitcnt lgkmcnt(2)
v_cvt_pk_bf16_f32 v243, v190, v191
v_mfma_f32_16x16x32_bf16 a[48:51], v[0:3], a[240:243], a[48:51]
s_waitcnt lgkmcnt(0)
ds_read_b64_tr_b16 v[8:9], v184 offset:16640
v_accvgpr_read_b32 v188, a104
v_mfma_f32_16x16x32_bf16 a[48:51], v[12:15], v[40:43], a[48:51]
ds_read_b64_tr_b16 v[10:11], v184 offset:18688
v_accvgpr_read_b32 v189, a105
v_mfma_f32_16x16x32_bf16 a[56:59], v[0:3], a[244:247], a[56:59]
ds_read_b64_tr_b16 v[4:5], v184 offset:20736
v_accvgpr_read_b32 v190, a106
v_mfma_f32_16x16x32_bf16 a[56:59], v[12:15], v[44:47], a[56:59]
ds_read_b64_tr_b16 v[6:7], v184 offset:22784
v_accvgpr_read_b32 v191, a107
v_mfma_f32_16x16x32_bf16 a[64:67], v[0:3], a[248:251], a[64:67]
buffer_store_dwordx4 v[204:207], v18, s[24:27], s51 offen sc1
v_mfma_f32_16x16x32_bf16 a[64:67], v[12:15], v[48:51], a[64:67]
v_mul_f32 v188, v188, v27
v_mul_f32 v189, v189, v27
v_mfma_f32_16x16x32_bf16 a[72:75], v[0:3], a[252:255], a[72:75]
v_cvt_pk_bf16_f32 v22, v188, v189
v_mfma_f32_16x16x32_bf16 a[72:75], v[12:15], v[52:55], a[72:75]
ds_write_b64 v236, v[244:245] offset:2048
v_mfma_f32_16x16x32_bf16 a[80:83], v[0:3], v[32:35], a[80:83]
v_accvgpr_read_b32 v188, a108
v_mfma_f32_16x16x32_bf16 a[80:83], v[12:15], v[56:59], a[80:83]
v_accvgpr_read_b32 v189, a109
v_mfma_f32_16x16x32_bf16 a[88:91], v[0:3], v[36:39], a[88:91]
v_mul_f32 v190, v190, v27
v_mfma_f32_16x16x32_bf16 a[88:91], v[12:15], v[60:63], a[88:91]
s_waitcnt lgkmcnt(3)
v_mul_f32 v191, v191, v27
v_mfma_f32_16x16x32_bf16 a[52:55], v[8:11], a[240:243], a[52:55]
s_waitcnt lgkmcnt(1)
ds_read_b64_tr_b16 v[12:13], v184 offset:24576
v_cvt_pk_bf16_f32 v23, v190, v191
v_mfma_f32_16x16x32_bf16 a[52:55], v[4:7], v[40:43], a[52:55]
ds_read_b64_tr_b16 v[14:15], v184 offset:26624
v_mfma_f32_16x16x32_bf16 a[60:63], v[8:11], a[244:247], a[60:63]
ds_read_b64_tr_b16 v[0:1], v184 offset:28672
v_accvgpr_read_b32 v190, a110
v_mfma_f32_16x16x32_bf16 a[60:63], v[4:7], v[44:47], a[60:63]
ds_read_b64_tr_b16 v[2:3], v184 offset:30720
v_accvgpr_read_b32 v191, a111
v_mfma_f32_16x16x32_bf16 a[68:71], v[8:11], a[248:251], a[68:71]
ds_write_b64 v238, v[22:23] offset:2048
v_mfma_f32_16x16x32_bf16 a[68:71], v[4:7], v[48:51], a[68:71]
v_mul_f32 v188, v188, v27
v_mul_f32 v189, v189, v27
v_mfma_f32_16x16x32_bf16 a[76:79], v[8:11], a[252:255], a[76:79]
v_cvt_pk_bf16_f32 v24, v188, v189
v_mfma_f32_16x16x32_bf16 a[76:79], v[4:7], v[52:55], a[76:79]
ds_write_b64 v237, v[246:247] offset:2048
v_mfma_f32_16x16x32_bf16 a[84:87], v[8:11], v[32:35], a[84:87]
v_mul_f32 v190, v190, v27
v_mul_f32 v191, v191, v27
v_mfma_f32_16x16x32_bf16 a[84:87], v[4:7], v[56:59], a[84:87]
v_cvt_pk_bf16_f32 v25, v190, v191
v_mfma_f32_16x16x32_bf16 a[92:95], v[8:11], v[36:39], a[92:95]
ds_write_b64 v239, v[24:25] offset:2048
v_mfma_f32_16x16x32_bf16 a[92:95], v[4:7], v[60:63], a[92:95]
s_waitcnt lgkmcnt(5)
ds_read_b128 v[200:203], v186 offset:2048
v_mfma_f32_16x16x32_bf16 a[48:51], v[12:15], v[64:67], a[48:51]
s_waitcnt lgkmcnt(4)
ds_read_b64_tr_b16 v[4:5], v184 offset:24832
v_mfma_f32_16x16x32_bf16 a[48:51], v[0:3], v[88:91], a[48:51]
ds_read_b64_tr_b16 v[6:7], v184 offset:26880
v_accvgpr_read_b32 v188, a128
v_mfma_f32_16x16x32_bf16 a[56:59], v[12:15], v[68:71], a[56:59]
ds_read_b64_tr_b16 v[8:9], v184 offset:28928
v_accvgpr_read_b32 v189, a129
v_mfma_f32_16x16x32_bf16 a[56:59], v[0:3], v[92:95], a[56:59]
ds_read_b64_tr_b16 v[10:11], v184 offset:30976
v_accvgpr_read_b32 v190, a130
v_mfma_f32_16x16x32_bf16 a[64:67], v[12:15], v[72:75], a[64:67]
ds_read_b128 v[204:207], v186 offset:3072
v_accvgpr_read_b32 v191, a131
v_mfma_f32_16x16x32_bf16 a[64:67], v[0:3], v[96:99], a[64:67]
v_mul_f32 v188, v188, v30
v_mul_f32 v189, v189, v30
v_mfma_f32_16x16x32_bf16 a[72:75], v[12:15], v[76:79], a[72:75]
s_add_u32 s51, s49, 6272
v_cvt_pk_bf16_f32 v244, v188, v189
v_mfma_f32_16x16x32_bf16 a[72:75], v[0:3], v[100:103], a[72:75]
v_accvgpr_read_b32 v188, a132
v_mfma_f32_16x16x32_bf16 a[80:83], v[12:15], v[80:83], a[80:83]
v_accvgpr_read_b32 v189, a133
v_mfma_f32_16x16x32_bf16 a[80:83], v[0:3], v[104:107], a[80:83]
v_mul_f32 v190, v190, v30
v_mfma_f32_16x16x32_bf16 a[88:91], v[12:15], v[84:87], a[88:91]
v_mul_f32 v191, v191, v30
v_mfma_f32_16x16x32_bf16 a[88:91], v[0:3], v[108:111], a[88:91]
s_waitcnt lgkmcnt(3)
v_cvt_pk_bf16_f32 v245, v190, v191
v_mfma_f32_16x16x32_bf16 a[52:55], v[4:7], v[64:67], a[52:55]
s_waitcnt lgkmcnt(1)
ds_read_b64_tr_b16 v[0:1], v184 offset:32768
v_mfma_f32_16x16x32_bf16 a[52:55], v[8:11], v[88:91], a[52:55]
ds_read_b64_tr_b16 v[2:3], v184 offset:34816
v_accvgpr_read_b32 v190, a134
v_mfma_f32_16x16x32_bf16 a[60:63], v[4:7], v[68:71], a[60:63]
ds_read_b64_tr_b16 v[12:13], v184 offset:36864
v_accvgpr_read_b32 v191, a135
v_mfma_f32_16x16x32_bf16 a[60:63], v[8:11], v[92:95], a[60:63]
ds_read_b64_tr_b16 v[14:15], v184 offset:38912
v_mul_f32 v188, v188, v30
v_mfma_f32_16x16x32_bf16 a[68:71], v[4:7], v[72:75], a[68:71]
buffer_store_dwordx4 v[200:203], v18, s[24:27], s51 offen sc1
v_mfma_f32_16x16x32_bf16 a[68:71], v[8:11], v[96:99], a[68:71]
v_mul_f32 v189, v189, v30
v_cvt_pk_bf16_f32 v246, v188, v189
v_mfma_f32_16x16x32_bf16 a[76:79], v[4:7], v[76:79], a[76:79]
v_mul_f32 v190, v190, v30
v_mfma_f32_16x16x32_bf16 a[76:79], v[8:11], v[100:103], a[76:79]
s_add_u32 s51, s49, 9344
v_mul_f32 v191, v191, v30
v_cvt_pk_bf16_f32 v247, v190, v191
v_mfma_f32_16x16x32_bf16 a[84:87], v[4:7], v[80:83], a[84:87]
v_accvgpr_read_b32 v188, a112
v_mfma_f32_16x16x32_bf16 a[84:87], v[8:11], v[104:107], a[84:87]
v_accvgpr_read_b32 v189, a113
v_mfma_f32_16x16x32_bf16 a[92:95], v[4:7], v[84:87], a[92:95]
v_accvgpr_read_b32 v190, a114
v_mfma_f32_16x16x32_bf16 a[92:95], v[8:11], v[108:111], a[92:95]
s_waitcnt lgkmcnt(2)
v_accvgpr_read_b32 v191, a115
v_mfma_f32_16x16x32_bf16 a[48:51], v[0:3], v[112:115], a[48:51]
s_waitcnt lgkmcnt(0)
ds_read_b64_tr_b16 v[8:9], v184 offset:33024
v_mfma_f32_16x16x32_bf16 a[48:51], v[12:15], v[136:139], a[48:51]
ds_read_b64_tr_b16 v[10:11], v184 offset:35072
v_mul_f32 v188, v188, v28
v_mfma_f32_16x16x32_bf16 a[56:59], v[0:3], v[116:119], a[56:59]
ds_read_b64_tr_b16 v[4:5], v184 offset:37120
v_mul_f32 v189, v189, v28
v_mfma_f32_16x16x32_bf16 a[56:59], v[12:15], v[140:143], a[56:59]
ds_read_b64_tr_b16 v[6:7], v184 offset:39168
v_cvt_pk_bf16_f32 v22, v188, v189
v_mfma_f32_16x16x32_bf16 a[64:67], v[0:3], v[120:123], a[64:67]
buffer_store_dwordx4 v[204:207], v18, s[24:27], s51 offen sc1
v_mfma_f32_16x16x32_bf16 a[64:67], v[12:15], v[144:147], a[64:67]
ds_write_b64 v236, v[248:249]
v_mfma_f32_16x16x32_bf16 a[72:75], v[0:3], v[124:127], a[72:75]
v_accvgpr_read_b32 v188, a116
v_accvgpr_read_b32 v189, a117
v_mfma_f32_16x16x32_bf16 a[72:75], v[12:15], v[148:151], a[72:75]
v_mul_f32 v190, v190, v28
v_mfma_f32_16x16x32_bf16 a[80:83], v[0:3], v[128:131], a[80:83]
v_mul_f32 v191, v191, v28
v_cvt_pk_bf16_f32 v23, v190, v191
v_mfma_f32_16x16x32_bf16 a[80:83], v[12:15], v[152:155], a[80:83]
ds_write_b64 v238, v[22:23]
v_mfma_f32_16x16x32_bf16 a[88:91], v[0:3], v[132:135], a[88:91]
v_mfma_f32_16x16x32_bf16 a[88:91], v[12:15], v[156:159], a[88:91]
s_waitcnt lgkmcnt(4)
v_accvgpr_read_b32 v190, a118
v_accvgpr_read_b32 v191, a119
v_mfma_f32_16x16x32_bf16 a[52:55], v[8:11], v[112:115], a[52:55]
s_waitcnt lgkmcnt(2)
ds_read_b64_tr_b16 v[12:13], v184 offset:40960
v_mul_f32 v188, v188, v28
v_mfma_f32_16x16x32_bf16 a[52:55], v[4:7], v[136:139], a[52:55]
ds_read_b64_tr_b16 v[14:15], v184 offset:43008
v_mul_f32 v189, v189, v28
v_mfma_f32_16x16x32_bf16 a[60:63], v[8:11], v[116:119], a[60:63]
ds_read_b64_tr_b16 v[0:1], v184 offset:45056
v_cvt_pk_bf16_f32 v24, v188, v189
v_mfma_f32_16x16x32_bf16 a[60:63], v[4:7], v[140:143], a[60:63]
ds_read_b64_tr_b16 v[2:3], v184 offset:47104
v_mfma_f32_16x16x32_bf16 a[68:71], v[8:11], v[120:123], a[68:71]
ds_write_b64 v237, v[250:251]
v_mfma_f32_16x16x32_bf16 a[68:71], v[4:7], v[144:147], a[68:71]
v_mul_f32 v190, v190, v28
v_mul_f32 v191, v191, v28
v_mfma_f32_16x16x32_bf16 a[76:79], v[8:11], v[124:127], a[76:79]
v_cvt_pk_bf16_f32 v25, v190, v191
v_mfma_f32_16x16x32_bf16 a[76:79], v[4:7], v[148:151], a[76:79]
ds_write_b64 v239, v[24:25]
v_mfma_f32_16x16x32_bf16 a[84:87], v[8:11], v[128:131], a[84:87]
ds_read_b128 v[200:203], v186 offset:0
v_mfma_f32_16x16x32_bf16 a[84:87], v[4:7], v[152:155], a[84:87]
ds_read_b128 v[204:207], v186 offset:1024
v_mfma_f32_16x16x32_bf16 a[92:95], v[8:11], v[132:135], a[92:95]
v_accvgpr_read_b32 v188, a136
v_accvgpr_read_b32 v189, a137
v_mfma_f32_16x16x32_bf16 a[92:95], v[4:7], v[156:159], a[92:95]
s_waitcnt lgkmcnt(6)
v_accvgpr_read_b32 v190, a138
v_mfma_f32_16x16x32_bf16 a[48:51], v[12:15], v[160:163], a[48:51]
s_waitcnt lgkmcnt(4)
ds_read_b64_tr_b16 v[4:5], v184 offset:41216
v_accvgpr_read_b32 v191, a139
v_mfma_f32_16x16x32_bf16 a[48:51], v[0:3], v[208:211], a[48:51]
ds_read_b64_tr_b16 v[6:7], v184 offset:43264
v_mul_f32 v188, v188, v31
v_mfma_f32_16x16x32_bf16 a[56:59], v[12:15], v[164:167], a[56:59]
ds_read_b64_tr_b16 v[8:9], v184 offset:45312
v_mul_f32 v189, v189, v31
v_mfma_f32_16x16x32_bf16 a[56:59], v[0:3], v[212:215], a[56:59]
s_add_u32 s51, s49, 12416
ds_read_b64_tr_b16 v[10:11], v184 offset:47360
v_cvt_pk_bf16_f32 v248, v188, v189
v_mfma_f32_16x16x32_bf16 a[64:67], v[12:15], v[168:171], a[64:67]
v_accvgpr_read_b32 v188, a140
v_mfma_f32_16x16x32_bf16 a[64:67], v[0:3], v[216:219], a[64:67]
v_accvgpr_read_b32 v189, a141
v_mfma_f32_16x16x32_bf16 a[72:75], v[12:15], v[172:175], a[72:75]
v_mul_f32 v190, v190, v31
v_mul_f32 v191, v191, v31
v_mfma_f32_16x16x32_bf16 a[72:75], v[0:3], v[220:223], a[72:75]
v_cvt_pk_bf16_f32 v249, v190, v191
v_mfma_f32_16x16x32_bf16 a[80:83], v[12:15], v[176:179], a[80:83]
s_waitcnt lgkmcnt(5)
buffer_store_dwordx4 v[200:203], v18, s[24:27], s51 offen sc1
v_mfma_f32_16x16x32_bf16 a[80:83], v[0:3], v[224:227], a[80:83]
v_mfma_f32_16x16x32_bf16 a[88:91], v[12:15], v[180:183], a[88:91]
v_accvgpr_read_b32 v190, a142
v_mfma_f32_16x16x32_bf16 a[88:91], v[0:3], v[228:231], a[88:91]
s_waitcnt lgkmcnt(2)
v_accvgpr_read_b32 v191, a143
v_mul_f32 v188, v188, v31
v_mfma_f32_16x16x32_bf16 a[52:55], v[4:7], v[160:163], a[52:55]
s_waitcnt lgkmcnt(0)
ds_read_b64_tr_b16 v[0:1], v184 offset:512
v_mul_f32 v189, v189, v31
v_mfma_f32_16x16x32_bf16 a[52:55], v[8:11], v[208:211], a[52:55]
ds_read_b64_tr_b16 v[2:3], v184 offset:2560
v_cvt_pk_bf16_f32 v250, v188, v189
v_mfma_f32_16x16x32_bf16 a[60:63], v[4:7], v[164:167], a[60:63]
ds_read_b64_tr_b16 v[12:13], v184 offset:4608
v_mul_f32 v190, v190, v31
v_mfma_f32_16x16x32_bf16 a[60:63], v[8:11], v[212:215], a[60:63]
s_add_u32 s51, s49, 15488
ds_read_b64_tr_b16 v[14:15], v184 offset:6656
v_mul_f32 v191, v191, v31
v_mfma_f32_16x16x32_bf16 a[68:71], v[4:7], v[168:171], a[68:71]
v_cvt_pk_bf16_f32 v251, v190, v191
v_mfma_f32_16x16x32_bf16 a[68:71], v[8:11], v[216:219], a[68:71]
v_mfma_f32_16x16x32_bf16 a[76:79], v[4:7], v[172:175], a[76:79]
v_mfma_f32_16x16x32_bf16 a[76:79], v[8:11], v[220:223], a[76:79]
v_mfma_f32_16x16x32_bf16 a[84:87], v[4:7], v[176:179], a[84:87]
v_mfma_f32_16x16x32_bf16 a[84:87], v[8:11], v[224:227], a[84:87]
buffer_store_dwordx4 v[204:207], v18, s[24:27], s51 offen sc1
v_mfma_f32_16x16x32_bf16 a[92:95], v[4:7], v[180:183], a[92:95]
v_mfma_f32_16x16x32_bf16 a[92:95], v[8:11], v[228:231], a[92:95]
s_waitcnt lgkmcnt(2)
v_mfma_f32_16x16x32_bf16 a[96:99], v[0:3], a[144:147], 0
s_waitcnt lgkmcnt(0)
ds_read_b64_tr_b16 v[8:9], v184 offset:768
v_mfma_f32_16x16x32_bf16 a[96:99], v[12:15], a[168:171], a[96:99]
ds_read_b64_tr_b16 v[10:11], v184 offset:2816
v_mfma_f32_16x16x32_bf16 a[104:107], v[0:3], a[148:151], 0
ds_read_b64_tr_b16 v[4:5], v184 offset:4864
v_mfma_f32_16x16x32_bf16 a[104:107], v[12:15], a[172:175], a[104:107]
ds_read_b64_tr_b16 v[6:7], v184 offset:6912
v_mfma_f32_16x16x32_bf16 a[112:115], v[0:3], a[152:155], 0
v_mfma_f32_16x16x32_bf16 a[112:115], v[12:15], a[176:179], a[112:115]
ds_write_b64 v236, v[252:253] offset:2048
v_mfma_f32_16x16x32_bf16 a[120:123], v[0:3], a[156:159], 0
ds_write_b64 v237, v[254:255] offset:2048
v_mfma_f32_16x16x32_bf16 a[120:123], v[12:15], a[180:183], a[120:123]
ds_write_b64 v238, v[240:241] offset:2048
v_mfma_f32_16x16x32_bf16 a[128:131], v[0:3], a[160:163], 0
ds_write_b64 v239, v[242:243] offset:2048
v_mfma_f32_16x16x32_bf16 a[128:131], v[12:15], a[184:187], a[128:131]
v_mfma_f32_16x16x32_bf16 a[136:139], v[0:3], a[164:167], 0
ds_read_b128 v[200:203], v186 offset:2048
v_mfma_f32_16x16x32_bf16 a[136:139], v[12:15], a[188:191], a[136:139]
s_waitcnt lgkmcnt(7)
ds_read_b128 v[204:207], v186 offset:3072
v_accvgpr_read_b32 v188, a48
v_mfma_f32_16x16x32_bf16 a[100:103], v[8:11], a[144:147], 0
s_waitcnt lgkmcnt(6)
ds_read_b64_tr_b16 v[12:13], v184 offset:8704
v_accvgpr_read_b32 v189, a49
v_mfma_f32_16x16x32_bf16 a[100:103], v[4:7], a[168:171], a[100:103]
ds_read_b64_tr_b16 v[14:15], v184 offset:10752
v_accvgpr_read_b32 v190, a50
v_mfma_f32_16x16x32_bf16 a[108:111], v[8:11], a[148:151], 0
ds_read_b64_tr_b16 v[0:1], v184 offset:12800
v_accvgpr_read_b32 v191, a51
v_mfma_f32_16x16x32_bf16 a[108:111], v[4:7], a[172:175], a[108:111]
ds_read_b64_tr_b16 v[2:3], v184 offset:14848
v_mul_f32 v188, v188, v26
v_mfma_f32_16x16x32_bf16 a[116:119], v[8:11], a[152:155], 0
v_mul_f32 v189, v189, v26
v_mfma_f32_16x16x32_bf16 a[116:119], v[4:7], a[176:179], a[116:119]
s_add_u32 s51, s49, 18560
v_cvt_pk_bf16_f32 v240, v188, v189
v_accvgpr_read_b32 v188, a52
v_mfma_f32_16x16x32_bf16 a[124:127], v[8:11], a[156:159], 0
v_accvgpr_read_b32 v189, a53
v_mfma_f32_16x16x32_bf16 a[124:127], v[4:7], a[180:183], a[124:127]
v_mul_f32 v190, v190, v26
v_mfma_f32_16x16x32_bf16 a[132:135], v[8:11], a[160:163], 0
v_mul_f32 v191, v191, v26
v_mfma_f32_16x16x32_bf16 a[132:135], v[4:7], a[184:187], a[132:135]
v_cvt_pk_bf16_f32 v241, v190, v191
v_mfma_f32_16x16x32_bf16 a[140:143], v[8:11], a[164:167], 0
s_waitcnt lgkmcnt(5)
buffer_store_dwordx4 v[200:203], v18, s[24:27], s51 offen sc1
v_mfma_f32_16x16x32_bf16 a[140:143], v[4:7], a[188:191], a[140:143]
s_waitcnt lgkmcnt(2)
v_accvgpr_read_b32 v190, a54
v_mfma_f32_16x16x32_bf16 a[96:99], v[12:15], a[192:195], a[96:99]
s_waitcnt lgkmcnt(0)
ds_read_b64_tr_b16 v[4:5], v184 offset:8960
v_accvgpr_read_b32 v191, a55
v_mfma_f32_16x16x32_bf16 a[96:99], v[0:3], a[216:219], a[96:99]
ds_read_b64_tr_b16 v[6:7], v184 offset:11008
v_mul_f32 v188, v188, v26
v_mfma_f32_16x16x32_bf16 a[104:107], v[12:15], a[196:199], a[104:107]
ds_read_b64_tr_b16 v[8:9], v184 offset:13056
v_mul_f32 v189, v189, v26
v_mfma_f32_16x16x32_bf16 a[104:107], v[0:3], a[220:223], a[104:107]
ds_read_b64_tr_b16 v[10:11], v184 offset:15104
v_cvt_pk_bf16_f32 v242, v188, v189
v_mfma_f32_16x16x32_bf16 a[112:115], v[12:15], a[200:203], a[112:115]
v_mul_f32 v190, v190, v26
v_mfma_f32_16x16x32_bf16 a[112:115], v[0:3], a[224:227], a[112:115]
s_add_u32 s51, s49, 21632
v_mul_f32 v191, v191, v26
v_cvt_pk_bf16_f32 v243, v190, v191
v_mfma_f32_16x16x32_bf16 a[120:123], v[12:15], a[204:207], a[120:123]
v_accvgpr_read_b32 v188, a72
v_mfma_f32_16x16x32_bf16 a[120:123], v[0:3], a[228:231], a[120:123]
s_waitcnt lgkmcnt(2)
s_barrier
v_mfma_f32_16x16x32_bf16 a[128:131], v[12:15], a[208:211], a[128:131]
v_accvgpr_read_b32 v189, a73
v_accvgpr_read_b32 v190, a74
v_mfma_f32_16x16x32_bf16 a[128:131], v[0:3], a[232:235], a[128:131]
s_add_u32 m0, s48, 98304
v_accvgpr_read_b32 v191, a75
v_mfma_f32_16x16x32_bf16 a[136:139], v[12:15], a[212:215], a[136:139]
s_add_u32 s50, s49, 24576
v_mul_f32 v188, v188, v29
v_mul_f32 v189, v189, v29
v_mfma_f32_16x16x32_bf16 a[136:139], v[0:3], a[236:239], a[136:139]
buffer_store_dwordx4 v[204:207], v18, s[24:27], s51 offen sc1
v_mfma_f32_16x16x32_bf16 a[100:103], v[4:7], a[192:195], a[100:103]
s_waitcnt lgkmcnt(0)
ds_read_b64_tr_b16 v[0:1], v184 offset:16896
v_mfma_f32_16x16x32_bf16 a[100:103], v[8:11], a[216:219], a[100:103]
ds_read_b64_tr_b16 v[2:3], v184 offset:18944
v_cvt_pk_bf16_f32 v252, v188, v189
v_mfma_f32_16x16x32_bf16 a[108:111], v[4:7], a[196:199], a[108:111]
ds_read_b64_tr_b16 v[12:13], v184 offset:20992
v_accvgpr_read_b32 v188, a76
v_mfma_f32_16x16x32_bf16 a[108:111], v[8:11], a[220:223], a[108:111]
ds_read_b64_tr_b16 v[14:15], v184 offset:23040
v_accvgpr_read_b32 v189, a77
v_mfma_f32_16x16x32_bf16 a[116:119], v[4:7], a[200:203], a[116:119]
buffer_load_dwordx4 v18, s[28:31], s50 offen nt lds
v_mfma_f32_16x16x32_bf16 a[116:119], v[8:11], a[224:227], a[116:119]
v_mul_f32 v190, v190, v29
v_mul_f32 v191, v191, v29
v_mfma_f32_16x16x32_bf16 a[124:127], v[4:7], a[204:207], a[124:127]
v_cvt_pk_bf16_f32 v253, v190, v191
v_accvgpr_read_b32 v190, a78
v_mfma_f32_16x16x32_bf16 a[124:127], v[8:11], a[228:231], a[124:127]
s_add_u32 m0, s48, 102400
v_accvgpr_read_b32 v191, a79
v_mfma_f32_16x16x32_bf16 a[132:135], v[4:7], a[208:211], a[132:135]
s_add_u32 s50, s49, 27648
v_mul_f32 v188, v188, v29
v_mul_f32 v189, v189, v29
v_mfma_f32_16x16x32_bf16 a[132:135], v[8:11], a[232:235], a[132:135]
buffer_load_dwordx4 v18, s[28:31], s50 offen nt lds
v_mfma_f32_16x16x32_bf16 a[140:143], v[4:7], a[212:215], a[140:143]
v_cvt_pk_bf16_f32 v254, v188, v189
v_mul_f32 v190, v190, v29
v_mfma_f32_16x16x32_bf16 a[140:143], v[8:11], a[236:239], a[140:143]
s_waitcnt lgkmcnt(2)
v_mul_f32 v191, v191, v29
v_mfma_f32_16x16x32_bf16 a[96:99], v[0:3], a[240:243], a[96:99]
s_waitcnt lgkmcnt(0)
ds_read_b64_tr_b16 v[8:9], v184 offset:17152
v_cvt_pk_bf16_f32 v255, v190, v191
v_mfma_f32_16x16x32_bf16 a[96:99], v[12:15], v[40:43], a[96:99]
ds_read_b64_tr_b16 v[10:11], v184 offset:19200
v_mfma_f32_16x16x32_bf16 a[104:107], v[0:3], a[244:247], a[104:107]
ds_read_b64_tr_b16 v[4:5], v184 offset:21248
v_mfma_f32_16x16x32_bf16 a[104:107], v[12:15], v[44:47], a[104:107]
ds_read_b64_tr_b16 v[6:7], v184 offset:23296
v_mfma_f32_16x16x32_bf16 a[112:115], v[0:3], a[248:251], a[112:115]
ds_write_b64 v236, v[192:193]
v_mfma_f32_16x16x32_bf16 a[112:115], v[12:15], v[48:51], a[112:115]
s_add_u32 m0, s48, 106496
ds_write_b64 v237, v[194:195]
v_mfma_f32_16x16x32_bf16 a[120:123], v[0:3], a[252:255], a[120:123]
s_add_u32 s50, s49, 30720
ds_write_b64 v238, v[244:245]
v_mfma_f32_16x16x32_bf16 a[120:123], v[12:15], v[52:55], a[120:123]
ds_write_b64 v239, v[246:247]
v_mfma_f32_16x16x32_bf16 a[128:131], v[0:3], v[32:35], a[128:131]
ds_read_b128 v[200:203], v186 offset:0
v_accvgpr_read_b32 v188, a56
v_mfma_f32_16x16x32_bf16 a[128:131], v[12:15], v[56:59], a[128:131]
s_waitcnt lgkmcnt(5)
s_barrier
ds_read_b128 v[204:207], v186 offset:1024
v_mfma_f32_16x16x32_bf16 a[136:139], v[0:3], v[36:39], a[136:139]
buffer_load_dwordx4 v18, s[28:31], s50 offen nt lds
v_mfma_f32_16x16x32_bf16 a[136:139], v[12:15], v[60:63], a[136:139]
v_accvgpr_read_b32 v189, a57
v_accvgpr_read_b32 v190, a58
v_mfma_f32_16x16x32_bf16 a[100:103], v[8:11], a[240:243], a[100:103]
ds_read_b64_tr_b16 v[12:13], v184 offset:25088
v_accvgpr_read_b32 v191, a59
v_mfma_f32_16x16x32_bf16 a[100:103], v[4:7], v[40:43], a[100:103]
ds_read_b64_tr_b16 v[14:15], v184 offset:27136
v_mul_f32 v188, v188, v27
v_mfma_f32_16x16x32_bf16 a[108:111], v[8:11], a[244:247], a[108:111]
ds_read_b64_tr_b16 v[0:1], v184 offset:29184
v_mul_f32 v189, v189, v27
v_mfma_f32_16x16x32_bf16 a[108:111], v[4:7], v[44:47], a[108:111]
s_add_u32 s51, s49, 24704
ds_read_b64_tr_b16 v[2:3], v184 offset:31232
v_cvt_pk_bf16_f32 v244, v188, v189
v_mfma_f32_16x16x32_bf16 a[116:119], v[8:11], a[248:251], a[116:119]
s_add_u32 m0, s48, 110592
v_accvgpr_read_b32 v188, a60
v_accvgpr_read_b32 v189, a61
v_mfma_f32_16x16x32_bf16 a[116:119], v[4:7], v[48:51], a[116:119]
s_add_u32 s50, s49, 33792
buffer_load_dwordx4 v18, s[28:31], s50 offen nt lds
v_mfma_f32_16x16x32_bf16 a[124:127], v[8:11], a[252:255], a[124:127]
v_mul_f32 v190, v190, v27
v_mul_f32 v191, v191, v27
v_mfma_f32_16x16x32_bf16 a[124:127], v[4:7], v[52:55], a[124:127]
v_cvt_pk_bf16_f32 v245, v190, v191
v_accvgpr_read_b32 v190, a62
v_mfma_f32_16x16x32_bf16 a[132:135], v[8:11], v[32:35], a[132:135]
s_waitcnt lgkmcnt(5)
buffer_store_dwordx4 v[200:203], v18, s[24:27], s51 offen sc1
v_mfma_f32_16x16x32_bf16 a[132:135], v[4:7], v[56:59], a[132:135]
v_accvgpr_read_b32 v191, a63
v_mul_f32 v188, v188, v27
v_mfma_f32_16x16x32_bf16 a[140:143], v[8:11], v[36:39], a[140:143]
v_mul_f32 v189, v189, v27
v_mfma_f32_16x16x32_bf16 a[140:143], v[4:7], v[60:63], a[140:143]
s_waitcnt lgkmcnt(2)
v_cvt_pk_bf16_f32 v246, v188, v189
v_mfma_f32_16x16x32_bf16 a[96:99], v[12:15], v[64:67], a[96:99]
s_waitcnt lgkmcnt(0)
ds_read_b64_tr_b16 v[4:5], v184 offset:25344
v_mul_f32 v190, v190, v27
v_mfma_f32_16x16x32_bf16 a[96:99], v[0:3], v[88:91], a[96:99]
s_add_u32 s51, s49, 27776
ds_read_b64_tr_b16 v[6:7], v184 offset:27392
v_mul_f32 v191, v191, v27
v_mfma_f32_16x16x32_bf16 a[104:107], v[12:15], v[68:71], a[104:107]
s_add_u32 m0, s48, 114688
ds_read_b64_tr_b16 v[8:9], v184 offset:29440
v_cvt_pk_bf16_f32 v247, v190, v191
v_mfma_f32_16x16x32_bf16 a[104:107], v[0:3], v[92:95], a[104:107]
s_add_u32 s50, s49, 24704
ds_read_b64_tr_b16 v[10:11], v184 offset:31488
v_accvgpr_read_b32 v188, a80
v_mfma_f32_16x16x32_bf16 a[112:115], v[12:15], v[72:75], a[112:115]
buffer_load_dwordx4 v18, s[28:31], s50 offen nt lds
v_mfma_f32_16x16x32_bf16 a[112:115], v[0:3], v[96:99], a[112:115]
v_accvgpr_read_b32 v189, a81
v_accvgpr_read_b32 v190, a82
v_mfma_f32_16x16x32_bf16 a[120:123], v[12:15], v[76:79], a[120:123]
v_accvgpr_read_b32 v191, a83
v_mul_f32 v188, v188, v30
v_mfma_f32_16x16x32_bf16 a[120:123], v[0:3], v[100:103], a[120:123]
v_mul_f32 v189, v189, v30
v_mfma_f32_16x16x32_bf16 a[128:131], v[12:15], v[80:83], a[128:131]
buffer_store_dwordx4 v[204:207], v18, s[24:27], s51 offen sc1
v_mfma_f32_16x16x32_bf16 a[128:131], v[0:3], v[104:107], a[128:131]
v_cvt_pk_bf16_f32 v192, v188, v189
v_mfma_f32_16x16x32_bf16 a[136:139], v[12:15], v[84:87], a[136:139]
v_accvgpr_read_b32 v188, a84
v_mfma_f32_16x16x32_bf16 a[136:139], v[0:3], v[108:111], a[136:139]
s_waitcnt lgkmcnt(2)
v_accvgpr_read_b32 v189, a85
v_mfma_f32_16x16x32_bf16 a[100:103], v[4:7], v[64:67], a[100:103]
s_waitcnt lgkmcnt(0)
ds_read_b64_tr_b16 v[0:1], v184 offset:33280
v_mul_f32 v190, v190, v30
v_mfma_f32_16x16x32_bf16 a[100:103], v[8:11], v[88:91], a[100:103]
s_add_u32 m0, s48, 118784
ds_read_b64_tr_b16 v[2:3], v184 offset:35328
v_mul_f32 v191, v191, v30
v_mfma_f32_16x16x32_bf16 a[108:111], v[4:7], v[68:71], a[108:111]
s_add_u32 s50, s49, 27776
ds_read_b64_tr_b16 v[12:13], v184 offset:37376
v_cvt_pk_bf16_f32 v193, v190, v191
v_mfma_f32_16x16x32_bf16 a[108:111], v[8:11], v[92:95], a[108:111]
ds_read_b64_tr_b16 v[14:15], v184 offset:39424
v_accvgpr_read_b32 v190, a86
v_mfma_f32_16x16x32_bf16 a[116:119], v[4:7], v[72:75], a[116:119]
buffer_load_dwordx4 v18, s[28:31], s50 offen nt lds
v_mfma_f32_16x16x32_bf16 a[116:119], v[8:11], v[96:99], a[116:119]
v_accvgpr_read_b32 v191, a87
v_mul_f32 v188, v188, v30
v_mfma_f32_16x16x32_bf16 a[124:127], v[4:7], v[76:79], a[124:127]
v_mul_f32 v189, v189, v30
v_cvt_pk_bf16_f32 v194, v188, v189
v_mfma_f32_16x16x32_bf16 a[124:127], v[8:11], v[100:103], a[124:127]
v_mul_f32 v190, v190, v30
v_mul_f32 v191, v191, v30
v_mfma_f32_16x16x32_bf16 a[132:135], v[4:7], v[80:83], a[132:135]
v_cvt_pk_bf16_f32 v195, v190, v191
v_mfma_f32_16x16x32_bf16 a[132:135], v[8:11], v[104:107], a[132:135]
ds_write_b64 v236, v[196:197] offset:2048
v_mfma_f32_16x16x32_bf16 a[140:143], v[4:7], v[84:87], a[140:143]
ds_write_b64 v237, v[198:199] offset:2048
v_mfma_f32_16x16x32_bf16 a[140:143], v[8:11], v[108:111], a[140:143]
s_waitcnt lgkmcnt(4)
ds_write_b64 v238, v[248:249] offset:2048
v_mfma_f32_16x16x32_bf16 a[96:99], v[0:3], v[112:115], a[96:99]
s_waitcnt lgkmcnt(3)
ds_read_b64_tr_b16 v[8:9], v184 offset:33536
v_mfma_f32_16x16x32_bf16 a[96:99], v[12:15], v[136:139], a[96:99]
ds_read_b64_tr_b16 v[10:11], v184 offset:35584
v_mfma_f32_16x16x32_bf16 a[104:107], v[0:3], v[116:119], a[104:107]
ds_read_b64_tr_b16 v[4:5], v184 offset:37632
v_mfma_f32_16x16x32_bf16 a[104:107], v[12:15], v[140:143], a[104:107]
ds_read_b64_tr_b16 v[6:7], v184 offset:39680
v_accvgpr_read_b32 v188, a64
v_mfma_f32_16x16x32_bf16 a[112:115], v[0:3], v[120:123], a[112:115]
ds_write_b64 v239, v[250:251] offset:2048
v_mfma_f32_16x16x32_bf16 a[112:115], v[12:15], v[144:147], a[112:115]
ds_read_b128 v[200:203], v186 offset:2048
v_accvgpr_read_b32 v189, a65
v_mfma_f32_16x16x32_bf16 a[120:123], v[0:3], v[124:127], a[120:123]
ds_read_b128 v[204:207], v186 offset:3072
v_accvgpr_read_b32 v190, a66
v_mfma_f32_16x16x32_bf16 a[120:123], v[12:15], v[148:151], a[120:123]
s_waitcnt lgkmcnt(5)
s_barrier
v_mfma_f32_16x16x32_bf16 a[128:131], v[0:3], v[128:131], a[128:131]
v_accvgpr_read_b32 v191, a67
v_mul_f32 v188, v188, v28
v_mfma_f32_16x16x32_bf16 a[128:131], v[12:15], v[152:155], a[128:131]
s_add_u32 m0, s48, 122880
v_mul_f32 v189, v189, v28
v_cvt_pk_bf16_f32 v248, v188, v189
v_mfma_f32_16x16x32_bf16 a[136:139], v[0:3], v[132:135], a[136:139]
s_add_u32 s51, s49, 30848
v_accvgpr_read_b32 v188, a68
v_mfma_f32_16x16x32_bf16 a[136:139], v[12:15], v[156:159], a[136:139]
v_accvgpr_read_b32 v189, a69
v_mul_f32 v190, v190, v28
v_mfma_f32_16x16x32_bf16 a[100:103], v[8:11], v[112:115], a[100:103]
s_waitcnt lgkmcnt(3)
ds_read_b64_tr_b16 v[12:13], v184 offset:41472
v_mul_f32 v191, v191, v28
v_mfma_f32_16x16x32_bf16 a[100:103], v[4:7], v[136:139], a[100:103]
s_add_u32 s50, s49, 30848
ds_read_b64_tr_b16 v[14:15], v184 offset:43520
v_cvt_pk_bf16_f32 v249, v190, v191
v_mfma_f32_16x16x32_bf16 a[108:111], v[8:11], v[116:119], a[108:111]
ds_read_b64_tr_b16 v[0:1], v184 offset:45568
v_mfma_f32_16x16x32_bf16 a[108:111], v[4:7], v[140:143], a[108:111]
ds_read_b64_tr_b16 v[2:3], v184 offset:47616
v_mfma_f32_16x16x32_bf16 a[116:119], v[8:11], v[120:123], a[116:119]
s_waitcnt lgkmcnt(5)
buffer_store_dwordx4 v[200:203], v18, s[24:27], s51 offen sc1
v_mfma_f32_16x16x32_bf16 a[116:119], v[4:7], v[144:147], a[116:119]
buffer_load_dwordx4 v18, s[28:31], s50 offen nt lds
v_mfma_f32_16x16x32_bf16 a[124:127], v[8:11], v[124:127], a[124:127]
v_accvgpr_read_b32 v190, a70
v_accvgpr_read_b32 v191, a71
v_mfma_f32_16x16x32_bf16 a[124:127], v[4:7], v[148:151], a[124:127]
s_add_u32 m0, s48, 126976
v_mul_f32 v188, v188, v28
v_mul_f32 v189, v189, v28
v_mfma_f32_16x16x32_bf16 a[132:135], v[8:11], v[128:131], a[132:135]
s_add_u32 s50, s49, 33920
v_cvt_pk_bf16_f32 v250, v188, v189
v_mbcnt_lo_u32_b32 v235, -1, 0
v_mfma_f32_16x16x32_bf16 a[132:135], v[4:7], v[152:155], a[132:135]
buffer_load_dwordx4 v18, s[28:31], s50 offen nt lds
v_mfma_f32_16x16x32_bf16 a[140:143], v[8:11], v[132:135], a[140:143]
v_mul_f32 v190, v190, v28
v_mbcnt_hi_u32_b32 v235, -1, v235
v_mfma_f32_16x16x32_bf16 a[140:143], v[4:7], v[156:159], a[140:143]
s_waitcnt lgkmcnt(2)
v_mul_f32 v191, v191, v28
v_bfe_u32 v233, v235, 1, 2
v_mfma_f32_16x16x32_bf16 a[96:99], v[12:15], v[160:163], a[96:99]
s_waitcnt lgkmcnt(0)
ds_read_b64_tr_b16 v[4:5], v184 offset:41728
v_cvt_pk_bf16_f32 v251, v190, v191
v_mfma_f32_16x16x32_bf16 a[96:99], v[0:3], v[208:211], a[96:99]
s_add_u32 s51, s49, 33920
ds_read_b64_tr_b16 v[6:7], v184 offset:43776
v_or_b32 v233, s54, v233
v_mfma_f32_16x16x32_bf16 a[104:107], v[12:15], v[164:167], a[104:107]
ds_read_b64_tr_b16 v[8:9], v184 offset:45824
v_accvgpr_read_b32 v188, a88
v_mfma_f32_16x16x32_bf16 a[104:107], v[0:3], v[212:215], a[104:107]
ds_read_b64_tr_b16 v[10:11], v184 offset:47872
v_accvgpr_read_b32 v189, a89
v_mfma_f32_16x16x32_bf16 a[112:115], v[12:15], v[168:171], a[112:115]
v_lshrrev_b32 v232, 4, v235
v_accvgpr_read_b32 v190, a90
v_mfma_f32_16x16x32_bf16 a[112:115], v[0:3], v[216:219], a[112:115]
s_waitcnt vmcnt(43)
s_barrier
v_add_u32 v16, 0xfffe8000, v16
v_mfma_f32_16x16x32_bf16 a[120:123], v[12:15], v[172:175], a[120:123]
s_add_u32 m0, s48, 131072
v_xor_b32 v232, v232, v233
v_accvgpr_read_b32 v191, a91
v_add_u32 v17, 0xfffe8000, v17
v_mfma_f32_16x16x32_bf16 a[120:123], v[0:3], v[220:223], a[120:123]
s_add_u32 s50, s49, 24832
ds_read_b128 v[140:143], v16 offset:0
v_lshlrev_b32 v232, 4, v232
v_mfma_f32_16x16x32_bf16 a[128:131], v[12:15], v[176:179], a[128:131]
ds_read_b128 v[136:139], v17 offset:0
v_mul_f32 v188, v188, v31
v_mfma_f32_16x16x32_bf16 a[128:131], v[0:3], v[224:227], a[128:131]
ds_read_b128 v[116:119], v16 offset:1024
s_waitcnt lgkmcnt(3)
s_barrier
v_and_b32 v233, 7, v235
v_mfma_f32_16x16x32_bf16 a[136:139], v[12:15], v[180:183], a[136:139]
ds_read_b128 v[112:115], v17 offset:1024
v_mul_f32 v189, v189, v31
v_lshl_add_u32 v232, v233, 7, v232
v_mfma_f32_16x16x32_bf16 a[136:139], v[0:3], v[228:231], a[136:139]
ds_read_b128 v[12:15], v16 offset:2048
buffer_store_dwordx4 v[204:207], v18, s[24:27], s51 offen sc1
v_bfe_u32 v233, v235, 3, 1
v_mfma_f32_16x16x32_bf16 a[100:103], v[4:7], v[160:163], a[100:103]
ds_read_b128 v[0:3], v17 offset:2048
v_cvt_pk_bf16_f32 v196, v188, v189
v_lshl_add_u32 v232, v233, 12, v232
v_mfma_f32_16x16x32_bf16 a[100:103], v[8:11], v[208:211], a[100:103]
buffer_load_dwordx4 v18, s[28:31], s50 offen nt lds
v_accvgpr_read_b32 v188, a92
v_add_u32 v232, s48, v232
v_mfma_f32_16x16x32_bf16 a[108:111], v[4:7], v[164:167], a[108:111]
v_accvgpr_read_b32 v189, a93
v_add_u32 v232, 49152, v232
v_mfma_f32_16x16x32_bf16 a[108:111], v[8:11], v[212:215], a[108:111]
s_add_u32 m0, s48, 135168
v_mul_f32 v190, v190, v31
v_xor_b32 v233, 64, v232
v_mfma_f32_16x16x32_bf16 a[116:119], v[4:7], v[168:171], a[116:119]
s_waitcnt vmcnt(21)
ds_read_b128 a[48:51], v232 offset:0
v_mul_f32 v191, v191, v31
v_cvt_pk_bf16_f32 v197, v190, v191
v_mfma_f32_16x16x32_bf16 a[116:119], v[8:11], v[216:219], a[116:119]
s_add_u32 s50, s49, 27904
ds_read_b128 a[56:59], v232 offset:8192
v_accvgpr_read_b32 v190, a94
v_mfma_f32_16x16x32_bf16 a[124:127], v[4:7], v[172:175], a[124:127]
ds_read_b128 a[52:55], v233 offset:0
v_accvgpr_read_b32 v191, a95
v_mfma_f32_16x16x32_bf16 a[124:127], v[8:11], v[220:223], a[124:127]
ds_read_b128 v[92:95], v16 offset:6144
v_mul_f32 v188, v188, v31
v_mfma_f32_16x16x32_bf16 a[132:135], v[4:7], v[176:179], a[132:135]
ds_read_b128 v[88:91], v17 offset:6144
v_mul_f32 v189, v189, v31
v_mfma_f32_16x16x32_bf16 a[132:135], v[8:11], v[224:227], a[132:135]
ds_read_b128 a[60:63], v233 offset:8192
v_cvt_pk_bf16_f32 v198, v188, v189
v_mul_f32 v190, v190, v31
v_mfma_f32_16x16x32_bf16 a[140:143], v[4:7], v[180:183], a[140:143]
ds_read_b128 v[4:7], v16 offset:7168
v_mul_f32 v191, v191, v31
v_mfma_f32_16x16x32_bf16 a[140:143], v[8:11], v[228:231], a[140:143]
s_waitcnt lgkmcnt(12)
ds_read_b128 v[8:11], v17 offset:7168
v_cvt_pk_bf16_f32 v199, v190, v191
v_mfma_f32_16x16x32_bf16 v[32:35], v[140:143], a[0:3], 0
s_waitcnt lgkmcnt(12)
ds_read_b128 a[64:67], v232 offset:16384
buffer_load_dwordx4 v18, s[28:31], s50 offen nt lds
v_mfma_f32_16x16x32_bf16 v[32:35], v[136:139], a[4:7], v[32:35]
s_waitcnt lgkmcnt(12)
ds_read_b128 a[72:75], v232 offset:24576
v_mfma_f32_16x16x32_bf16 v[32:35], v[116:119], a[16:19], v[32:35]
s_waitcnt lgkmcnt(12)
ds_read_b128 a[68:71], v233 offset:16384
v_mfma_f32_16x16x32_bf16 v[32:35], v[112:115], a[20:23], v[32:35]
s_waitcnt lgkmcnt(12)
v_mfma_f32_16x16x32_bf16 v[32:35], v[12:15], a[32:35], v[32:35]
s_waitcnt lgkmcnt(11)
ds_read_b128 v[152:155], v16 offset:8192
v_mfma_f32_16x16x32_bf16 v[32:35], v[0:3], a[36:39], v[32:35]
ds_read_b128 v[156:159], v17 offset:8192
v_accvgpr_read_b32 v188, a96
v_accvgpr_read_b32 v189, a97
v_accvgpr_read_b32 v190, a98
v_mfma_f32_16x16x32_bf16 v[40:43], v[140:143], a[8:11], 0
ds_read_b128 a[76:79], v233 offset:24576
v_accvgpr_read_b32 v191, a99
v_mul_f32 v188, v188, v26
v_mfma_f32_16x16x32_bf16 v[40:43], v[136:139], a[12:15], v[40:43]
ds_read_b128 v[140:143], v16 offset:12288
v_mul_f32 v189, v189, v26
v_cvt_pk_bf16_f32 v80, v188, v189
v_mfma_f32_16x16x32_bf16 v[40:43], v[116:119], a[24:27], v[40:43]
s_waitcnt lgkmcnt(14)
ds_read_b128 v[136:139], v17 offset:12288
v_accvgpr_read_b32 v188, a100
v_mfma_f32_16x16x32_bf16 v[40:43], v[112:115], a[28:31], v[40:43]
s_add_u32 m0, s48, 139264
s_waitcnt lgkmcnt(14)
ds_read_b128 v[116:119], v16 offset:13312
v_accvgpr_read_b32 v189, a101
v_mul_f32 v190, v190, v26
v_mfma_f32_16x16x32_bf16 v[40:43], v[12:15], a[40:43], v[40:43]
s_add_u32 s50, s49, 30976
s_waitcnt lgkmcnt(14)
ds_read_b128 v[112:115], v17 offset:13312
v_mul_f32 v191, v191, v26
v_cvt_pk_bf16_f32 v81, v190, v191
v_mfma_f32_16x16x32_bf16 v[40:43], v[0:3], a[44:47], v[40:43]
s_waitcnt lgkmcnt(14)
ds_read_b128 v[12:15], v16 offset:14336
v_accvgpr_read_b32 v190, a102
v_mfma_f32_16x16x32_bf16 v[36:39], v[92:95], a[0:3], 0
s_waitcnt lgkmcnt(14)
ds_read_b128 v[0:3], v17 offset:14336
v_accvgpr_read_b32 v191, a103
v_mul_f32 v188, v188, v26
v_mfma_f32_16x16x32_bf16 v[36:39], v[88:91], a[4:7], v[36:39]
s_waitcnt lgkmcnt(13)
ds_read_b128 a[80:83], v232 offset:32768
v_mul_f32 v189, v189, v26
v_cvt_pk_bf16_f32 v82, v188, v189
v_mfma_f32_16x16x32_bf16 v[36:39], v[4:7], a[16:19], v[36:39]
s_waitcnt lgkmcnt(13)
ds_read_b128 a[88:91], v232 offset:40960
v_mul_f32 v190, v190, v26
v_mfma_f32_16x16x32_bf16 v[36:39], v[8:11], a[20:23], v[36:39]
s_waitcnt lgkmcnt(10)
ds_read_b128 a[84:87], v233 offset:32768
ds_write_b64 v236, v[240:241]
v_mul_f32 v191, v191, v26
v_cvt_pk_bf16_f32 v83, v190, v191
v_mfma_f32_16x16x32_bf16 v[36:39], v[152:155], a[32:35], v[36:39]
s_waitcnt lgkmcnt(11)
ds_read_b128 a[92:95], v233 offset:40960
v_mfma_f32_16x16x32_bf16 v[36:39], v[156:159], a[36:39], v[36:39]
ds_write_b64 v238, v[80:81]
v_accvgpr_read_b32 v188, a120
v_mfma_f32_16x16x32_bf16 v[44:47], v[92:95], a[8:11], 0
ds_write_b64 v237, v[242:243]
buffer_load_dwordx4 v18, s[28:31], s50 offen nt lds
v_accvgpr_read_b32 v189, a121
v_accvgpr_read_b32 v190, a122
v_mfma_f32_16x16x32_bf16 v[44:47], v[88:91], a[12:15], v[44:47]
ds_read_b128 v[92:95], v16 offset:18432
v_accvgpr_read_b32 v191, a123
v_mul_f32 v188, v188, v29
v_mfma_f32_16x16x32_bf16 v[44:47], v[4:7], a[24:27], v[44:47]
s_waitcnt lgkmcnt(14)
ds_read_b128 v[88:91], v17 offset:18432
v_mul_f32 v189, v189, v29
v_cvt_pk_bf16_f32 v240, v188, v189
v_mfma_f32_16x16x32_bf16 v[44:47], v[8:11], a[28:31], v[44:47]
s_waitcnt lgkmcnt(14)
ds_read_b128 v[4:7], v16 offset:19456
v_accvgpr_read_b32 v188, a124
v_accvgpr_read_b32 v189, a125
v_mfma_f32_16x16x32_bf16 v[44:47], v[152:155], a[40:43], v[44:47]
s_waitcnt lgkmcnt(14)
ds_read_b128 v[8:11], v17 offset:19456
v_mul_f32 v190, v190, v29
v_mul_f32 v191, v191, v29
v_mfma_f32_16x16x32_bf16 v[44:47], v[156:159], a[44:47], v[44:47]
s_waitcnt lgkmcnt(14)
ds_read_b128 v[152:155], v16 offset:20480
s_waitcnt lgkmcnt(14)
ds_write_b64 v239, v[82:83]
v_cvt_pk_bf16_f32 v241, v190, v191
v_mfma_f32_16x16x32_bf16 v[48:51], v[140:143], a[0:3], 0
s_waitcnt lgkmcnt(14)
ds_read_b128 v[156:159], v17 offset:20480
s_waitcnt lgkmcnt(14)
ds_read_b128 v[200:203], v186 offset:0
s_waitcnt lgkmcnt(14)
ds_read_b128 v[204:207], v186 offset:1024
v_accvgpr_read_b32 v190, a126
v_mfma_f32_16x16x32_bf16 v[48:51], v[136:139], a[4:7], v[48:51]
v_accvgpr_read_b32 v191, a127
v_mul_f32 v188, v188, v29
v_mfma_f32_16x16x32_bf16 v[48:51], v[116:119], a[16:19], v[48:51]
v_mul_f32 v189, v189, v29
v_cvt_pk_bf16_f32 v242, v188, v189
v_mfma_f32_16x16x32_bf16 v[48:51], v[112:115], a[20:23], v[48:51]
s_add_u32 s51, s49, 256
s_waitcnt lgkmcnt(1)
buffer_store_dwordx4 v[200:203], v18, s[24:27], s51 offen sc1
v_mfma_f32_16x16x32_bf16 v[48:51], v[12:15], a[32:35], v[48:51]
v_max3_f32 v148, v32, v33, v34
v_max3_f32 v149, v40, v41, v42
v_max3_f32 v148, v148, v35, v36
v_mfma_f32_16x16x32_bf16 v[48:51], v[0:3], a[36:39], v[48:51]
s_barrier
v_mul_f32 v190, v190, v29
v_max3_f32 v149, v149, v43, v44
v_max3_f32 v148, v148, v37, v38
v_max3_f32 v149, v149, v45, v46
v_mfma_f32_16x16x32_bf16 v[56:59], v[140:143], a[8:11], 0
s_add_u32 s51, s49, 3328
v_max_f32 v148, v148, v39
v_mul_f32 v191, v191, v29
v_max_f32 v149, v149, v47
v_mov_b32 v20, v148
v_mov_b32 v21, v149
v_cvt_pk_bf16_f32 v243, v190, v191
v_mfma_f32_16x16x32_bf16 v[56:59], v[136:139], a[12:15], v[56:59]
s_add_u32 m0, s48, 143360
ds_read_b128 v[140:143], v16 offset:24576
v_permlane16_swap_b32 v148, v20
v_permlane16_swap_b32 v149, v21
v_accvgpr_read_b32 v188, a104
v_mfma_f32_16x16x32_bf16 v[56:59], v[116:119], a[24:27], v[56:59]
s_add_u32 s50, s49, 34048
ds_read_b128 v[136:139], v17 offset:24576
v_max_f32 v148, v148, v20
v_max_f32 v149, v149, v21
v_accvgpr_read_b32 v189, a105
v_mov_b32 v20, v148
v_mov_b32 v21, v149
v_mfma_f32_16x16x32_bf16 v[56:59], v[112:115], a[28:31], v[56:59]
ds_read_b128 v[116:119], v16 offset:25600
v_permlane32_swap_b32 v148, v20
v_accvgpr_read_b32 v190, a106
v_permlane32_swap_b32 v149, v21
v_mfma_f32_16x16x32_bf16 v[56:59], v[12:15], a[40:43], v[56:59]
ds_read_b128 v[112:115], v17 offset:25600
v_accvgpr_read_b32 v191, a107
v_max_f32 v148, v148, v20
v_max_f32 v149, v149, v21
v_mul_f32 v20, s45, v148
v_mfma_f32_16x16x32_bf16 v[56:59], v[0:3], a[44:47], v[56:59]
ds_read_b128 v[12:15], v16 offset:26624
v_mul_f32 v21, s45, v149
v_fma_f32 v32, v32, s44, v20
v_fma_f32 v33, v33, s44, v20
v_fma_f32 v34, v34, s44, v20
v_mfma_f32_16x16x32_bf16 v[52:55], v[92:95], a[0:3], 0
ds_read_b128 v[0:3], v17 offset:26624
buffer_load_dwordx4 v18, s[28:31], s50 offen nt lds
v_exp_f32 v32, v32
v_mul_f32 v188, v188, v27
v_fma_f32 v35, v35, s44, v20
v_exp_f32 v33, v33
v_mfma_f32_16x16x32_bf16 v[52:55], v[88:91], a[4:7], v[52:55]
s_waitcnt lgkmcnt(6)
buffer_store_dwordx4 v[204:207], v18, s[24:27], s51 offen sc1
v_mul_f32 v189, v189, v27
v_fma_f32 v36, v36, s44, v20
v_exp_f32 v34, v34
v_cvt_pk_bf16_f32 v80, v188, v189
v_mfma_f32_16x16x32_bf16 v[52:55], v[4:7], a[16:19], v[52:55]
ds_write_b64 v236, v[244:245] offset:2048
v_fma_f32 v37, v37, s44, v20
v_exp_f32 v35, v35
v_mfma_f32_16x16x32_bf16 v[52:55], v[8:11], a[20:23], v[52:55]
v_fma_f32 v38, v38, s44, v20
v_cvt_pk_bf16_f32 v32, v32, v33
v_exp_f32 v36, v36
v_accvgpr_read_b32 v188, a108
v_mfma_f32_16x16x32_bf16 v[52:55], v[152:155], a[32:35], v[52:55]
v_fma_f32 v39, v39, s44, v20
v_exp_f32 v37, v37
v_accvgpr_read_b32 v189, a109
v_fma_f32 v40, v40, s44, v21
v_mfma_f32_16x16x32_bf16 v[52:55], v[156:159], a[36:39], v[52:55]
v_cvt_pk_bf16_f32 v33, v34, v35
v_mul_f32 v190, v190, v27
v_accvgpr_write_b32 a144, v32
v_exp_f32 v38, v38
v_mfma_f32_16x16x32_bf16 v[60:63], v[92:95], a[8:11], 0
v_mul_f32 v191, v191, v27
v_fma_f32 v41, v41, s44, v21
v_exp_f32 v39, v39
v_cvt_pk_bf16_f32 v81, v190, v191
v_mfma_f32_16x16x32_bf16 v[60:63], v[88:91], a[12:15], v[60:63]
ds_read_b128 v[92:95], v16 offset:30720
v_fma_f32 v42, v42, s44, v21
v_cvt_pk_bf16_f32 v34, v36, v37
v_accvgpr_write_b32 a145, v33
v_exp_f32 v40, v40
v_mfma_f32_16x16x32_bf16 v[60:63], v[4:7], a[24:27], v[60:63]
ds_read_b128 v[88:91], v17 offset:30720
v_fma_f32 v43, v43, s44, v21
v_exp_f32 v41, v41
v_accvgpr_read_b32 v190, a110
v_mfma_f32_16x16x32_bf16 v[60:63], v[8:11], a[28:31], v[60:63]
ds_read_b128 v[4:7], v16 offset:31744
v_fma_f32 v44, v44, s44, v21
v_cvt_pk_bf16_f32 v35, v38, v39
v_accvgpr_read_b32 v191, a111
v_accvgpr_write_b32 a146, v34
v_mfma_f32_16x16x32_bf16 v[60:63], v[152:155], a[40:43], v[60:63]
ds_read_b128 v[8:11], v17 offset:31744
v_exp_f32 v42, v42
v_mul_f32 v188, v188, v27
v_fma_f32 v45, v45, s44, v21
v_exp_f32 v43, v43
v_mfma_f32_16x16x32_bf16 v[60:63], v[156:159], a[44:47], v[60:63]
s_waitcnt lgkmcnt(10)
ds_read_b128 v[152:155], v16 offset:32768
v_mul_f32 v189, v189, v27
v_fma_f32 v46, v46, s44, v21
v_cvt_pk_bf16_f32 v36, v40, v41
v_accvgpr_write_b32 a147, v35
v_cvt_pk_bf16_f32 v82, v188, v189
v_mfma_f32_16x16x32_bf16 v[64:67], v[140:143], a[0:3], 0
s_waitcnt lgkmcnt(10)
ds_read_b128 v[156:159], v17 offset:32768
v_exp_f32 v44, v44
v_fma_f32 v47, v47, s44, v21
v_exp_f32 v45, v45
v_mfma_f32_16x16x32_bf16 v[64:67], v[136:139], a[4:7], v[64:67]
s_waitcnt lgkmcnt(10)
ds_write_b64 v238, v[80:81] offset:2048
v_cvt_pk_bf16_f32 v37, v42, v43
v_accvgpr_write_b32 a148, v36
v_mul_f32 v190, v190, v27
v_mfma_f32_16x16x32_bf16 v[64:67], v[116:119], a[16:19], v[64:67]
s_waitcnt lgkmcnt(10)
ds_write_b64 v237, v[246:247] offset:2048
v_exp_f32 v46, v46
v_exp_f32 v47, v47
v_mul_f32 v191, v191, v27
v_mfma_f32_16x16x32_bf16 v[64:67], v[112:115], a[20:23], v[64:67]
s_waitcnt lgkmcnt(10)
v_cvt_pk_bf16_f32 v38, v44, v45
v_accvgpr_write_b32 a149, v37
v_cvt_pk_bf16_f32 v83, v190, v191
v_cvt_pk_bf16_f32 v39, v46, v47
v_accvgpr_write_b32 a150, v38
v_mfma_f32_16x16x32_bf16 v[64:67], v[12:15], a[32:35], v[64:67]
s_waitcnt lgkmcnt(9)
ds_write_b64 v239, v[82:83] offset:2048
v_accvgpr_write_b32 a151, v39
v_fma_f32 v48, v48, s44, v20
v_fma_f32 v49, v49, s44, v20
v_mfma_f32_16x16x32_bf16 v[64:67], v[0:3], a[36:39], v[64:67]
ds_read_b128 v[200:203], v186 offset:2048
v_fma_f32 v50, v50, s44, v20
v_exp_f32 v48, v48
v_mfma_f32_16x16x32_bf16 v[72:75], v[140:143], a[8:11], 0
ds_read_b128 v[204:207], v186 offset:3072
v_fma_f32 v51, v51, s44, v20
v_exp_f32 v49, v49
v_accvgpr_read_b32 v188, a128
v_mfma_f32_16x16x32_bf16 v[72:75], v[136:139], a[12:15], v[72:75]
ds_read_b128 v[140:143], v16 offset:36864
v_fma_f32 v52, v52, s44, v20
v_accvgpr_read_b32 v189, a129
v_exp_f32 v50, v50
v_mfma_f32_16x16x32_bf16 v[72:75], v[116:119], a[24:27], v[72:75]
ds_read_b128 v[136:139], v17 offset:36864
v_accvgpr_read_b32 v190, a130
v_fma_f32 v53, v53, s44, v20
v_exp_f32 v51, v51
v_mfma_f32_16x16x32_bf16 v[72:75], v[112:115], a[28:31], v[72:75]
ds_read_b128 v[116:119], v16 offset:37888
v_accvgpr_read_b32 v191, a131
v_fma_f32 v54, v54, s44, v20
v_mul_f32 v188, v188, v30
v_mfma_f32_16x16x32_bf16 v[72:75], v[12:15], a[40:43], v[72:75]
s_waitcnt lgkmcnt(14)
ds_read_b128 v[112:115], v17 offset:37888
v_cvt_pk_bf16_f32 v48, v48, v49
v_exp_f32 v52, v52
v_mul_f32 v189, v189, v30
v_mfma_f32_16x16x32_bf16 v[72:75], v[0:3], a[44:47], v[72:75]
s_waitcnt lgkmcnt(14)
ds_read_b128 v[12:15], v16 offset:38912
v_fma_f32 v55, v55, s44, v20
v_exp_f32 v53, v53
v_cvt_pk_bf16_f32 v244, v188, v189
v_mfma_f32_16x16x32_bf16 v[68:71], v[92:95], a[0:3], 0
s_waitcnt lgkmcnt(14)
ds_read_b128 v[0:3], v17 offset:38912
v_fma_f32 v56, v56, s44, v21
v_accvgpr_read_b32 v188, a132
v_cvt_pk_bf16_f32 v49, v50, v51
v_mfma_f32_16x16x32_bf16 v[68:71], v[88:91], a[4:7], v[68:71]
s_waitcnt lgkmcnt(14)
v_accvgpr_write_b32 a168, v48
v_accvgpr_read_b32 v189, a133
v_exp_f32 v54, v54
v_mfma_f32_16x16x32_bf16 v[68:71], v[4:7], a[16:19], v[68:71]
s_waitcnt lgkmcnt(13)
v_fma_f32 v57, v57, s44, v21
v_mul_f32 v190, v190, v30
v_exp_f32 v55, v55
v_mul_f32 v191, v191, v30
v_mfma_f32_16x16x32_bf16 v[68:71], v[8:11], a[20:23], v[68:71]
s_waitcnt lgkmcnt(12)
v_fma_f32 v58, v58, s44, v21
v_cvt_pk_bf16_f32 v50, v52, v53
v_cvt_pk_bf16_f32 v245, v190, v191
v_mfma_f32_16x16x32_bf16 v[68:71], v[152:155], a[32:35], v[68:71]
s_waitcnt lgkmcnt(11)
v_accvgpr_write_b32 a169, v49
v_exp_f32 v56, v56
v_mfma_f32_16x16x32_bf16 v[68:71], v[156:159], a[36:39], v[68:71]
s_add_u32 s51, s49, 6400
s_waitcnt lgkmcnt(7)
buffer_store_dwordx4 v[200:203], v18, s[24:27], s51 offen sc1
v_fma_f32 v59, v59, s44, v21
v_exp_f32 v57, v57
v_mfma_f32_16x16x32_bf16 v[76:79], v[92:95], a[8:11], 0
v_accvgpr_read_b32 v190, a134
v_fma_f32 v60, v60, s44, v21
v_cvt_pk_bf16_f32 v51, v54, v55
v_accvgpr_read_b32 v191, a135
v_mfma_f32_16x16x32_bf16 v[76:79], v[88:91], a[12:15], v[76:79]
ds_read_b128 v[92:95], v16 offset:43008
v_accvgpr_write_b32 a170, v50
v_exp_f32 v58, v58
v_mul_f32 v188, v188, v30
v_mfma_f32_16x16x32_bf16 v[76:79], v[4:7], a[24:27], v[76:79]
ds_read_b128 v[88:91], v17 offset:43008
v_fma_f32 v61, v61, s44, v21
v_mul_f32 v189, v189, v30
v_exp_f32 v59, v59
v_mfma_f32_16x16x32_bf16 v[76:79], v[8:11], a[28:31], v[76:79]
ds_read_b128 v[4:7], v16 offset:44032
v_cvt_pk_bf16_f32 v246, v188, v189
v_fma_f32 v62, v62, s44, v21
v_cvt_pk_bf16_f32 v52, v56, v57
v_mul_f32 v190, v190, v30
v_mfma_f32_16x16x32_bf16 v[76:79], v[152:155], a[40:43], v[76:79]
s_add_u32 s51, s49, 9472
ds_read_b128 v[8:11], v17 offset:44032
v_accvgpr_write_b32 a171, v51
v_exp_f32 v60, v60
v_mfma_f32_16x16x32_bf16 v[76:79], v[156:159], a[44:47], v[76:79]
s_waitcnt lgkmcnt(9)
ds_read_b128 v[152:155], v16 offset:45056
v_mul_f32 v191, v191, v30
v_fma_f32 v63, v63, s44, v21
v_exp_f32 v61, v61
v_cvt_pk_bf16_f32 v247, v190, v191
v_mfma_f32_16x16x32_bf16 v[96:99], v[140:143], a[0:3], 0
s_waitcnt lgkmcnt(9)
ds_read_b128 v[156:159], v17 offset:45056
v_cvt_pk_bf16_f32 v53, v58, v59
v_accvgpr_read_b32 v188, a112
v_accvgpr_write_b32 a172, v52
v_mfma_f32_16x16x32_bf16 v[96:99], v[136:139], a[4:7], v[96:99]
s_waitcnt lgkmcnt(9)
v_exp_f32 v62, v62
v_accvgpr_read_b32 v189, a113
v_exp_f32 v63, v63
v_mfma_f32_16x16x32_bf16 v[96:99], v[116:119], a[16:19], v[96:99]
s_waitcnt lgkmcnt(8)
v_accvgpr_read_b32 v190, a114
v_cvt_pk_bf16_f32 v54, v60, v61
v_accvgpr_read_b32 v191, a115
v_accvgpr_write_b32 a173, v53
v_mfma_f32_16x16x32_bf16 v[96:99], v[112:115], a[20:23], v[96:99]
s_waitcnt lgkmcnt(7)
buffer_store_dwordx4 v[204:207], v18, s[24:27], s51 offen sc1
v_cvt_pk_bf16_f32 v55, v62, v63
v_accvgpr_write_b32 a174, v54
v_mfma_f32_16x16x32_bf16 v[96:99], v[12:15], a[32:35], v[96:99]
s_waitcnt lgkmcnt(6)
v_accvgpr_write_b32 a175, v55
v_fma_f32 v64, v64, s44, v20
v_fma_f32 v65, v65, s44, v20
v_mfma_f32_16x16x32_bf16 v[96:99], v[0:3], a[36:39], v[96:99]
v_fma_f32 v66, v66, s44, v20
v_mul_f32 v188, v188, v28
v_exp_f32 v64, v64
v_mul_f32 v189, v189, v28
v_mfma_f32_16x16x32_bf16 v[104:107], v[140:143], a[8:11], 0
v_fma_f32 v67, v67, s44, v20
v_exp_f32 v65, v65
v_cvt_pk_bf16_f32 v80, v188, v189
v_mfma_f32_16x16x32_bf16 v[104:107], v[136:139], a[12:15], v[104:107]
ds_read_b128 v[140:143], v16 offset:0
v_fma_f32 v68, v68, s44, v20
v_exp_f32 v66, v66
v_mfma_f32_16x16x32_bf16 v[104:107], v[116:119], a[24:27], v[104:107]
ds_read_b128 v[136:139], v17 offset:0
v_fma_f32 v69, v69, s44, v20
v_accvgpr_read_b32 v188, a116
v_exp_f32 v67, v67
v_mfma_f32_16x16x32_bf16 v[104:107], v[112:115], a[28:31], v[104:107]
ds_read_b128 v[116:119], v16 offset:1024
v_accvgpr_read_b32 v189, a117
v_fma_f32 v70, v70, s44, v20
v_mfma_f32_16x16x32_bf16 v[104:107], v[12:15], a[40:43], v[104:107]
ds_read_b128 v[112:115], v17 offset:1024
v_cvt_pk_bf16_f32 v64, v64, v65
v_mul_f32 v190, v190, v28
v_exp_f32 v68, v68
v_mul_f32 v191, v191, v28
v_mfma_f32_16x16x32_bf16 v[104:107], v[0:3], a[44:47], v[104:107]
s_waitcnt lgkmcnt(9)
ds_read_b128 v[12:15], v16 offset:2048
v_fma_f32 v71, v71, s44, v20
v_exp_f32 v69, v69
v_cvt_pk_bf16_f32 v81, v190, v191
v_mfma_f32_16x16x32_bf16 v[100:103], v[92:95], a[0:3], 0
s_waitcnt lgkmcnt(9)
ds_read_b128 v[0:3], v17 offset:2048
v_fma_f32 v72, v72, s44, v21
v_cvt_pk_bf16_f32 v65, v66, v67
v_mfma_f32_16x16x32_bf16 v[100:103], v[88:91], a[4:7], v[100:103]
s_waitcnt lgkmcnt(9)
ds_write_b64 v236, v[248:249]
v_accvgpr_write_b32 a192, v64
v_exp_f32 v70, v70
v_accvgpr_read_b32 v190, a118
v_mfma_f32_16x16x32_bf16 v[100:103], v[4:7], a[16:19], v[100:103]
s_waitcnt lgkmcnt(9)
ds_write_b64 v238, v[80:81]
v_fma_f32 v73, v73, s44, v21
v_accvgpr_read_b32 v191, a119
v_exp_f32 v71, v71
v_mfma_f32_16x16x32_bf16 v[100:103], v[8:11], a[20:23], v[100:103]
s_waitcnt lgkmcnt(9)
v_mul_f32 v188, v188, v28
v_fma_f32 v74, v74, s44, v21
v_cvt_pk_bf16_f32 v66, v68, v69
v_mfma_f32_16x16x32_bf16 v[100:103], v[152:155], a[32:35], v[100:103]
s_waitcnt lgkmcnt(8)
v_mul_f32 v189, v189, v28
v_accvgpr_write_b32 a193, v65
v_exp_f32 v72, v72
v_cvt_pk_bf16_f32 v82, v188, v189
v_mfma_f32_16x16x32_bf16 v[100:103], v[156:159], a[36:39], v[100:103]
ds_write_b64 v237, v[250:251]
v_fma_f32 v75, v75, s44, v21
v_exp_f32 v73, v73
v_mfma_f32_16x16x32_bf16 v[108:111], v[92:95], a[8:11], 0
v_fma_f32 v76, v76, s44, v21
v_cvt_pk_bf16_f32 v67, v70, v71
v_mul_f32 v190, v190, v28
v_mfma_f32_16x16x32_bf16 v[108:111], v[88:91], a[12:15], v[108:111]
ds_read_b128 v[92:95], v16 offset:6144
v_accvgpr_write_b32 a194, v66
v_exp_f32 v74, v74
v_mul_f32 v191, v191, v28
v_mfma_f32_16x16x32_bf16 v[108:111], v[4:7], a[24:27], v[108:111]
ds_read_b128 v[88:91], v17 offset:6144
v_fma_f32 v77, v77, s44, v21
v_cvt_pk_bf16_f32 v83, v190, v191
v_exp_f32 v75, v75
v_mfma_f32_16x16x32_bf16 v[108:111], v[8:11], a[28:31], v[108:111]
ds_read_b128 v[4:7], v16 offset:7168
v_fma_f32 v78, v78, s44, v21
v_cvt_pk_bf16_f32 v68, v72, v73
v_mfma_f32_16x16x32_bf16 v[108:111], v[152:155], a[40:43], v[108:111]
ds_read_b128 v[8:11], v17 offset:7168
v_accvgpr_write_b32 a195, v67
v_exp_f32 v76, v76
v_mfma_f32_16x16x32_bf16 v[108:111], v[156:159], a[44:47], v[108:111]
s_waitcnt lgkmcnt(12)
ds_read_b128 v[152:155], v16 offset:8192
v_fma_f32 v79, v79, s44, v21
v_exp_f32 v77, v77
v_accvgpr_read_b32 v188, a136
v_mfma_f32_16x16x32_bf16 v[120:123], v[140:143], a[48:51], 0
s_waitcnt lgkmcnt(12)
ds_read_b128 v[156:159], v17 offset:8192
v_cvt_pk_bf16_f32 v69, v74, v75
v_accvgpr_read_b32 v189, a137
v_accvgpr_write_b32 a196, v68
v_mfma_f32_16x16x32_bf16 v[120:123], v[136:139], a[52:55], v[120:123]
s_waitcnt lgkmcnt(12)
ds_write_b64 v239, v[82:83]
v_exp_f32 v78, v78
v_accvgpr_read_b32 v190, a138
v_exp_f32 v79, v79
v_mfma_f32_16x16x32_bf16 v[120:123], v[116:119], a[64:67], v[120:123]
s_waitcnt lgkmcnt(12)
ds_read_b128 v[200:203], v186 offset:0
v_accvgpr_read_b32 v191, a139
v_cvt_pk_bf16_f32 v70, v76, v77
v_mul_f32 v188, v188, v31
v_accvgpr_write_b32 a197, v69
v_mfma_f32_16x16x32_bf16 v[120:123], v[112:115], a[68:71], v[120:123]
s_waitcnt lgkmcnt(12)
ds_read_b128 v[204:207], v186 offset:1024
v_cvt_pk_bf16_f32 v71, v78, v79
v_mul_f32 v189, v189, v31
v_accvgpr_write_b32 a198, v70
v_mfma_f32_16x16x32_bf16 v[120:123], v[12:15], a[80:83], v[120:123]
s_waitcnt lgkmcnt(12)
v_accvgpr_write_b32 a199, v71
v_fma_f32 v96, v96, s44, v20
v_cvt_pk_bf16_f32 v248, v188, v189
v_fma_f32 v97, v97, s44, v20
v_mfma_f32_16x16x32_bf16 v[120:123], v[0:3], a[84:87], v[120:123]
s_add_u32 s51, s49, 12544
v_fma_f32 v98, v98, s44, v20
v_accvgpr_read_b32 v188, a140
v_exp_f32 v96, v96
v_mfma_f32_16x16x32_bf16 v[128:131], v[140:143], a[56:59], 0
v_accvgpr_read_b32 v189, a141
v_fma_f32 v99, v99, s44, v20
v_exp_f32 v97, v97
v_mfma_f32_16x16x32_bf16 v[128:131], v[136:139], a[60:63], v[128:131]
ds_read_b128 v[140:143], v16 offset:12288
v_mul_f32 v190, v190, v31
v_fma_f32 v100, v100, s44, v20
v_exp_f32 v98, v98
v_mul_f32 v191, v191, v31
v_mfma_f32_16x16x32_bf16 v[128:131], v[116:119], a[72:75], v[128:131]
ds_read_b128 v[136:139], v17 offset:12288
v_fma_f32 v101, v101, s44, v20
v_cvt_pk_bf16_f32 v249, v190, v191
v_exp_f32 v99, v99
v_mfma_f32_16x16x32_bf16 v[128:131], v[112:115], a[76:79], v[128:131]
ds_read_b128 v[116:119], v16 offset:13312
v_fma_f32 v102, v102, s44, v20
v_mfma_f32_16x16x32_bf16 v[128:131], v[12:15], a[88:91], v[128:131]
s_waitcnt lgkmcnt(14)
ds_read_b128 v[112:115], v17 offset:13312
v_cvt_pk_bf16_f32 v96, v96, v97
v_exp_f32 v100, v100
v_accvgpr_read_b32 v190, a142
v_mfma_f32_16x16x32_bf16 v[128:131], v[0:3], a[92:95], v[128:131]
s_waitcnt lgkmcnt(12)
ds_read_b128 v[12:15], v16 offset:14336
v_fma_f32 v103, v103, s44, v20
v_exp_f32 v101, v101
v_accvgpr_read_b32 v191, a143
v_mfma_f32_16x16x32_bf16 v[124:127], v[92:95], a[48:51], 0
s_waitcnt lgkmcnt(12)
ds_read_b128 v[0:3], v17 offset:14336
v_fma_f32 v104, v104, s44, v21
v_mul_f32 v188, v188, v31
v_cvt_pk_bf16_f32 v97, v98, v99
v_mfma_f32_16x16x32_bf16 v[124:127], v[88:91], a[52:55], v[124:127]
s_waitcnt lgkmcnt(12)
s_waitcnt lgkmcnt(7)
buffer_store_dwordx4 v[200:203], v18, s[24:27], s51 offen sc1
v_accvgpr_write_b32 a216, v96
v_mul_f32 v189, v189, v31
v_exp_f32 v102, v102
v_cvt_pk_bf16_f32 v250, v188, v189
v_mfma_f32_16x16x32_bf16 v[124:127], v[4:7], a[64:67], v[124:127]
v_fma_f32 v105, v105, s44, v21
v_exp_f32 v103, v103
v_mul_f32 v190, v190, v31
v_mfma_f32_16x16x32_bf16 v[124:127], v[8:11], a[68:71], v[124:127]
v_fma_f32 v106, v106, s44, v21
v_cvt_pk_bf16_f32 v98, v100, v101
v_mul_f32 v191, v191, v31
v_mfma_f32_16x16x32_bf16 v[124:127], v[152:155], a[80:83], v[124:127]
v_accvgpr_write_b32 a217, v97
v_exp_f32 v104, v104
v_cvt_pk_bf16_f32 v251, v190, v191
v_mfma_f32_16x16x32_bf16 v[124:127], v[156:159], a[84:87], v[124:127]
s_add_u32 s51, s49, 15616
s_waitcnt lgkmcnt(6)
buffer_store_dwordx4 v[204:207], v18, s[24:27], s51 offen sc1
v_fma_f32 v107, v107, s44, v21
v_exp_f32 v105, v105
v_mfma_f32_16x16x32_bf16 v[132:135], v[92:95], a[56:59], 0
v_fma_f32 v108, v108, s44, v21
v_cvt_pk_bf16_f32 v99, v102, v103
v_mfma_f32_16x16x32_bf16 v[132:135], v[88:91], a[60:63], v[132:135]
ds_read_b128 v[92:95], v16 offset:18432
v_accvgpr_write_b32 a218, v98
v_exp_f32 v106, v106
v_mfma_f32_16x16x32_bf16 v[132:135], v[4:7], a[72:75], v[132:135]
ds_read_b128 v[88:91], v17 offset:18432
v_fma_f32 v109, v109, s44, v21
v_exp_f32 v107, v107
v_mfma_f32_16x16x32_bf16 v[132:135], v[8:11], a[76:79], v[132:135]
ds_read_b128 v[4:7], v16 offset:19456
v_fma_f32 v110, v110, s44, v21
v_cvt_pk_bf16_f32 v100, v104, v105
v_mfma_f32_16x16x32_bf16 v[132:135], v[152:155], a[88:91], v[132:135]
ds_read_b128 v[8:11], v17 offset:19456
v_accvgpr_write_b32 a219, v99
v_exp_f32 v108, v108
v_mfma_f32_16x16x32_bf16 v[132:135], v[156:159], a[92:95], v[132:135]
s_waitcnt lgkmcnt(9)
ds_read_b128 v[152:155], v16 offset:20480
v_fma_f32 v111, v111, s44, v21
v_exp_f32 v109, v109
v_mfma_f32_16x16x32_bf16 v[32:35], v[140:143], a[48:51], 0
s_waitcnt lgkmcnt(9)
ds_read_b128 v[156:159], v17 offset:20480
v_cvt_pk_bf16_f32 v101, v106, v107
v_accvgpr_write_b32 a220, v100
v_mfma_f32_16x16x32_bf16 v[32:35], v[136:139], a[52:55], v[32:35]
s_waitcnt lgkmcnt(9)
v_exp_f32 v110, v110
v_exp_f32 v111, v111
v_mfma_f32_16x16x32_bf16 v[32:35], v[116:119], a[64:67], v[32:35]
s_waitcnt lgkmcnt(8)
v_cvt_pk_bf16_f32 v102, v108, v109
v_accvgpr_write_b32 a221, v101
v_mfma_f32_16x16x32_bf16 v[32:35], v[112:115], a[68:71], v[32:35]
s_waitcnt lgkmcnt(7)
v_cvt_pk_bf16_f32 v103, v110, v111
v_accvgpr_write_b32 a222, v102
v_mfma_f32_16x16x32_bf16 v[32:35], v[12:15], a[80:83], v[32:35]
s_waitcnt lgkmcnt(6)
v_accvgpr_write_b32 a223, v103
v_max3_f32 v148, v120, v121, v122
v_max3_f32 v149, v128, v129, v130
v_max3_f32 v148, v148, v123, v124
v_mfma_f32_16x16x32_bf16 v[32:35], v[0:3], a[84:87], v[32:35]
s_add_u32 m0, s47, 49152
ds_write_b64 v236, v[252:253] offset:2048
v_max3_f32 v149, v149, v131, v132
v_max3_f32 v148, v148, v125, v126
v_max3_f32 v149, v149, v133, v134
v_mfma_f32_16x16x32_bf16 v[40:43], v[140:143], a[56:59], 0
s_add_u32 s50, s85, 12288
buffer_load_dwordx4 v18, s[32:35], s50 offen nt lds
v_max_f32 v148, v148, v127
v_max_f32 v149, v149, v135
v_mov_b32 v22, v148
v_mov_b32 v23, v149
v_mfma_f32_16x16x32_bf16 v[40:43], v[136:139], a[60:63], v[40:43]
ds_read_b128 v[140:143], v16 offset:24576
v_permlane16_swap_b32 v148, v22
v_permlane16_swap_b32 v149, v23
v_mfma_f32_16x16x32_bf16 v[40:43], v[116:119], a[72:75], v[40:43]
ds_read_b128 v[136:139], v17 offset:24576
v_max_f32 v148, v148, v22
v_max_f32 v149, v149, v23
v_mov_b32 v22, v148
v_mov_b32 v23, v149
v_mfma_f32_16x16x32_bf16 v[40:43], v[112:115], a[76:79], v[40:43]
ds_read_b128 v[116:119], v16 offset:25600
v_permlane32_swap_b32 v148, v22
v_permlane32_swap_b32 v149, v23
v_mfma_f32_16x16x32_bf16 v[40:43], v[12:15], a[88:91], v[40:43]
ds_read_b128 v[112:115], v17 offset:25600
v_max_f32 v148, v148, v22
v_max_f32 v149, v149, v23
v_mul_f32 v22, s45, v148
v_mfma_f32_16x16x32_bf16 v[40:43], v[0:3], a[92:95], v[40:43]
s_waitcnt lgkmcnt(10)
ds_read_b128 v[12:15], v16 offset:26624
v_mul_f32 v23, s45, v149
v_fma_f32 v120, v120, s44, v22
v_fma_f32 v121, v121, s44, v22
v_fma_f32 v122, v122, s44, v22
v_mfma_f32_16x16x32_bf16 v[36:39], v[92:95], a[48:51], 0
s_waitcnt lgkmcnt(10)
ds_read_b128 v[0:3], v17 offset:26624
v_exp_f32 v120, v120
v_fma_f32 v123, v123, s44, v22
v_exp_f32 v121, v121
v_mfma_f32_16x16x32_bf16 v[36:39], v[88:91], a[52:55], v[36:39]
s_waitcnt lgkmcnt(10)
ds_write_b64 v237, v[254:255] offset:2048
v_fma_f32 v124, v124, s44, v22
v_exp_f32 v122, v122
v_mfma_f32_16x16x32_bf16 v[36:39], v[4:7], a[64:67], v[36:39]
s_waitcnt lgkmcnt(10)
ds_write_b64 v238, v[240:241] offset:2048
v_fma_f32 v125, v125, s44, v22
v_exp_f32 v123, v123
v_mfma_f32_16x16x32_bf16 v[36:39], v[8:11], a[68:71], v[36:39]
s_waitcnt lgkmcnt(10)
ds_write_b64 v239, v[242:243] offset:2048
v_fma_f32 v126, v126, s44, v22
v_cvt_pk_bf16_f32 v120, v120, v121
v_exp_f32 v124, v124
v_mfma_f32_16x16x32_bf16 v[36:39], v[152:155], a[80:83], v[36:39]
s_waitcnt lgkmcnt(10)
v_fma_f32 v127, v127, s44, v22
v_exp_f32 v125, v125
v_fma_f32 v128, v128, s44, v23
v_mfma_f32_16x16x32_bf16 v[36:39], v[156:159], a[84:87], v[36:39]
s_add_u32 m0, s47, 50048
ds_read_b128 v[200:203], v186 offset:2048
v_cvt_pk_bf16_f32 v121, v122, v123
v_accvgpr_write_b32 a152, v120
v_exp_f32 v126, v126
v_mfma_f32_16x16x32_bf16 v[44:47], v[92:95], a[56:59], 0
buffer_load_dwordx4 v18, s[32:35], s50 offen offset:128 nt lds
v_fma_f32 v129, v129, s44, v23
v_exp_f32 v127, v127
v_mfma_f32_16x16x32_bf16 v[44:47], v[88:91], a[60:63], v[44:47]
ds_read_b128 v[92:95], v16 offset:30720
v_fma_f32 v130, v130, s44, v23
v_cvt_pk_bf16_f32 v122, v124, v125
v_accvgpr_write_b32 a153, v121
v_exp_f32 v128, v128
v_mfma_f32_16x16x32_bf16 v[44:47], v[4:7], a[72:75], v[44:47]
ds_read_b128 v[88:91], v17 offset:30720
v_fma_f32 v131, v131, s44, v23
v_exp_f32 v129, v129
v_mfma_f32_16x16x32_bf16 v[44:47], v[8:11], a[76:79], v[44:47]
ds_read_b128 v[4:7], v16 offset:31744
v_fma_f32 v132, v132, s44, v23
v_cvt_pk_bf16_f32 v123, v126, v127
v_accvgpr_write_b32 a154, v122
v_mfma_f32_16x16x32_bf16 v[44:47], v[152:155], a[88:91], v[44:47]
ds_read_b128 v[8:11], v17 offset:31744
v_exp_f32 v130, v130
v_fma_f32 v133, v133, s44, v23
v_exp_f32 v131, v131
v_mfma_f32_16x16x32_bf16 v[44:47], v[156:159], a[92:95], v[44:47]
s_waitcnt lgkmcnt(13)
ds_read_b128 v[152:155], v16 offset:32768
v_mbcnt_lo_u32_b32 v147, -1, 0
v_fma_f32 v134, v134, s44, v23
v_cvt_pk_bf16_f32 v124, v128, v129
v_accvgpr_write_b32 a155, v123
v_mfma_f32_16x16x32_bf16 v[48:51], v[140:143], a[48:51], 0
s_waitcnt lgkmcnt(13)
ds_read_b128 v[156:159], v17 offset:32768
v_mbcnt_hi_u32_b32 v147, -1, v147
v_exp_f32 v132, v132
v_fma_f32 v135, v135, s44, v23
v_exp_f32 v133, v133
v_mfma_f32_16x16x32_bf16 v[48:51], v[136:139], a[52:55], v[48:51]
s_waitcnt lgkmcnt(13)
ds_read_b128 v[204:207], v186 offset:3072
v_bfe_u32 v145, v147, 1, 2
v_cvt_pk_bf16_f32 v125, v130, v131
v_accvgpr_write_b32 a156, v124
v_mfma_f32_16x16x32_bf16 v[48:51], v[116:119], a[64:67], v[48:51]
s_waitcnt lgkmcnt(13)
v_or_b32 v145, s54, v145
v_exp_f32 v134, v134
v_exp_f32 v135, v135
v_mfma_f32_16x16x32_bf16 v[48:51], v[112:115], a[68:71], v[48:51]
s_waitcnt lgkmcnt(12)
v_lshrrev_b32 v144, 4, v147
v_cvt_pk_bf16_f32 v126, v132, v133
v_accvgpr_write_b32 a157, v125
v_cvt_pk_bf16_f32 v127, v134, v135
v_accvgpr_write_b32 a158, v126
v_mfma_f32_16x16x32_bf16 v[48:51], v[12:15], a[80:83], v[48:51]
s_waitcnt lgkmcnt(11)
s_add_u32 s51, s49, 18688
s_waitcnt lgkmcnt(7)
buffer_store_dwordx4 v[200:203], v18, s[24:27], s51 offen sc1
v_xor_b32 v144, v144, v145
v_accvgpr_write_b32 a159, v127
v_fma_f32 v32, v32, s44, v22
v_fma_f32 v33, v33, s44, v22
v_mfma_f32_16x16x32_bf16 v[48:51], v[0:3], a[84:87], v[48:51]
s_add_u32 s51, s49, 21760
s_waitcnt lgkmcnt(0)
buffer_store_dwordx4 v[204:207], v18, s[24:27], s51 offen sc1
v_lshlrev_b32 v144, 4, v144
v_fma_f32 v34, v34, s44, v22
v_exp_f32 v32, v32
v_mfma_f32_16x16x32_bf16 v[56:59], v[140:143], a[56:59], 0
s_add_u32 m0, s47, 50944
s_nop 0
buffer_load_dwordx4 v18, s[32:35], s50 offen offset:256 nt lds
v_and_b32 v145, 7, v147
v_fma_f32 v35, v35, s44, v22
v_exp_f32 v33, v33
v_mfma_f32_16x16x32_bf16 v[56:59], v[136:139], a[60:63], v[56:59]
ds_read_b128 v[140:143], v16 offset:36864
v_lshl_add_u32 v144, v145, 7, v144
v_fma_f32 v36, v36, s44, v22
v_exp_f32 v34, v34
v_mfma_f32_16x16x32_bf16 v[56:59], v[116:119], a[72:75], v[56:59]
ds_read_b128 v[136:139], v17 offset:36864
v_bfe_u32 v145, v147, 3, 1
v_fma_f32 v37, v37, s44, v22
v_exp_f32 v35, v35
v_mfma_f32_16x16x32_bf16 v[56:59], v[112:115], a[76:79], v[56:59]
ds_read_b128 v[116:119], v16 offset:37888
v_lshl_add_u32 v144, v145, 12, v144
v_fma_f32 v38, v38, s44, v22
v_mfma_f32_16x16x32_bf16 v[56:59], v[12:15], a[88:91], v[56:59]
ds_read_b128 v[112:115], v17 offset:37888
v_add_u32 v144, s48, v144
v_cvt_pk_bf16_f32 v32, v32, v33
v_exp_f32 v36, v36
v_mfma_f32_16x16x32_bf16 v[56:59], v[0:3], a[92:95], v[56:59]
ds_read_b128 v[12:15], v16 offset:38912
v_add_u32 v144, 98304, v144
v_fma_f32 v39, v39, s44, v22
v_exp_f32 v37, v37
v_mfma_f32_16x16x32_bf16 v[52:55], v[92:95], a[48:51], 0
ds_read_b128 v[0:3], v17 offset:38912
v_xor_b32 v145, 64, v144
v_fma_f32 v40, v40, s44, v23
v_cvt_pk_bf16_f32 v33, v34, v35
v_mfma_f32_16x16x32_bf16 v[52:55], v[88:91], a[52:55], v[52:55]
ds_write_b64 v236, v[192:193]
v_accvgpr_write_b32 a176, v32
v_exp_f32 v38, v38
v_mfma_f32_16x16x32_bf16 v[52:55], v[4:7], a[64:67], v[52:55]
ds_write_b64 v237, v[194:195]
v_fma_f32 v41, v41, s44, v23
v_exp_f32 v39, v39
v_mfma_f32_16x16x32_bf16 v[52:55], v[8:11], a[68:71], v[52:55]
ds_write_b64 v238, v[244:245]
v_fma_f32 v42, v42, s44, v23
v_cvt_pk_bf16_f32 v34, v36, v37
v_mfma_f32_16x16x32_bf16 v[52:55], v[152:155], a[80:83], v[52:55]
ds_write_b64 v239, v[246:247]
v_accvgpr_write_b32 a177, v33
v_exp_f32 v40, v40
v_mfma_f32_16x16x32_bf16 v[52:55], v[156:159], a[84:87], v[52:55]
s_waitcnt vmcnt(10)
ds_read_b128 a[96:99], v144 offset:0
v_fma_f32 v43, v43, s44, v23
v_exp_f32 v41, v41
v_mfma_f32_16x16x32_bf16 v[60:63], v[92:95], a[56:59], 0
s_add_u32 m0, s47, 61440
v_fma_f32 v44, v44, s44, v23
v_cvt_pk_bf16_f32 v35, v38, v39
v_mfma_f32_16x16x32_bf16 v[60:63], v[88:91], a[60:63], v[60:63]
s_add_u32 s50, s85, 24576
ds_read_b128 v[92:95], v16 offset:43008
v_accvgpr_write_b32 a178, v34
v_exp_f32 v42, v42
v_mfma_f32_16x16x32_bf16 v[60:63], v[4:7], a[72:75], v[60:63]
ds_read_b128 v[88:91], v17 offset:43008
v_fma_f32 v45, v45, s44, v23
v_exp_f32 v43, v43
v_mfma_f32_16x16x32_bf16 v[60:63], v[8:11], a[76:79], v[60:63]
ds_read_b128 v[4:7], v16 offset:44032
v_fma_f32 v46, v46, s44, v23
v_cvt_pk_bf16_f32 v36, v40, v41
v_mfma_f32_16x16x32_bf16 v[60:63], v[152:155], a[88:91], v[60:63]
ds_read_b128 v[8:11], v17 offset:44032
v_accvgpr_write_b32 a179, v35
v_exp_f32 v44, v44
v_mfma_f32_16x16x32_bf16 v[60:63], v[156:159], a[92:95], v[60:63]
s_waitcnt lgkmcnt(14)
ds_read_b128 v[152:155], v16 offset:45056
v_fma_f32 v47, v47, s44, v23
v_exp_f32 v45, v45
v_mfma_f32_16x16x32_bf16 v[64:67], v[140:143], a[48:51], 0
s_waitcnt lgkmcnt(14)
ds_read_b128 v[156:159], v17 offset:45056
v_cvt_pk_bf16_f32 v37, v42, v43
v_accvgpr_write_b32 a180, v36
v_mfma_f32_16x16x32_bf16 v[64:67], v[136:139], a[52:55], v[64:67]
s_waitcnt lgkmcnt(14)
ds_read_b128 a[104:107], v144 offset:8192
v_exp_f32 v46, v46
v_exp_f32 v47, v47
v_mfma_f32_16x16x32_bf16 v[64:67], v[116:119], a[64:67], v[64:67]
s_waitcnt lgkmcnt(14)
ds_read_b128 a[100:103], v145 offset:0
s_waitcnt lgkmcnt(14)
ds_read_b128 v[200:203], v186 offset:0
v_cvt_pk_bf16_f32 v38, v44, v45
v_accvgpr_write_b32 a181, v37
v_mfma_f32_16x16x32_bf16 v[64:67], v[112:115], a[68:71], v[64:67]
s_waitcnt lgkmcnt(14)
ds_read_b128 a[108:111], v145 offset:8192
buffer_load_dwordx4 v18, s[32:35], s50 offen nt lds
v_cvt_pk_bf16_f32 v39, v46, v47
v_accvgpr_write_b32 a182, v38
v_mfma_f32_16x16x32_bf16 v[64:67], v[12:15], a[80:83], v[64:67]
s_waitcnt lgkmcnt(14)
ds_read_b128 a[112:115], v144 offset:16384
v_accvgpr_write_b32 a183, v39
v_fma_f32 v48, v48, s44, v22
v_fma_f32 v49, v49, s44, v22
v_mfma_f32_16x16x32_bf16 v[64:67], v[0:3], a[84:87], v[64:67]
s_waitcnt lgkmcnt(14)
ds_read_b128 a[120:123], v144 offset:24576
s_waitcnt lgkmcnt(14)
ds_read_b128 v[204:207], v186 offset:1024
v_fma_f32 v50, v50, s44, v22
v_exp_f32 v48, v48
v_mfma_f32_16x16x32_bf16 v[72:75], v[140:143], a[56:59], 0
s_add_u32 s51, s49, 24832
s_waitcnt lgkmcnt(14)
ds_read_b128 a[116:119], v145 offset:16384
v_fma_f32 v51, v51, s44, v22
v_exp_f32 v49, v49
v_mfma_f32_16x16x32_bf16 v[72:75], v[136:139], a[60:63], v[72:75]
s_waitcnt lgkmcnt(14)
ds_read_b128 v[140:143], v16 offset:0
v_fma_f32 v52, v52, s44, v22
v_exp_f32 v50, v50
v_mfma_f32_16x16x32_bf16 v[72:75], v[116:119], a[72:75], v[72:75]
s_waitcnt lgkmcnt(14)
ds_read_b128 v[136:139], v17 offset:0
s_waitcnt lgkmcnt(7)
buffer_store_dwordx4 v[200:203], v18, s[24:27], s51 offen sc1
v_fma_f32 v53, v53, s44, v22
v_exp_f32 v51, v51
v_mfma_f32_16x16x32_bf16 v[72:75], v[112:115], a[76:79], v[72:75]
s_add_u32 s51, s49, 27904
ds_read_b128 v[116:119], v16 offset:1024
v_fma_f32 v54, v54, s44, v22
v_mfma_f32_16x16x32_bf16 v[72:75], v[12:15], a[88:91], v[72:75]
ds_read_b128 v[112:115], v17 offset:1024
v_cvt_pk_bf16_f32 v48, v48, v49
v_exp_f32 v52, v52
v_mfma_f32_16x16x32_bf16 v[72:75], v[0:3], a[92:95], v[72:75]
ds_read_b128 v[12:15], v16 offset:2048
v_fma_f32 v55, v55, s44, v22
v_exp_f32 v53, v53
v_mfma_f32_16x16x32_bf16 v[68:71], v[92:95], a[48:51], 0
ds_read_b128 v[0:3], v17 offset:2048
v_fma_f32 v56, v56, s44, v23
v_cvt_pk_bf16_f32 v49, v50, v51
v_mfma_f32_16x16x32_bf16 v[68:71], v[88:91], a[52:55], v[68:71]
ds_read_b128 a[124:127], v145 offset:24576
s_waitcnt lgkmcnt(8)
buffer_store_dwordx4 v[204:207], v18, s[24:27], s51 offen sc1
v_accvgpr_write_b32 a200, v48
v_exp_f32 v54, v54
v_mfma_f32_16x16x32_bf16 v[68:71], v[4:7], a[64:67], v[68:71]
ds_read_b128 a[128:131], v144 offset:32768
v_fma_f32 v57, v57, s44, v23
v_exp_f32 v55, v55
v_mfma_f32_16x16x32_bf16 v[68:71], v[8:11], a[68:71], v[68:71]
ds_read_b128 a[136:139], v144 offset:40960
v_fma_f32 v58, v58, s44, v23
v_cvt_pk_bf16_f32 v50, v52, v53
v_mfma_f32_16x16x32_bf16 v[68:71], v[152:155], a[80:83], v[68:71]
ds_read_b128 a[132:135], v145 offset:32768
v_accvgpr_write_b32 a201, v49
v_exp_f32 v56, v56
v_mfma_f32_16x16x32_bf16 v[68:71], v[156:159], a[84:87], v[68:71]
s_add_u32 m0, s47, 62336
ds_read_b128 a[140:143], v145 offset:40960
ds_write_b64 v236, v[196:197] offset:2048
v_fma_f32 v59, v59, s44, v23
v_exp_f32 v57, v57
v_mfma_f32_16x16x32_bf16 v[76:79], v[92:95], a[56:59], 0
ds_write_b64 v237, v[198:199] offset:2048
v_fma_f32 v60, v60, s44, v23
v_cvt_pk_bf16_f32 v51, v54, v55
v_mfma_f32_16x16x32_bf16 v[76:79], v[88:91], a[60:63], v[76:79]
ds_read_b128 v[92:95], v16 offset:6144
v_accvgpr_write_b32 a202, v50
v_exp_f32 v58, v58
v_mfma_f32_16x16x32_bf16 v[76:79], v[4:7], a[72:75], v[76:79]
s_waitcnt lgkmcnt(14)
ds_read_b128 v[88:91], v17 offset:6144
v_fma_f32 v61, v61, s44, v23
v_exp_f32 v59, v59
v_mfma_f32_16x16x32_bf16 v[76:79], v[8:11], a[76:79], v[76:79]
s_waitcnt lgkmcnt(14)
ds_read_b128 v[4:7], v16 offset:7168
buffer_load_dwordx4 v18, s[32:35], s50 offen offset:128 nt lds
v_fma_f32 v62, v62, s44, v23
v_cvt_pk_bf16_f32 v52, v56, v57
v_mfma_f32_16x16x32_bf16 v[76:79], v[152:155], a[88:91], v[76:79]
s_waitcnt lgkmcnt(14)
ds_read_b128 v[8:11], v17 offset:7168
v_accvgpr_write_b32 a203, v51
v_exp_f32 v60, v60
v_mfma_f32_16x16x32_bf16 v[76:79], v[156:159], a[92:95], v[76:79]
s_waitcnt lgkmcnt(14)
ds_read_b128 v[152:155], v16 offset:8192
s_waitcnt lgkmcnt(14)
ds_write_b64 v238, v[248:249] offset:2048
v_fma_f32 v63, v63, s44, v23
v_exp_f32 v61, v61
v_mfma_f32_16x16x32_bf16 v[96:99], v[140:143], a[96:99], 0
s_waitcnt lgkmcnt(14)
ds_read_b128 v[156:159], v17 offset:8192
v_cvt_pk_bf16_f32 v53, v58, v59
v_accvgpr_write_b32 a204, v52
v_mfma_f32_16x16x32_bf16 v[96:99], v[136:139], a[100:103], v[96:99]
s_waitcnt lgkmcnt(14)
ds_write_b64 v239, v[250:251] offset:2048
v_exp_f32 v62, v62
v_exp_f32 v63, v63
v_mfma_f32_16x16x32_bf16 v[96:99], v[116:119], a[112:115], v[96:99]
s_waitcnt lgkmcnt(14)
ds_read_b128 v[200:203], v186 offset:2048
v_cvt_pk_bf16_f32 v54, v60, v61
v_accvgpr_write_b32 a205, v53
v_mfma_f32_16x16x32_bf16 v[96:99], v[112:115], a[116:119], v[96:99]
s_waitcnt lgkmcnt(14)
ds_read_b128 v[204:207], v186 offset:3072
v_cvt_pk_bf16_f32 v55, v62, v63
v_accvgpr_write_b32 a206, v54
v_mfma_f32_16x16x32_bf16 v[96:99], v[12:15], a[128:131], v[96:99]
s_waitcnt lgkmcnt(13)
v_accvgpr_write_b32 a207, v55
v_fma_f32 v64, v64, s44, v22
v_fma_f32 v65, v65, s44, v22
v_mfma_f32_16x16x32_bf16 v[96:99], v[0:3], a[132:135], v[96:99]
s_add_u32 s51, s49, 30976
s_waitcnt lgkmcnt(1)
buffer_store_dwordx4 v[200:203], v18, s[24:27], s51 offen sc1
v_fma_f32 v66, v66, s44, v22
v_exp_f32 v64, v64
v_mfma_f32_16x16x32_bf16 v[104:107], v[140:143], a[104:107], 0
v_fma_f32 v67, v67, s44, v22
v_exp_f32 v65, v65
v_mfma_f32_16x16x32_bf16 v[104:107], v[136:139], a[108:111], v[104:107]
s_add_u32 s51, s49, 34048
ds_read_b128 v[140:143], v16 offset:12288
v_fma_f32 v68, v68, s44, v22
v_exp_f32 v66, v66
v_mfma_f32_16x16x32_bf16 v[104:107], v[116:119], a[120:123], v[104:107]
s_add_u32 m0, s47, 63232
ds_read_b128 v[136:139], v17 offset:12288
v_fma_f32 v69, v69, s44, v22
v_exp_f32 v67, v67
v_mfma_f32_16x16x32_bf16 v[104:107], v[112:115], a[124:127], v[104:107]
ds_read_b128 v[116:119], v16 offset:13312
v_fma_f32 v70, v70, s44, v22
v_mfma_f32_16x16x32_bf16 v[104:107], v[12:15], a[136:139], v[104:107]
ds_read_b128 v[112:115], v17 offset:13312
v_cvt_pk_bf16_f32 v64, v64, v65
v_exp_f32 v68, v68
v_mfma_f32_16x16x32_bf16 v[104:107], v[0:3], a[140:143], v[104:107]
ds_read_b128 v[12:15], v16 offset:14336
v_fma_f32 v71, v71, s44, v22
v_exp_f32 v69, v69
v_mfma_f32_16x16x32_bf16 v[100:103], v[92:95], a[96:99], 0
ds_read_b128 v[0:3], v17 offset:14336
v_fma_f32 v72, v72, s44, v23
v_cvt_pk_bf16_f32 v65, v66, v67
v_mfma_f32_16x16x32_bf16 v[100:103], v[88:91], a[100:103], v[100:103]
s_waitcnt lgkmcnt(6)
buffer_store_dwordx4 v[204:207], v18, s[24:27], s51 offen sc1
v_accvgpr_write_b32 a224, v64
v_exp_f32 v70, v70
v_mfma_f32_16x16x32_bf16 v[100:103], v[4:7], a[112:115], v[100:103]
buffer_load_dwordx4 v18, s[32:35], s50 offen offset:256 nt lds
v_fma_f32 v73, v73, s44, v23
v_exp_f32 v71, v71
v_mfma_f32_16x16x32_bf16 v[100:103], v[8:11], a[116:119], v[100:103]
v_fma_f32 v74, v74, s44, v23
v_cvt_pk_bf16_f32 v66, v68, v69
v_mfma_f32_16x16x32_bf16 v[100:103], v[152:155], a[128:131], v[100:103]
v_accvgpr_write_b32 a225, v65
v_exp_f32 v72, v72
v_mfma_f32_16x16x32_bf16 v[100:103], v[156:159], a[132:135], v[100:103]
v_fma_f32 v75, v75, s44, v23
v_exp_f32 v73, v73
v_mfma_f32_16x16x32_bf16 v[108:111], v[92:95], a[104:107], 0
v_fma_f32 v76, v76, s44, v23
v_cvt_pk_bf16_f32 v67, v70, v71
v_mfma_f32_16x16x32_bf16 v[108:111], v[88:91], a[108:111], v[108:111]
ds_read_b128 v[92:95], v16 offset:18432
v_accvgpr_write_b32 a226, v66
v_exp_f32 v74, v74
v_mfma_f32_16x16x32_bf16 v[108:111], v[4:7], a[120:123], v[108:111]
ds_read_b128 v[88:91], v17 offset:18432
v_fma_f32 v77, v77, s44, v23
v_exp_f32 v75, v75
v_mfma_f32_16x16x32_bf16 v[108:111], v[8:11], a[124:127], v[108:111]
ds_read_b128 v[4:7], v16 offset:19456
v_fma_f32 v78, v78, s44, v23
v_cvt_pk_bf16_f32 v68, v72, v73
v_mfma_f32_16x16x32_bf16 v[108:111], v[152:155], a[136:139], v[108:111]
ds_read_b128 v[8:11], v17 offset:19456
v_accvgpr_write_b32 a227, v67
v_exp_f32 v76, v76
v_mfma_f32_16x16x32_bf16 v[108:111], v[156:159], a[140:143], v[108:111]
s_waitcnt lgkmcnt(9)
ds_read_b128 v[152:155], v16 offset:20480
v_fma_f32 v79, v79, s44, v23
v_exp_f32 v77, v77
v_mfma_f32_16x16x32_bf16 v[120:123], v[140:143], a[96:99], 0
s_waitcnt lgkmcnt(9)
ds_read_b128 v[156:159], v17 offset:20480
v_cvt_pk_bf16_f32 v69, v74, v75
v_accvgpr_write_b32 a228, v68
v_mfma_f32_16x16x32_bf16 v[120:123], v[136:139], a[100:103], v[120:123]
s_waitcnt lgkmcnt(9)
v_exp_f32 v78, v78
v_exp_f32 v79, v79
v_mfma_f32_16x16x32_bf16 v[120:123], v[116:119], a[112:115], v[120:123]
s_waitcnt lgkmcnt(8)
v_cvt_pk_bf16_f32 v70, v76, v77
v_accvgpr_write_b32 a229, v69
v_mfma_f32_16x16x32_bf16 v[120:123], v[112:115], a[116:119], v[120:123]
s_waitcnt lgkmcnt(7)
v_cvt_pk_bf16_f32 v71, v78, v79
v_accvgpr_write_b32 a230, v70
v_mfma_f32_16x16x32_bf16 v[120:123], v[12:15], a[128:131], v[120:123]
s_waitcnt lgkmcnt(6)
v_accvgpr_write_b32 a231, v71
v_max3_f32 v148, v96, v97, v98
v_max3_f32 v149, v104, v105, v106
v_max3_f32 v148, v148, v99, v100
v_mfma_f32_16x16x32_bf16 v[120:123], v[0:3], a[132:135], v[120:123]
s_add_u32 m0, s47, 73728
v_max3_f32 v149, v149, v107, v108
v_max3_f32 v148, v148, v101, v102
v_max3_f32 v149, v149, v109, v110
v_mfma_f32_16x16x32_bf16 v[128:131], v[140:143], a[104:107], 0
s_add_u32 s50, s86, 0
buffer_load_dwordx4 v18, s[32:35], s50 offen nt lds
v_max_f32 v148, v148, v103
v_max_f32 v149, v149, v111
v_mov_b32 v24, v148
v_mov_b32 v25, v149
v_mfma_f32_16x16x32_bf16 v[128:131], v[136:139], a[108:111], v[128:131]
ds_read_b128 v[140:143], v16 offset:24576
v_permlane16_swap_b32 v148, v24
v_permlane16_swap_b32 v149, v25
v_mfma_f32_16x16x32_bf16 v[128:131], v[116:119], a[120:123], v[128:131]
ds_read_b128 v[136:139], v17 offset:24576
v_max_f32 v148, v148, v24
v_max_f32 v149, v149, v25
v_mov_b32 v24, v148
v_mov_b32 v25, v149
v_mfma_f32_16x16x32_bf16 v[128:131], v[112:115], a[124:127], v[128:131]
ds_read_b128 v[116:119], v16 offset:25600
v_permlane32_swap_b32 v148, v24
v_permlane32_swap_b32 v149, v25
v_mfma_f32_16x16x32_bf16 v[128:131], v[12:15], a[136:139], v[128:131]
ds_read_b128 v[112:115], v17 offset:25600
v_max_f32 v148, v148, v24
v_max_f32 v149, v149, v25
v_mul_f32 v24, s45, v148
v_mfma_f32_16x16x32_bf16 v[128:131], v[0:3], a[140:143], v[128:131]
s_waitcnt lgkmcnt(9)
ds_read_b128 v[12:15], v16 offset:26624
v_mul_f32 v25, s45, v149
v_fma_f32 v96, v96, s44, v24
v_fma_f32 v97, v97, s44, v24
v_fma_f32 v98, v98, s44, v24
v_mfma_f32_16x16x32_bf16 v[124:127], v[92:95], a[96:99], 0
s_waitcnt lgkmcnt(9)
ds_read_b128 v[0:3], v17 offset:26624
v_exp_f32 v96, v96
v_fma_f32 v99, v99, s44, v24
v_exp_f32 v97, v97
v_mfma_f32_16x16x32_bf16 v[124:127], v[88:91], a[100:103], v[124:127]
s_waitcnt lgkmcnt(9)
v_fma_f32 v100, v100, s44, v24
v_exp_f32 v98, v98
v_mfma_f32_16x16x32_bf16 v[124:127], v[4:7], a[112:115], v[124:127]
s_waitcnt lgkmcnt(8)
v_fma_f32 v101, v101, s44, v24
v_exp_f32 v99, v99
v_mfma_f32_16x16x32_bf16 v[124:127], v[8:11], a[116:119], v[124:127]
s_waitcnt lgkmcnt(7)
v_fma_f32 v102, v102, s44, v24
v_cvt_pk_bf16_f32 v96, v96, v97
v_exp_f32 v100, v100
v_mfma_f32_16x16x32_bf16 v[124:127], v[152:155], a[128:131], v[124:127]
s_waitcnt lgkmcnt(6)
v_fma_f32 v103, v103, s44, v24
v_exp_f32 v101, v101
v_fma_f32 v104, v104, s44, v25
v_mfma_f32_16x16x32_bf16 v[124:127], v[156:159], a[132:135], v[124:127]
v_cvt_pk_bf16_f32 v97, v98, v99
v_accvgpr_write_b32 a160, v96
v_exp_f32 v102, v102
v_mfma_f32_16x16x32_bf16 v[132:135], v[92:95], a[104:107], 0
v_fma_f32 v105, v105, s44, v25
v_exp_f32 v103, v103
v_mfma_f32_16x16x32_bf16 v[132:135], v[88:91], a[108:111], v[132:135]
s_add_u32 m0, s47, 74624
ds_read_b128 v[92:95], v16 offset:30720
v_fma_f32 v106, v106, s44, v25
v_cvt_pk_bf16_f32 v98, v100, v101
v_accvgpr_write_b32 a161, v97
v_exp_f32 v104, v104
v_mfma_f32_16x16x32_bf16 v[132:135], v[4:7], a[120:123], v[132:135]
ds_read_b128 v[88:91], v17 offset:30720
v_fma_f32 v107, v107, s44, v25
v_exp_f32 v105, v105
v_mfma_f32_16x16x32_bf16 v[132:135], v[8:11], a[124:127], v[132:135]
ds_read_b128 v[4:7], v16 offset:31744
v_fma_f32 v108, v108, s44, v25
v_cvt_pk_bf16_f32 v99, v102, v103
v_accvgpr_write_b32 a162, v98
v_mfma_f32_16x16x32_bf16 v[132:135], v[152:155], a[136:139], v[132:135]
ds_read_b128 v[8:11], v17 offset:31744
v_exp_f32 v106, v106
v_fma_f32 v109, v109, s44, v25
v_exp_f32 v107, v107
v_mfma_f32_16x16x32_bf16 v[132:135], v[156:159], a[140:143], v[132:135]
s_waitcnt lgkmcnt(9)
ds_read_b128 v[152:155], v16 offset:32768
v_fma_f32 v110, v110, s44, v25
v_cvt_pk_bf16_f32 v100, v104, v105
v_accvgpr_write_b32 a163, v99
v_mfma_f32_16x16x32_bf16 v[32:35], v[140:143], a[96:99], 0
s_waitcnt lgkmcnt(9)
ds_read_b128 v[156:159], v17 offset:32768
v_exp_f32 v108, v108
v_fma_f32 v111, v111, s44, v25
v_exp_f32 v109, v109
v_mfma_f32_16x16x32_bf16 v[32:35], v[136:139], a[100:103], v[32:35]
s_waitcnt lgkmcnt(9)
buffer_load_dwordx4 v18, s[32:35], s50 offen offset:128 nt lds
v_cvt_pk_bf16_f32 v101, v106, v107
v_accvgpr_write_b32 a164, v100
v_mfma_f32_16x16x32_bf16 v[32:35], v[116:119], a[112:115], v[32:35]
s_waitcnt lgkmcnt(8)
v_exp_f32 v110, v110
v_exp_f32 v111, v111
v_mfma_f32_16x16x32_bf16 v[32:35], v[112:115], a[116:119], v[32:35]
s_waitcnt lgkmcnt(7)
v_cvt_pk_bf16_f32 v102, v108, v109
v_accvgpr_write_b32 a165, v101
v_cvt_pk_bf16_f32 v103, v110, v111
v_accvgpr_write_b32 a166, v102
v_mfma_f32_16x16x32_bf16 v[32:35], v[12:15], a[128:131], v[32:35]
s_waitcnt lgkmcnt(6)
v_accvgpr_write_b32 a167, v103
v_fma_f32 v120, v120, s44, v24
v_fma_f32 v121, v121, s44, v24
v_mfma_f32_16x16x32_bf16 v[32:35], v[0:3], a[132:135], v[32:35]
v_fma_f32 v122, v122, s44, v24
v_exp_f32 v120, v120
v_mfma_f32_16x16x32_bf16 v[40:43], v[140:143], a[104:107], 0
v_fma_f32 v123, v123, s44, v24
v_exp_f32 v121, v121
v_mfma_f32_16x16x32_bf16 v[40:43], v[136:139], a[108:111], v[40:43]
ds_read_b128 v[140:143], v16 offset:36864
v_fma_f32 v124, v124, s44, v24
v_exp_f32 v122, v122
v_mfma_f32_16x16x32_bf16 v[40:43], v[116:119], a[120:123], v[40:43]
ds_read_b128 v[136:139], v17 offset:36864
v_fma_f32 v125, v125, s44, v24
v_exp_f32 v123, v123
v_mfma_f32_16x16x32_bf16 v[40:43], v[112:115], a[124:127], v[40:43]
ds_read_b128 v[116:119], v16 offset:37888
v_fma_f32 v126, v126, s44, v24
v_mfma_f32_16x16x32_bf16 v[40:43], v[12:15], a[136:139], v[40:43]
ds_read_b128 v[112:115], v17 offset:37888
v_cvt_pk_bf16_f32 v120, v120, v121
v_exp_f32 v124, v124
v_mfma_f32_16x16x32_bf16 v[40:43], v[0:3], a[140:143], v[40:43]
s_waitcnt lgkmcnt(9)
ds_read_b128 v[12:15], v16 offset:38912
v_fma_f32 v127, v127, s44, v24
v_exp_f32 v125, v125
v_mfma_f32_16x16x32_bf16 v[36:39], v[92:95], a[96:99], 0
s_waitcnt lgkmcnt(9)
ds_read_b128 v[0:3], v17 offset:38912
v_fma_f32 v128, v128, s44, v25
v_cvt_pk_bf16_f32 v121, v122, v123
v_mfma_f32_16x16x32_bf16 v[36:39], v[88:91], a[100:103], v[36:39]
s_waitcnt lgkmcnt(9)
v_accvgpr_write_b32 a184, v120
v_exp_f32 v126, v126
v_mfma_f32_16x16x32_bf16 v[36:39], v[4:7], a[112:115], v[36:39]
s_waitcnt lgkmcnt(8)
v_fma_f32 v129, v129, s44, v25
v_exp_f32 v127, v127
v_mfma_f32_16x16x32_bf16 v[36:39], v[8:11], a[116:119], v[36:39]
s_waitcnt lgkmcnt(7)
v_fma_f32 v130, v130, s44, v25
v_cvt_pk_bf16_f32 v122, v124, v125
v_mfma_f32_16x16x32_bf16 v[36:39], v[152:155], a[128:131], v[36:39]
s_waitcnt lgkmcnt(6)
v_accvgpr_write_b32 a185, v121
v_exp_f32 v128, v128
v_mfma_f32_16x16x32_bf16 v[36:39], v[156:159], a[132:135], v[36:39]
s_add_u32 m0, s47, 75520
s_nop 0
buffer_load_dwordx4 v18, s[32:35], s50 offen offset:256 nt lds
v_fma_f32 v131, v131, s44, v25
v_exp_f32 v129, v129
v_mfma_f32_16x16x32_bf16 v[44:47], v[92:95], a[104:107], 0
v_fma_f32 v132, v132, s44, v25
v_cvt_pk_bf16_f32 v123, v126, v127
v_mfma_f32_16x16x32_bf16 v[44:47], v[88:91], a[108:111], v[44:47]
ds_read_b128 v[92:95], v16 offset:43008
v_accvgpr_write_b32 a186, v122
v_exp_f32 v130, v130
v_mfma_f32_16x16x32_bf16 v[44:47], v[4:7], a[120:123], v[44:47]
ds_read_b128 v[88:91], v17 offset:43008
v_fma_f32 v133, v133, s44, v25
v_exp_f32 v131, v131
v_mfma_f32_16x16x32_bf16 v[44:47], v[8:11], a[124:127], v[44:47]
ds_read_b128 v[4:7], v16 offset:44032
v_fma_f32 v134, v134, s44, v25
v_cvt_pk_bf16_f32 v124, v128, v129
v_mfma_f32_16x16x32_bf16 v[44:47], v[152:155], a[136:139], v[44:47]
ds_read_b128 v[8:11], v17 offset:44032
v_accvgpr_write_b32 a187, v123
v_exp_f32 v132, v132
v_mfma_f32_16x16x32_bf16 v[44:47], v[156:159], a[140:143], v[44:47]
s_waitcnt lgkmcnt(9)
ds_read_b128 v[152:155], v16 offset:45056
v_fma_f32 v135, v135, s44, v25
v_exp_f32 v133, v133
v_mfma_f32_16x16x32_bf16 v[48:51], v[140:143], a[96:99], 0
s_waitcnt lgkmcnt(9)
ds_read_b128 v[156:159], v17 offset:45056
s_waitcnt vmcnt(10)
s_barrier
v_add_u32 v16, 0xc000, v16
v_cvt_pk_bf16_f32 v125, v130, v131
v_accvgpr_write_b32 a188, v124
v_mfma_f32_16x16x32_bf16 v[48:51], v[136:139], a[100:103], v[48:51]
s_waitcnt lgkmcnt(9)
v_exp_f32 v134, v134
v_exp_f32 v135, v135
v_mfma_f32_16x16x32_bf16 v[48:51], v[116:119], a[112:115], v[48:51]
s_waitcnt lgkmcnt(8)
ds_read_b128 v[28:31], v16 offset:0
v_cvt_pk_bf16_f32 v126, v132, v133
v_accvgpr_write_b32 a189, v125
v_mfma_f32_16x16x32_bf16 v[48:51], v[112:115], a[116:119], v[48:51]
s_waitcnt lgkmcnt(8)
v_cvt_pk_bf16_f32 v127, v134, v135
v_accvgpr_write_b32 a190, v126
v_mfma_f32_16x16x32_bf16 v[48:51], v[12:15], a[128:131], v[48:51]
s_waitcnt lgkmcnt(7)
v_accvgpr_write_b32 a191, v127
v_fma_f32 v32, v32, s44, v24
v_fma_f32 v33, v33, s44, v24
v_mfma_f32_16x16x32_bf16 v[48:51], v[0:3], a[132:135], v[48:51]
v_fma_f32 v34, v34, s44, v24
v_exp_f32 v32, v32
v_mfma_f32_16x16x32_bf16 v[56:59], v[140:143], a[104:107], 0
s_add_u32 m0, s47, 86016
v_fma_f32 v35, v35, s44, v24
v_exp_f32 v33, v33
v_mfma_f32_16x16x32_bf16 v[56:59], v[136:139], a[108:111], v[56:59]
s_add_u32 s50, s86, 12288
v_fma_f32 v36, v36, s44, v24
v_exp_f32 v34, v34
v_mfma_f32_16x16x32_bf16 v[56:59], v[116:119], a[120:123], v[56:59]
buffer_load_dwordx4 v18, s[32:35], s50 offen nt lds
v_add_u32 v17, 0xc000, v17
v_fma_f32 v37, v37, s44, v24
v_exp_f32 v35, v35
v_mfma_f32_16x16x32_bf16 v[56:59], v[112:115], a[124:127], v[56:59]
v_fma_f32 v38, v38, s44, v24
v_mfma_f32_16x16x32_bf16 v[56:59], v[12:15], a[136:139], v[56:59]
ds_read_b128 v[12:15], v17 offset:0
v_cvt_pk_bf16_f32 v32, v32, v33
v_exp_f32 v36, v36
v_mfma_f32_16x16x32_bf16 v[56:59], v[0:3], a[140:143], v[56:59]
s_waitcnt lgkmcnt(7)
v_fma_f32 v39, v39, s44, v24
v_exp_f32 v37, v37
v_mfma_f32_16x16x32_bf16 v[52:55], v[92:95], a[96:99], 0
s_waitcnt lgkmcnt(6)
ds_read_b128 v[0:3], v16 offset:1024
v_fma_f32 v40, v40, s44, v25
v_cvt_pk_bf16_f32 v33, v34, v35
v_mfma_f32_16x16x32_bf16 v[52:55], v[88:91], a[100:103], v[52:55]
s_waitcnt lgkmcnt(6)
v_accvgpr_write_b32 a208, v32
v_exp_f32 v38, v38
v_mfma_f32_16x16x32_bf16 v[52:55], v[4:7], a[112:115], v[52:55]
s_waitcnt lgkmcnt(5)
v_fma_f32 v41, v41, s44, v25
v_exp_f32 v39, v39
v_mfma_f32_16x16x32_bf16 v[52:55], v[8:11], a[116:119], v[52:55]
s_waitcnt lgkmcnt(4)
v_fma_f32 v42, v42, s44, v25
v_cvt_pk_bf16_f32 v34, v36, v37
v_mfma_f32_16x16x32_bf16 v[52:55], v[152:155], a[128:131], v[52:55]
s_waitcnt lgkmcnt(3)
v_accvgpr_write_b32 a209, v33
v_exp_f32 v40, v40
v_mfma_f32_16x16x32_bf16 v[52:55], v[156:159], a[132:135], v[52:55]
v_fma_f32 v43, v43, s44, v25
v_exp_f32 v41, v41
v_mfma_f32_16x16x32_bf16 v[60:63], v[92:95], a[104:107], 0
v_fma_f32 v44, v44, s44, v25
v_cvt_pk_bf16_f32 v35, v38, v39
v_mfma_f32_16x16x32_bf16 v[60:63], v[88:91], a[108:111], v[60:63]
v_accvgpr_write_b32 a210, v34
v_exp_f32 v42, v42
v_mfma_f32_16x16x32_bf16 v[60:63], v[4:7], a[120:123], v[60:63]
ds_read_b128 v[4:7], v17 offset:1024
v_fma_f32 v45, v45, s44, v25
v_exp_f32 v43, v43
v_mfma_f32_16x16x32_bf16 v[60:63], v[8:11], a[124:127], v[60:63]
v_fma_f32 v46, v46, s44, v25
v_cvt_pk_bf16_f32 v36, v40, v41
v_mfma_f32_16x16x32_bf16 v[60:63], v[152:155], a[136:139], v[60:63]
ds_read_b128 v[152:155], v16 offset:2048
v_accvgpr_write_b32 a211, v35
v_exp_f32 v44, v44
v_mfma_f32_16x16x32_bf16 v[60:63], v[156:159], a[140:143], v[60:63]
s_waitcnt lgkmcnt(4)
v_fma_f32 v47, v47, s44, v25
v_exp_f32 v45, v45
v_mfma_f32_16x16x32_bf16 v[160:163], v[28:31], a[0:3], 0
s_waitcnt lgkmcnt(3)
ds_read_b128 v[156:159], v17 offset:2048
v_cvt_pk_bf16_f32 v37, v42, v43
v_accvgpr_write_b32 a212, v36
v_mfma_f32_16x16x32_bf16 v[160:163], v[12:15], a[4:7], v[160:163]
s_waitcnt lgkmcnt(3)
v_exp_f32 v46, v46
v_exp_f32 v47, v47
v_mfma_f32_16x16x32_bf16 v[160:163], v[0:3], a[16:19], v[160:163]
s_waitcnt lgkmcnt(2)
v_cvt_pk_bf16_f32 v38, v44, v45
v_accvgpr_write_b32 a213, v37
v_mfma_f32_16x16x32_bf16 v[160:163], v[4:7], a[20:23], v[160:163]
s_waitcnt lgkmcnt(1)
v_cvt_pk_bf16_f32 v39, v46, v47
v_accvgpr_write_b32 a214, v38
v_mfma_f32_16x16x32_bf16 v[160:163], v[152:155], a[32:35], v[160:163]
s_waitcnt lgkmcnt(0)
v_accvgpr_write_b32 a215, v39
v_fma_f32 v48, v48, s44, v24
v_mfma_f32_16x16x32_bf16 v[160:163], v[156:159], a[36:39], v[160:163]
s_add_u32 m0, s47, 86912
s_nop 0
buffer_load_dwordx4 v18, s[32:35], s50 offen offset:128 nt lds
v_fma_f32 v49, v49, s44, v24
v_fma_f32 v50, v50, s44, v24
v_mfma_f32_16x16x32_bf16 v[168:171], v[28:31], a[8:11], 0
v_exp_f32 v48, v48
v_mfma_f32_16x16x32_bf16 v[168:171], v[12:15], a[12:15], v[168:171]
v_mfma_f32_16x16x32_bf16 v[168:171], v[0:3], a[24:27], v[168:171]
v_fma_f32 v51, v51, s44, v24
v_exp_f32 v49, v49
v_mfma_f32_16x16x32_bf16 v[168:171], v[4:7], a[28:31], v[168:171]
v_mfma_f32_16x16x32_bf16 v[168:171], v[152:155], a[40:43], v[168:171]
v_fma_f32 v52, v52, s44, v24
v_mfma_f32_16x16x32_bf16 v[168:171], v[156:159], a[44:47], v[168:171]
ds_read_b128 v[8:11], v16 offset:6144
v_exp_f32 v50, v50
v_mfma_f32_16x16x32_bf16 v[176:179], v[28:31], a[48:51], 0
v_fma_f32 v53, v53, s44, v24
v_mfma_f32_16x16x32_bf16 v[176:179], v[12:15], a[52:55], v[176:179]
v_exp_f32 v51, v51
v_mfma_f32_16x16x32_bf16 v[176:179], v[0:3], a[64:67], v[176:179]
v_fma_f32 v54, v54, s44, v24
v_mfma_f32_16x16x32_bf16 v[176:179], v[4:7], a[68:71], v[176:179]
v_cvt_pk_bf16_f32 v48, v48, v49
v_mfma_f32_16x16x32_bf16 v[176:179], v[152:155], a[80:83], v[176:179]
v_exp_f32 v52, v52
v_mfma_f32_16x16x32_bf16 v[176:179], v[156:159], a[84:87], v[176:179]
v_fma_f32 v55, v55, s44, v24
v_mfma_f32_16x16x32_bf16 v[184:187], v[28:31], a[56:59], 0
v_exp_f32 v53, v53
v_mfma_f32_16x16x32_bf16 v[184:187], v[12:15], a[60:63], v[184:187]
s_add_u32 m0, s47, 87808
v_mfma_f32_16x16x32_bf16 v[184:187], v[0:3], a[72:75], v[184:187]
ds_read_b128 v[112:115], v17 offset:6144
v_fma_f32 v56, v56, s44, v25
v_cvt_pk_bf16_f32 v49, v50, v51
v_mfma_f32_16x16x32_bf16 v[184:187], v[4:7], a[76:79], v[184:187]
buffer_load_dwordx4 v18, s[32:35], s50 offen offset:256 nt lds
v_accvgpr_write_b32 a232, v48
v_mfma_f32_16x16x32_bf16 v[184:187], v[152:155], a[88:91], v[184:187]
ds_read_b128 v[116:119], v16 offset:7168
v_exp_f32 v54, v54
v_mfma_f32_16x16x32_bf16 v[184:187], v[156:159], a[92:95], v[184:187]
v_mbcnt_lo_u32_b32 v150, -1, 0
v_mbcnt_hi_u32_b32 v150, -1, v150
s_lshl_b32 s52, s3, 13
s_add_u32 s52, s52, 65536
v_lshl_add_u32 v150, v150, 7, s52
v_min_u32 v150, L_end-standalone__gqa_softmax__near_ridge_kernel, v150
v_mov_b32 v151, 0
s_lshl_b32 m0, s3, 12
s_add_u32 m0, m0, 147456
v_lshl_add_u64 v[150:151], v[150:151], 0, s[60:61]
global_load_lds_dword v[150:151], off
v_fma_f32 v57, v57, s44, v25
v_mfma_f32_16x16x32_bf16 v[192:195], v[28:31], a[96:99], 0
ds_read_b128 v[136:139], v17 offset:7168
v_exp_f32 v55, v55
v_mfma_f32_16x16x32_bf16 v[192:195], v[12:15], a[100:103], v[192:195]
v_fma_f32 v58, v58, s44, v25
v_mfma_f32_16x16x32_bf16 v[192:195], v[0:3], a[112:115], v[192:195]
ds_read_b128 v[140:143], v16 offset:8192
v_cvt_pk_bf16_f32 v50, v52, v53
v_mfma_f32_16x16x32_bf16 v[192:195], v[4:7], a[116:119], v[192:195]
v_accvgpr_write_b32 a233, v49
v_mfma_f32_16x16x32_bf16 v[192:195], v[152:155], a[128:131], v[192:195]
v_exp_f32 v56, v56
v_mfma_f32_16x16x32_bf16 v[192:195], v[156:159], a[132:135], v[192:195]
v_fma_f32 v59, v59, s44, v25
v_mfma_f32_16x16x32_bf16 v[200:203], v[28:31], a[104:107], 0
ds_read_b128 v[28:31], v17 offset:8192
v_exp_f32 v57, v57
v_mfma_f32_16x16x32_bf16 v[200:203], v[12:15], a[108:111], v[200:203]
v_fma_f32 v60, v60, s44, v25
v_mfma_f32_16x16x32_bf16 v[200:203], v[0:3], a[120:123], v[200:203]
v_cvt_pk_bf16_f32 v51, v54, v55
v_mfma_f32_16x16x32_bf16 v[200:203], v[4:7], a[124:127], v[200:203]
v_accvgpr_write_b32 a234, v50
v_mfma_f32_16x16x32_bf16 v[200:203], v[152:155], a[136:139], v[200:203]
v_exp_f32 v58, v58
v_mfma_f32_16x16x32_bf16 v[200:203], v[156:159], a[140:143], v[200:203]
s_waitcnt lgkmcnt(5)
v_fma_f32 v61, v61, s44, v25
v_mfma_f32_16x16x32_bf16 v[164:167], v[8:11], a[0:3], 0
s_waitcnt lgkmcnt(4)
v_exp_f32 v59, v59
v_mfma_f32_16x16x32_bf16 v[164:167], v[112:115], a[4:7], v[164:167]
s_waitcnt lgkmcnt(3)
v_fma_f32 v62, v62, s44, v25
v_mfma_f32_16x16x32_bf16 v[164:167], v[116:119], a[16:19], v[164:167]
s_waitcnt lgkmcnt(2)
v_cvt_pk_bf16_f32 v52, v56, v57
v_mfma_f32_16x16x32_bf16 v[164:167], v[136:139], a[20:23], v[164:167]
s_waitcnt lgkmcnt(1)
v_accvgpr_write_b32 a235, v51
v_mfma_f32_16x16x32_bf16 v[164:167], v[140:143], a[32:35], v[164:167]
s_waitcnt lgkmcnt(0)
v_exp_f32 v60, v60
v_mfma_f32_16x16x32_bf16 v[164:167], v[28:31], a[36:39], v[164:167]
s_add_u32 m0, s47, 98304
v_fma_f32 v63, v63, s44, v25
v_mfma_f32_16x16x32_bf16 v[172:175], v[8:11], a[8:11], 0
s_add_u32 s50, s86, 24576
buffer_load_dwordx4 v18, s[32:35], s50 offen nt lds
v_exp_f32 v61, v61
v_mfma_f32_16x16x32_bf16 v[172:175], v[112:115], a[12:15], v[172:175]
v_cvt_pk_bf16_f32 v53, v58, v59
v_mfma_f32_16x16x32_bf16 v[172:175], v[116:119], a[24:27], v[172:175]
v_accvgpr_write_b32 a236, v52
v_mfma_f32_16x16x32_bf16 v[172:175], v[136:139], a[28:31], v[172:175]
s_waitcnt vmcnt(8)
s_barrier
v_exp_f32 v62, v62
v_mfma_f32_16x16x32_bf16 v[172:175], v[140:143], a[40:43], v[172:175]
v_exp_f32 v63, v63
v_mfma_f32_16x16x32_bf16 v[172:175], v[28:31], a[44:47], v[172:175]
ds_read_b128 v[156:159], v16 offset:12288
v_mfma_f32_16x16x32_bf16 v[180:183], v[8:11], a[48:51], 0
v_cvt_pk_bf16_f32 v54, v60, v61
v_mfma_f32_16x16x32_bf16 v[180:183], v[112:115], a[52:55], v[180:183]
ds_read_b128 v[152:155], v17 offset:12288
v_accvgpr_write_b32 a237, v53
v_cvt_pk_bf16_f32 v55, v62, v63
v_mfma_f32_16x16x32_bf16 v[180:183], v[116:119], a[64:67], v[180:183]
v_accvgpr_write_b32 a238, v54
v_mfma_f32_16x16x32_bf16 v[180:183], v[136:139], a[68:71], v[180:183]
ds_read_b128 v[4:7], v16 offset:13312
v_accvgpr_write_b32 a239, v55
v_mfma_f32_16x16x32_bf16 v[180:183], v[140:143], a[80:83], v[180:183]
v_mfma_f32_16x16x32_bf16 v[180:183], v[28:31], a[84:87], v[180:183]
ds_read_b128 v[0:3], v17 offset:13312
v_mfma_f32_16x16x32_bf16 v[188:191], v[8:11], a[56:59], 0
v_mfma_f32_16x16x32_bf16 v[188:191], v[112:115], a[60:63], v[188:191]
s_add_u32 m0, s47, 99200
ds_read_b128 v[12:15], v16 offset:14336
v_mfma_f32_16x16x32_bf16 v[188:191], v[116:119], a[72:75], v[188:191]
buffer_load_dwordx4 v18, s[32:35], s50 offen offset:128 nt lds
v_mfma_f32_16x16x32_bf16 v[188:191], v[136:139], a[76:79], v[188:191]
ds_read_b128 v[120:123], v17 offset:14336
v_mfma_f32_16x16x32_bf16 v[188:191], v[140:143], a[88:91], v[188:191]
v_mfma_f32_16x16x32_bf16 v[188:191], v[28:31], a[92:95], v[188:191]
v_mfma_f32_16x16x32_bf16 v[196:199], v[8:11], a[96:99], 0
v_mfma_f32_16x16x32_bf16 v[196:199], v[112:115], a[100:103], v[196:199]
v_mfma_f32_16x16x32_bf16 v[196:199], v[116:119], a[112:115], v[196:199]
v_mfma_f32_16x16x32_bf16 v[196:199], v[136:139], a[116:119], v[196:199]
v_mfma_f32_16x16x32_bf16 v[196:199], v[140:143], a[128:131], v[196:199]
v_mfma_f32_16x16x32_bf16 v[196:199], v[28:31], a[132:135], v[196:199]
v_mfma_f32_16x16x32_bf16 v[204:207], v[8:11], a[104:107], 0
v_mfma_f32_16x16x32_bf16 v[204:207], v[112:115], a[108:111], v[204:207]
v_mfma_f32_16x16x32_bf16 v[204:207], v[116:119], a[120:123], v[204:207]
v_mfma_f32_16x16x32_bf16 v[204:207], v[136:139], a[124:127], v[204:207]
v_mfma_f32_16x16x32_bf16 v[204:207], v[140:143], a[136:139], v[204:207]
v_mfma_f32_16x16x32_bf16 v[204:207], v[28:31], a[140:143], v[204:207]
s_waitcnt lgkmcnt(5)
v_mfma_f32_16x16x32_bf16 v[208:211], v[156:159], a[0:3], 0
s_waitcnt lgkmcnt(4)
v_mfma_f32_16x16x32_bf16 v[208:211], v[152:155], a[4:7], v[208:211]
s_waitcnt lgkmcnt(3)
v_mfma_f32_16x16x32_bf16 v[208:211], v[4:7], a[16:19], v[208:211]
s_waitcnt lgkmcnt(2)
v_fma_f32 v160, v160, s44, v20
v_fma_f32 v161, v161, s44, v20
v_mfma_f32_16x16x32_bf16 v[208:211], v[0:3], a[20:23], v[208:211]
s_waitcnt lgkmcnt(1)
v_fma_f32 v162, v162, s44, v20
v_exp_f32 v160, v160
v_mfma_f32_16x16x32_bf16 v[208:211], v[12:15], a[32:35], v[208:211]
s_waitcnt lgkmcnt(0)
v_fma_f32 v163, v163, s44, v20
v_exp_f32 v161, v161
v_mfma_f32_16x16x32_bf16 v[208:211], v[120:123], a[36:39], v[208:211]
s_add_u32 m0, s47, 100096
s_nop 0
buffer_load_dwordx4 v18, s[32:35], s50 offen offset:256 nt lds
v_fma_f32 v164, v164, s44, v20
v_exp_f32 v162, v162
v_mfma_f32_16x16x32_bf16 v[216:219], v[156:159], a[8:11], 0
v_fma_f32 v165, v165, s44, v20
v_mfma_f32_16x16x32_bf16 v[216:219], v[152:155], a[12:15], v[216:219]
v_exp_f32 v163, v163
v_fma_f32 v166, v166, s44, v20
v_mfma_f32_16x16x32_bf16 v[216:219], v[4:7], a[24:27], v[216:219]
v_cvt_pk_bf16_f32 v160, v160, v161
v_exp_f32 v164, v164
v_mfma_f32_16x16x32_bf16 v[216:219], v[0:3], a[28:31], v[216:219]
v_fma_f32 v167, v167, s44, v20
v_exp_f32 v165, v165
v_mfma_f32_16x16x32_bf16 v[216:219], v[12:15], a[40:43], v[216:219]
v_fma_f32 v168, v168, s44, v21
v_mfma_f32_16x16x32_bf16 v[216:219], v[120:123], a[44:47], v[216:219]
ds_read_b128 v[28:31], v16 offset:18432
v_cvt_pk_bf16_f32 v161, v162, v163
v_accvgpr_write_b32 a240, v160
v_exp_f32 v166, v166
v_mfma_f32_16x16x32_bf16 v[224:227], v[156:159], a[48:51], 0
v_fma_f32 v169, v169, s44, v21
v_exp_f32 v167, v167
v_mfma_f32_16x16x32_bf16 v[224:227], v[152:155], a[52:55], v[224:227]
ds_read_b128 v[140:143], v17 offset:18432
v_fma_f32 v170, v170, s44, v21
v_mfma_f32_16x16x32_bf16 v[224:227], v[4:7], a[64:67], v[224:227]
v_cvt_pk_bf16_f32 v162, v164, v165
v_accvgpr_write_b32 a241, v161
v_exp_f32 v168, v168
v_mfma_f32_16x16x32_bf16 v[224:227], v[0:3], a[68:71], v[224:227]
ds_read_b128 v[136:139], v16 offset:19456
v_fma_f32 v171, v171, s44, v21
v_mfma_f32_16x16x32_bf16 v[224:227], v[12:15], a[80:83], v[224:227]
v_exp_f32 v169, v169
v_fma_f32 v172, v172, s44, v21
v_mfma_f32_16x16x32_bf16 v[224:227], v[120:123], a[84:87], v[224:227]
ds_read_b128 v[116:119], v17 offset:19456
v_cvt_pk_bf16_f32 v163, v166, v167
v_accvgpr_write_b32 a242, v162
v_mfma_f32_16x16x32_bf16 v[232:235], v[156:159], a[56:59], 0
s_add_u32 m0, s47, 110592
v_exp_f32 v170, v170
v_fma_f32 v173, v173, s44, v21
v_mfma_f32_16x16x32_bf16 v[232:235], v[152:155], a[60:63], v[232:235]
s_add_u32 s50, s87, 0
ds_read_b128 v[112:115], v16 offset:20480
v_exp_f32 v171, v171
v_mfma_f32_16x16x32_bf16 v[232:235], v[4:7], a[72:75], v[232:235]
buffer_load_dwordx4 v18, s[32:35], s50 offen nt lds
v_fma_f32 v174, v174, s44, v21
v_cvt_pk_bf16_f32 v164, v168, v169
v_accvgpr_write_b32 a243, v163
v_mfma_f32_16x16x32_bf16 v[232:235], v[0:3], a[76:79], v[232:235]
ds_read_b128 v[8:11], v17 offset:20480
v_exp_f32 v172, v172
v_fma_f32 v175, v175, s44, v21
v_mfma_f32_16x16x32_bf16 v[232:235], v[12:15], a[88:91], v[232:235]
v_exp_f32 v173, v173
v_mfma_f32_16x16x32_bf16 v[232:235], v[120:123], a[92:95], v[232:235]
v_cvt_pk_bf16_f32 v165, v170, v171
v_accvgpr_write_b32 a244, v164
v_exp_f32 v174, v174
v_mfma_f32_16x16x32_bf16 v[240:243], v[156:159], a[96:99], 0
v_exp_f32 v175, v175
v_mfma_f32_16x16x32_bf16 v[240:243], v[152:155], a[100:103], v[240:243]
v_cvt_pk_bf16_f32 v166, v172, v173
v_accvgpr_write_b32 a245, v165
v_mfma_f32_16x16x32_bf16 v[240:243], v[4:7], a[112:115], v[240:243]
v_cvt_pk_bf16_f32 v167, v174, v175
v_accvgpr_write_b32 a246, v166
v_mfma_f32_16x16x32_bf16 v[240:243], v[0:3], a[116:119], v[240:243]
v_accvgpr_write_b32 a247, v167
v_fma_f32 v176, v176, s44, v22
v_fma_f32 v177, v177, s44, v22
v_mfma_f32_16x16x32_bf16 v[240:243], v[12:15], a[128:131], v[240:243]
v_fma_f32 v178, v178, s44, v22
v_exp_f32 v176, v176
v_mfma_f32_16x16x32_bf16 v[240:243], v[120:123], a[132:135], v[240:243]
v_fma_f32 v179, v179, s44, v22
v_exp_f32 v177, v177
v_mfma_f32_16x16x32_bf16 v[248:251], v[156:159], a[104:107], 0
v_fma_f32 v180, v180, s44, v22
v_exp_f32 v178, v178
v_mfma_f32_16x16x32_bf16 v[248:251], v[152:155], a[108:111], v[248:251]
v_fma_f32 v181, v181, s44, v22
v_mfma_f32_16x16x32_bf16 v[248:251], v[4:7], a[120:123], v[248:251]
v_exp_f32 v179, v179
v_fma_f32 v182, v182, s44, v22
v_mfma_f32_16x16x32_bf16 v[248:251], v[0:3], a[124:127], v[248:251]
v_cvt_pk_bf16_f32 v176, v176, v177
v_exp_f32 v180, v180
v_mfma_f32_16x16x32_bf16 v[248:251], v[12:15], a[136:139], v[248:251]
v_fma_f32 v183, v183, s44, v22
v_exp_f32 v181, v181
v_mfma_f32_16x16x32_bf16 v[248:251], v[120:123], a[140:143], v[248:251]
s_waitcnt lgkmcnt(5)
v_fma_f32 v184, v184, s44, v23
v_mfma_f32_16x16x32_bf16 v[212:215], v[28:31], a[0:3], 0
s_waitcnt lgkmcnt(4)
v_cvt_pk_bf16_f32 v177, v178, v179
v_accvgpr_write_b32 a248, v176
v_exp_f32 v182, v182
v_mfma_f32_16x16x32_bf16 v[212:215], v[140:143], a[4:7], v[212:215]
s_waitcnt lgkmcnt(3)
v_fma_f32 v185, v185, s44, v23
v_mfma_f32_16x16x32_bf16 v[212:215], v[136:139], a[16:19], v[212:215]
s_waitcnt lgkmcnt(2)
v_exp_f32 v183, v183
v_fma_f32 v186, v186, s44, v23
v_mfma_f32_16x16x32_bf16 v[212:215], v[116:119], a[20:23], v[212:215]
s_waitcnt lgkmcnt(1)
v_cvt_pk_bf16_f32 v178, v180, v181
v_accvgpr_write_b32 a249, v177
v_exp_f32 v184, v184
v_mfma_f32_16x16x32_bf16 v[212:215], v[112:115], a[32:35], v[212:215]
s_waitcnt lgkmcnt(0)
v_fma_f32 v187, v187, s44, v23
v_mfma_f32_16x16x32_bf16 v[212:215], v[8:11], a[36:39], v[212:215]
s_add_u32 m0, s47, 111488
s_nop 0
buffer_load_dwordx4 v18, s[32:35], s50 offen offset:128 nt lds
v_exp_f32 v185, v185
v_fma_f32 v188, v188, s44, v23
v_mfma_f32_16x16x32_bf16 v[220:223], v[28:31], a[8:11], 0
v_cvt_pk_bf16_f32 v179, v182, v183
v_accvgpr_write_b32 a250, v178
v_mfma_f32_16x16x32_bf16 v[220:223], v[140:143], a[12:15], v[220:223]
v_exp_f32 v186, v186
v_fma_f32 v189, v189, s44, v23
v_mfma_f32_16x16x32_bf16 v[220:223], v[136:139], a[24:27], v[220:223]
v_exp_f32 v187, v187
v_mfma_f32_16x16x32_bf16 v[220:223], v[116:119], a[28:31], v[220:223]
s_waitcnt vmcnt(9)
s_barrier
v_fma_f32 v190, v190, s44, v23
v_cvt_pk_bf16_f32 v180, v184, v185
v_accvgpr_write_b32 a251, v179
v_mfma_f32_16x16x32_bf16 v[220:223], v[112:115], a[40:43], v[220:223]
v_exp_f32 v188, v188
v_mfma_f32_16x16x32_bf16 v[220:223], v[8:11], a[44:47], v[220:223]
ds_read_b128 v[120:123], v16 offset:24576
v_fma_f32 v191, v191, s44, v23
v_exp_f32 v189, v189
v_mfma_f32_16x16x32_bf16 v[228:231], v[28:31], a[48:51], 0
v_cvt_pk_bf16_f32 v181, v186, v187
v_accvgpr_write_b32 a252, v180
v_exp_f32 v190, v190
v_mfma_f32_16x16x32_bf16 v[228:231], v[140:143], a[52:55], v[228:231]
ds_read_b128 v[12:15], v17 offset:24576
v_exp_f32 v191, v191
v_mfma_f32_16x16x32_bf16 v[228:231], v[136:139], a[64:67], v[228:231]
v_cvt_pk_bf16_f32 v182, v188, v189
v_accvgpr_write_b32 a253, v181
v_mfma_f32_16x16x32_bf16 v[228:231], v[116:119], a[68:71], v[228:231]
ds_read_b128 v[0:3], v16 offset:25600
v_cvt_pk_bf16_f32 v183, v190, v191
v_accvgpr_write_b32 a254, v182
v_mfma_f32_16x16x32_bf16 v[228:231], v[112:115], a[80:83], v[228:231]
v_accvgpr_write_b32 a255, v183
v_fma_f32 v192, v192, s44, v24
v_fma_f32 v193, v193, s44, v24
v_mfma_f32_16x16x32_bf16 v[228:231], v[8:11], a[84:87], v[228:231]
ds_read_b128 v[4:7], v17 offset:25600
v_fma_f32 v194, v194, s44, v24
v_exp_f32 v192, v192
v_mfma_f32_16x16x32_bf16 v[236:239], v[28:31], a[56:59], 0
v_fma_f32 v195, v195, s44, v24
v_exp_f32 v193, v193
v_mfma_f32_16x16x32_bf16 v[236:239], v[140:143], a[60:63], v[236:239]
s_add_u32 m0, s47, 112384
ds_read_b128 v[152:155], v16 offset:26624
v_fma_f32 v196, v196, s44, v24
v_mfma_f32_16x16x32_bf16 v[236:239], v[136:139], a[72:75], v[236:239]
buffer_load_dwordx4 v18, s[32:35], s50 offen offset:256 nt lds
v_exp_f32 v194, v194
v_fma_f32 v197, v197, s44, v24
v_mfma_f32_16x16x32_bf16 v[236:239], v[116:119], a[76:79], v[236:239]
ds_read_b128 v[156:159], v17 offset:26624
v_exp_f32 v195, v195
v_fma_f32 v198, v198, s44, v24
v_mfma_f32_16x16x32_bf16 v[236:239], v[112:115], a[88:91], v[236:239]
v_cvt_pk_bf16_f32 v32, v192, v193
v_exp_f32 v196, v196
v_mfma_f32_16x16x32_bf16 v[236:239], v[8:11], a[92:95], v[236:239]
v_fma_f32 v199, v199, s44, v24
v_exp_f32 v197, v197
v_mfma_f32_16x16x32_bf16 v[244:247], v[28:31], a[96:99], 0
v_fma_f32 v200, v200, s44, v25
v_mfma_f32_16x16x32_bf16 v[244:247], v[140:143], a[100:103], v[244:247]
v_cvt_pk_bf16_f32 v33, v194, v195
v_exp_f32 v198, v198
v_mfma_f32_16x16x32_bf16 v[244:247], v[136:139], a[112:115], v[244:247]
v_fma_f32 v201, v201, s44, v25
v_exp_f32 v199, v199
v_mfma_f32_16x16x32_bf16 v[244:247], v[116:119], a[116:119], v[244:247]
v_fma_f32 v202, v202, s44, v25
v_cvt_pk_bf16_f32 v34, v196, v197
v_mfma_f32_16x16x32_bf16 v[244:247], v[112:115], a[128:131], v[244:247]
v_exp_f32 v200, v200
v_mfma_f32_16x16x32_bf16 v[244:247], v[8:11], a[132:135], v[244:247]
v_fma_f32 v203, v203, s44, v25
v_exp_f32 v201, v201
v_mfma_f32_16x16x32_bf16 v[252:255], v[28:31], a[104:107], 0
v_fma_f32 v204, v204, s44, v25
v_cvt_pk_bf16_f32 v35, v198, v199
v_exp_f32 v202, v202
v_mfma_f32_16x16x32_bf16 v[252:255], v[140:143], a[108:111], v[252:255]
v_fma_f32 v205, v205, s44, v25
v_mfma_f32_16x16x32_bf16 v[252:255], v[136:139], a[120:123], v[252:255]
v_exp_f32 v203, v203
v_fma_f32 v206, v206, s44, v25
v_mfma_f32_16x16x32_bf16 v[252:255], v[116:119], a[124:127], v[252:255]
v_cvt_pk_bf16_f32 v36, v200, v201
v_exp_f32 v204, v204
v_mfma_f32_16x16x32_bf16 v[252:255], v[112:115], a[136:139], v[252:255]
v_fma_f32 v207, v207, s44, v25
v_exp_f32 v205, v205
v_mfma_f32_16x16x32_bf16 v[252:255], v[8:11], a[140:143], v[252:255]
s_waitcnt lgkmcnt(5)
v_cvt_pk_bf16_f32 v37, v202, v203
v_mfma_f32_16x16x32_bf16 v[160:163], v[120:123], a[0:3], 0
s_waitcnt lgkmcnt(4)
v_exp_f32 v206, v206
v_exp_f32 v207, v207
v_mfma_f32_16x16x32_bf16 v[160:163], v[12:15], a[4:7], v[160:163]
s_waitcnt lgkmcnt(3)
v_cvt_pk_bf16_f32 v38, v204, v205
v_mfma_f32_16x16x32_bf16 v[160:163], v[0:3], a[16:19], v[160:163]
s_waitcnt lgkmcnt(2)
v_cvt_pk_bf16_f32 v39, v206, v207
v_fma_f32 v208, v208, s44, v20
v_fma_f32 v209, v209, s44, v20
v_mfma_f32_16x16x32_bf16 v[160:163], v[4:7], a[20:23], v[160:163]
s_waitcnt lgkmcnt(1)
v_fma_f32 v210, v210, s44, v20
v_exp_f32 v208, v208
v_mfma_f32_16x16x32_bf16 v[160:163], v[152:155], a[32:35], v[160:163]
s_waitcnt lgkmcnt(0)
v_fma_f32 v211, v211, s44, v20
v_exp_f32 v209, v209
v_mfma_f32_16x16x32_bf16 v[160:163], v[156:159], a[36:39], v[160:163]
s_add_u32 m0, s47, 122880
v_fma_f32 v212, v212, s44, v20
v_mfma_f32_16x16x32_bf16 v[168:171], v[120:123], a[8:11], 0
s_add_u32 s50, s87, 12288
buffer_load_dwordx4 v18, s[32:35], s50 offen nt lds
v_exp_f32 v210, v210
v_mfma_f32_16x16x32_bf16 v[168:171], v[12:15], a[12:15], v[168:171]
v_fma_f32 v213, v213, s44, v20
v_exp_f32 v211, v211
v_mfma_f32_16x16x32_bf16 v[168:171], v[0:3], a[24:27], v[168:171]
v_fma_f32 v214, v214, s44, v20
v_cvt_pk_bf16_f32 v40, v208, v209
v_mfma_f32_16x16x32_bf16 v[168:171], v[4:7], a[28:31], v[168:171]
v_exp_f32 v212, v212
v_mfma_f32_16x16x32_bf16 v[168:171], v[152:155], a[40:43], v[168:171]
v_fma_f32 v215, v215, s44, v20
v_exp_f32 v213, v213
v_mfma_f32_16x16x32_bf16 v[168:171], v[156:159], a[44:47], v[168:171]
ds_read_b128 v[8:11], v16 offset:30720
v_fma_f32 v216, v216, s44, v21
v_cvt_pk_bf16_f32 v41, v210, v211
v_mfma_f32_16x16x32_bf16 v[176:179], v[120:123], a[48:51], 0
v_exp_f32 v214, v214
v_mfma_f32_16x16x32_bf16 v[176:179], v[12:15], a[52:55], v[176:179]
ds_read_b128 v[112:115], v17 offset:30720
v_fma_f32 v217, v217, s44, v21
v_exp_f32 v215, v215
v_mfma_f32_16x16x32_bf16 v[176:179], v[0:3], a[64:67], v[176:179]
v_fma_f32 v218, v218, s44, v21
v_cvt_pk_bf16_f32 v42, v212, v213
v_mfma_f32_16x16x32_bf16 v[176:179], v[4:7], a[68:71], v[176:179]
ds_read_b128 v[116:119], v16 offset:31744
v_exp_f32 v216, v216
v_mfma_f32_16x16x32_bf16 v[176:179], v[152:155], a[80:83], v[176:179]
v_fma_f32 v219, v219, s44, v21
v_exp_f32 v217, v217
v_mfma_f32_16x16x32_bf16 v[176:179], v[156:159], a[84:87], v[176:179]
ds_read_b128 v[136:139], v17 offset:31744
v_fma_f32 v220, v220, s44, v21
v_cvt_pk_bf16_f32 v43, v214, v215
v_mfma_f32_16x16x32_bf16 v[184:187], v[120:123], a[56:59], 0
v_exp_f32 v218, v218
v_mfma_f32_16x16x32_bf16 v[184:187], v[12:15], a[60:63], v[184:187]
s_add_u32 m0, s47, 123776
ds_read_b128 v[140:143], v16 offset:32768
v_fma_f32 v221, v221, s44, v21
v_exp_f32 v219, v219
v_mfma_f32_16x16x32_bf16 v[184:187], v[0:3], a[72:75], v[184:187]
buffer_load_dwordx4 v18, s[32:35], s50 offen offset:128 nt lds
v_fma_f32 v222, v222, s44, v21
v_cvt_pk_bf16_f32 v44, v216, v217
v_mfma_f32_16x16x32_bf16 v[184:187], v[4:7], a[76:79], v[184:187]
ds_read_b128 v[28:31], v17 offset:32768
v_exp_f32 v220, v220
v_mfma_f32_16x16x32_bf16 v[184:187], v[152:155], a[88:91], v[184:187]
v_fma_f32 v223, v223, s44, v21
v_exp_f32 v221, v221
v_mfma_f32_16x16x32_bf16 v[184:187], v[156:159], a[92:95], v[184:187]
v_cvt_pk_bf16_f32 v45, v218, v219
v_exp_f32 v222, v222
v_mfma_f32_16x16x32_bf16 v[192:195], v[120:123], a[96:99], 0
v_exp_f32 v223, v223
v_mfma_f32_16x16x32_bf16 v[192:195], v[12:15], a[100:103], v[192:195]
v_cvt_pk_bf16_f32 v46, v220, v221
v_cvt_pk_bf16_f32 v47, v222, v223
v_mfma_f32_16x16x32_bf16 v[192:195], v[0:3], a[112:115], v[192:195]
v_fma_f32 v224, v224, s44, v22
v_fma_f32 v225, v225, s44, v22
v_mfma_f32_16x16x32_bf16 v[192:195], v[4:7], a[116:119], v[192:195]
v_fma_f32 v226, v226, s44, v22
v_exp_f32 v224, v224
v_mfma_f32_16x16x32_bf16 v[192:195], v[152:155], a[128:131], v[192:195]
v_fma_f32 v227, v227, s44, v22
v_exp_f32 v225, v225
v_mfma_f32_16x16x32_bf16 v[192:195], v[156:159], a[132:135], v[192:195]
v_fma_f32 v228, v228, s44, v22
v_mfma_f32_16x16x32_bf16 v[200:203], v[120:123], a[104:107], 0
v_exp_f32 v226, v226
v_mfma_f32_16x16x32_bf16 v[200:203], v[12:15], a[108:111], v[200:203]
v_fma_f32 v229, v229, s44, v22
v_exp_f32 v227, v227
v_mfma_f32_16x16x32_bf16 v[200:203], v[0:3], a[120:123], v[200:203]
v_fma_f32 v230, v230, s44, v22
v_cvt_pk_bf16_f32 v48, v224, v225
v_mfma_f32_16x16x32_bf16 v[200:203], v[4:7], a[124:127], v[200:203]
v_exp_f32 v228, v228
v_mfma_f32_16x16x32_bf16 v[200:203], v[152:155], a[136:139], v[200:203]
v_fma_f32 v231, v231, s44, v22
v_exp_f32 v229, v229
v_mfma_f32_16x16x32_bf16 v[200:203], v[156:159], a[140:143], v[200:203]
s_waitcnt lgkmcnt(5)
v_fma_f32 v232, v232, s44, v23
v_cvt_pk_bf16_f32 v49, v226, v227
v_mfma_f32_16x16x32_bf16 v[164:167], v[8:11], a[0:3], 0
s_waitcnt lgkmcnt(4)
v_exp_f32 v230, v230
v_mfma_f32_16x16x32_bf16 v[164:167], v[112:115], a[4:7], v[164:167]
s_waitcnt lgkmcnt(3)
v_fma_f32 v233, v233, s44, v23
v_exp_f32 v231, v231
v_mfma_f32_16x16x32_bf16 v[164:167], v[116:119], a[16:19], v[164:167]
s_waitcnt lgkmcnt(2)
v_fma_f32 v234, v234, s44, v23
v_cvt_pk_bf16_f32 v50, v228, v229
v_mfma_f32_16x16x32_bf16 v[164:167], v[136:139], a[20:23], v[164:167]
s_waitcnt lgkmcnt(1)
v_exp_f32 v232, v232
v_mfma_f32_16x16x32_bf16 v[164:167], v[140:143], a[32:35], v[164:167]
s_waitcnt lgkmcnt(0)
v_fma_f32 v235, v235, s44, v23
v_exp_f32 v233, v233
v_mfma_f32_16x16x32_bf16 v[164:167], v[28:31], a[36:39], v[164:167]
s_add_u32 m0, s47, 124672
s_nop 0
buffer_load_dwordx4 v18, s[32:35], s50 offen offset:256 nt lds
v_fma_f32 v236, v236, s44, v23
v_cvt_pk_bf16_f32 v51, v230, v231
v_mfma_f32_16x16x32_bf16 v[172:175], v[8:11], a[8:11], 0
v_exp_f32 v234, v234
v_mfma_f32_16x16x32_bf16 v[172:175], v[112:115], a[12:15], v[172:175]
v_fma_f32 v237, v237, s44, v23
v_exp_f32 v235, v235
v_mfma_f32_16x16x32_bf16 v[172:175], v[116:119], a[24:27], v[172:175]
v_fma_f32 v238, v238, s44, v23
v_cvt_pk_bf16_f32 v52, v232, v233
v_mfma_f32_16x16x32_bf16 v[172:175], v[136:139], a[28:31], v[172:175]
s_waitcnt vmcnt(10)
s_barrier
v_exp_f32 v236, v236
v_mfma_f32_16x16x32_bf16 v[172:175], v[140:143], a[40:43], v[172:175]
v_fma_f32 v239, v239, s44, v23
v_exp_f32 v237, v237
v_mfma_f32_16x16x32_bf16 v[172:175], v[28:31], a[44:47], v[172:175]
ds_read_b128 v[156:159], v16 offset:36864
v_cvt_pk_bf16_f32 v53, v234, v235
v_exp_f32 v238, v238
v_mfma_f32_16x16x32_bf16 v[180:183], v[8:11], a[48:51], 0
v_exp_f32 v239, v239
v_mfma_f32_16x16x32_bf16 v[180:183], v[112:115], a[52:55], v[180:183]
ds_read_b128 v[152:155], v17 offset:36864
v_cvt_pk_bf16_f32 v54, v236, v237
v_cvt_pk_bf16_f32 v55, v238, v239
v_mfma_f32_16x16x32_bf16 v[180:183], v[116:119], a[64:67], v[180:183]
v_fma_f32 v240, v240, s44, v24
v_fma_f32 v241, v241, s44, v24
v_mfma_f32_16x16x32_bf16 v[180:183], v[136:139], a[68:71], v[180:183]
ds_read_b128 v[4:7], v16 offset:37888
v_fma_f32 v242, v242, s44, v24
v_exp_f32 v240, v240
v_mfma_f32_16x16x32_bf16 v[180:183], v[140:143], a[80:83], v[180:183]
v_fma_f32 v243, v243, s44, v24
v_exp_f32 v241, v241
v_mfma_f32_16x16x32_bf16 v[180:183], v[28:31], a[84:87], v[180:183]
ds_read_b128 v[0:3], v17 offset:37888
v_fma_f32 v244, v244, s44, v24
v_mfma_f32_16x16x32_bf16 v[188:191], v[8:11], a[56:59], 0
s_add_u32 m0, s47, 135168
v_exp_f32 v242, v242
v_mfma_f32_16x16x32_bf16 v[188:191], v[112:115], a[60:63], v[188:191]
s_add_u32 s50, s87, 24576
ds_read_b128 v[12:15], v16 offset:38912
v_fma_f32 v245, v245, s44, v24
v_exp_f32 v243, v243
v_mfma_f32_16x16x32_bf16 v[188:191], v[116:119], a[72:75], v[188:191]
buffer_load_dwordx4 v18, s[32:35], s50 offen nt lds
v_fma_f32 v246, v246, s44, v24
v_cvt_pk_bf16_f32 v56, v240, v241
v_mfma_f32_16x16x32_bf16 v[188:191], v[136:139], a[76:79], v[188:191]
ds_read_b128 v[120:123], v17 offset:38912
v_exp_f32 v244, v244
v_mfma_f32_16x16x32_bf16 v[188:191], v[140:143], a[88:91], v[188:191]
v_fma_f32 v247, v247, s44, v24
v_exp_f32 v245, v245
v_mfma_f32_16x16x32_bf16 v[188:191], v[28:31], a[92:95], v[188:191]
v_fma_f32 v248, v248, s44, v25
v_cvt_pk_bf16_f32 v57, v242, v243
v_mfma_f32_16x16x32_bf16 v[196:199], v[8:11], a[96:99], 0
v_exp_f32 v246, v246
v_mfma_f32_16x16x32_bf16 v[196:199], v[112:115], a[100:103], v[196:199]
v_fma_f32 v249, v249, s44, v25
v_exp_f32 v247, v247
v_mfma_f32_16x16x32_bf16 v[196:199], v[116:119], a[112:115], v[196:199]
v_fma_f32 v250, v250, s44, v25
v_cvt_pk_bf16_f32 v58, v244, v245
v_mfma_f32_16x16x32_bf16 v[196:199], v[136:139], a[116:119], v[196:199]
v_exp_f32 v248, v248
v_mfma_f32_16x16x32_bf16 v[196:199], v[140:143], a[128:131], v[196:199]
v_fma_f32 v251, v251, s44, v25
v_exp_f32 v249, v249
v_mfma_f32_16x16x32_bf16 v[196:199], v[28:31], a[132:135], v[196:199]
v_fma_f32 v252, v252, s44, v25
v_cvt_pk_bf16_f32 v59, v246, v247
v_mfma_f32_16x16x32_bf16 v[204:207], v[8:11], a[104:107], 0
v_exp_f32 v250, v250
v_mfma_f32_16x16x32_bf16 v[204:207], v[112:115], a[108:111], v[204:207]
v_fma_f32 v253, v253, s44, v25
v_exp_f32 v251, v251
v_mfma_f32_16x16x32_bf16 v[204:207], v[116:119], a[120:123], v[204:207]
v_fma_f32 v254, v254, s44, v25
v_cvt_pk_bf16_f32 v60, v248, v249
v_mfma_f32_16x16x32_bf16 v[204:207], v[136:139], a[124:127], v[204:207]
v_exp_f32 v252, v252
v_mfma_f32_16x16x32_bf16 v[204:207], v[140:143], a[136:139], v[204:207]
v_fma_f32 v255, v255, s44, v25
v_exp_f32 v253, v253
v_mfma_f32_16x16x32_bf16 v[204:207], v[28:31], a[140:143], v[204:207]
s_waitcnt lgkmcnt(5)
v_cvt_pk_bf16_f32 v61, v250, v251
v_exp_f32 v254, v254
v_mfma_f32_16x16x32_bf16 v[208:211], v[156:159], a[0:3], 0
s_waitcnt lgkmcnt(4)
v_exp_f32 v255, v255
v_mfma_f32_16x16x32_bf16 v[208:211], v[152:155], a[4:7], v[208:211]
s_waitcnt lgkmcnt(3)
v_cvt_pk_bf16_f32 v62, v252, v253
v_cvt_pk_bf16_f32 v63, v254, v255
v_mfma_f32_16x16x32_bf16 v[208:211], v[4:7], a[16:19], v[208:211]
s_waitcnt lgkmcnt(2)
v_fma_f32 v160, v160, s44, v20
v_fma_f32 v161, v161, s44, v20
v_mfma_f32_16x16x32_bf16 v[208:211], v[0:3], a[20:23], v[208:211]
s_waitcnt lgkmcnt(1)
v_fma_f32 v162, v162, s44, v20
v_exp_f32 v160, v160
v_mfma_f32_16x16x32_bf16 v[208:211], v[12:15], a[32:35], v[208:211]
s_waitcnt lgkmcnt(0)
v_fma_f32 v163, v163, s44, v20
v_exp_f32 v161, v161
v_mfma_f32_16x16x32_bf16 v[208:211], v[120:123], a[36:39], v[208:211]
s_add_u32 m0, s47, 136064
s_nop 0
buffer_load_dwordx4 v18, s[32:35], s50 offen offset:128 nt lds
v_fma_f32 v164, v164, s44, v20
v_mfma_f32_16x16x32_bf16 v[216:219], v[156:159], a[8:11], 0
v_exp_f32 v162, v162
v_mfma_f32_16x16x32_bf16 v[216:219], v[152:155], a[12:15], v[216:219]
v_fma_f32 v165, v165, s44, v20
v_exp_f32 v163, v163
v_mfma_f32_16x16x32_bf16 v[216:219], v[4:7], a[24:27], v[216:219]
v_fma_f32 v166, v166, s44, v20
v_cvt_pk_bf16_f32 v64, v160, v161
v_mfma_f32_16x16x32_bf16 v[216:219], v[0:3], a[28:31], v[216:219]
v_exp_f32 v164, v164
v_mfma_f32_16x16x32_bf16 v[216:219], v[12:15], a[40:43], v[216:219]
v_fma_f32 v167, v167, s44, v20
v_exp_f32 v165, v165
v_mfma_f32_16x16x32_bf16 v[216:219], v[120:123], a[44:47], v[216:219]
ds_read_b128 v[28:31], v16 offset:43008
v_fma_f32 v168, v168, s44, v21
v_cvt_pk_bf16_f32 v65, v162, v163
v_mfma_f32_16x16x32_bf16 v[224:227], v[156:159], a[48:51], 0
v_exp_f32 v166, v166
v_mfma_f32_16x16x32_bf16 v[224:227], v[152:155], a[52:55], v[224:227]
ds_read_b128 v[140:143], v17 offset:43008
v_fma_f32 v169, v169, s44, v21
v_exp_f32 v167, v167
v_mfma_f32_16x16x32_bf16 v[224:227], v[4:7], a[64:67], v[224:227]
v_fma_f32 v170, v170, s44, v21
v_cvt_pk_bf16_f32 v66, v164, v165
v_mfma_f32_16x16x32_bf16 v[224:227], v[0:3], a[68:71], v[224:227]
ds_read_b128 v[136:139], v16 offset:44032
v_exp_f32 v168, v168
v_mfma_f32_16x16x32_bf16 v[224:227], v[12:15], a[80:83], v[224:227]
v_fma_f32 v171, v171, s44, v21
v_exp_f32 v169, v169
v_mfma_f32_16x16x32_bf16 v[224:227], v[120:123], a[84:87], v[224:227]
ds_read_b128 v[116:119], v17 offset:44032
v_fma_f32 v172, v172, s44, v21
v_cvt_pk_bf16_f32 v67, v166, v167
v_mfma_f32_16x16x32_bf16 v[232:235], v[156:159], a[56:59], 0
v_exp_f32 v170, v170
v_mfma_f32_16x16x32_bf16 v[232:235], v[152:155], a[60:63], v[232:235]
s_add_u32 m0, s47, 136960
ds_read_b128 v[112:115], v16 offset:45056
v_fma_f32 v173, v173, s44, v21
v_exp_f32 v171, v171
v_mfma_f32_16x16x32_bf16 v[232:235], v[4:7], a[72:75], v[232:235]
buffer_load_dwordx4 v18, s[32:35], s50 offen offset:256 nt lds
v_fma_f32 v174, v174, s44, v21
v_cvt_pk_bf16_f32 v68, v168, v169
v_mfma_f32_16x16x32_bf16 v[232:235], v[0:3], a[76:79], v[232:235]
ds_read_b128 v[8:11], v17 offset:45056
v_exp_f32 v172, v172
v_mfma_f32_16x16x32_bf16 v[232:235], v[12:15], a[88:91], v[232:235]
v_fma_f32 v175, v175, s44, v21
v_exp_f32 v173, v173
v_mfma_f32_16x16x32_bf16 v[232:235], v[120:123], a[92:95], v[232:235]
v_cvt_pk_bf16_f32 v69, v170, v171
v_exp_f32 v174, v174
v_mfma_f32_16x16x32_bf16 v[240:243], v[156:159], a[96:99], 0
v_exp_f32 v175, v175
v_mfma_f32_16x16x32_bf16 v[240:243], v[152:155], a[100:103], v[240:243]
v_cvt_pk_bf16_f32 v70, v172, v173
v_cvt_pk_bf16_f32 v71, v174, v175
v_mfma_f32_16x16x32_bf16 v[240:243], v[4:7], a[112:115], v[240:243]
v_fma_f32 v176, v176, s44, v22
v_fma_f32 v177, v177, s44, v22
v_mfma_f32_16x16x32_bf16 v[240:243], v[0:3], a[116:119], v[240:243]
v_fma_f32 v178, v178, s44, v22
v_exp_f32 v176, v176
v_mfma_f32_16x16x32_bf16 v[240:243], v[12:15], a[128:131], v[240:243]
v_fma_f32 v179, v179, s44, v22
v_exp_f32 v177, v177
v_mfma_f32_16x16x32_bf16 v[240:243], v[120:123], a[132:135], v[240:243]
v_fma_f32 v180, v180, s44, v22
v_mfma_f32_16x16x32_bf16 v[248:251], v[156:159], a[104:107], 0
v_exp_f32 v178, v178
v_mfma_f32_16x16x32_bf16 v[248:251], v[152:155], a[108:111], v[248:251]
v_fma_f32 v181, v181, s44, v22
v_exp_f32 v179, v179
v_mfma_f32_16x16x32_bf16 v[248:251], v[4:7], a[120:123], v[248:251]
v_fma_f32 v182, v182, s44, v22
v_cvt_pk_bf16_f32 v72, v176, v177
v_mfma_f32_16x16x32_bf16 v[248:251], v[0:3], a[124:127], v[248:251]
v_exp_f32 v180, v180
v_mfma_f32_16x16x32_bf16 v[248:251], v[12:15], a[136:139], v[248:251]
v_fma_f32 v183, v183, s44, v22
v_exp_f32 v181, v181
v_mfma_f32_16x16x32_bf16 v[248:251], v[120:123], a[140:143], v[248:251]
s_waitcnt lgkmcnt(5)
v_fma_f32 v184, v184, s44, v23
v_cvt_pk_bf16_f32 v73, v178, v179
v_mfma_f32_16x16x32_bf16 v[212:215], v[28:31], a[0:3], 0
s_waitcnt lgkmcnt(4)
v_exp_f32 v182, v182
v_mfma_f32_16x16x32_bf16 v[212:215], v[140:143], a[4:7], v[212:215]
s_waitcnt lgkmcnt(3)
v_fma_f32 v185, v185, s44, v23
v_exp_f32 v183, v183
v_mfma_f32_16x16x32_bf16 v[212:215], v[136:139], a[16:19], v[212:215]
s_waitcnt lgkmcnt(2)
v_fma_f32 v186, v186, s44, v23
v_cvt_pk_bf16_f32 v74, v180, v181
v_mfma_f32_16x16x32_bf16 v[212:215], v[116:119], a[20:23], v[212:215]
s_waitcnt lgkmcnt(1)
v_exp_f32 v184, v184
v_mfma_f32_16x16x32_bf16 v[212:215], v[112:115], a[32:35], v[212:215]
s_waitcnt lgkmcnt(0)
v_fma_f32 v187, v187, s44, v23
v_exp_f32 v185, v185
v_mfma_f32_16x16x32_bf16 v[212:215], v[8:11], a[36:39], v[212:215]
s_add_u32 m0, s47, 12288
v_fma_f32 v188, v188, s44, v23
v_cvt_pk_bf16_f32 v75, v182, v183
v_mfma_f32_16x16x32_bf16 v[220:223], v[28:31], a[8:11], 0
s_add_u32 s50, s85, 0
buffer_load_dwordx4 v19, s[36:39], s50 offen nt lds
v_exp_f32 v186, v186
v_mfma_f32_16x16x32_bf16 v[220:223], v[140:143], a[12:15], v[220:223]
v_fma_f32 v189, v189, s44, v23
v_exp_f32 v187, v187
v_mfma_f32_16x16x32_bf16 v[220:223], v[136:139], a[24:27], v[220:223]
v_fma_f32 v190, v190, s44, v23
v_cvt_pk_bf16_f32 v76, v184, v185
v_mfma_f32_16x16x32_bf16 v[220:223], v[116:119], a[28:31], v[220:223]
s_waitcnt vmcnt(10)
s_barrier
v_add_u32 v16, 0xc000, v16
v_exp_f32 v188, v188
v_mfma_f32_16x16x32_bf16 v[220:223], v[112:115], a[40:43], v[220:223]
v_fma_f32 v191, v191, s44, v23
v_exp_f32 v189, v189
v_mfma_f32_16x16x32_bf16 v[220:223], v[8:11], a[44:47], v[220:223]
ds_read_b128 v[120:123], v16 offset:0
v_add_u32 v17, 0xc000, v17
v_cvt_pk_bf16_f32 v77, v186, v187
v_exp_f32 v190, v190
v_mfma_f32_16x16x32_bf16 v[228:231], v[28:31], a[48:51], 0
v_exp_f32 v191, v191
v_mfma_f32_16x16x32_bf16 v[228:231], v[140:143], a[52:55], v[228:231]
ds_read_b128 v[12:15], v17 offset:0
v_cvt_pk_bf16_f32 v78, v188, v189
v_cvt_pk_bf16_f32 v79, v190, v191
v_mfma_f32_16x16x32_bf16 v[228:231], v[136:139], a[64:67], v[228:231]
v_fma_f32 v192, v192, s44, v24
v_fma_f32 v193, v193, s44, v24
v_mfma_f32_16x16x32_bf16 v[228:231], v[116:119], a[68:71], v[228:231]
ds_read_b128 v[0:3], v16 offset:1024
v_fma_f32 v194, v194, s44, v24
v_exp_f32 v192, v192
v_mfma_f32_16x16x32_bf16 v[228:231], v[112:115], a[80:83], v[228:231]
v_fma_f32 v195, v195, s44, v24
v_exp_f32 v193, v193
v_mfma_f32_16x16x32_bf16 v[228:231], v[8:11], a[84:87], v[228:231]
ds_read_b128 v[4:7], v17 offset:1024
v_fma_f32 v196, v196, s44, v24
v_mfma_f32_16x16x32_bf16 v[236:239], v[28:31], a[56:59], 0
s_add_u32 m0, s47, 13312
v_exp_f32 v194, v194
v_mfma_f32_16x16x32_bf16 v[236:239], v[140:143], a[60:63], v[236:239]
s_add_u32 s50, s85, 3072
ds_read_b128 v[152:155], v16 offset:2048
v_fma_f32 v197, v197, s44, v24
v_exp_f32 v195, v195
v_mfma_f32_16x16x32_bf16 v[236:239], v[136:139], a[72:75], v[236:239]
buffer_load_dwordx4 v19, s[36:39], s50 offen nt lds
v_fma_f32 v198, v198, s44, v24
v_cvt_pk_bf16_f32 v80, v192, v193
v_mfma_f32_16x16x32_bf16 v[236:239], v[116:119], a[76:79], v[236:239]
ds_read_b128 v[156:159], v17 offset:2048
v_exp_f32 v196, v196
v_mfma_f32_16x16x32_bf16 v[236:239], v[112:115], a[88:91], v[236:239]
v_fma_f32 v199, v199, s44, v24
v_exp_f32 v197, v197
v_mfma_f32_16x16x32_bf16 v[236:239], v[8:11], a[92:95], v[236:239]
v_fma_f32 v200, v200, s44, v25
v_cvt_pk_bf16_f32 v81, v194, v195
v_mfma_f32_16x16x32_bf16 v[244:247], v[28:31], a[96:99], 0
v_exp_f32 v198, v198
v_mfma_f32_16x16x32_bf16 v[244:247], v[140:143], a[100:103], v[244:247]
v_fma_f32 v201, v201, s44, v25
v_exp_f32 v199, v199
v_mfma_f32_16x16x32_bf16 v[244:247], v[136:139], a[112:115], v[244:247]
v_fma_f32 v202, v202, s44, v25
v_cvt_pk_bf16_f32 v82, v196, v197
v_mfma_f32_16x16x32_bf16 v[244:247], v[116:119], a[116:119], v[244:247]
v_exp_f32 v200, v200
v_mfma_f32_16x16x32_bf16 v[244:247], v[112:115], a[128:131], v[244:247]
v_fma_f32 v203, v203, s44, v25
v_exp_f32 v201, v201
v_mfma_f32_16x16x32_bf16 v[244:247], v[8:11], a[132:135], v[244:247]
v_fma_f32 v204, v204, s44, v25
v_cvt_pk_bf16_f32 v83, v198, v199
v_mfma_f32_16x16x32_bf16 v[252:255], v[28:31], a[104:107], 0
v_exp_f32 v202, v202
v_mfma_f32_16x16x32_bf16 v[252:255], v[140:143], a[108:111], v[252:255]
v_fma_f32 v205, v205, s44, v25
v_exp_f32 v203, v203
v_mfma_f32_16x16x32_bf16 v[252:255], v[136:139], a[120:123], v[252:255]
v_fma_f32 v206, v206, s44, v25
v_cvt_pk_bf16_f32 v84, v200, v201
v_mfma_f32_16x16x32_bf16 v[252:255], v[116:119], a[124:127], v[252:255]
v_exp_f32 v204, v204
v_mfma_f32_16x16x32_bf16 v[252:255], v[112:115], a[136:139], v[252:255]
v_fma_f32 v207, v207, s44, v25
v_exp_f32 v205, v205
v_mfma_f32_16x16x32_bf16 v[252:255], v[8:11], a[140:143], v[252:255]
s_waitcnt lgkmcnt(5)
v_cvt_pk_bf16_f32 v85, v202, v203
v_exp_f32 v206, v206
v_mfma_f32_16x16x32_bf16 v[160:163], v[120:123], a[0:3], 0
s_waitcnt lgkmcnt(4)
v_exp_f32 v207, v207
v_mfma_f32_16x16x32_bf16 v[160:163], v[12:15], a[4:7], v[160:163]
s_waitcnt lgkmcnt(3)
v_cvt_pk_bf16_f32 v86, v204, v205
v_cvt_pk_bf16_f32 v87, v206, v207
v_mfma_f32_16x16x32_bf16 v[160:163], v[0:3], a[16:19], v[160:163]
s_waitcnt lgkmcnt(2)
v_fma_f32 v208, v208, s44, v20
v_fma_f32 v209, v209, s44, v20
v_mfma_f32_16x16x32_bf16 v[160:163], v[4:7], a[20:23], v[160:163]
s_waitcnt lgkmcnt(1)
v_fma_f32 v210, v210, s44, v20
v_exp_f32 v208, v208
v_mfma_f32_16x16x32_bf16 v[160:163], v[152:155], a[32:35], v[160:163]
s_waitcnt lgkmcnt(0)
v_fma_f32 v211, v211, s44, v20
v_exp_f32 v209, v209
v_mfma_f32_16x16x32_bf16 v[160:163], v[156:159], a[36:39], v[160:163]
s_add_u32 m0, s47, 14336
v_fma_f32 v212, v212, s44, v20
v_mfma_f32_16x16x32_bf16 v[168:171], v[120:123], a[8:11], 0
s_add_u32 s50, s85, 6144
buffer_load_dwordx4 v19, s[36:39], s50 offen nt lds
v_exp_f32 v210, v210
v_mfma_f32_16x16x32_bf16 v[168:171], v[12:15], a[12:15], v[168:171]
v_fma_f32 v213, v213, s44, v20
v_exp_f32 v211, v211
v_mfma_f32_16x16x32_bf16 v[168:171], v[0:3], a[24:27], v[168:171]
v_fma_f32 v214, v214, s44, v20
v_cvt_pk_bf16_f32 v88, v208, v209
v_mfma_f32_16x16x32_bf16 v[168:171], v[4:7], a[28:31], v[168:171]
v_exp_f32 v212, v212
v_mfma_f32_16x16x32_bf16 v[168:171], v[152:155], a[40:43], v[168:171]
v_fma_f32 v215, v215, s44, v20
v_exp_f32 v213, v213
v_mfma_f32_16x16x32_bf16 v[168:171], v[156:159], a[44:47], v[168:171]
ds_read_b128 v[8:11], v16 offset:6144
v_fma_f32 v216, v216, s44, v21
v_cvt_pk_bf16_f32 v89, v210, v211
v_mfma_f32_16x16x32_bf16 v[176:179], v[120:123], a[48:51], 0
v_exp_f32 v214, v214
v_mfma_f32_16x16x32_bf16 v[176:179], v[12:15], a[52:55], v[176:179]
ds_read_b128 v[112:115], v17 offset:6144
v_fma_f32 v217, v217, s44, v21
v_exp_f32 v215, v215
v_mfma_f32_16x16x32_bf16 v[176:179], v[0:3], a[64:67], v[176:179]
v_fma_f32 v218, v218, s44, v21
v_cvt_pk_bf16_f32 v90, v212, v213
v_mfma_f32_16x16x32_bf16 v[176:179], v[4:7], a[68:71], v[176:179]
ds_read_b128 v[116:119], v16 offset:7168
v_exp_f32 v216, v216
v_mfma_f32_16x16x32_bf16 v[176:179], v[152:155], a[80:83], v[176:179]
v_fma_f32 v219, v219, s44, v21
v_exp_f32 v217, v217
v_mfma_f32_16x16x32_bf16 v[176:179], v[156:159], a[84:87], v[176:179]
ds_read_b128 v[136:139], v17 offset:7168
v_fma_f32 v220, v220, s44, v21
v_cvt_pk_bf16_f32 v91, v214, v215
v_mfma_f32_16x16x32_bf16 v[184:187], v[120:123], a[56:59], 0
s_add_u32 m0, s47, 0
v_exp_f32 v218, v218
v_mfma_f32_16x16x32_bf16 v[184:187], v[12:15], a[60:63], v[184:187]
s_add_u32 s50, s84, 0
ds_read_b128 v[140:143], v16 offset:8192
v_fma_f32 v221, v221, s44, v21
v_exp_f32 v219, v219
v_mfma_f32_16x16x32_bf16 v[184:187], v[0:3], a[72:75], v[184:187]
buffer_load_dwordx4 v19, s[36:39], s50 offen nt lds
v_fma_f32 v222, v222, s44, v21
v_cvt_pk_bf16_f32 v92, v216, v217
v_mfma_f32_16x16x32_bf16 v[184:187], v[4:7], a[76:79], v[184:187]
ds_read_b128 v[28:31], v17 offset:8192
v_exp_f32 v220, v220
v_mfma_f32_16x16x32_bf16 v[184:187], v[152:155], a[88:91], v[184:187]
v_fma_f32 v223, v223, s44, v21
v_exp_f32 v221, v221
v_mfma_f32_16x16x32_bf16 v[184:187], v[156:159], a[92:95], v[184:187]
v_cvt_pk_bf16_f32 v93, v218, v219
v_exp_f32 v222, v222
v_mfma_f32_16x16x32_bf16 v[192:195], v[120:123], a[96:99], 0
v_exp_f32 v223, v223
v_mfma_f32_16x16x32_bf16 v[192:195], v[12:15], a[100:103], v[192:195]
v_cvt_pk_bf16_f32 v94, v220, v221
v_cvt_pk_bf16_f32 v95, v222, v223
v_mfma_f32_16x16x32_bf16 v[192:195], v[0:3], a[112:115], v[192:195]
v_fma_f32 v224, v224, s44, v22
v_fma_f32 v225, v225, s44, v22
v_mfma_f32_16x16x32_bf16 v[192:195], v[4:7], a[116:119], v[192:195]
v_fma_f32 v226, v226, s44, v22
v_exp_f32 v224, v224
v_mfma_f32_16x16x32_bf16 v[192:195], v[152:155], a[128:131], v[192:195]
v_fma_f32 v227, v227, s44, v22
v_exp_f32 v225, v225
v_mfma_f32_16x16x32_bf16 v[192:195], v[156:159], a[132:135], v[192:195]
v_fma_f32 v228, v228, s44, v22
v_mfma_f32_16x16x32_bf16 v[200:203], v[120:123], a[104:107], 0
v_exp_f32 v226, v226
v_mfma_f32_16x16x32_bf16 v[200:203], v[12:15], a[108:111], v[200:203]
v_fma_f32 v229, v229, s44, v22
v_exp_f32 v227, v227
v_mfma_f32_16x16x32_bf16 v[200:203], v[0:3], a[120:123], v[200:203]
v_fma_f32 v230, v230, s44, v22
v_cvt_pk_bf16_f32 v96, v224, v225
v_mfma_f32_16x16x32_bf16 v[200:203], v[4:7], a[124:127], v[200:203]
v_exp_f32 v228, v228
v_mfma_f32_16x16x32_bf16 v[200:203], v[152:155], a[136:139], v[200:203]
v_fma_f32 v231, v231, s44, v22
v_exp_f32 v229, v229
v_mfma_f32_16x16x32_bf16 v[200:203], v[156:159], a[140:143], v[200:203]
s_waitcnt lgkmcnt(5)
v_fma_f32 v232, v232, s44, v23
v_cvt_pk_bf16_f32 v97, v226, v227
v_mfma_f32_16x16x32_bf16 v[164:167], v[8:11], a[0:3], 0
s_waitcnt lgkmcnt(4)
v_exp_f32 v230, v230
v_mfma_f32_16x16x32_bf16 v[164:167], v[112:115], a[4:7], v[164:167]
s_waitcnt lgkmcnt(3)
v_fma_f32 v233, v233, s44, v23
v_exp_f32 v231, v231
v_mfma_f32_16x16x32_bf16 v[164:167], v[116:119], a[16:19], v[164:167]
s_waitcnt lgkmcnt(2)
v_fma_f32 v234, v234, s44, v23
v_cvt_pk_bf16_f32 v98, v228, v229
v_mfma_f32_16x16x32_bf16 v[164:167], v[136:139], a[20:23], v[164:167]
s_waitcnt lgkmcnt(1)
v_exp_f32 v232, v232
v_mfma_f32_16x16x32_bf16 v[164:167], v[140:143], a[32:35], v[164:167]
s_waitcnt lgkmcnt(0)
v_fma_f32 v235, v235, s44, v23
v_exp_f32 v233, v233
v_mfma_f32_16x16x32_bf16 v[164:167], v[28:31], a[36:39], v[164:167]
s_add_u32 m0, s47, 1024
v_fma_f32 v236, v236, s44, v23
v_cvt_pk_bf16_f32 v99, v230, v231
v_mfma_f32_16x16x32_bf16 v[172:175], v[8:11], a[8:11], 0
s_add_u32 s50, s84, 3072
buffer_load_dwordx4 v19, s[36:39], s50 offen nt lds
v_exp_f32 v234, v234
v_mfma_f32_16x16x32_bf16 v[172:175], v[112:115], a[12:15], v[172:175]
v_fma_f32 v237, v237, s44, v23
v_exp_f32 v235, v235
v_mfma_f32_16x16x32_bf16 v[172:175], v[116:119], a[24:27], v[172:175]
v_fma_f32 v238, v238, s44, v23
v_cvt_pk_bf16_f32 v100, v232, v233
v_mfma_f32_16x16x32_bf16 v[172:175], v[136:139], a[28:31], v[172:175]
v_exp_f32 v236, v236
v_mfma_f32_16x16x32_bf16 v[172:175], v[140:143], a[40:43], v[172:175]
v_fma_f32 v239, v239, s44, v23
v_exp_f32 v237, v237
v_mfma_f32_16x16x32_bf16 v[172:175], v[28:31], a[44:47], v[172:175]
v_cvt_pk_bf16_f32 v101, v234, v235
v_exp_f32 v238, v238
v_mfma_f32_16x16x32_bf16 v[180:183], v[8:11], a[48:51], 0
v_exp_f32 v239, v239
v_mfma_f32_16x16x32_bf16 v[180:183], v[112:115], a[52:55], v[180:183]
v_cvt_pk_bf16_f32 v102, v236, v237
v_cvt_pk_bf16_f32 v103, v238, v239
v_mfma_f32_16x16x32_bf16 v[180:183], v[116:119], a[64:67], v[180:183]
v_fma_f32 v240, v240, s44, v24
v_fma_f32 v241, v241, s44, v24
v_mfma_f32_16x16x32_bf16 v[180:183], v[136:139], a[68:71], v[180:183]
s_waitcnt vmcnt(11)
s_barrier
v_fma_f32 v242, v242, s44, v24
v_exp_f32 v240, v240
v_mfma_f32_16x16x32_bf16 v[180:183], v[140:143], a[80:83], v[180:183]
v_fma_f32 v243, v243, s44, v24
v_exp_f32 v241, v241
v_mfma_f32_16x16x32_bf16 v[180:183], v[28:31], a[84:87], v[180:183]
ds_read_b128 v[156:159], v16 offset:12288
v_fma_f32 v244, v244, s44, v24
v_mfma_f32_16x16x32_bf16 v[188:191], v[8:11], a[56:59], 0
s_add_u32 m0, s47, 2048
v_exp_f32 v242, v242
v_mfma_f32_16x16x32_bf16 v[188:191], v[112:115], a[60:63], v[188:191]
s_add_u32 s50, s84, 6144
ds_read_b128 v[152:155], v17 offset:12288
v_fma_f32 v245, v245, s44, v24
v_exp_f32 v243, v243
v_mfma_f32_16x16x32_bf16 v[188:191], v[116:119], a[72:75], v[188:191]
buffer_load_dwordx4 v19, s[36:39], s50 offen nt lds
v_fma_f32 v246, v246, s44, v24
v_cvt_pk_bf16_f32 v104, v240, v241
v_mfma_f32_16x16x32_bf16 v[188:191], v[136:139], a[76:79], v[188:191]
ds_read_b128 v[4:7], v16 offset:13312
v_exp_f32 v244, v244
v_mfma_f32_16x16x32_bf16 v[188:191], v[140:143], a[88:91], v[188:191]
v_fma_f32 v247, v247, s44, v24
v_exp_f32 v245, v245
v_mfma_f32_16x16x32_bf16 v[188:191], v[28:31], a[92:95], v[188:191]
v_fma_f32 v248, v248, s44, v25
v_cvt_pk_bf16_f32 v105, v242, v243
v_mfma_f32_16x16x32_bf16 v[196:199], v[8:11], a[96:99], 0
v_exp_f32 v246, v246
v_mfma_f32_16x16x32_bf16 v[196:199], v[112:115], a[100:103], v[196:199]
v_fma_f32 v249, v249, s44, v25
v_exp_f32 v247, v247
v_mfma_f32_16x16x32_bf16 v[196:199], v[116:119], a[112:115], v[196:199]
v_fma_f32 v250, v250, s44, v25
v_cvt_pk_bf16_f32 v106, v244, v245
v_mfma_f32_16x16x32_bf16 v[196:199], v[136:139], a[116:119], v[196:199]
v_exp_f32 v248, v248
v_mfma_f32_16x16x32_bf16 v[196:199], v[140:143], a[128:131], v[196:199]
v_fma_f32 v251, v251, s44, v25
v_exp_f32 v249, v249
v_mfma_f32_16x16x32_bf16 v[196:199], v[28:31], a[132:135], v[196:199]
v_fma_f32 v252, v252, s44, v25
v_cvt_pk_bf16_f32 v107, v246, v247
v_mfma_f32_16x16x32_bf16 v[204:207], v[8:11], a[104:107], 0
v_exp_f32 v250, v250
v_mfma_f32_16x16x32_bf16 v[204:207], v[112:115], a[108:111], v[204:207]
v_fma_f32 v253, v253, s44, v25
v_exp_f32 v251, v251
v_mfma_f32_16x16x32_bf16 v[204:207], v[116:119], a[120:123], v[204:207]
v_fma_f32 v254, v254, s44, v25
v_cvt_pk_bf16_f32 v108, v248, v249
v_mfma_f32_16x16x32_bf16 v[204:207], v[136:139], a[124:127], v[204:207]
v_exp_f32 v252, v252
v_mfma_f32_16x16x32_bf16 v[204:207], v[140:143], a[136:139], v[204:207]
v_fma_f32 v255, v255, s44, v25
v_exp_f32 v253, v253
v_mfma_f32_16x16x32_bf16 v[204:207], v[28:31], a[140:143], v[204:207]
s_waitcnt lgkmcnt(2)
ds_read_b128 v[140:143], v16 offset:18432
v_cvt_pk_bf16_f32 v109, v250, v251
v_exp_f32 v254, v254
v_mfma_f32_16x16x32_bf16 v[208:211], v[156:159], a[0:3], 0
s_waitcnt lgkmcnt(2)
v_exp_f32 v255, v255
v_mfma_f32_16x16x32_bf16 v[208:211], v[152:155], a[4:7], v[208:211]
s_waitcnt lgkmcnt(1)
ds_read_b128 v[28:31], v17 offset:18432
v_cvt_pk_bf16_f32 v110, v252, v253
v_cvt_pk_bf16_f32 v111, v254, v255
v_mfma_f32_16x16x32_bf16 v[208:211], v[4:7], a[16:19], v[208:211]
s_add_u32 m0, s47, 36864
v_fma_f32 v160, v160, s44, v20
v_fma_f32 v161, v161, s44, v20
v_mfma_f32_16x16x32_bf16 v[216:219], v[156:159], a[8:11], 0
s_add_u32 s50, s87, 0
ds_read_b128 v[136:139], v16 offset:19456
v_fma_f32 v162, v162, s44, v20
v_exp_f32 v160, v160
v_mfma_f32_16x16x32_bf16 v[216:219], v[152:155], a[12:15], v[216:219]
buffer_load_dwordx4 v19, s[36:39], s50 offen nt lds
v_fma_f32 v163, v163, s44, v20
v_exp_f32 v161, v161
v_mfma_f32_16x16x32_bf16 v[216:219], v[4:7], a[24:27], v[216:219]
v_fma_f32 v164, v164, s44, v20
v_mfma_f32_16x16x32_bf16 v[224:227], v[156:159], a[48:51], 0
v_exp_f32 v162, v162
v_mfma_f32_16x16x32_bf16 v[224:227], v[152:155], a[52:55], v[224:227]
v_fma_f32 v165, v165, s44, v20
v_exp_f32 v163, v163
v_mfma_f32_16x16x32_bf16 v[224:227], v[4:7], a[64:67], v[224:227]
v_fma_f32 v166, v166, s44, v20
v_cvt_pk_bf16_f32 v112, v160, v161
v_mfma_f32_16x16x32_bf16 v[232:235], v[156:159], a[56:59], 0
v_exp_f32 v164, v164
v_mfma_f32_16x16x32_bf16 v[232:235], v[152:155], a[60:63], v[232:235]
v_fma_f32 v167, v167, s44, v20
v_exp_f32 v165, v165
v_mfma_f32_16x16x32_bf16 v[232:235], v[4:7], a[72:75], v[232:235]
v_fma_f32 v168, v168, s44, v21
v_cvt_pk_bf16_f32 v113, v162, v163
v_mfma_f32_16x16x32_bf16 v[240:243], v[156:159], a[96:99], 0
v_exp_f32 v166, v166
v_mfma_f32_16x16x32_bf16 v[240:243], v[152:155], a[100:103], v[240:243]
v_fma_f32 v169, v169, s44, v21
v_exp_f32 v167, v167
v_mfma_f32_16x16x32_bf16 v[240:243], v[4:7], a[112:115], v[240:243]
v_fma_f32 v170, v170, s44, v21
v_cvt_pk_bf16_f32 v114, v164, v165
v_mfma_f32_16x16x32_bf16 v[248:251], v[156:159], a[104:107], 0
v_exp_f32 v168, v168
v_mfma_f32_16x16x32_bf16 v[248:251], v[152:155], a[108:111], v[248:251]
v_fma_f32 v171, v171, s44, v21
v_exp_f32 v169, v169
v_mfma_f32_16x16x32_bf16 v[248:251], v[4:7], a[120:123], v[248:251]
s_waitcnt lgkmcnt(2)
ds_read_b128 v[152:155], v17 offset:13312
v_fma_f32 v172, v172, s44, v21
v_cvt_pk_bf16_f32 v115, v166, v167
v_mfma_f32_16x16x32_bf16 v[212:215], v[140:143], a[0:3], 0
s_waitcnt lgkmcnt(2)
v_exp_f32 v170, v170
v_mfma_f32_16x16x32_bf16 v[212:215], v[28:31], a[4:7], v[212:215]
s_waitcnt lgkmcnt(1)
ds_read_b128 v[4:7], v16 offset:14336
v_fma_f32 v173, v173, s44, v21
v_exp_f32 v171, v171
v_mfma_f32_16x16x32_bf16 v[212:215], v[136:139], a[16:19], v[212:215]
s_add_u32 m0, s47, 37888
v_fma_f32 v174, v174, s44, v21
v_cvt_pk_bf16_f32 v116, v168, v169
v_mfma_f32_16x16x32_bf16 v[220:223], v[140:143], a[8:11], 0
s_add_u32 s50, s87, 3072
ds_read_b128 v[156:159], v17 offset:14336
v_exp_f32 v172, v172
v_mfma_f32_16x16x32_bf16 v[220:223], v[28:31], a[12:15], v[220:223]
buffer_load_dwordx4 v19, s[36:39], s50 offen nt lds
v_fma_f32 v175, v175, s44, v21
v_exp_f32 v173, v173
v_mfma_f32_16x16x32_bf16 v[220:223], v[136:139], a[24:27], v[220:223]
v_cvt_pk_bf16_f32 v117, v170, v171
v_exp_f32 v174, v174
v_mfma_f32_16x16x32_bf16 v[228:231], v[140:143], a[48:51], 0
v_exp_f32 v175, v175
v_mfma_f32_16x16x32_bf16 v[228:231], v[28:31], a[52:55], v[228:231]
v_cvt_pk_bf16_f32 v118, v172, v173
v_cvt_pk_bf16_f32 v119, v174, v175
v_mfma_f32_16x16x32_bf16 v[228:231], v[136:139], a[64:67], v[228:231]
v_fma_f32 v176, v176, s44, v22
v_fma_f32 v177, v177, s44, v22
v_mfma_f32_16x16x32_bf16 v[236:239], v[140:143], a[56:59], 0
v_fma_f32 v178, v178, s44, v22
v_exp_f32 v176, v176
v_mfma_f32_16x16x32_bf16 v[236:239], v[28:31], a[60:63], v[236:239]
v_fma_f32 v179, v179, s44, v22
v_exp_f32 v177, v177
v_mfma_f32_16x16x32_bf16 v[236:239], v[136:139], a[72:75], v[236:239]
v_fma_f32 v180, v180, s44, v22
v_mfma_f32_16x16x32_bf16 v[244:247], v[140:143], a[96:99], 0
v_exp_f32 v178, v178
v_mfma_f32_16x16x32_bf16 v[244:247], v[28:31], a[100:103], v[244:247]
v_fma_f32 v181, v181, s44, v22
v_exp_f32 v179, v179
v_mfma_f32_16x16x32_bf16 v[244:247], v[136:139], a[112:115], v[244:247]
v_fma_f32 v182, v182, s44, v22
v_cvt_pk_bf16_f32 v120, v176, v177
v_mfma_f32_16x16x32_bf16 v[252:255], v[140:143], a[104:107], 0
v_exp_f32 v180, v180
v_mfma_f32_16x16x32_bf16 v[252:255], v[28:31], a[108:111], v[252:255]
v_fma_f32 v183, v183, s44, v22
v_exp_f32 v181, v181
v_mfma_f32_16x16x32_bf16 v[252:255], v[136:139], a[120:123], v[252:255]
s_waitcnt lgkmcnt(2)
ds_read_b128 v[28:31], v17 offset:19456
v_fma_f32 v184, v184, s44, v23
v_cvt_pk_bf16_f32 v121, v178, v179
v_mfma_f32_16x16x32_bf16 v[208:211], v[152:155], a[20:23], v[208:211]
s_waitcnt lgkmcnt(2)
v_exp_f32 v182, v182
v_mfma_f32_16x16x32_bf16 v[208:211], v[4:7], a[32:35], v[208:211]
s_waitcnt lgkmcnt(1)
ds_read_b128 v[136:139], v16 offset:20480
v_fma_f32 v185, v185, s44, v23
v_exp_f32 v183, v183
v_mfma_f32_16x16x32_bf16 v[208:211], v[156:159], a[36:39], v[208:211]
s_add_u32 m0, s47, 38912
v_fma_f32 v186, v186, s44, v23
v_cvt_pk_bf16_f32 v122, v180, v181
v_mfma_f32_16x16x32_bf16 v[216:219], v[152:155], a[28:31], v[216:219]
s_add_u32 s50, s87, 6144
ds_read_b128 v[8:11], v17 offset:20480
v_exp_f32 v184, v184
v_mfma_f32_16x16x32_bf16 v[216:219], v[4:7], a[40:43], v[216:219]
buffer_load_dwordx4 v19, s[36:39], s50 offen nt lds
v_fma_f32 v187, v187, s44, v23
v_exp_f32 v185, v185
v_mfma_f32_16x16x32_bf16 v[216:219], v[156:159], a[44:47], v[216:219]
v_fma_f32 v188, v188, s44, v23
v_cvt_pk_bf16_f32 v123, v182, v183
v_mfma_f32_16x16x32_bf16 v[224:227], v[152:155], a[68:71], v[224:227]
v_exp_f32 v186, v186
v_mfma_f32_16x16x32_bf16 v[224:227], v[4:7], a[80:83], v[224:227]
v_fma_f32 v189, v189, s44, v23
v_exp_f32 v187, v187
v_mfma_f32_16x16x32_bf16 v[224:227], v[156:159], a[84:87], v[224:227]
v_fma_f32 v190, v190, s44, v23
v_cvt_pk_bf16_f32 v124, v184, v185
v_mfma_f32_16x16x32_bf16 v[232:235], v[152:155], a[76:79], v[232:235]
v_exp_f32 v188, v188
v_mfma_f32_16x16x32_bf16 v[232:235], v[4:7], a[88:91], v[232:235]
v_fma_f32 v191, v191, s44, v23
v_exp_f32 v189, v189
v_mfma_f32_16x16x32_bf16 v[232:235], v[156:159], a[92:95], v[232:235]
v_cvt_pk_bf16_f32 v125, v186, v187
v_exp_f32 v190, v190
v_mfma_f32_16x16x32_bf16 v[240:243], v[152:155], a[116:119], v[240:243]
v_exp_f32 v191, v191
v_mfma_f32_16x16x32_bf16 v[240:243], v[4:7], a[128:131], v[240:243]
v_cvt_pk_bf16_f32 v126, v188, v189
v_cvt_pk_bf16_f32 v127, v190, v191
v_mfma_f32_16x16x32_bf16 v[240:243], v[156:159], a[132:135], v[240:243]
v_fma_f32 v192, v192, s44, v24
v_fma_f32 v193, v193, s44, v24
v_mfma_f32_16x16x32_bf16 v[248:251], v[152:155], a[124:127], v[248:251]
v_fma_f32 v194, v194, s44, v24
v_exp_f32 v192, v192
v_mfma_f32_16x16x32_bf16 v[248:251], v[4:7], a[136:139], v[248:251]
v_fma_f32 v195, v195, s44, v24
v_exp_f32 v193, v193
v_mfma_f32_16x16x32_bf16 v[248:251], v[156:159], a[140:143], v[248:251]
s_waitcnt vmcnt(12) lgkmcnt(2)
s_barrier
v_fma_f32 v196, v196, s44, v24
v_mfma_f32_16x16x32_bf16 v[212:215], v[28:31], a[20:23], v[212:215]
s_waitcnt lgkmcnt(1)
v_exp_f32 v194, v194
v_mfma_f32_16x16x32_bf16 v[212:215], v[136:139], a[32:35], v[212:215]
s_waitcnt lgkmcnt(0)
ds_read_b128 v[156:159], v16 offset:24576
v_fma_f32 v197, v197, s44, v24
v_exp_f32 v195, v195
v_mfma_f32_16x16x32_bf16 v[212:215], v[8:11], a[36:39], v[212:215]
s_add_u32 m0, s47, 24576
ds_read_b128 v[4:7], v17 offset:24576
v_fma_f32 v198, v198, s44, v24
v_cvt_pk_bf16_f32 v128, v192, v193
v_mfma_f32_16x16x32_bf16 v[220:223], v[28:31], a[28:31], v[220:223]
s_add_u32 s50, s86, 0
buffer_load_dwordx4 v19, s[36:39], s50 offen nt lds
v_exp_f32 v196, v196
v_mfma_f32_16x16x32_bf16 v[220:223], v[136:139], a[40:43], v[220:223]
v_fma_f32 v199, v199, s44, v24
v_exp_f32 v197, v197
v_mfma_f32_16x16x32_bf16 v[220:223], v[8:11], a[44:47], v[220:223]
v_fma_f32 v200, v200, s44, v25
v_cvt_pk_bf16_f32 v129, v194, v195
v_mfma_f32_16x16x32_bf16 v[228:231], v[28:31], a[68:71], v[228:231]
v_exp_f32 v198, v198
v_mfma_f32_16x16x32_bf16 v[228:231], v[136:139], a[80:83], v[228:231]
v_fma_f32 v201, v201, s44, v25
v_exp_f32 v199, v199
v_mfma_f32_16x16x32_bf16 v[228:231], v[8:11], a[84:87], v[228:231]
v_fma_f32 v202, v202, s44, v25
v_cvt_pk_bf16_f32 v130, v196, v197
v_mfma_f32_16x16x32_bf16 v[236:239], v[28:31], a[76:79], v[236:239]
v_exp_f32 v200, v200
v_mfma_f32_16x16x32_bf16 v[236:239], v[136:139], a[88:91], v[236:239]
v_fma_f32 v203, v203, s44, v25
v_exp_f32 v201, v201
v_mfma_f32_16x16x32_bf16 v[236:239], v[8:11], a[92:95], v[236:239]
v_fma_f32 v204, v204, s44, v25
v_cvt_pk_bf16_f32 v131, v198, v199
v_mfma_f32_16x16x32_bf16 v[244:247], v[28:31], a[116:119], v[244:247]
v_exp_f32 v202, v202
v_mfma_f32_16x16x32_bf16 v[244:247], v[136:139], a[128:131], v[244:247]
ds_read_b128 v[152:155], v16 offset:30720
v_fma_f32 v205, v205, s44, v25
v_exp_f32 v203, v203
v_mfma_f32_16x16x32_bf16 v[244:247], v[8:11], a[132:135], v[244:247]
ds_read_b128 v[0:3], v17 offset:30720
v_fma_f32 v206, v206, s44, v25
v_cvt_pk_bf16_f32 v132, v200, v201
v_mfma_f32_16x16x32_bf16 v[252:255], v[28:31], a[124:127], v[252:255]
v_exp_f32 v204, v204
v_mfma_f32_16x16x32_bf16 v[252:255], v[136:139], a[136:139], v[252:255]
v_fma_f32 v207, v207, s44, v25
v_exp_f32 v205, v205
v_mfma_f32_16x16x32_bf16 v[252:255], v[8:11], a[140:143], v[252:255]
s_waitcnt lgkmcnt(3)
v_cvt_pk_bf16_f32 v133, v202, v203
v_exp_f32 v206, v206
v_mfma_f32_16x16x32_bf16 v[160:163], v[156:159], a[0:3], 0
s_waitcnt lgkmcnt(2)
v_exp_f32 v207, v207
v_mfma_f32_16x16x32_bf16 v[160:163], v[4:7], a[4:7], v[160:163]
s_add_u32 m0, s47, 25600
v_cvt_pk_bf16_f32 v134, v204, v205
v_cvt_pk_bf16_f32 v135, v206, v207
v_mfma_f32_16x16x32_bf16 v[168:171], v[156:159], a[8:11], 0
s_add_u32 s50, s86, 3072
buffer_load_dwordx4 v19, s[36:39], s50 offen nt lds
v_fma_f32 v208, v208, s44, v20
v_fma_f32 v209, v209, s44, v20
v_mfma_f32_16x16x32_bf16 v[168:171], v[4:7], a[12:15], v[168:171]
v_fma_f32 v210, v210, s44, v20
v_exp_f32 v208, v208
v_mfma_f32_16x16x32_bf16 v[176:179], v[156:159], a[48:51], 0
v_fma_f32 v211, v211, s44, v20
v_exp_f32 v209, v209
v_mfma_f32_16x16x32_bf16 v[176:179], v[4:7], a[52:55], v[176:179]
v_fma_f32 v212, v212, s44, v20
v_mfma_f32_16x16x32_bf16 v[184:187], v[156:159], a[56:59], 0
v_exp_f32 v210, v210
v_mfma_f32_16x16x32_bf16 v[184:187], v[4:7], a[60:63], v[184:187]
ds_read_b128 v[8:11], v16 offset:25600
v_fma_f32 v213, v213, s44, v20
v_exp_f32 v211, v211
v_mfma_f32_16x16x32_bf16 v[192:195], v[156:159], a[96:99], 0
ds_read_b128 v[28:31], v17 offset:25600
v_fma_f32 v214, v214, s44, v20
v_cvt_pk_bf16_f32 v136, v208, v209
v_mfma_f32_16x16x32_bf16 v[192:195], v[4:7], a[100:103], v[192:195]
v_exp_f32 v212, v212
v_mfma_f32_16x16x32_bf16 v[200:203], v[156:159], a[104:107], 0
v_fma_f32 v215, v215, s44, v20
v_exp_f32 v213, v213
v_mfma_f32_16x16x32_bf16 v[200:203], v[4:7], a[108:111], v[200:203]
s_waitcnt lgkmcnt(3)
v_fma_f32 v216, v216, s44, v21
v_cvt_pk_bf16_f32 v137, v210, v211
v_mfma_f32_16x16x32_bf16 v[164:167], v[152:155], a[0:3], 0
s_waitcnt lgkmcnt(2)
v_exp_f32 v214, v214
v_mfma_f32_16x16x32_bf16 v[164:167], v[0:3], a[4:7], v[164:167]
v_fma_f32 v217, v217, s44, v21
v_exp_f32 v215, v215
v_mfma_f32_16x16x32_bf16 v[172:175], v[152:155], a[8:11], 0
v_fma_f32 v218, v218, s44, v21
v_cvt_pk_bf16_f32 v138, v212, v213
v_mfma_f32_16x16x32_bf16 v[172:175], v[0:3], a[12:15], v[172:175]
v_exp_f32 v216, v216
v_mfma_f32_16x16x32_bf16 v[180:183], v[152:155], a[48:51], 0
v_fma_f32 v219, v219, s44, v21
v_exp_f32 v217, v217
v_mfma_f32_16x16x32_bf16 v[180:183], v[0:3], a[52:55], v[180:183]
v_fma_f32 v220, v220, s44, v21
v_cvt_pk_bf16_f32 v139, v214, v215
v_mfma_f32_16x16x32_bf16 v[188:191], v[152:155], a[56:59], 0
s_add_u32 m0, s47, 26624
v_exp_f32 v218, v218
v_mfma_f32_16x16x32_bf16 v[188:191], v[0:3], a[60:63], v[188:191]
s_add_u32 s50, s86, 6144
ds_read_b128 v[4:7], v16 offset:31744
v_fma_f32 v221, v221, s44, v21
v_exp_f32 v219, v219
v_mfma_f32_16x16x32_bf16 v[196:199], v[152:155], a[96:99], 0
ds_read_b128 v[12:15], v17 offset:31744
v_fma_f32 v222, v222, s44, v21
v_cvt_pk_bf16_f32 v140, v216, v217
v_mfma_f32_16x16x32_bf16 v[196:199], v[0:3], a[100:103], v[196:199]
buffer_load_dwordx4 v19, s[36:39], s50 offen nt lds
v_exp_f32 v220, v220
v_mfma_f32_16x16x32_bf16 v[204:207], v[152:155], a[104:107], 0
v_fma_f32 v223, v223, s44, v21
v_exp_f32 v221, v221
v_mfma_f32_16x16x32_bf16 v[204:207], v[0:3], a[108:111], v[204:207]
s_waitcnt lgkmcnt(3)
v_cvt_pk_bf16_f32 v141, v218, v219
v_exp_f32 v222, v222
v_mfma_f32_16x16x32_bf16 v[160:163], v[8:11], a[16:19], v[160:163]
s_waitcnt lgkmcnt(2)
v_exp_f32 v223, v223
v_mfma_f32_16x16x32_bf16 v[160:163], v[28:31], a[20:23], v[160:163]
v_cvt_pk_bf16_f32 v142, v220, v221
v_cvt_pk_bf16_f32 v143, v222, v223
v_mfma_f32_16x16x32_bf16 v[168:171], v[8:11], a[24:27], v[168:171]
v_fma_f32 v224, v224, s44, v22
v_fma_f32 v225, v225, s44, v22
v_mfma_f32_16x16x32_bf16 v[168:171], v[28:31], a[28:31], v[168:171]
v_fma_f32 v226, v226, s44, v22
v_exp_f32 v224, v224
v_mfma_f32_16x16x32_bf16 v[176:179], v[8:11], a[64:67], v[176:179]
v_fma_f32 v227, v227, s44, v22
v_exp_f32 v225, v225
v_mfma_f32_16x16x32_bf16 v[176:179], v[28:31], a[68:71], v[176:179]
v_fma_f32 v228, v228, s44, v22
v_mfma_f32_16x16x32_bf16 v[184:187], v[8:11], a[72:75], v[184:187]
v_exp_f32 v226, v226
v_mfma_f32_16x16x32_bf16 v[184:187], v[28:31], a[76:79], v[184:187]
ds_read_b128 v[0:3], v16 offset:26624
v_fma_f32 v229, v229, s44, v22
v_exp_f32 v227, v227
v_mfma_f32_16x16x32_bf16 v[192:195], v[8:11], a[112:115], v[192:195]
v_fma_f32 v230, v230, s44, v22
v_cvt_pk_bf16_f32 v144, v224, v225
v_mfma_f32_16x16x32_bf16 v[192:195], v[28:31], a[116:119], v[192:195]
v_exp_f32 v228, v228
v_mfma_f32_16x16x32_bf16 v[200:203], v[8:11], a[120:123], v[200:203]
ds_read_b128 v[8:11], v17 offset:26624
v_fma_f32 v231, v231, s44, v22
v_exp_f32 v229, v229
v_mfma_f32_16x16x32_bf16 v[200:203], v[28:31], a[124:127], v[200:203]
s_waitcnt lgkmcnt(3)
v_fma_f32 v232, v232, s44, v23
v_cvt_pk_bf16_f32 v145, v226, v227
v_mfma_f32_16x16x32_bf16 v[164:167], v[4:7], a[16:19], v[164:167]
s_waitcnt lgkmcnt(2)
v_exp_f32 v230, v230
v_mfma_f32_16x16x32_bf16 v[164:167], v[12:15], a[20:23], v[164:167]
s_add_u32 m0, s47, 86016
v_fma_f32 v233, v233, s44, v23
v_exp_f32 v231, v231
v_mfma_f32_16x16x32_bf16 v[172:175], v[4:7], a[24:27], v[172:175]
s_add_u32 s50, s87, 128
buffer_load_dwordx4 v19, s[36:39], s50 offen nt lds
v_fma_f32 v234, v234, s44, v23
v_cvt_pk_bf16_f32 v146, v228, v229
v_mfma_f32_16x16x32_bf16 v[172:175], v[12:15], a[28:31], v[172:175]
v_exp_f32 v232, v232
v_mfma_f32_16x16x32_bf16 v[180:183], v[4:7], a[64:67], v[180:183]
v_fma_f32 v235, v235, s44, v23
v_exp_f32 v233, v233
v_mfma_f32_16x16x32_bf16 v[180:183], v[12:15], a[68:71], v[180:183]
v_fma_f32 v236, v236, s44, v23
v_cvt_pk_bf16_f32 v147, v230, v231
v_mfma_f32_16x16x32_bf16 v[188:191], v[4:7], a[72:75], v[188:191]
v_exp_f32 v234, v234
v_mfma_f32_16x16x32_bf16 v[188:191], v[12:15], a[76:79], v[188:191]
ds_read_b128 v[28:31], v16 offset:32768
v_fma_f32 v237, v237, s44, v23
v_exp_f32 v235, v235
v_mfma_f32_16x16x32_bf16 v[196:199], v[4:7], a[112:115], v[196:199]
v_fma_f32 v238, v238, s44, v23
v_cvt_pk_bf16_f32 v148, v232, v233
v_mfma_f32_16x16x32_bf16 v[196:199], v[12:15], a[116:119], v[196:199]
v_exp_f32 v236, v236
v_mfma_f32_16x16x32_bf16 v[204:207], v[4:7], a[120:123], v[204:207]
ds_read_b128 v[4:7], v17 offset:32768
v_fma_f32 v239, v239, s44, v23
v_exp_f32 v237, v237
v_mfma_f32_16x16x32_bf16 v[204:207], v[12:15], a[124:127], v[204:207]
s_waitcnt lgkmcnt(3)
v_cvt_pk_bf16_f32 v149, v234, v235
v_exp_f32 v238, v238
v_mfma_f32_16x16x32_bf16 v[160:163], v[0:3], a[32:35], v[160:163]
s_waitcnt lgkmcnt(2)
v_exp_f32 v239, v239
v_mfma_f32_16x16x32_bf16 v[160:163], v[8:11], a[36:39], v[160:163]
v_cvt_pk_bf16_f32 v150, v236, v237
v_cvt_pk_bf16_f32 v151, v238, v239
v_mfma_f32_16x16x32_bf16 v[168:171], v[0:3], a[40:43], v[168:171]
v_fma_f32 v240, v240, s44, v24
v_fma_f32 v241, v241, s44, v24
v_mfma_f32_16x16x32_bf16 v[168:171], v[8:11], a[44:47], v[168:171]
v_fma_f32 v242, v242, s44, v24
v_exp_f32 v240, v240
v_mfma_f32_16x16x32_bf16 v[176:179], v[0:3], a[80:83], v[176:179]
v_fma_f32 v243, v243, s44, v24
v_exp_f32 v241, v241
v_mfma_f32_16x16x32_bf16 v[176:179], v[8:11], a[84:87], v[176:179]
s_waitcnt vmcnt(13)
s_barrier
v_fma_f32 v244, v244, s44, v24
v_mfma_f32_16x16x32_bf16 v[184:187], v[0:3], a[88:91], v[184:187]
s_add_u32 m0, s47, 87040
v_exp_f32 v242, v242
v_mfma_f32_16x16x32_bf16 v[184:187], v[8:11], a[92:95], v[184:187]
s_add_u32 s50, s87, 3200
ds_read_b128 v[12:15], v16 offset:36864
v_fma_f32 v245, v245, s44, v24
v_exp_f32 v243, v243
v_mfma_f32_16x16x32_bf16 v[192:195], v[0:3], a[128:131], v[192:195]
buffer_load_dwordx4 v19, s[36:39], s50 offen nt lds
v_fma_f32 v246, v246, s44, v24
v_cvt_pk_bf16_f32 v152, v240, v241
v_mfma_f32_16x16x32_bf16 v[192:195], v[8:11], a[132:135], v[192:195]
v_exp_f32 v244, v244
v_mfma_f32_16x16x32_bf16 v[200:203], v[0:3], a[136:139], v[200:203]
ds_read_b128 v[0:3], v17 offset:36864
v_fma_f32 v247, v247, s44, v24
v_exp_f32 v245, v245
v_mfma_f32_16x16x32_bf16 v[200:203], v[8:11], a[140:143], v[200:203]
s_waitcnt lgkmcnt(3)
v_fma_f32 v248, v248, s44, v25
v_cvt_pk_bf16_f32 v153, v242, v243
v_mfma_f32_16x16x32_bf16 v[164:167], v[28:31], a[32:35], v[164:167]
s_waitcnt lgkmcnt(2)
v_exp_f32 v246, v246
v_mfma_f32_16x16x32_bf16 v[164:167], v[4:7], a[36:39], v[164:167]
v_fma_f32 v249, v249, s44, v25
v_exp_f32 v247, v247
v_mfma_f32_16x16x32_bf16 v[172:175], v[28:31], a[40:43], v[172:175]
v_fma_f32 v250, v250, s44, v25
v_cvt_pk_bf16_f32 v154, v244, v245
v_mfma_f32_16x16x32_bf16 v[172:175], v[4:7], a[44:47], v[172:175]
v_exp_f32 v248, v248
v_mfma_f32_16x16x32_bf16 v[180:183], v[28:31], a[80:83], v[180:183]
v_fma_f32 v251, v251, s44, v25
v_exp_f32 v249, v249
v_mfma_f32_16x16x32_bf16 v[180:183], v[4:7], a[84:87], v[180:183]
v_fma_f32 v252, v252, s44, v25
v_cvt_pk_bf16_f32 v155, v246, v247
v_mfma_f32_16x16x32_bf16 v[188:191], v[28:31], a[88:91], v[188:191]
v_exp_f32 v250, v250
v_mfma_f32_16x16x32_bf16 v[188:191], v[4:7], a[92:95], v[188:191]
ds_read_b128 v[8:11], v16 offset:43008
v_fma_f32 v253, v253, s44, v25
v_exp_f32 v251, v251
v_mfma_f32_16x16x32_bf16 v[196:199], v[28:31], a[128:131], v[196:199]
v_fma_f32 v254, v254, s44, v25
v_cvt_pk_bf16_f32 v156, v248, v249
v_mfma_f32_16x16x32_bf16 v[196:199], v[4:7], a[132:135], v[196:199]
v_exp_f32 v252, v252
v_mfma_f32_16x16x32_bf16 v[204:207], v[28:31], a[136:139], v[204:207]
ds_read_b128 v[28:31], v17 offset:43008
v_fma_f32 v255, v255, s44, v25
v_exp_f32 v253, v253
v_mfma_f32_16x16x32_bf16 v[204:207], v[4:7], a[140:143], v[204:207]
s_waitcnt lgkmcnt(3)
v_cvt_pk_bf16_f32 v157, v250, v251
v_exp_f32 v254, v254
v_mfma_f32_16x16x32_bf16 v[208:211], v[12:15], a[0:3], 0
s_waitcnt lgkmcnt(2)
v_exp_f32 v255, v255
v_mfma_f32_16x16x32_bf16 v[208:211], v[0:3], a[4:7], v[208:211]
s_add_u32 m0, s47, 88064
v_cvt_pk_bf16_f32 v158, v252, v253
v_cvt_pk_bf16_f32 v159, v254, v255
v_mfma_f32_16x16x32_bf16 v[216:219], v[12:15], a[8:11], 0
s_add_u32 s50, s87, 6272
buffer_load_dwordx4 v19, s[36:39], s50 offen nt lds
v_fma_f32 v160, v160, s44, v20
v_mfma_f32_16x16x32_bf16 v[216:219], v[0:3], a[12:15], v[216:219]
v_fma_f32 v161, v161, s44, v20
v_fma_f32 v162, v162, s44, v20
v_mfma_f32_16x16x32_bf16 v[224:227], v[12:15], a[48:51], 0
v_exp_f32 v160, v160
v_mfma_f32_16x16x32_bf16 v[224:227], v[0:3], a[52:55], v[224:227]
v_fma_f32 v163, v163, s44, v20
v_mfma_f32_16x16x32_bf16 v[232:235], v[12:15], a[56:59], 0
v_exp_f32 v161, v161
v_mfma_f32_16x16x32_bf16 v[232:235], v[0:3], a[60:63], v[232:235]
ds_read_b128 v[4:7], v16 offset:37888
v_fma_f32 v164, v164, s44, v20
v_mfma_f32_16x16x32_bf16 v[240:243], v[12:15], a[96:99], 0
v_exp_f32 v162, v162
v_mfma_f32_16x16x32_bf16 v[240:243], v[0:3], a[100:103], v[240:243]
v_fma_f32 v165, v165, s44, v20
v_mfma_f32_16x16x32_bf16 v[248:251], v[12:15], a[104:107], 0
ds_read_b128 v[12:15], v17 offset:37888
v_exp_f32 v163, v163
v_mfma_f32_16x16x32_bf16 v[248:251], v[0:3], a[108:111], v[248:251]
s_waitcnt lgkmcnt(3)
v_fma_f32 v166, v166, s44, v20
v_mfma_f32_16x16x32_bf16 v[212:215], v[8:11], a[0:3], 0
s_waitcnt lgkmcnt(2)
v_cvt_pk_bf16_f32 v160, v160, v161
v_exp_f32 v164, v164
v_mfma_f32_16x16x32_bf16 v[212:215], v[28:31], a[4:7], v[212:215]
v_mfma_f32_16x16x32_bf16 v[220:223], v[8:11], a[8:11], 0
v_fma_f32 v167, v167, s44, v20
v_exp_f32 v165, v165
v_mfma_f32_16x16x32_bf16 v[220:223], v[28:31], a[12:15], v[220:223]
v_mfma_f32_16x16x32_bf16 v[228:231], v[8:11], a[48:51], 0
v_fma_f32 v168, v168, s44, v21
v_cvt_pk_bf16_f32 v161, v162, v163
v_mfma_f32_16x16x32_bf16 v[228:231], v[28:31], a[52:55], v[228:231]
v_exp_f32 v166, v166
v_mfma_f32_16x16x32_bf16 v[236:239], v[8:11], a[56:59], 0
s_add_u32 m0, s47, 73728
v_fma_f32 v169, v169, s44, v21
v_mfma_f32_16x16x32_bf16 v[236:239], v[28:31], a[60:63], v[236:239]
s_add_u32 s50, s86, 128
ds_read_b128 v[0:3], v16 offset:44032
v_exp_f32 v167, v167
v_mfma_f32_16x16x32_bf16 v[244:247], v[8:11], a[96:99], 0
buffer_load_dwordx4 v19, s[36:39], s50 offen nt lds
v_fma_f32 v170, v170, s44, v21
v_mfma_f32_16x16x32_bf16 v[244:247], v[28:31], a[100:103], v[244:247]
v_cvt_pk_bf16_f32 v162, v164, v165
v_exp_f32 v168, v168
v_mfma_f32_16x16x32_bf16 v[252:255], v[8:11], a[104:107], 0
ds_read_b128 v[8:11], v17 offset:44032
v_mfma_f32_16x16x32_bf16 v[252:255], v[28:31], a[108:111], v[252:255]
s_waitcnt lgkmcnt(3)
v_fma_f32 v171, v171, s44, v21
v_exp_f32 v169, v169
v_mfma_f32_16x16x32_bf16 v[208:211], v[4:7], a[16:19], v[208:211]
s_waitcnt lgkmcnt(2)
v_mfma_f32_16x16x32_bf16 v[208:211], v[12:15], a[20:23], v[208:211]
v_fma_f32 v172, v172, s44, v21
v_cvt_pk_bf16_f32 v163, v166, v167
v_mfma_f32_16x16x32_bf16 v[216:219], v[4:7], a[24:27], v[216:219]
v_exp_f32 v170, v170
v_mfma_f32_16x16x32_bf16 v[216:219], v[12:15], a[28:31], v[216:219]
v_fma_f32 v173, v173, s44, v21
v_mfma_f32_16x16x32_bf16 v[224:227], v[4:7], a[64:67], v[224:227]
v_exp_f32 v171, v171
v_mfma_f32_16x16x32_bf16 v[224:227], v[12:15], a[68:71], v[224:227]
v_fma_f32 v174, v174, s44, v21
v_mfma_f32_16x16x32_bf16 v[232:235], v[4:7], a[72:75], v[232:235]
v_cvt_pk_bf16_f32 v164, v168, v169
v_mfma_f32_16x16x32_bf16 v[232:235], v[12:15], a[76:79], v[232:235]
ds_read_b128 v[28:31], v16 offset:38912
v_exp_f32 v172, v172
v_mfma_f32_16x16x32_bf16 v[240:243], v[4:7], a[112:115], v[240:243]
v_fma_f32 v175, v175, s44, v21
v_mfma_f32_16x16x32_bf16 v[240:243], v[12:15], a[116:119], v[240:243]
v_exp_f32 v173, v173
v_mfma_f32_16x16x32_bf16 v[248:251], v[4:7], a[120:123], v[248:251]
ds_read_b128 v[4:7], v17 offset:38912
v_cvt_pk_bf16_f32 v165, v170, v171
v_mfma_f32_16x16x32_bf16 v[248:251], v[12:15], a[124:127], v[248:251]
s_waitcnt lgkmcnt(3)
v_exp_f32 v174, v174
v_mfma_f32_16x16x32_bf16 v[212:215], v[0:3], a[16:19], v[212:215]
s_waitcnt lgkmcnt(2)
v_exp_f32 v175, v175
v_mfma_f32_16x16x32_bf16 v[212:215], v[8:11], a[20:23], v[212:215]
s_add_u32 m0, s47, 74752
v_cvt_pk_bf16_f32 v166, v172, v173
v_mfma_f32_16x16x32_bf16 v[220:223], v[0:3], a[24:27], v[220:223]
s_add_u32 s50, s86, 3200
buffer_load_dwordx4 v19, s[36:39], s50 offen nt lds
v_cvt_pk_bf16_f32 v167, v174, v175
v_fma_f32 v176, v176, s44, v22
v_mfma_f32_16x16x32_bf16 v[220:223], v[8:11], a[28:31], v[220:223]
v_fma_f32 v177, v177, s44, v22
v_mfma_f32_16x16x32_bf16 v[228:231], v[0:3], a[64:67], v[228:231]
v_fma_f32 v178, v178, s44, v22
v_exp_f32 v176, v176
v_mfma_f32_16x16x32_bf16 v[228:231], v[8:11], a[68:71], v[228:231]
v_mfma_f32_16x16x32_bf16 v[236:239], v[0:3], a[72:75], v[236:239]
v_fma_f32 v179, v179, s44, v22
v_exp_f32 v177, v177
v_mfma_f32_16x16x32_bf16 v[236:239], v[8:11], a[76:79], v[236:239]
ds_read_b128 v[12:15], v16 offset:45056
v_mfma_f32_16x16x32_bf16 v[244:247], v[0:3], a[112:115], v[244:247]
v_fma_f32 v180, v180, s44, v22
v_exp_f32 v178, v178
v_mfma_f32_16x16x32_bf16 v[244:247], v[8:11], a[116:119], v[244:247]
v_mfma_f32_16x16x32_bf16 v[252:255], v[0:3], a[120:123], v[252:255]
ds_read_b128 v[0:3], v17 offset:45056
v_fma_f32 v181, v181, s44, v22
v_exp_f32 v179, v179
v_mfma_f32_16x16x32_bf16 v[252:255], v[8:11], a[124:127], v[252:255]
s_waitcnt lgkmcnt(3)
v_mfma_f32_16x16x32_bf16 v[208:211], v[28:31], a[32:35], v[208:211]
s_waitcnt lgkmcnt(2)
v_fma_f32 v182, v182, s44, v22
v_cvt_pk_bf16_f32 v168, v176, v177
v_mfma_f32_16x16x32_bf16 v[208:211], v[4:7], a[36:39], v[208:211]
v_exp_f32 v180, v180
v_mfma_f32_16x16x32_bf16 v[216:219], v[28:31], a[40:43], v[216:219]
v_fma_f32 v183, v183, s44, v22
v_mfma_f32_16x16x32_bf16 v[216:219], v[4:7], a[44:47], v[216:219]
v_exp_f32 v181, v181
v_mfma_f32_16x16x32_bf16 v[224:227], v[28:31], a[80:83], v[224:227]
v_fma_f32 v184, v184, s44, v23
v_mfma_f32_16x16x32_bf16 v[224:227], v[4:7], a[84:87], v[224:227]
v_cvt_pk_bf16_f32 v169, v178, v179
v_exp_f32 v182, v182
v_mfma_f32_16x16x32_bf16 v[232:235], v[28:31], a[88:91], v[232:235]
s_add_u32 m0, s47, 75776
v_mfma_f32_16x16x32_bf16 v[232:235], v[4:7], a[92:95], v[232:235]
s_add_u32 s50, s86, 6272
v_fma_f32 v185, v185, s44, v23
v_exp_f32 v183, v183
v_mfma_f32_16x16x32_bf16 v[240:243], v[28:31], a[128:131], v[240:243]
buffer_load_dwordx4 v19, s[36:39], s50 offen nt lds
v_mfma_f32_16x16x32_bf16 v[240:243], v[4:7], a[132:135], v[240:243]
v_fma_f32 v186, v186, s44, v23
v_cvt_pk_bf16_f32 v170, v180, v181
v_mfma_f32_16x16x32_bf16 v[248:251], v[28:31], a[136:139], v[248:251]
v_exp_f32 v184, v184
v_mfma_f32_16x16x32_bf16 v[248:251], v[4:7], a[140:143], v[248:251]
s_waitcnt lgkmcnt(1)
v_fma_f32 v187, v187, s44, v23
v_mfma_f32_16x16x32_bf16 v[212:215], v[12:15], a[32:35], v[212:215]
s_waitcnt lgkmcnt(0)
v_exp_f32 v185, v185
v_mfma_f32_16x16x32_bf16 v[212:215], v[0:3], a[36:39], v[212:215]
v_fma_f32 v188, v188, s44, v23
v_mfma_f32_16x16x32_bf16 v[220:223], v[12:15], a[40:43], v[220:223]
v_cvt_pk_bf16_f32 v171, v182, v183
v_mfma_f32_16x16x32_bf16 v[220:223], v[0:3], a[44:47], v[220:223]
v_mbcnt_lo_u32_b32 v27, -1, 0
v_exp_f32 v186, v186
v_mfma_f32_16x16x32_bf16 v[228:231], v[12:15], a[80:83], v[228:231]
v_mbcnt_hi_u32_b32 v27, -1, v27
v_mov_b32 v28, 0x3f803f80
v_fma_f32 v189, v189, s44, v23
v_mfma_f32_16x16x32_bf16 v[228:231], v[0:3], a[84:87], v[228:231]
v_lshrrev_b32 v26, 5, v27
v_mov_b32 v29, 0x3f803f80
v_exp_f32 v187, v187
v_mfma_f32_16x16x32_bf16 v[236:239], v[12:15], a[88:91], v[236:239]
v_lshlrev_b32 v26, 10, v26
v_mov_b32 v30, 0x3f803f80
v_fma_f32 v190, v190, s44, v23
v_cvt_pk_bf16_f32 v172, v184, v185
v_mfma_f32_16x16x32_bf16 v[236:239], v[0:3], a[92:95], v[236:239]
v_and_b32 v27, 31, v27
v_mov_b32 v31, 0x3f803f80
v_exp_f32 v188, v188
v_mfma_f32_16x16x32_bf16 v[244:247], v[12:15], a[128:131], v[244:247]
v_lshl_add_u32 v26, v27, 3, v26
v_fma_f32 v191, v191, s44, v23
v_mfma_f32_16x16x32_bf16 v[244:247], v[0:3], a[132:135], v[244:247]
v_exp_f32 v189, v189
v_mfma_f32_16x16x32_bf16 v[252:255], v[12:15], a[136:139], v[252:255]
s_waitcnt vmcnt(12)
s_barrier
v_cvt_pk_bf16_f32 v173, v186, v187
v_mfma_f32_16x16x32_bf16 v[252:255], v[0:3], a[140:143], v[252:255]
v_exp_f32 v190, v190
v_mfma_f32_16x16x32_bf16 a[120:123], v[28:31], a[144:147], 0
s_add_u32 m0, s47, 61440
ds_read_b64_tr_b16 v[0:1], v26 offset:0
v_mfma_f32_16x16x32_bf16 a[120:123], v[28:31], a[168:171], a[120:123]
s_add_u32 s50, s85, 128
ds_read_b64_tr_b16 v[2:3], v26 offset:2048
v_mfma_f32_16x16x32_bf16 a[124:127], v[28:31], a[148:151], 0
ds_read_b64_tr_b16 v[12:13], v26 offset:4096
v_mfma_f32_16x16x32_bf16 a[124:127], v[28:31], a[172:175], a[124:127]
ds_read_b64_tr_b16 v[14:15], v26 offset:6144
v_mfma_f32_16x16x32_bf16 a[128:131], v[28:31], a[152:155], 0
buffer_load_dwordx4 v19, s[36:39], s50 offen nt lds
v_mfma_f32_16x16x32_bf16 a[128:131], v[28:31], a[176:179], a[128:131]
v_exp_f32 v191, v191
v_mfma_f32_16x16x32_bf16 a[132:135], v[28:31], a[156:159], 0
v_cvt_pk_bf16_f32 v174, v188, v189
v_cvt_pk_bf16_f32 v175, v190, v191
v_mfma_f32_16x16x32_bf16 a[132:135], v[28:31], a[180:183], a[132:135]
v_fma_f32 v192, v192, s44, v24
v_fma_f32 v193, v193, s44, v24
v_mfma_f32_16x16x32_bf16 a[136:139], v[28:31], a[160:163], 0
v_fma_f32 v194, v194, s44, v24
v_mfma_f32_16x16x32_bf16 a[136:139], v[28:31], a[184:187], a[136:139]
v_exp_f32 v192, v192
v_mfma_f32_16x16x32_bf16 a[140:143], v[28:31], a[164:167], 0
v_fma_f32 v195, v195, s44, v24
v_mfma_f32_16x16x32_bf16 a[140:143], v[28:31], a[188:191], a[140:143]
s_waitcnt lgkmcnt(2)
v_exp_f32 v193, v193
v_mfma_f32_16x16x32_bf16 a[48:51], v[0:3], a[144:147], 0
s_waitcnt lgkmcnt(0)
ds_read_b64_tr_b16 v[4:5], v26 offset:256
v_fma_f32 v196, v196, s44, v24
v_mfma_f32_16x16x32_bf16 a[48:51], v[12:15], a[168:171], a[48:51]
ds_read_b64_tr_b16 v[6:7], v26 offset:2304
v_mfma_f32_16x16x32_bf16 a[56:59], v[0:3], a[148:151], 0
s_add_u32 m0, s47, 62464
ds_read_b64_tr_b16 v[8:9], v26 offset:4352
v_mfma_f32_16x16x32_bf16 a[56:59], v[12:15], a[172:175], a[56:59]
s_add_u32 s50, s85, 3200
ds_read_b64_tr_b16 v[10:11], v26 offset:6400
v_mfma_f32_16x16x32_bf16 a[64:67], v[0:3], a[152:155], 0
buffer_load_dwordx4 v19, s[36:39], s50 offen nt lds
v_exp_f32 v194, v194
v_mfma_f32_16x16x32_bf16 a[64:67], v[12:15], a[176:179], a[64:67]
v_fma_f32 v197, v197, s44, v24
v_mfma_f32_16x16x32_bf16 a[72:75], v[0:3], a[156:159], 0
v_exp_f32 v195, v195
v_mfma_f32_16x16x32_bf16 a[72:75], v[12:15], a[180:183], a[72:75]
v_fma_f32 v198, v198, s44, v24
v_cvt_pk_bf16_f32 v176, v192, v193
v_mfma_f32_16x16x32_bf16 a[80:83], v[0:3], a[160:163], 0
v_exp_f32 v196, v196
v_mfma_f32_16x16x32_bf16 a[80:83], v[12:15], a[184:187], a[80:83]
v_fma_f32 v199, v199, s44, v24
v_mfma_f32_16x16x32_bf16 a[88:91], v[0:3], a[164:167], 0
v_exp_f32 v197, v197
v_mfma_f32_16x16x32_bf16 a[88:91], v[12:15], a[188:191], a[88:91]
s_waitcnt lgkmcnt(2)
v_fma_f32 v200, v200, s44, v25
v_cvt_pk_bf16_f32 v177, v194, v195
v_mfma_f32_16x16x32_bf16 a[52:55], v[4:7], a[144:147], 0
s_waitcnt lgkmcnt(0)
v_exp_f32 v198, v198
v_mfma_f32_16x16x32_bf16 a[52:55], v[8:11], a[168:171], a[52:55]
v_fma_f32 v201, v201, s44, v25
v_mfma_f32_16x16x32_bf16 a[60:63], v[4:7], a[148:151], 0
v_exp_f32 v199, v199
v_mfma_f32_16x16x32_bf16 a[60:63], v[8:11], a[172:175], a[60:63]
v_fma_f32 v202, v202, s44, v25
v_cvt_pk_bf16_f32 v178, v196, v197
v_mfma_f32_16x16x32_bf16 a[68:71], v[4:7], a[152:155], 0
s_add_u32 m0, s47, 63488
v_exp_f32 v200, v200
v_mfma_f32_16x16x32_bf16 a[68:71], v[8:11], a[176:179], a[68:71]
s_add_u32 s50, s85, 6272
v_fma_f32 v203, v203, s44, v25
v_mfma_f32_16x16x32_bf16 a[76:79], v[4:7], a[156:159], 0
buffer_load_dwordx4 v19, s[36:39], s50 offen nt lds
v_mfma_f32_16x16x32_bf16 a[76:79], v[8:11], a[180:183], a[76:79]
v_exp_f32 v201, v201
v_mfma_f32_16x16x32_bf16 a[84:87], v[4:7], a[160:163], 0
v_fma_f32 v204, v204, s44, v25
v_cvt_pk_bf16_f32 v179, v198, v199
v_mfma_f32_16x16x32_bf16 a[84:87], v[8:11], a[184:187], a[84:87]
v_exp_f32 v202, v202
v_mfma_f32_16x16x32_bf16 a[92:95], v[4:7], a[164:167], 0
v_fma_f32 v205, v205, s44, v25
v_mfma_f32_16x16x32_bf16 a[92:95], v[8:11], a[188:191], a[92:95]
v_exp_f32 v203, v203
v_mfma_f32_16x16x32_bf16 a[120:123], v[28:31], a[192:195], a[120:123]
ds_read_b64_tr_b16 v[8:9], v26 offset:8192
v_fma_f32 v206, v206, s44, v25
v_mfma_f32_16x16x32_bf16 a[120:123], v[28:31], a[216:219], a[120:123]
ds_read_b64_tr_b16 v[10:11], v26 offset:10240
v_cvt_pk_bf16_f32 v180, v200, v201
v_mfma_f32_16x16x32_bf16 a[124:127], v[28:31], a[196:199], a[124:127]
ds_read_b64_tr_b16 v[4:5], v26 offset:12288
v_mfma_f32_16x16x32_bf16 a[124:127], v[28:31], a[220:223], a[124:127]
ds_read_b64_tr_b16 v[6:7], v26 offset:14336
v_exp_f32 v204, v204
v_mfma_f32_16x16x32_bf16 a[128:131], v[28:31], a[200:203], a[128:131]
v_fma_f32 v207, v207, s44, v25
v_mfma_f32_16x16x32_bf16 a[128:131], v[28:31], a[224:227], a[128:131]
v_exp_f32 v205, v205
v_mfma_f32_16x16x32_bf16 a[132:135], v[28:31], a[204:207], a[132:135]
s_add_u32 m0, s47, 49152
v_cvt_pk_bf16_f32 v181, v202, v203
v_mfma_f32_16x16x32_bf16 a[132:135], v[28:31], a[228:231], a[132:135]
s_add_u32 s50, s84, 128
v_exp_f32 v206, v206
v_mfma_f32_16x16x32_bf16 a[136:139], v[28:31], a[208:211], a[136:139]
buffer_load_dwordx4 v19, s[36:39], s50 offen nt lds
v_exp_f32 v207, v207
v_mov_b32 v184, v26
v_mov_b32 v185, v26
v_mfma_f32_16x16x32_bf16 a[136:139], v[28:31], a[232:235], a[136:139]
v_cvt_pk_bf16_f32 v182, v204, v205
v_cvt_pk_bf16_f32 v183, v206, v207
v_mfma_f32_16x16x32_bf16 a[140:143], v[28:31], a[212:215], a[140:143]
v_fma_f32 v208, v208, s44, v20
v_fma_f32 v209, v209, s44, v20
v_mfma_f32_16x16x32_bf16 a[140:143], v[28:31], a[236:239], a[140:143]
s_waitcnt lgkmcnt(2)
v_fma_f32 v210, v210, s44, v20
v_mfma_f32_16x16x32_bf16 a[48:51], v[8:11], a[192:195], a[48:51]
s_waitcnt lgkmcnt(0)
ds_read_b64_tr_b16 v[12:13], v184 offset:8448
v_mfma_f32_16x16x32_bf16 a[48:51], v[4:7], a[216:219], a[48:51]
ds_read_b64_tr_b16 v[14:15], v184 offset:10496
v_exp_f32 v208, v208
v_mfma_f32_16x16x32_bf16 a[56:59], v[8:11], a[196:199], a[56:59]
ds_read_b64_tr_b16 v[0:1], v184 offset:12544
v_fma_f32 v211, v211, s44, v20
v_mfma_f32_16x16x32_bf16 a[56:59], v[4:7], a[220:223], a[56:59]
ds_read_b64_tr_b16 v[2:3], v184 offset:14592
v_exp_f32 v209, v209
v_mfma_f32_16x16x32_bf16 a[64:67], v[8:11], a[200:203], a[64:67]
v_fma_f32 v212, v212, s44, v20
v_mfma_f32_16x16x32_bf16 a[64:67], v[4:7], a[224:227], a[64:67]
v_exp_f32 v210, v210
v_mfma_f32_16x16x32_bf16 a[72:75], v[8:11], a[204:207], a[72:75]
v_fma_f32 v213, v213, s44, v20
v_mfma_f32_16x16x32_bf16 a[72:75], v[4:7], a[228:231], a[72:75]
v_exp_f32 v211, v211
v_mfma_f32_16x16x32_bf16 a[80:83], v[8:11], a[208:211], a[80:83]
s_add_u32 m0, s47, 50176
v_fma_f32 v214, v214, s44, v20
v_cvt_pk_bf16_f32 v208, v208, v209
v_mfma_f32_16x16x32_bf16 a[80:83], v[4:7], a[232:235], a[80:83]
s_add_u32 s50, s84, 3200
v_exp_f32 v212, v212
v_mfma_f32_16x16x32_bf16 a[88:91], v[8:11], a[212:215], a[88:91]
buffer_load_dwordx4 v19, s[36:39], s50 offen nt lds
v_mfma_f32_16x16x32_bf16 a[88:91], v[4:7], a[236:239], a[88:91]
s_waitcnt lgkmcnt(2)
v_fma_f32 v215, v215, s44, v20
v_mfma_f32_16x16x32_bf16 a[52:55], v[12:15], a[192:195], a[52:55]
s_waitcnt lgkmcnt(0)
v_exp_f32 v213, v213
v_mfma_f32_16x16x32_bf16 a[52:55], v[0:3], a[216:219], a[52:55]
v_fma_f32 v216, v216, s44, v21
v_cvt_pk_bf16_f32 v209, v210, v211
v_mfma_f32_16x16x32_bf16 a[60:63], v[12:15], a[196:199], a[60:63]
v_exp_f32 v214, v214
v_mfma_f32_16x16x32_bf16 a[60:63], v[0:3], a[220:223], a[60:63]
v_fma_f32 v217, v217, s44, v21
v_mfma_f32_16x16x32_bf16 a[68:71], v[12:15], a[200:203], a[68:71]
v_exp_f32 v215, v215
v_mfma_f32_16x16x32_bf16 a[68:71], v[0:3], a[224:227], a[68:71]
v_fma_f32 v218, v218, s44, v21
v_cvt_pk_bf16_f32 v210, v212, v213
v_mfma_f32_16x16x32_bf16 a[76:79], v[12:15], a[204:207], a[76:79]
v_exp_f32 v216, v216
v_mfma_f32_16x16x32_bf16 a[76:79], v[0:3], a[228:231], a[76:79]
v_fma_f32 v219, v219, s44, v21
v_mfma_f32_16x16x32_bf16 a[84:87], v[12:15], a[208:211], a[84:87]
v_exp_f32 v217, v217
v_mfma_f32_16x16x32_bf16 a[84:87], v[0:3], a[232:235], a[84:87]
v_fma_f32 v220, v220, s44, v21
v_cvt_pk_bf16_f32 v211, v214, v215
v_mfma_f32_16x16x32_bf16 a[92:95], v[12:15], a[212:215], a[92:95]
s_add_u32 m0, s47, 51200
v_exp_f32 v218, v218
v_mfma_f32_16x16x32_bf16 a[92:95], v[0:3], a[236:239], a[92:95]
s_add_u32 s50, s84, 6272
v_fma_f32 v221, v221, s44, v21
v_mfma_f32_16x16x32_bf16 a[120:123], v[28:31], a[240:243], a[120:123]
ds_read_b64_tr_b16 v[0:1], v184 offset:16384
v_mfma_f32_16x16x32_bf16 a[120:123], v[28:31], v[40:43], a[120:123]
ds_read_b64_tr_b16 v[2:3], v184 offset:18432
v_mfma_f32_16x16x32_bf16 a[124:127], v[28:31], a[244:247], a[124:127]
ds_read_b64_tr_b16 v[12:13], v184 offset:20480
v_mfma_f32_16x16x32_bf16 a[124:127], v[28:31], v[44:47], a[124:127]
ds_read_b64_tr_b16 v[14:15], v184 offset:22528
v_mfma_f32_16x16x32_bf16 a[128:131], v[28:31], a[248:251], a[128:131]
buffer_load_dwordx4 v19, s[36:39], s50 offen nt lds
v_exp_f32 v219, v219
v_mfma_f32_16x16x32_bf16 a[128:131], v[28:31], v[48:51], a[128:131]
v_fma_f32 v222, v222, s44, v21
v_cvt_pk_bf16_f32 v212, v216, v217
v_mfma_f32_16x16x32_bf16 a[132:135], v[28:31], a[252:255], a[132:135]
v_exp_f32 v220, v220
v_mfma_f32_16x16x32_bf16 a[132:135], v[28:31], v[52:55], a[132:135]
v_fma_f32 v223, v223, s44, v21
v_mfma_f32_16x16x32_bf16 a[136:139], v[28:31], v[32:35], a[136:139]
v_exp_f32 v221, v221
v_mfma_f32_16x16x32_bf16 a[136:139], v[28:31], v[56:59], a[136:139]
v_cvt_pk_bf16_f32 v213, v218, v219
v_mfma_f32_16x16x32_bf16 a[140:143], v[28:31], v[36:39], a[140:143]
v_exp_f32 v222, v222
v_mfma_f32_16x16x32_bf16 a[140:143], v[28:31], v[60:63], a[140:143]
s_waitcnt lgkmcnt(2)
v_exp_f32 v223, v223
v_mfma_f32_16x16x32_bf16 a[48:51], v[0:3], a[240:243], a[48:51]
s_waitcnt lgkmcnt(0)
ds_read_b64_tr_b16 v[4:5], v184 offset:16640
v_cvt_pk_bf16_f32 v214, v220, v221
v_mfma_f32_16x16x32_bf16 a[48:51], v[12:15], v[40:43], a[48:51]
s_add_u32 m0, s47, 135168
ds_read_b64_tr_b16 v[6:7], v184 offset:18688
v_cvt_pk_bf16_f32 v215, v222, v223
v_mfma_f32_16x16x32_bf16 a[56:59], v[0:3], a[244:247], a[56:59]
s_add_u32 s50, s87, 256
ds_read_b64_tr_b16 v[8:9], v184 offset:20736
v_fma_f32 v224, v224, s44, v22
v_mfma_f32_16x16x32_bf16 a[56:59], v[12:15], v[44:47], a[56:59]
ds_read_b64_tr_b16 v[10:11], v184 offset:22784
v_fma_f32 v225, v225, s44, v22
v_mfma_f32_16x16x32_bf16 a[64:67], v[0:3], a[248:251], a[64:67]
buffer_load_dwordx4 v19, s[36:39], s50 offen nt lds
v_mfma_f32_16x16x32_bf16 a[64:67], v[12:15], v[48:51], a[64:67]
v_fma_f32 v226, v226, s44, v22
v_mfma_f32_16x16x32_bf16 a[72:75], v[0:3], a[252:255], a[72:75]
v_exp_f32 v224, v224
v_mfma_f32_16x16x32_bf16 a[72:75], v[12:15], v[52:55], a[72:75]
v_fma_f32 v227, v227, s44, v22
v_mfma_f32_16x16x32_bf16 a[80:83], v[0:3], v[32:35], a[80:83]
v_exp_f32 v225, v225
v_mfma_f32_16x16x32_bf16 a[80:83], v[12:15], v[56:59], a[80:83]
v_fma_f32 v228, v228, s44, v22
v_mfma_f32_16x16x32_bf16 a[88:91], v[0:3], v[36:39], a[88:91]
v_exp_f32 v226, v226
v_mfma_f32_16x16x32_bf16 a[88:91], v[12:15], v[60:63], a[88:91]
s_waitcnt lgkmcnt(2)
v_fma_f32 v229, v229, s44, v22
v_mfma_f32_16x16x32_bf16 a[52:55], v[4:7], a[240:243], a[52:55]
s_waitcnt lgkmcnt(0)
v_exp_f32 v227, v227
v_mfma_f32_16x16x32_bf16 a[52:55], v[8:11], v[40:43], a[52:55]
v_fma_f32 v230, v230, s44, v22
v_cvt_pk_bf16_f32 v216, v224, v225
v_mfma_f32_16x16x32_bf16 a[60:63], v[4:7], a[244:247], a[60:63]
s_add_u32 m0, s47, 136192
v_exp_f32 v228, v228
v_mfma_f32_16x16x32_bf16 a[60:63], v[8:11], v[44:47], a[60:63]
s_add_u32 s50, s87, 3328
v_fma_f32 v231, v231, s44, v22
v_mfma_f32_16x16x32_bf16 a[68:71], v[4:7], a[248:251], a[68:71]
buffer_load_dwordx4 v19, s[36:39], s50 offen nt lds
v_mfma_f32_16x16x32_bf16 a[68:71], v[8:11], v[48:51], a[68:71]
v_exp_f32 v229, v229
v_mfma_f32_16x16x32_bf16 a[76:79], v[4:7], a[252:255], a[76:79]
v_fma_f32 v232, v232, s44, v23
v_cvt_pk_bf16_f32 v217, v226, v227
v_mfma_f32_16x16x32_bf16 a[76:79], v[8:11], v[52:55], a[76:79]
v_exp_f32 v230, v230
v_mfma_f32_16x16x32_bf16 a[84:87], v[4:7], v[32:35], a[84:87]
v_fma_f32 v233, v233, s44, v23
v_mfma_f32_16x16x32_bf16 a[84:87], v[8:11], v[56:59], a[84:87]
v_exp_f32 v231, v231
v_mfma_f32_16x16x32_bf16 a[92:95], v[4:7], v[36:39], a[92:95]
s_waitcnt vmcnt(14)
s_barrier
v_mfma_f32_16x16x32_bf16 a[92:95], v[8:11], v[60:63], a[92:95]
v_fma_f32 v234, v234, s44, v23
v_cvt_pk_bf16_f32 v218, v228, v229
v_mfma_f32_16x16x32_bf16 a[120:123], v[28:31], v[64:67], a[120:123]
ds_read_b64_tr_b16 v[8:9], v184 offset:24576
v_mfma_f32_16x16x32_bf16 a[120:123], v[28:31], v[88:91], a[120:123]
ds_read_b64_tr_b16 v[10:11], v184 offset:26624
v_mfma_f32_16x16x32_bf16 a[124:127], v[28:31], v[68:71], a[124:127]
ds_read_b64_tr_b16 v[4:5], v184 offset:28672
v_exp_f32 v232, v232
v_mfma_f32_16x16x32_bf16 a[124:127], v[28:31], v[92:95], a[124:127]
ds_read_b64_tr_b16 v[6:7], v184 offset:30720
v_fma_f32 v235, v235, s44, v23
v_mfma_f32_16x16x32_bf16 a[128:131], v[28:31], v[72:75], a[128:131]
s_add_u32 m0, s47, 137216
v_exp_f32 v233, v233
v_mfma_f32_16x16x32_bf16 a[128:131], v[28:31], v[96:99], a[128:131]
s_add_u32 s50, s87, 6400
v_fma_f32 v236, v236, s44, v23
v_cvt_pk_bf16_f32 v219, v230, v231
v_mfma_f32_16x16x32_bf16 a[132:135], v[28:31], v[76:79], a[132:135]
buffer_load_dwordx4 v19, s[36:39], s50 offen nt lds
v_mfma_f32_16x16x32_bf16 a[132:135], v[28:31], v[100:103], a[132:135]
v_exp_f32 v234, v234
v_mfma_f32_16x16x32_bf16 a[136:139], v[28:31], v[80:83], a[136:139]
v_fma_f32 v237, v237, s44, v23
v_mfma_f32_16x16x32_bf16 a[136:139], v[28:31], v[104:107], a[136:139]
v_exp_f32 v235, v235
v_mfma_f32_16x16x32_bf16 a[140:143], v[28:31], v[84:87], a[140:143]
v_fma_f32 v238, v238, s44, v23
v_cvt_pk_bf16_f32 v220, v232, v233
v_mfma_f32_16x16x32_bf16 a[140:143], v[28:31], v[108:111], a[140:143]
s_waitcnt lgkmcnt(2)
v_exp_f32 v236, v236
v_mfma_f32_16x16x32_bf16 a[48:51], v[8:11], v[64:67], a[48:51]
s_waitcnt lgkmcnt(0)
ds_read_b64_tr_b16 v[12:13], v184 offset:24832
v_fma_f32 v239, v239, s44, v23
v_mfma_f32_16x16x32_bf16 a[48:51], v[4:7], v[88:91], a[48:51]
ds_read_b64_tr_b16 v[14:15], v184 offset:26880
v_mfma_f32_16x16x32_bf16 a[56:59], v[8:11], v[68:71], a[56:59]
ds_read_b64_tr_b16 v[0:1], v184 offset:28928
v_mfma_f32_16x16x32_bf16 a[56:59], v[4:7], v[92:95], a[56:59]
ds_read_b64_tr_b16 v[2:3], v184 offset:30976
v_exp_f32 v237, v237
v_mfma_f32_16x16x32_bf16 a[64:67], v[8:11], v[72:75], a[64:67]
v_cvt_pk_bf16_f32 v221, v234, v235
v_mfma_f32_16x16x32_bf16 a[64:67], v[4:7], v[96:99], a[64:67]
v_exp_f32 v238, v238
v_mfma_f32_16x16x32_bf16 a[72:75], v[8:11], v[76:79], a[72:75]
s_add_u32 m0, s47, 122880
v_exp_f32 v239, v239
v_mfma_f32_16x16x32_bf16 a[72:75], v[4:7], v[100:103], a[72:75]
s_add_u32 s50, s86, 256
v_cvt_pk_bf16_f32 v222, v236, v237
v_cvt_pk_bf16_f32 v223, v238, v239
v_mfma_f32_16x16x32_bf16 a[80:83], v[8:11], v[80:83], a[80:83]
buffer_load_dwordx4 v19, s[36:39], s50 offen nt lds
v_mfma_f32_16x16x32_bf16 a[80:83], v[4:7], v[104:107], a[80:83]
v_fma_f32 v240, v240, s44, v24
v_fma_f32 v241, v241, s44, v24
v_mfma_f32_16x16x32_bf16 a[88:91], v[8:11], v[84:87], a[88:91]
v_fma_f32 v242, v242, s44, v24
v_mfma_f32_16x16x32_bf16 a[88:91], v[4:7], v[108:111], a[88:91]
s_waitcnt lgkmcnt(2)
v_exp_f32 v240, v240
v_mfma_f32_16x16x32_bf16 a[52:55], v[12:15], v[64:67], a[52:55]
s_waitcnt lgkmcnt(0)
v_fma_f32 v243, v243, s44, v24
v_mfma_f32_16x16x32_bf16 a[52:55], v[0:3], v[88:91], a[52:55]
v_exp_f32 v241, v241
v_mfma_f32_16x16x32_bf16 a[60:63], v[12:15], v[68:71], a[60:63]
v_fma_f32 v244, v244, s44, v24
v_mfma_f32_16x16x32_bf16 a[60:63], v[0:3], v[92:95], a[60:63]
v_exp_f32 v242, v242
v_mfma_f32_16x16x32_bf16 a[68:71], v[12:15], v[72:75], a[68:71]
v_fma_f32 v245, v245, s44, v24
v_mfma_f32_16x16x32_bf16 a[68:71], v[0:3], v[96:99], a[68:71]
v_exp_f32 v243, v243
v_mfma_f32_16x16x32_bf16 a[76:79], v[12:15], v[76:79], a[76:79]
v_fma_f32 v246, v246, s44, v24
v_cvt_pk_bf16_f32 v224, v240, v241
v_mfma_f32_16x16x32_bf16 a[76:79], v[0:3], v[100:103], a[76:79]
v_exp_f32 v244, v244
v_mfma_f32_16x16x32_bf16 a[84:87], v[12:15], v[80:83], a[84:87]
s_add_u32 m0, s47, 123904
v_fma_f32 v247, v247, s44, v24
v_mfma_f32_16x16x32_bf16 a[84:87], v[0:3], v[104:107], a[84:87]
s_add_u32 s50, s86, 3328
v_exp_f32 v245, v245
v_mfma_f32_16x16x32_bf16 a[92:95], v[12:15], v[84:87], a[92:95]
buffer_load_dwordx4 v19, s[36:39], s50 offen nt lds
v_mfma_f32_16x16x32_bf16 a[92:95], v[0:3], v[108:111], a[92:95]
v_fma_f32 v248, v248, s44, v25
v_cvt_pk_bf16_f32 v225, v242, v243
v_mfma_f32_16x16x32_bf16 a[120:123], v[28:31], v[112:115], a[120:123]
ds_read_b64_tr_b16 v[0:1], v184 offset:32768
v_mfma_f32_16x16x32_bf16 a[120:123], v[28:31], v[136:139], a[120:123]
ds_read_b64_tr_b16 v[2:3], v184 offset:34816
v_mfma_f32_16x16x32_bf16 a[124:127], v[28:31], v[116:119], a[124:127]
ds_read_b64_tr_b16 v[12:13], v184 offset:36864
v_exp_f32 v246, v246
v_mfma_f32_16x16x32_bf16 a[124:127], v[28:31], v[140:143], a[124:127]
ds_read_b64_tr_b16 v[14:15], v184 offset:38912
v_fma_f32 v249, v249, s44, v25
v_mfma_f32_16x16x32_bf16 a[128:131], v[28:31], v[120:123], a[128:131]
v_exp_f32 v247, v247
v_mfma_f32_16x16x32_bf16 a[128:131], v[28:31], v[144:147], a[128:131]
v_fma_f32 v250, v250, s44, v25
v_cvt_pk_bf16_f32 v226, v244, v245
v_mfma_f32_16x16x32_bf16 a[132:135], v[28:31], v[124:127], a[132:135]
v_exp_f32 v248, v248
v_mfma_f32_16x16x32_bf16 a[132:135], v[28:31], v[148:151], a[132:135]
v_fma_f32 v251, v251, s44, v25
v_mfma_f32_16x16x32_bf16 a[136:139], v[28:31], v[128:131], a[136:139]
v_exp_f32 v249, v249
v_mfma_f32_16x16x32_bf16 a[136:139], v[28:31], v[152:155], a[136:139]
v_fma_f32 v252, v252, s44, v25
v_cvt_pk_bf16_f32 v227, v246, v247
v_mfma_f32_16x16x32_bf16 a[140:143], v[28:31], v[132:135], a[140:143]
s_add_u32 m0, s47, 124928
v_exp_f32 v250, v250
v_mfma_f32_16x16x32_bf16 a[140:143], v[28:31], v[156:159], a[140:143]
s_waitcnt lgkmcnt(2)
v_fma_f32 v253, v253, s44, v25
v_mfma_f32_16x16x32_bf16 a[48:51], v[0:3], v[112:115], a[48:51]
s_waitcnt lgkmcnt(0)
ds_read_b64_tr_b16 v[4:5], v184 offset:33024
v_mfma_f32_16x16x32_bf16 a[48:51], v[12:15], v[136:139], a[48:51]
s_add_u32 s50, s86, 6400
ds_read_b64_tr_b16 v[6:7], v184 offset:35072
v_mfma_f32_16x16x32_bf16 a[56:59], v[0:3], v[116:119], a[56:59]
ds_read_b64_tr_b16 v[8:9], v184 offset:37120
v_mfma_f32_16x16x32_bf16 a[56:59], v[12:15], v[140:143], a[56:59]
ds_read_b64_tr_b16 v[10:11], v184 offset:39168
v_exp_f32 v251, v251
v_mfma_f32_16x16x32_bf16 a[64:67], v[0:3], v[120:123], a[64:67]
buffer_load_dwordx4 v19, s[36:39], s50 offen nt lds
v_fma_f32 v254, v254, s44, v25
v_mfma_f32_16x16x32_bf16 a[64:67], v[12:15], v[144:147], a[64:67]
v_cvt_pk_bf16_f32 v228, v248, v249
v_mfma_f32_16x16x32_bf16 a[72:75], v[0:3], v[124:127], a[72:75]
v_exp_f32 v252, v252
v_mfma_f32_16x16x32_bf16 a[72:75], v[12:15], v[148:151], a[72:75]
v_fma_f32 v255, v255, s44, v25
v_mfma_f32_16x16x32_bf16 a[80:83], v[0:3], v[128:131], a[80:83]
v_exp_f32 v253, v253
v_mfma_f32_16x16x32_bf16 a[80:83], v[12:15], v[152:155], a[80:83]
v_cvt_pk_bf16_f32 v229, v250, v251
v_mbcnt_lo_u32_b32 v238, -1, 0
v_mfma_f32_16x16x32_bf16 a[88:91], v[0:3], v[132:135], a[88:91]
v_exp_f32 v254, v254
v_mfma_f32_16x16x32_bf16 a[88:91], v[12:15], v[156:159], a[88:91]
s_waitcnt lgkmcnt(2)
v_exp_f32 v255, v255
v_mfma_f32_16x16x32_bf16 a[52:55], v[4:7], v[112:115], a[52:55]
s_waitcnt lgkmcnt(0)
v_cvt_pk_bf16_f32 v230, v252, v253
v_cvt_pk_bf16_f32 v231, v254, v255
v_mfma_f32_16x16x32_bf16 a[52:55], v[8:11], v[136:139], a[52:55]
s_add_u32 m0, s47, 110592
v_mbcnt_hi_u32_b32 v238, -1, v238
v_lshrrev_b32 v237, 5, v238
v_mfma_f32_16x16x32_bf16 a[60:63], v[4:7], v[116:119], a[60:63]
s_add_u32 s50, s85, 256
buffer_load_dwordx4 v19, s[36:39], s50 offen nt lds
v_mfma_f32_16x16x32_bf16 a[60:63], v[8:11], v[140:143], a[60:63]
v_and_b32 v236, 7, v238
v_xor_b32 v236, v237, v236
v_mfma_f32_16x16x32_bf16 a[68:71], v[4:7], v[120:123], a[68:71]
v_lshlrev_b32 v236, 4, v236
v_and_b32 v237, 15, v238
v_mfma_f32_16x16x32_bf16 a[68:71], v[8:11], v[144:147], a[68:71]
v_lshl_add_u32 v236, v237, 7, v236
v_mfma_f32_16x16x32_bf16 a[76:79], v[4:7], v[124:127], a[76:79]
v_bfe_u32 v237, v238, 4, 1
v_mfma_f32_16x16x32_bf16 a[76:79], v[8:11], v[148:151], a[76:79]
v_lshl_add_u32 v236, v237, 3, v236
v_mfma_f32_16x16x32_bf16 a[84:87], v[4:7], v[128:131], a[84:87]
v_add_u32 v236, s55, v236
v_mfma_f32_16x16x32_bf16 a[84:87], v[8:11], v[152:155], a[84:87]
v_lshrrev_b32 v186, 3, v238
v_mfma_f32_16x16x32_bf16 a[92:95], v[4:7], v[132:135], a[92:95]
v_mfma_f32_16x16x32_bf16 a[92:95], v[8:11], v[156:159], a[92:95]
v_mul_u32_u24 v186, 0x90, v186
v_mfma_f32_16x16x32_bf16 a[120:123], v[28:31], v[160:163], a[120:123]
ds_read_b64_tr_b16 v[8:9], v184 offset:40960
v_and_b32 v237, 0x70, v18
v_mfma_f32_16x16x32_bf16 a[120:123], v[28:31], v[208:211], a[120:123]
ds_read_b64_tr_b16 v[10:11], v184 offset:43008
v_xor_b32 v186, v186, v237
v_mfma_f32_16x16x32_bf16 a[124:127], v[28:31], v[164:167], a[124:127]
s_add_u32 m0, s47, 111616
ds_read_b64_tr_b16 v[4:5], v184 offset:45056
v_add_u32 v186, s55, v186
v_mfma_f32_16x16x32_bf16 a[124:127], v[28:31], v[212:215], a[124:127]
s_add_u32 s50, s85, 3328
ds_read_b64_tr_b16 v[6:7], v184 offset:47104
v_mfma_f32_16x16x32_bf16 a[128:131], v[28:31], v[168:171], a[128:131]
buffer_load_dwordx4 v19, s[36:39], s50 offen nt lds
v_mfma_f32_16x16x32_bf16 a[128:131], v[28:31], v[216:219], a[128:131]
v_xor_b32 v237, 32, v236
v_xor_b32 v238, 64, v236
v_mfma_f32_16x16x32_bf16 a[132:135], v[28:31], v[172:175], a[132:135]
v_xor_b32 v239, 96, v236
v_mfma_f32_16x16x32_bf16 a[132:135], v[28:31], v[220:223], a[132:135]
v_mfma_f32_16x16x32_bf16 a[136:139], v[28:31], v[176:179], a[136:139]
v_mfma_f32_16x16x32_bf16 a[136:139], v[28:31], v[224:227], a[136:139]
v_mfma_f32_16x16x32_bf16 a[140:143], v[28:31], v[180:183], a[140:143]
v_mfma_f32_16x16x32_bf16 a[140:143], v[28:31], v[228:231], a[140:143]
s_waitcnt lgkmcnt(2)
v_mfma_f32_16x16x32_bf16 a[48:51], v[8:11], v[160:163], a[48:51]
s_waitcnt lgkmcnt(0)
ds_read_b64_tr_b16 v[12:13], v184 offset:41216
v_mfma_f32_16x16x32_bf16 a[48:51], v[4:7], v[208:211], a[48:51]
ds_read_b64_tr_b16 v[14:15], v184 offset:43264
v_mfma_f32_16x16x32_bf16 a[56:59], v[8:11], v[164:167], a[56:59]
ds_read_b64_tr_b16 v[0:1], v184 offset:45312
v_mfma_f32_16x16x32_bf16 a[56:59], v[4:7], v[212:215], a[56:59]
ds_read_b64_tr_b16 v[2:3], v184 offset:47360
v_mfma_f32_16x16x32_bf16 a[64:67], v[8:11], v[168:171], a[64:67]
s_add_u32 m0, s47, 112640
ds_read_b64_tr_b16 v[232:233], v184 offset:512
v_mfma_f32_16x16x32_bf16 a[64:67], v[4:7], v[216:219], a[64:67]
s_add_u32 s50, s85, 6400
ds_read_b64_tr_b16 v[234:235], v184 offset:2560
v_mfma_f32_16x16x32_bf16 a[72:75], v[8:11], v[172:175], a[72:75]
ds_read_b64_tr_b16 a[0:1], v184 offset:4608
v_accvgpr_read_b32 v26, a120
v_mfma_f32_16x16x32_bf16 a[72:75], v[4:7], v[220:223], a[72:75]
ds_read_b64_tr_b16 a[2:3], v184 offset:6656
v_accvgpr_read_b32 v27, a124
v_mfma_f32_16x16x32_bf16 a[80:83], v[8:11], v[176:179], a[80:83]
ds_read_b64_tr_b16 a[4:5], v184 offset:8704
v_accvgpr_read_b32 v28, a128
v_mfma_f32_16x16x32_bf16 a[80:83], v[4:7], v[224:227], a[80:83]
ds_read_b64_tr_b16 a[6:7], v184 offset:10752
v_accvgpr_read_b32 v29, a132
v_mfma_f32_16x16x32_bf16 a[88:91], v[8:11], v[180:183], a[88:91]
ds_read_b64_tr_b16 a[8:9], v184 offset:12800
v_accvgpr_read_b32 v30, a136
v_mfma_f32_16x16x32_bf16 a[88:91], v[4:7], v[228:231], a[88:91]
s_waitcnt lgkmcnt(9)
ds_read_b64_tr_b16 a[10:11], v184 offset:14848
v_accvgpr_read_b32 v31, a140
v_mfma_f32_16x16x32_bf16 a[52:55], v[12:15], v[160:163], a[52:55]
s_waitcnt lgkmcnt(8)
ds_read_b64_tr_b16 v[4:5], v184 offset:16896
v_add_f32 v20, v26, v27
v_mfma_f32_16x16x32_bf16 a[52:55], v[0:3], v[208:211], a[52:55]
ds_read_b64_tr_b16 v[6:7], v184 offset:18944
buffer_load_dwordx4 v19, s[36:39], s50 offen nt lds
v_mfma_f32_16x16x32_bf16 a[60:63], v[12:15], v[164:167], a[60:63]
ds_read_b64_tr_b16 v[8:9], v184 offset:20992
v_min_f32 v21, v26, v27
v_mfma_f32_16x16x32_bf16 a[60:63], v[0:3], v[212:215], a[60:63]
ds_read_b64_tr_b16 v[10:11], v184 offset:23040
v_cmp_nle_f32 s[96:97], v20, s46
v_mfma_f32_16x16x32_bf16 a[68:71], v[12:15], v[168:171], a[68:71]
v_cmp_nle_f32 vcc, 0.5, v21
v_mfma_f32_16x16x32_bf16 a[68:71], v[0:3], v[216:219], a[68:71]
s_or_b64 s[96:97], s[96:97], vcc
v_rcp_f32 v26, v26
v_mfma_f32_16x16x32_bf16 a[76:79], v[12:15], v[172:175], a[76:79]
s_add_u32 m0, s47, 98304
v_rcp_f32 v27, v27
v_mfma_f32_16x16x32_bf16 a[76:79], v[0:3], v[220:223], a[76:79]
s_add_u32 s50, s84, 256
v_add_f32 v20, v28, v29
v_min_f32 v21, v28, v29
v_mfma_f32_16x16x32_bf16 a[84:87], v[12:15], v[176:179], a[84:87]
buffer_load_dwordx4 v19, s[36:39], s50 offen nt lds
v_mfma_f32_16x16x32_bf16 a[84:87], v[0:3], v[224:227], a[84:87]
v_cmp_nle_f32 s[98:99], v20, s46
v_cmp_nle_f32 vcc, 0.5, v21
v_mfma_f32_16x16x32_bf16 a[92:95], v[12:15], v[180:183], a[92:95]
s_or_b64 s[98:99], s[98:99], vcc
v_rcp_f32 v28, v28
v_mfma_f32_16x16x32_bf16 a[92:95], v[0:3], v[228:231], a[92:95]
s_waitcnt lgkmcnt(10)
v_rcp_f32 v29, v29
v_mfma_f32_16x16x32_bf16 a[96:99], v[232:235], a[144:147], 0
s_waitcnt lgkmcnt(8)
v_add_f32 v20, v30, v31
v_min_f32 v21, v30, v31
v_mfma_f32_16x16x32_bf16 a[96:99], a[0:3], a[168:171], a[96:99]
s_waitcnt lgkmcnt(6)
v_cmp_nle_f32 s[100:101], v20, s46
v_cmp_nle_f32 vcc, 0.5, v21
v_mfma_f32_16x16x32_bf16 a[96:99], a[4:7], a[192:195], a[96:99]
s_waitcnt lgkmcnt(4)
v_rcp_f32 v30, v30
v_mfma_f32_16x16x32_bf16 a[96:99], a[8:11], a[216:219], a[96:99]
s_waitcnt lgkmcnt(2)
v_rcp_f32 v31, v31
v_mfma_f32_16x16x32_bf16 a[96:99], v[4:7], a[240:243], a[96:99]
s_waitcnt lgkmcnt(0)
v_mfma_f32_16x16x32_bf16 a[96:99], v[8:11], v[40:43], a[96:99]
s_or_b64 s[100:101], s[100:101], vcc
v_accvgpr_read_b32 v188, a48
v_mfma_f32_16x16x32_bf16 a[104:107], v[232:235], a[148:151], 0
v_accvgpr_read_b32 v189, a49
v_mfma_f32_16x16x32_bf16 a[104:107], a[0:3], a[172:175], a[104:107]
v_accvgpr_read_b32 v190, a50
v_mfma_f32_16x16x32_bf16 a[104:107], a[4:7], a[196:199], a[104:107]
s_add_u32 m0, s47, 99328
v_accvgpr_read_b32 v191, a51
v_mfma_f32_16x16x32_bf16 a[104:107], a[8:11], a[220:223], a[104:107]
s_add_u32 s50, s84, 3328
v_mul_f32 v188, v188, v26
v_mfma_f32_16x16x32_bf16 a[104:107], v[4:7], a[244:247], a[104:107]
buffer_load_dwordx4 v19, s[36:39], s50 offen nt lds
v_mfma_f32_16x16x32_bf16 a[104:107], v[8:11], v[44:47], a[104:107]
v_mul_f32 v189, v189, v26
v_cvt_pk_bf16_f32 v240, v188, v189
v_mfma_f32_16x16x32_bf16 a[112:115], v[232:235], a[152:155], 0
v_accvgpr_read_b32 v188, a52
v_mfma_f32_16x16x32_bf16 a[112:115], a[0:3], a[176:179], a[112:115]
v_accvgpr_read_b32 v189, a53
v_mfma_f32_16x16x32_bf16 a[112:115], a[4:7], a[200:203], a[112:115]
v_mul_f32 v190, v190, v26
v_mfma_f32_16x16x32_bf16 a[112:115], a[8:11], a[224:227], a[112:115]
v_mfma_f32_16x16x32_bf16 a[112:115], v[4:7], a[248:251], a[112:115]
ds_read_b64_tr_b16 v[0:1], v184 offset:768
v_mul_f32 v191, v191, v26
v_mfma_f32_16x16x32_bf16 a[112:115], v[8:11], v[48:51], a[112:115]
ds_read_b64_tr_b16 v[2:3], v184 offset:2816
v_cvt_pk_bf16_f32 v241, v190, v191
v_mfma_f32_16x16x32_bf16 a[120:123], v[232:235], a[156:159], 0
ds_read_b64_tr_b16 v[12:13], v184 offset:4864
v_accvgpr_read_b32 v190, a54
v_mfma_f32_16x16x32_bf16 a[120:123], a[0:3], a[180:183], a[120:123]
ds_read_b64_tr_b16 v[14:15], v184 offset:6912
v_accvgpr_read_b32 v191, a55
v_mfma_f32_16x16x32_bf16 a[120:123], a[4:7], a[204:207], a[120:123]
ds_read_b64_tr_b16 a[12:13], v184 offset:8960
v_mul_f32 v188, v188, v26
v_mfma_f32_16x16x32_bf16 a[120:123], a[8:11], a[228:231], a[120:123]
ds_read_b64_tr_b16 a[14:15], v184 offset:11008
v_mul_f32 v189, v189, v26
v_mfma_f32_16x16x32_bf16 a[120:123], v[4:7], a[252:255], a[120:123]
s_add_u32 m0, s47, 100352
ds_read_b64_tr_b16 a[16:17], v184 offset:13056
v_cvt_pk_bf16_f32 v242, v188, v189
v_mfma_f32_16x16x32_bf16 a[120:123], v[8:11], v[52:55], a[120:123]
s_add_u32 s50, s84, 6400
ds_read_b64_tr_b16 a[18:19], v184 offset:15104
v_mul_f32 v190, v190, v26
v_mfma_f32_16x16x32_bf16 a[128:131], v[232:235], a[160:163], 0
ds_read_b64_tr_b16 a[20:21], v184 offset:17152
v_mul_f32 v191, v191, v26
v_mfma_f32_16x16x32_bf16 a[128:131], a[0:3], a[184:187], a[128:131]
ds_read_b64_tr_b16 a[22:23], v184 offset:19200
v_cvt_pk_bf16_f32 v243, v190, v191
v_mfma_f32_16x16x32_bf16 a[128:131], a[4:7], a[208:211], a[128:131]
ds_read_b64_tr_b16 a[24:25], v184 offset:21248
v_mfma_f32_16x16x32_bf16 a[128:131], a[8:11], a[232:235], a[128:131]
ds_read_b64_tr_b16 a[26:27], v184 offset:23296
v_accvgpr_read_b32 v188, a72
v_mfma_f32_16x16x32_bf16 a[128:131], v[4:7], v[32:35], a[128:131]
buffer_load_dwordx4 v19, s[36:39], s50 offen nt lds
v_mfma_f32_16x16x32_bf16 a[128:131], v[8:11], v[56:59], a[128:131]
v_accvgpr_read_b32 v189, a73
v_accvgpr_read_b32 v190, a74
v_mfma_f32_16x16x32_bf16 a[136:139], v[232:235], a[164:167], 0
v_accvgpr_read_b32 v191, a75
v_mfma_f32_16x16x32_bf16 a[136:139], a[0:3], a[188:191], a[136:139]
v_mul_f32 v188, v188, v29
v_mfma_f32_16x16x32_bf16 a[136:139], a[4:7], a[212:215], a[136:139]
v_mul_f32 v189, v189, v29
v_mfma_f32_16x16x32_bf16 a[136:139], a[8:11], a[236:239], a[136:139]
v_cvt_pk_bf16_f32 v252, v188, v189
v_mfma_f32_16x16x32_bf16 a[136:139], v[4:7], v[36:39], a[136:139]
v_accvgpr_read_b32 v188, a76
v_mfma_f32_16x16x32_bf16 a[136:139], v[8:11], v[60:63], a[136:139]
s_waitcnt lgkmcnt(10)
v_accvgpr_read_b32 v189, a77
v_mfma_f32_16x16x32_bf16 a[100:103], v[0:3], a[144:147], 0
s_waitcnt lgkmcnt(8)
v_mfma_f32_16x16x32_bf16 a[100:103], v[12:15], a[168:171], a[100:103]
s_waitcnt lgkmcnt(6)
v_mul_f32 v190, v190, v29
v_mfma_f32_16x16x32_bf16 a[100:103], a[12:15], a[192:195], a[100:103]
s_waitcnt lgkmcnt(4)
v_mul_f32 v191, v191, v29
v_mfma_f32_16x16x32_bf16 a[100:103], a[16:19], a[216:219], a[100:103]
s_waitcnt lgkmcnt(2)
v_cvt_pk_bf16_f32 v253, v190, v191
v_mfma_f32_16x16x32_bf16 a[100:103], a[20:23], a[240:243], a[100:103]
s_waitcnt lgkmcnt(0)
v_accvgpr_read_b32 v190, a78
v_mfma_f32_16x16x32_bf16 a[100:103], a[24:27], v[40:43], a[100:103]
v_accvgpr_read_b32 v191, a79
v_mfma_f32_16x16x32_bf16 a[108:111], v[0:3], a[148:151], 0
v_mul_f32 v188, v188, v29
v_mfma_f32_16x16x32_bf16 a[108:111], v[12:15], a[172:175], a[108:111]
v_mul_f32 v189, v189, v29
v_mfma_f32_16x16x32_bf16 a[108:111], a[12:15], a[196:199], a[108:111]
v_cvt_pk_bf16_f32 v254, v188, v189
v_mfma_f32_16x16x32_bf16 a[108:111], a[16:19], a[220:223], a[108:111]
v_mul_f32 v190, v190, v29
v_mfma_f32_16x16x32_bf16 a[108:111], a[20:23], a[244:247], a[108:111]
v_mul_f32 v191, v191, v29
v_mfma_f32_16x16x32_bf16 a[108:111], a[24:27], v[44:47], a[108:111]
v_mfma_f32_16x16x32_bf16 a[116:119], v[0:3], a[152:155], 0
v_cvt_pk_bf16_f32 v255, v190, v191
v_mfma_f32_16x16x32_bf16 a[116:119], v[12:15], a[176:179], a[116:119]
v_accvgpr_read_b32 v188, a56
v_mfma_f32_16x16x32_bf16 a[116:119], a[12:15], a[200:203], a[116:119]
v_accvgpr_read_b32 v189, a57
v_mfma_f32_16x16x32_bf16 a[116:119], a[16:19], a[224:227], a[116:119]
v_accvgpr_read_b32 v190, a58
v_mfma_f32_16x16x32_bf16 a[116:119], a[20:23], a[248:251], a[116:119]
ds_read_b64_tr_b16 v[8:9], v184 offset:25088
v_accvgpr_read_b32 v191, a59
v_mfma_f32_16x16x32_bf16 a[116:119], a[24:27], v[48:51], a[116:119]
ds_read_b64_tr_b16 v[10:11], v184 offset:27136
v_mul_f32 v188, v188, v27
v_mfma_f32_16x16x32_bf16 a[124:127], v[0:3], a[156:159], 0
ds_read_b64_tr_b16 v[4:5], v184 offset:29184
v_mul_f32 v189, v189, v27
v_mfma_f32_16x16x32_bf16 a[124:127], v[12:15], a[180:183], a[124:127]
ds_read_b64_tr_b16 v[6:7], v184 offset:31232
v_cvt_pk_bf16_f32 v244, v188, v189
v_mfma_f32_16x16x32_bf16 a[124:127], a[12:15], a[204:207], a[124:127]
ds_read_b64_tr_b16 a[8:9], v184 offset:33280
v_accvgpr_read_b32 v188, a60
v_mfma_f32_16x16x32_bf16 a[124:127], a[16:19], a[228:231], a[124:127]
ds_read_b64_tr_b16 a[10:11], v184 offset:35328
v_accvgpr_read_b32 v189, a61
v_mfma_f32_16x16x32_bf16 a[124:127], a[20:23], a[252:255], a[124:127]
ds_read_b64_tr_b16 a[4:5], v184 offset:37376
v_mfma_f32_16x16x32_bf16 a[124:127], a[24:27], v[52:55], a[124:127]
ds_read_b64_tr_b16 a[6:7], v184 offset:39424
v_mul_f32 v190, v190, v27
v_mfma_f32_16x16x32_bf16 a[132:135], v[0:3], a[160:163], 0
ds_read_b64_tr_b16 a[0:1], v184 offset:41472
v_mul_f32 v191, v191, v27
v_mfma_f32_16x16x32_bf16 a[132:135], v[12:15], a[184:187], a[132:135]
ds_read_b64_tr_b16 a[2:3], v184 offset:43520
v_cvt_pk_bf16_f32 v245, v190, v191
v_mfma_f32_16x16x32_bf16 a[132:135], a[12:15], a[208:211], a[132:135]
ds_read_b64_tr_b16 v[232:233], v184 offset:45568
v_accvgpr_read_b32 v190, a62
v_mfma_f32_16x16x32_bf16 a[132:135], a[16:19], a[232:235], a[132:135]
ds_read_b64_tr_b16 v[234:235], v184 offset:47616
v_accvgpr_read_b32 v191, a63
v_mfma_f32_16x16x32_bf16 a[132:135], a[20:23], v[32:35], a[132:135]
v_mul_f32 v188, v188, v27
v_mfma_f32_16x16x32_bf16 a[132:135], a[24:27], v[56:59], a[132:135]
v_mul_f32 v189, v189, v27
v_mfma_f32_16x16x32_bf16 a[140:143], v[0:3], a[164:167], 0
v_cvt_pk_bf16_f32 v246, v188, v189
v_mfma_f32_16x16x32_bf16 a[140:143], v[12:15], a[188:191], a[140:143]
v_mul_f32 v190, v190, v27
v_mfma_f32_16x16x32_bf16 a[140:143], a[12:15], a[212:215], a[140:143]
v_mfma_f32_16x16x32_bf16 a[140:143], a[16:19], a[236:239], a[140:143]
v_mul_f32 v191, v191, v27
v_mfma_f32_16x16x32_bf16 a[140:143], a[20:23], v[36:39], a[140:143]
v_cvt_pk_bf16_f32 v247, v190, v191
v_mfma_f32_16x16x32_bf16 a[140:143], a[24:27], v[60:63], a[140:143]
s_waitcnt lgkmcnt(10)
v_accvgpr_read_b32 v188, a80
v_mfma_f32_16x16x32_bf16 a[96:99], v[8:11], v[64:67], a[96:99]
s_waitcnt lgkmcnt(8)
v_accvgpr_read_b32 v189, a81
v_mfma_f32_16x16x32_bf16 a[96:99], v[4:7], v[88:91], a[96:99]
s_waitcnt lgkmcnt(6)
v_accvgpr_read_b32 v190, a82
v_mfma_f32_16x16x32_bf16 a[96:99], a[8:11], v[112:115], a[96:99]
s_waitcnt lgkmcnt(4)
v_accvgpr_read_b32 v191, a83
v_mfma_f32_16x16x32_bf16 a[96:99], a[4:7], v[136:139], a[96:99]
s_waitcnt lgkmcnt(2)
v_mul_f32 v188, v188, v30
v_mfma_f32_16x16x32_bf16 a[96:99], a[0:3], v[160:163], a[96:99]
s_waitcnt lgkmcnt(0)
v_mul_f32 v189, v189, v30
v_mfma_f32_16x16x32_bf16 a[96:99], v[232:235], v[208:211], a[96:99]
v_cvt_pk_bf16_f32 v192, v188, v189
v_mfma_f32_16x16x32_bf16 a[104:107], v[8:11], v[68:71], a[104:107]
v_accvgpr_read_b32 v188, a84
v_mfma_f32_16x16x32_bf16 a[104:107], v[4:7], v[92:95], a[104:107]
v_mfma_f32_16x16x32_bf16 a[104:107], a[8:11], v[116:119], a[104:107]
v_accvgpr_read_b32 v189, a85
v_mfma_f32_16x16x32_bf16 a[104:107], a[4:7], v[140:143], a[104:107]
v_mul_f32 v190, v190, v30
v_mfma_f32_16x16x32_bf16 a[104:107], a[0:3], v[164:167], a[104:107]
v_mul_f32 v191, v191, v30
v_mfma_f32_16x16x32_bf16 a[104:107], v[232:235], v[212:215], a[104:107]
v_cvt_pk_bf16_f32 v193, v190, v191
v_mfma_f32_16x16x32_bf16 a[112:115], v[8:11], v[72:75], a[112:115]
v_accvgpr_read_b32 v190, a86
v_mfma_f32_16x16x32_bf16 a[112:115], v[4:7], v[96:99], a[112:115]
v_accvgpr_read_b32 v191, a87
v_mfma_f32_16x16x32_bf16 a[112:115], a[8:11], v[120:123], a[112:115]
v_mul_f32 v188, v188, v30
v_mfma_f32_16x16x32_bf16 a[112:115], a[4:7], v[144:147], a[112:115]
v_mul_f32 v189, v189, v30
v_mfma_f32_16x16x32_bf16 a[112:115], a[0:3], v[168:171], a[112:115]
ds_read_b64_tr_b16 a[24:25], v184 offset:25344
v_cvt_pk_bf16_f32 v194, v188, v189
v_mfma_f32_16x16x32_bf16 a[112:115], v[232:235], v[216:219], a[112:115]
ds_read_b64_tr_b16 a[26:27], v184 offset:27392
v_mfma_f32_16x16x32_bf16 a[120:123], v[8:11], v[76:79], a[120:123]
ds_read_b64_tr_b16 a[20:21], v184 offset:29440
v_mul_f32 v190, v190, v30
v_mfma_f32_16x16x32_bf16 a[120:123], v[4:7], v[100:103], a[120:123]
ds_read_b64_tr_b16 a[22:23], v184 offset:31488
v_mul_f32 v191, v191, v30
v_mfma_f32_16x16x32_bf16 a[120:123], a[8:11], v[124:127], a[120:123]
ds_read_b64_tr_b16 a[16:17], v184 offset:33536
v_cvt_pk_bf16_f32 v195, v190, v191
v_mfma_f32_16x16x32_bf16 a[120:123], a[4:7], v[148:151], a[120:123]
ds_read_b64_tr_b16 a[18:19], v184 offset:35584
v_accvgpr_read_b32 v188, a64
v_mfma_f32_16x16x32_bf16 a[120:123], a[0:3], v[172:175], a[120:123]
ds_read_b64_tr_b16 a[12:13], v184 offset:37632
v_accvgpr_read_b32 v189, a65
v_mfma_f32_16x16x32_bf16 a[120:123], v[232:235], v[220:223], a[120:123]
ds_read_b64_tr_b16 a[14:15], v184 offset:39680
v_accvgpr_read_b32 v190, a66
v_mfma_f32_16x16x32_bf16 a[128:131], v[8:11], v[80:83], a[128:131]
ds_read_b64_tr_b16 v[12:13], v184 offset:41728
v_accvgpr_read_b32 v191, a67
v_mfma_f32_16x16x32_bf16 a[128:131], v[4:7], v[104:107], a[128:131]
ds_read_b64_tr_b16 v[14:15], v184 offset:43776
v_mul_f32 v188, v188, v28
v_mfma_f32_16x16x32_bf16 a[128:131], a[8:11], v[128:131], a[128:131]
ds_read_b64_tr_b16 v[0:1], v184 offset:45824
v_mul_f32 v189, v189, v28
v_mfma_f32_16x16x32_bf16 a[128:131], a[4:7], v[152:155], a[128:131]
ds_read_b64_tr_b16 v[2:3], v184 offset:47872
v_cvt_pk_bf16_f32 v248, v188, v189
v_mfma_f32_16x16x32_bf16 a[128:131], a[0:3], v[176:179], a[128:131]
v_mfma_f32_16x16x32_bf16 a[128:131], v[232:235], v[224:227], a[128:131]
v_accvgpr_read_b32 v188, a68
v_mfma_f32_16x16x32_bf16 a[136:139], v[8:11], v[84:87], a[136:139]
v_accvgpr_read_b32 v189, a69
v_mfma_f32_16x16x32_bf16 a[136:139], v[4:7], v[108:111], a[136:139]
v_mul_f32 v190, v190, v28
v_mfma_f32_16x16x32_bf16 a[136:139], a[8:11], v[132:135], a[136:139]
v_mul_f32 v191, v191, v28
v_mfma_f32_16x16x32_bf16 a[136:139], a[4:7], v[156:159], a[136:139]
v_cvt_pk_bf16_f32 v249, v190, v191
v_mfma_f32_16x16x32_bf16 a[136:139], a[0:3], v[180:183], a[136:139]
v_accvgpr_read_b32 v190, a70
v_mfma_f32_16x16x32_bf16 a[136:139], v[232:235], v[228:231], a[136:139]
s_waitcnt lgkmcnt(10)
v_accvgpr_read_b32 v191, a71
v_mfma_f32_16x16x32_bf16 a[100:103], a[24:27], v[64:67], a[100:103]
s_waitcnt lgkmcnt(8)
v_mul_f32 v188, v188, v28
v_mfma_f32_16x16x32_bf16 a[100:103], a[20:23], v[88:91], a[100:103]
s_waitcnt lgkmcnt(6)
v_mul_f32 v189, v189, v28
v_mfma_f32_16x16x32_bf16 a[100:103], a[16:19], v[112:115], a[100:103]
s_waitcnt lgkmcnt(4)
v_cvt_pk_bf16_f32 v250, v188, v189
v_mfma_f32_16x16x32_bf16 a[100:103], a[12:15], v[136:139], a[100:103]
s_waitcnt lgkmcnt(2)
v_mfma_f32_16x16x32_bf16 a[100:103], v[12:15], v[160:163], a[100:103]
s_waitcnt lgkmcnt(0)
v_mul_f32 v190, v190, v28
v_mfma_f32_16x16x32_bf16 a[100:103], v[0:3], v[208:211], a[100:103]
v_mul_f32 v191, v191, v28
v_mfma_f32_16x16x32_bf16 a[108:111], a[24:27], v[68:71], a[108:111]
v_cvt_pk_bf16_f32 v251, v190, v191
v_mfma_f32_16x16x32_bf16 a[108:111], a[20:23], v[92:95], a[108:111]
v_accvgpr_read_b32 v188, a88
v_mfma_f32_16x16x32_bf16 a[108:111], a[16:19], v[116:119], a[108:111]
v_add_u32 v185, 0xc000, v185
v_accvgpr_read_b32 v189, a89
v_mfma_f32_16x16x32_bf16 a[108:111], a[12:15], v[140:143], a[108:111]
v_accvgpr_read_b32 v190, a90
v_mfma_f32_16x16x32_bf16 a[108:111], v[12:15], v[164:167], a[108:111]
v_accvgpr_read_b32 v191, a91
v_mfma_f32_16x16x32_bf16 a[108:111], v[0:3], v[212:215], a[108:111]
v_mul_f32 v188, v188, v31
v_mfma_f32_16x16x32_bf16 a[116:119], a[24:27], v[72:75], a[116:119]
v_mul_f32 v189, v189, v31
v_mfma_f32_16x16x32_bf16 a[116:119], a[20:23], v[96:99], a[116:119]
v_mfma_f32_16x16x32_bf16 a[116:119], a[16:19], v[120:123], a[116:119]
s_waitcnt vmcnt(12)
s_barrier
v_mfma_f32_16x16x32_bf16 a[116:119], a[12:15], v[144:147], a[116:119]
v_cvt_pk_bf16_f32 v196, v188, v189
v_accvgpr_read_b32 v188, a92
v_mfma_f32_16x16x32_bf16 a[116:119], v[12:15], v[168:171], a[116:119]
ds_read_b64_tr_b16 v[232:233], v185 offset:0
v_accvgpr_read_b32 v189, a93
v_mfma_f32_16x16x32_bf16 a[116:119], v[0:3], v[216:219], a[116:119]
ds_read_b64_tr_b16 v[234:235], v185 offset:2048
v_mul_f32 v190, v190, v31
v_mfma_f32_16x16x32_bf16 a[124:127], a[24:27], v[76:79], a[124:127]
ds_read_b64_tr_b16 a[0:1], v185 offset:4096
v_mul_f32 v191, v191, v31
v_mfma_f32_16x16x32_bf16 a[124:127], a[20:23], v[100:103], a[124:127]
ds_read_b64_tr_b16 a[2:3], v185 offset:6144
v_cvt_pk_bf16_f32 v197, v190, v191
v_mfma_f32_16x16x32_bf16 a[124:127], a[16:19], v[124:127], a[124:127]
ds_read_b64_tr_b16 a[4:5], v185 offset:8192
v_accvgpr_read_b32 v190, a94
v_mfma_f32_16x16x32_bf16 a[124:127], a[12:15], v[148:151], a[124:127]
ds_read_b64_tr_b16 a[6:7], v185 offset:10240
v_accvgpr_read_b32 v191, a95
v_mfma_f32_16x16x32_bf16 a[124:127], v[12:15], v[172:175], a[124:127]
ds_read_b64_tr_b16 a[8:9], v185 offset:12288
v_mul_f32 v188, v188, v31
v_mfma_f32_16x16x32_bf16 a[124:127], v[0:3], v[220:223], a[124:127]
ds_read_b64_tr_b16 a[10:11], v185 offset:14336
v_mul_f32 v189, v189, v31
v_mfma_f32_16x16x32_bf16 a[132:135], a[24:27], v[80:83], a[132:135]
ds_read_b64_tr_b16 v[4:5], v185 offset:16384
v_mfma_f32_16x16x32_bf16 a[132:135], a[20:23], v[104:107], a[132:135]
ds_read_b64_tr_b16 v[6:7], v185 offset:18432
v_cvt_pk_bf16_f32 v198, v188, v189
v_mfma_f32_16x16x32_bf16 a[132:135], a[16:19], v[128:131], a[132:135]
ds_read_b64_tr_b16 v[8:9], v185 offset:20480
v_mul_f32 v190, v190, v31
v_mfma_f32_16x16x32_bf16 a[132:135], a[12:15], v[152:155], a[132:135]
ds_read_b64_tr_b16 v[10:11], v185 offset:22528
v_mul_f32 v191, v191, v31
v_mfma_f32_16x16x32_bf16 a[132:135], v[12:15], v[176:179], a[132:135]
v_cvt_pk_bf16_f32 v199, v190, v191
v_mfma_f32_16x16x32_bf16 a[132:135], v[0:3], v[224:227], a[132:135]
v_mfma_f32_16x16x32_bf16 a[140:143], a[24:27], v[84:87], a[140:143]
v_mfma_f32_16x16x32_bf16 a[140:143], a[20:23], v[108:111], a[140:143]
v_mfma_f32_16x16x32_bf16 a[140:143], a[16:19], v[132:135], a[140:143]
v_mfma_f32_16x16x32_bf16 a[140:143], a[12:15], v[156:159], a[140:143]
v_mfma_f32_16x16x32_bf16 a[140:143], v[12:15], v[180:183], a[140:143]
v_mfma_f32_16x16x32_bf16 a[140:143], v[0:3], v[228:231], a[140:143]
s_waitcnt lgkmcnt(10)
v_mfma_f32_16x16x32_bf16 a[48:51], v[232:235], a[144:147], 0
s_waitcnt lgkmcnt(8)
v_mfma_f32_16x16x32_bf16 a[48:51], a[0:3], a[168:171], a[48:51]
s_waitcnt lgkmcnt(6)
v_mfma_f32_16x16x32_bf16 a[48:51], a[4:7], a[192:195], a[48:51]
s_waitcnt lgkmcnt(4)
v_mfma_f32_16x16x32_bf16 a[48:51], a[8:11], a[216:219], a[48:51]
s_waitcnt lgkmcnt(2)
v_mfma_f32_16x16x32_bf16 a[48:51], v[4:7], a[240:243], a[48:51]
s_waitcnt lgkmcnt(0)
v_mfma_f32_16x16x32_bf16 a[48:51], v[8:11], v[40:43], a[48:51]
v_accvgpr_read_b32 v188, a96
v_accvgpr_read_b32 v189, a97
v_mfma_f32_16x16x32_bf16 a[56:59], v[232:235], a[148:151], 0
v_accvgpr_read_b32 v190, a98
v_mfma_f32_16x16x32_bf16 a[56:59], a[0:3], a[172:175], a[56:59]
v_accvgpr_read_b32 v191, a99
v_mfma_f32_16x16x32_bf16 a[56:59], a[4:7], a[196:199], a[56:59]
v_mul_f32 v188, v188, v26
v_mfma_f32_16x16x32_bf16 a[56:59], a[8:11], a[220:223], a[56:59]
v_mul_f32 v189, v189, v26
v_mfma_f32_16x16x32_bf16 a[56:59], v[4:7], a[244:247], a[56:59]
v_cvt_pk_bf16_f32 v22, v188, v189
v_mfma_f32_16x16x32_bf16 a[56:59], v[8:11], v[44:47], a[56:59]
ds_write_b64 v236, v[240:241]
v_mfma_f32_16x16x32_bf16 a[64:67], v[232:235], a[152:155], 0
v_accvgpr_read_b32 v188, a100
v_mfma_f32_16x16x32_bf16 a[64:67], a[0:3], a[176:179], a[64:67]
v_accvgpr_read_b32 v189, a101
v_mul_f32 v190, v190, v26
v_mfma_f32_16x16x32_bf16 a[64:67], a[4:7], a[200:203], a[64:67]
v_mul_f32 v191, v191, v26
v_mfma_f32_16x16x32_bf16 a[64:67], a[8:11], a[224:227], a[64:67]
v_cvt_pk_bf16_f32 v23, v190, v191
v_mfma_f32_16x16x32_bf16 a[64:67], v[4:7], a[248:251], a[64:67]
ds_read_b64_tr_b16 v[0:1], v185 offset:256
v_mfma_f32_16x16x32_bf16 a[64:67], v[8:11], v[48:51], a[64:67]
ds_read_b64_tr_b16 v[2:3], v185 offset:2304
v_accvgpr_read_b32 v190, a102
v_mfma_f32_16x16x32_bf16 a[72:75], v[232:235], a[156:159], 0
ds_read_b64_tr_b16 v[12:13], v185 offset:4352
v_accvgpr_read_b32 v191, a103
v_mfma_f32_16x16x32_bf16 a[72:75], a[0:3], a[180:183], a[72:75]
ds_read_b64_tr_b16 v[14:15], v185 offset:6400
v_mul_f32 v188, v188, v26
v_mfma_f32_16x16x32_bf16 a[72:75], a[4:7], a[204:207], a[72:75]
ds_read_b64_tr_b16 a[12:13], v185 offset:8448
v_mul_f32 v189, v189, v26
v_mfma_f32_16x16x32_bf16 a[72:75], a[8:11], a[228:231], a[72:75]
ds_read_b64_tr_b16 a[14:15], v185 offset:10496
v_cvt_pk_bf16_f32 v24, v188, v189
v_mfma_f32_16x16x32_bf16 a[72:75], v[4:7], a[252:255], a[72:75]
ds_read_b64_tr_b16 a[16:17], v185 offset:12544
v_mfma_f32_16x16x32_bf16 a[72:75], v[8:11], v[52:55], a[72:75]
ds_read_b64_tr_b16 a[18:19], v185 offset:14592
ds_write_b64 v238, v[22:23]
v_mfma_f32_16x16x32_bf16 a[80:83], v[232:235], a[160:163], 0
ds_read_b64_tr_b16 a[20:21], v185 offset:16640
v_mul_f32 v190, v190, v26
v_mfma_f32_16x16x32_bf16 a[80:83], a[0:3], a[184:187], a[80:83]
ds_read_b64_tr_b16 a[22:23], v185 offset:18688
v_mul_f32 v191, v191, v26
v_mfma_f32_16x16x32_bf16 a[80:83], a[4:7], a[208:211], a[80:83]
ds_read_b64_tr_b16 a[24:25], v185 offset:20736
v_cvt_pk_bf16_f32 v25, v190, v191
v_mfma_f32_16x16x32_bf16 a[80:83], a[8:11], a[232:235], a[80:83]
ds_read_b64_tr_b16 a[26:27], v185 offset:22784
v_mfma_f32_16x16x32_bf16 a[80:83], v[4:7], v[32:35], a[80:83]
ds_write_b64 v237, v[242:243]
v_mfma_f32_16x16x32_bf16 a[80:83], v[8:11], v[56:59], a[80:83]
s_waitcnt lgkmcnt(14)
ds_write_b64 v239, v[24:25]
v_mfma_f32_16x16x32_bf16 a[88:91], v[232:235], a[164:167], 0
s_waitcnt lgkmcnt(14)
ds_read_b128 v[200:203], v186 offset:0
v_accvgpr_read_b32 v188, a120
v_mfma_f32_16x16x32_bf16 a[88:91], a[0:3], a[188:191], a[88:91]
s_waitcnt lgkmcnt(14)
ds_read_b128 v[204:207], v186 offset:1024
v_accvgpr_read_b32 v189, a121
v_mfma_f32_16x16x32_bf16 a[88:91], a[4:7], a[212:215], a[88:91]
v_accvgpr_read_b32 v190, a122
v_accvgpr_read_b32 v191, a123
v_mfma_f32_16x16x32_bf16 a[88:91], a[8:11], a[236:239], a[88:91]
v_mul_f32 v188, v188, v29
v_mul_f32 v189, v189, v29
v_mfma_f32_16x16x32_bf16 a[88:91], v[4:7], v[36:39], a[88:91]
s_add_u32 s51, s49, 0
v_cvt_pk_bf16_f32 v240, v188, v189
v_accvgpr_read_b32 v188, a124
v_mfma_f32_16x16x32_bf16 a[88:91], v[8:11], v[60:63], a[88:91]
v_accvgpr_read_b32 v189, a125
v_mfma_f32_16x16x32_bf16 a[52:55], v[0:3], a[144:147], 0
s_waitcnt lgkmcnt(13)
v_mul_f32 v190, v190, v29
v_mfma_f32_16x16x32_bf16 a[52:55], v[12:15], a[168:171], a[52:55]
s_waitcnt lgkmcnt(11)
v_mul_f32 v191, v191, v29
v_mfma_f32_16x16x32_bf16 a[52:55], a[12:15], a[192:195], a[52:55]
s_waitcnt lgkmcnt(9)
v_cvt_pk_bf16_f32 v241, v190, v191
v_mfma_f32_16x16x32_bf16 a[52:55], a[16:19], a[216:219], a[52:55]
s_waitcnt lgkmcnt(6)
s_waitcnt lgkmcnt(1)
buffer_store_dwordx4 v[200:203], v18, s[40:43], s51 offen sc1
v_mfma_f32_16x16x32_bf16 a[52:55], a[20:23], a[240:243], a[52:55]
v_accvgpr_read_b32 v190, a126
v_mfma_f32_16x16x32_bf16 a[52:55], a[24:27], v[40:43], a[52:55]
v_accvgpr_read_b32 v191, a127
v_mfma_f32_16x16x32_bf16 a[60:63], v[0:3], a[148:151], 0
v_mul_f32 v188, v188, v29
v_mfma_f32_16x16x32_bf16 a[60:63], v[12:15], a[172:175], a[60:63]
v_mul_f32 v189, v189, v29
v_mfma_f32_16x16x32_bf16 a[60:63], a[12:15], a[196:199], a[60:63]
v_cvt_pk_bf16_f32 v242, v188, v189
v_mfma_f32_16x16x32_bf16 a[60:63], a[16:19], a[220:223], a[60:63]
v_mul_f32 v190, v190, v29
v_mfma_f32_16x16x32_bf16 a[60:63], a[20:23], a[244:247], a[60:63]
s_add_u32 s51, s49, 3072
v_mul_f32 v191, v191, v29
v_mfma_f32_16x16x32_bf16 a[60:63], a[24:27], v[44:47], a[60:63]
v_cvt_pk_bf16_f32 v243, v190, v191
v_mfma_f32_16x16x32_bf16 a[68:71], v[0:3], a[152:155], 0
v_accvgpr_read_b32 v188, a104
v_accvgpr_read_b32 v189, a105
v_mfma_f32_16x16x32_bf16 a[68:71], v[12:15], a[176:179], a[68:71]
v_accvgpr_read_b32 v190, a106
v_mfma_f32_16x16x32_bf16 a[68:71], a[12:15], a[200:203], a[68:71]
v_accvgpr_read_b32 v191, a107
v_mfma_f32_16x16x32_bf16 a[68:71], a[16:19], a[224:227], a[68:71]
s_waitcnt lgkmcnt(0)
buffer_store_dwordx4 v[204:207], v18, s[40:43], s51 offen sc1
v_mfma_f32_16x16x32_bf16 a[68:71], a[20:23], a[248:251], a[68:71]
ds_read_b64_tr_b16 v[8:9], v185 offset:24576
v_mfma_f32_16x16x32_bf16 a[68:71], a[24:27], v[48:51], a[68:71]
ds_read_b64_tr_b16 v[10:11], v185 offset:26624
v_mul_f32 v188, v188, v27
v_mfma_f32_16x16x32_bf16 a[76:79], v[0:3], a[156:159], 0
ds_read_b64_tr_b16 v[4:5], v185 offset:28672
v_mul_f32 v189, v189, v27
v_mfma_f32_16x16x32_bf16 a[76:79], v[12:15], a[180:183], a[76:79]
ds_read_b64_tr_b16 v[6:7], v185 offset:30720
v_cvt_pk_bf16_f32 v22, v188, v189
v_mfma_f32_16x16x32_bf16 a[76:79], a[12:15], a[204:207], a[76:79]
ds_read_b64_tr_b16 a[8:9], v185 offset:32768
v_accvgpr_read_b32 v188, a108
v_mfma_f32_16x16x32_bf16 a[76:79], a[16:19], a[228:231], a[76:79]
ds_read_b64_tr_b16 a[10:11], v185 offset:34816
v_accvgpr_read_b32 v189, a109
v_mfma_f32_16x16x32_bf16 a[76:79], a[20:23], a[252:255], a[76:79]
ds_read_b64_tr_b16 a[4:5], v185 offset:36864
v_mul_f32 v190, v190, v27
v_mfma_f32_16x16x32_bf16 a[76:79], a[24:27], v[52:55], a[76:79]
ds_read_b64_tr_b16 a[6:7], v185 offset:38912
v_mul_f32 v191, v191, v27
v_mfma_f32_16x16x32_bf16 a[84:87], v[0:3], a[160:163], 0
ds_read_b64_tr_b16 a[0:1], v185 offset:40960
v_cvt_pk_bf16_f32 v23, v190, v191
v_mfma_f32_16x16x32_bf16 a[84:87], v[12:15], a[184:187], a[84:87]
ds_read_b64_tr_b16 a[2:3], v185 offset:43008
v_mfma_f32_16x16x32_bf16 a[84:87], a[12:15], a[208:211], a[84:87]
ds_read_b64_tr_b16 v[232:233], v185 offset:45056
ds_write_b64 v236, v[244:245] offset:2048
v_mfma_f32_16x16x32_bf16 a[84:87], a[16:19], a[232:235], a[84:87]
ds_read_b64_tr_b16 v[234:235], v185 offset:47104
v_accvgpr_read_b32 v190, a110
v_mfma_f32_16x16x32_bf16 a[84:87], a[20:23], v[32:35], a[84:87]
ds_write_b64 v238, v[22:23] offset:2048
v_mfma_f32_16x16x32_bf16 a[84:87], a[24:27], v[56:59], a[84:87]
v_accvgpr_read_b32 v191, a111
v_mul_f32 v188, v188, v27
v_mfma_f32_16x16x32_bf16 a[92:95], v[0:3], a[164:167], 0
v_mul_f32 v189, v189, v27
v_cvt_pk_bf16_f32 v24, v188, v189
v_mfma_f32_16x16x32_bf16 a[92:95], v[12:15], a[188:191], a[92:95]
ds_write_b64 v237, v[246:247] offset:2048
v_mfma_f32_16x16x32_bf16 a[92:95], a[12:15], a[212:215], a[92:95]
v_mul_f32 v190, v190, v27
v_mul_f32 v191, v191, v27
v_mfma_f32_16x16x32_bf16 a[92:95], a[16:19], a[236:239], a[92:95]
v_cvt_pk_bf16_f32 v25, v190, v191
v_mfma_f32_16x16x32_bf16 a[92:95], a[20:23], v[36:39], a[92:95]
s_waitcnt lgkmcnt(14)
ds_write_b64 v239, v[24:25] offset:2048
v_mfma_f32_16x16x32_bf16 a[92:95], a[24:27], v[60:63], a[92:95]
s_waitcnt lgkmcnt(14)
ds_read_b128 v[200:203], v186 offset:2048
v_mfma_f32_16x16x32_bf16 a[48:51], v[8:11], v[64:67], a[48:51]
s_waitcnt lgkmcnt(13)
ds_read_b128 v[204:207], v186 offset:3072
v_mfma_f32_16x16x32_bf16 a[48:51], v[4:7], v[88:91], a[48:51]
s_waitcnt lgkmcnt(12)
v_accvgpr_read_b32 v188, a128
v_mfma_f32_16x16x32_bf16 a[48:51], a[8:11], v[112:115], a[48:51]
s_waitcnt lgkmcnt(10)
v_accvgpr_read_b32 v189, a129
v_mfma_f32_16x16x32_bf16 a[48:51], a[4:7], v[136:139], a[48:51]
s_waitcnt lgkmcnt(8)
v_accvgpr_read_b32 v190, a130
v_accvgpr_read_b32 v191, a131
v_mfma_f32_16x16x32_bf16 a[48:51], a[0:3], v[160:163], a[48:51]
s_waitcnt lgkmcnt(5)
v_mul_f32 v188, v188, v30
v_mfma_f32_16x16x32_bf16 a[48:51], v[232:235], v[208:211], a[48:51]
v_mul_f32 v189, v189, v30
v_mfma_f32_16x16x32_bf16 a[56:59], v[8:11], v[68:71], a[56:59]
s_add_u32 s51, s49, 6144
v_cvt_pk_bf16_f32 v244, v188, v189
v_mfma_f32_16x16x32_bf16 a[56:59], v[4:7], v[92:95], a[56:59]
v_accvgpr_read_b32 v188, a132
v_mfma_f32_16x16x32_bf16 a[56:59], a[8:11], v[116:119], a[56:59]
v_accvgpr_read_b32 v189, a133
v_mfma_f32_16x16x32_bf16 a[56:59], a[4:7], v[140:143], a[56:59]
v_mul_f32 v190, v190, v30
v_mfma_f32_16x16x32_bf16 a[56:59], a[0:3], v[164:167], a[56:59]
v_mul_f32 v191, v191, v30
v_mfma_f32_16x16x32_bf16 a[56:59], v[232:235], v[212:215], a[56:59]
v_cvt_pk_bf16_f32 v245, v190, v191
v_mfma_f32_16x16x32_bf16 a[64:67], v[8:11], v[72:75], a[64:67]
s_waitcnt lgkmcnt(1)
buffer_store_dwordx4 v[200:203], v18, s[40:43], s51 offen sc1
v_mfma_f32_16x16x32_bf16 a[64:67], v[4:7], v[96:99], a[64:67]
v_accvgpr_read_b32 v190, a134
v_mfma_f32_16x16x32_bf16 a[64:67], a[8:11], v[120:123], a[64:67]
v_accvgpr_read_b32 v191, a135
v_mfma_f32_16x16x32_bf16 a[64:67], a[4:7], v[144:147], a[64:67]
v_mul_f32 v188, v188, v30
v_mfma_f32_16x16x32_bf16 a[64:67], a[0:3], v[168:171], a[64:67]
ds_read_b64_tr_b16 a[24:25], v185 offset:24832
v_mul_f32 v189, v189, v30
v_mfma_f32_16x16x32_bf16 a[64:67], v[232:235], v[216:219], a[64:67]
ds_read_b64_tr_b16 a[26:27], v185 offset:26880
v_cvt_pk_bf16_f32 v246, v188, v189
v_mfma_f32_16x16x32_bf16 a[72:75], v[8:11], v[76:79], a[72:75]
ds_read_b64_tr_b16 a[20:21], v185 offset:28928
v_mul_f32 v190, v190, v30
v_mfma_f32_16x16x32_bf16 a[72:75], v[4:7], v[100:103], a[72:75]
s_add_u32 s51, s49, 9216
ds_read_b64_tr_b16 a[22:23], v185 offset:30976
v_mul_f32 v191, v191, v30
v_mfma_f32_16x16x32_bf16 a[72:75], a[8:11], v[124:127], a[72:75]
ds_read_b64_tr_b16 a[16:17], v185 offset:33024
v_cvt_pk_bf16_f32 v247, v190, v191
v_mfma_f32_16x16x32_bf16 a[72:75], a[4:7], v[148:151], a[72:75]
ds_read_b64_tr_b16 a[18:19], v185 offset:35072
v_accvgpr_read_b32 v188, a112
v_mfma_f32_16x16x32_bf16 a[72:75], a[0:3], v[172:175], a[72:75]
ds_read_b64_tr_b16 a[12:13], v185 offset:37120
v_accvgpr_read_b32 v189, a113
v_mfma_f32_16x16x32_bf16 a[72:75], v[232:235], v[220:223], a[72:75]
ds_read_b64_tr_b16 a[14:15], v185 offset:39168
v_accvgpr_read_b32 v190, a114
v_mfma_f32_16x16x32_bf16 a[80:83], v[8:11], v[80:83], a[80:83]
ds_read_b64_tr_b16 v[12:13], v185 offset:41216
v_accvgpr_read_b32 v191, a115
v_mfma_f32_16x16x32_bf16 a[80:83], v[4:7], v[104:107], a[80:83]
ds_read_b64_tr_b16 v[14:15], v185 offset:43264
v_mul_f32 v188, v188, v28
v_mfma_f32_16x16x32_bf16 a[80:83], a[8:11], v[128:131], a[80:83]
ds_read_b64_tr_b16 v[0:1], v185 offset:45312
v_mul_f32 v189, v189, v28
v_mfma_f32_16x16x32_bf16 a[80:83], a[4:7], v[152:155], a[80:83]
ds_read_b64_tr_b16 v[2:3], v185 offset:47360
v_cvt_pk_bf16_f32 v22, v188, v189
v_mfma_f32_16x16x32_bf16 a[80:83], a[0:3], v[176:179], a[80:83]
s_waitcnt lgkmcnt(12)
buffer_store_dwordx4 v[204:207], v18, s[40:43], s51 offen sc1
v_mfma_f32_16x16x32_bf16 a[80:83], v[232:235], v[224:227], a[80:83]
ds_write_b64 v236, v[248:249]
v_mfma_f32_16x16x32_bf16 a[88:91], v[8:11], v[84:87], a[88:91]
v_accvgpr_read_b32 v188, a116
v_accvgpr_read_b32 v189, a117
v_mfma_f32_16x16x32_bf16 a[88:91], v[4:7], v[108:111], a[88:91]
v_mul_f32 v190, v190, v28
v_mfma_f32_16x16x32_bf16 a[88:91], a[8:11], v[132:135], a[88:91]
v_mul_f32 v191, v191, v28
v_cvt_pk_bf16_f32 v23, v190, v191
v_mfma_f32_16x16x32_bf16 a[88:91], a[4:7], v[156:159], a[88:91]
ds_write_b64 v238, v[22:23]
v_mfma_f32_16x16x32_bf16 a[88:91], a[0:3], v[180:183], a[88:91]
v_mfma_f32_16x16x32_bf16 a[88:91], v[232:235], v[228:231], a[88:91]
s_waitcnt lgkmcnt(12)
v_accvgpr_read_b32 v190, a118
v_accvgpr_read_b32 v191, a119
v_mfma_f32_16x16x32_bf16 a[52:55], a[24:27], v[64:67], a[52:55]
s_waitcnt lgkmcnt(10)
v_mul_f32 v188, v188, v28
v_mfma_f32_16x16x32_bf16 a[52:55], a[20:23], v[88:91], a[52:55]
s_waitcnt lgkmcnt(8)
v_mul_f32 v189, v189, v28
v_mfma_f32_16x16x32_bf16 a[52:55], a[16:19], v[112:115], a[52:55]
s_waitcnt lgkmcnt(6)
v_cvt_pk_bf16_f32 v24, v188, v189
v_mfma_f32_16x16x32_bf16 a[52:55], a[12:15], v[136:139], a[52:55]
s_waitcnt lgkmcnt(4)
ds_write_b64 v237, v[250:251]
v_mfma_f32_16x16x32_bf16 a[52:55], v[12:15], v[160:163], a[52:55]
s_waitcnt lgkmcnt(3)
v_mul_f32 v190, v190, v28
v_mfma_f32_16x16x32_bf16 a[52:55], v[0:3], v[208:211], a[52:55]
v_mul_f32 v191, v191, v28
v_mfma_f32_16x16x32_bf16 a[60:63], a[24:27], v[68:71], a[60:63]
v_cvt_pk_bf16_f32 v25, v190, v191
v_mfma_f32_16x16x32_bf16 a[60:63], a[20:23], v[92:95], a[60:63]
ds_write_b64 v239, v[24:25]
v_mfma_f32_16x16x32_bf16 a[60:63], a[16:19], v[116:119], a[60:63]
ds_read_b128 v[200:203], v186 offset:0
v_mfma_f32_16x16x32_bf16 a[60:63], a[12:15], v[140:143], a[60:63]
ds_read_b128 v[204:207], v186 offset:1024
v_mfma_f32_16x16x32_bf16 a[60:63], v[12:15], v[164:167], a[60:63]
v_accvgpr_read_b32 v188, a136
v_accvgpr_read_b32 v189, a137
v_mfma_f32_16x16x32_bf16 a[60:63], v[0:3], v[212:215], a[60:63]
v_accvgpr_read_b32 v190, a138
v_mfma_f32_16x16x32_bf16 a[68:71], a[24:27], v[72:75], a[68:71]
v_accvgpr_read_b32 v191, a139
v_mfma_f32_16x16x32_bf16 a[68:71], a[20:23], v[96:99], a[68:71]
v_mul_f32 v188, v188, v31
v_mfma_f32_16x16x32_bf16 a[68:71], a[16:19], v[120:123], a[68:71]
v_mul_f32 v189, v189, v31
v_mfma_f32_16x16x32_bf16 a[68:71], a[12:15], v[144:147], a[68:71]
s_add_u32 s51, s49, 12288
v_cvt_pk_bf16_f32 v248, v188, v189
v_mfma_f32_16x16x32_bf16 a[68:71], v[12:15], v[168:171], a[68:71]
ds_read_b64_tr_b16 v[232:233], v185 offset:512
v_accvgpr_read_b32 v188, a140
v_mfma_f32_16x16x32_bf16 a[68:71], v[0:3], v[216:219], a[68:71]
ds_read_b64_tr_b16 v[234:235], v185 offset:2560
v_accvgpr_read_b32 v189, a141
v_mfma_f32_16x16x32_bf16 a[76:79], a[24:27], v[76:79], a[76:79]
ds_read_b64_tr_b16 a[0:1], v185 offset:4608
v_mul_f32 v190, v190, v31
v_mfma_f32_16x16x32_bf16 a[76:79], a[20:23], v[100:103], a[76:79]
ds_read_b64_tr_b16 a[2:3], v185 offset:6656
v_mul_f32 v191, v191, v31
v_mfma_f32_16x16x32_bf16 a[76:79], a[16:19], v[124:127], a[76:79]
ds_read_b64_tr_b16 a[4:5], v185 offset:8704
v_cvt_pk_bf16_f32 v249, v190, v191
v_mfma_f32_16x16x32_bf16 a[76:79], a[12:15], v[148:151], a[76:79]
ds_read_b64_tr_b16 a[6:7], v185 offset:10752
v_mfma_f32_16x16x32_bf16 a[76:79], v[12:15], v[172:175], a[76:79]
ds_read_b64_tr_b16 a[8:9], v185 offset:12800
v_accvgpr_read_b32 v190, a142
v_mfma_f32_16x16x32_bf16 a[76:79], v[0:3], v[220:223], a[76:79]
ds_read_b64_tr_b16 a[10:11], v185 offset:14848
v_accvgpr_read_b32 v191, a143
v_mfma_f32_16x16x32_bf16 a[84:87], a[24:27], v[80:83], a[84:87]
ds_read_b64_tr_b16 v[4:5], v185 offset:16896
v_mul_f32 v188, v188, v31
v_mfma_f32_16x16x32_bf16 a[84:87], a[20:23], v[104:107], a[84:87]
s_waitcnt lgkmcnt(14)
ds_read_b64_tr_b16 v[6:7], v185 offset:18944
v_mul_f32 v189, v189, v31
v_mfma_f32_16x16x32_bf16 a[84:87], a[16:19], v[128:131], a[84:87]
s_waitcnt lgkmcnt(14)
ds_read_b64_tr_b16 v[8:9], v185 offset:20992
v_cvt_pk_bf16_f32 v250, v188, v189
v_mfma_f32_16x16x32_bf16 a[84:87], a[12:15], v[152:155], a[84:87]
s_waitcnt lgkmcnt(14)
ds_read_b64_tr_b16 v[10:11], v185 offset:23040
s_waitcnt lgkmcnt(13)
buffer_store_dwordx4 v[200:203], v18, s[40:43], s51 offen sc1
v_mfma_f32_16x16x32_bf16 a[84:87], v[12:15], v[176:179], a[84:87]
v_mul_f32 v190, v190, v31
v_mul_f32 v191, v191, v31
v_mfma_f32_16x16x32_bf16 a[84:87], v[0:3], v[224:227], a[84:87]
s_add_u32 s51, s49, 15360
v_cvt_pk_bf16_f32 v251, v190, v191
v_mfma_f32_16x16x32_bf16 a[92:95], a[24:27], v[84:87], a[92:95]
v_mfma_f32_16x16x32_bf16 a[92:95], a[20:23], v[108:111], a[92:95]
v_mfma_f32_16x16x32_bf16 a[92:95], a[16:19], v[132:135], a[92:95]
v_mfma_f32_16x16x32_bf16 a[92:95], a[12:15], v[156:159], a[92:95]
s_waitcnt lgkmcnt(12)
buffer_store_dwordx4 v[204:207], v18, s[40:43], s51 offen sc1
v_mfma_f32_16x16x32_bf16 a[92:95], v[12:15], v[180:183], a[92:95]
v_mfma_f32_16x16x32_bf16 a[92:95], v[0:3], v[228:231], a[92:95]
s_waitcnt lgkmcnt(10)
v_mfma_f32_16x16x32_bf16 a[96:99], v[232:235], a[144:147], 0
s_waitcnt lgkmcnt(8)
v_mfma_f32_16x16x32_bf16 a[96:99], a[0:3], a[168:171], a[96:99]
s_waitcnt lgkmcnt(6)
v_mfma_f32_16x16x32_bf16 a[96:99], a[4:7], a[192:195], a[96:99]
s_waitcnt lgkmcnt(4)
v_mfma_f32_16x16x32_bf16 a[96:99], a[8:11], a[216:219], a[96:99]
s_waitcnt lgkmcnt(2)
v_mfma_f32_16x16x32_bf16 a[96:99], v[4:7], a[240:243], a[96:99]
s_waitcnt lgkmcnt(0)
v_mfma_f32_16x16x32_bf16 a[96:99], v[8:11], v[40:43], a[96:99]
ds_write_b64 v236, v[252:253] offset:2048
v_mfma_f32_16x16x32_bf16 a[104:107], v[232:235], a[148:151], 0
ds_write_b64 v237, v[254:255] offset:2048
v_mfma_f32_16x16x32_bf16 a[104:107], a[0:3], a[172:175], a[104:107]
ds_write_b64 v238, v[240:241] offset:2048
v_mfma_f32_16x16x32_bf16 a[104:107], a[4:7], a[196:199], a[104:107]
ds_write_b64 v239, v[242:243] offset:2048
v_mfma_f32_16x16x32_bf16 a[104:107], a[8:11], a[220:223], a[104:107]
v_mfma_f32_16x16x32_bf16 a[104:107], v[4:7], a[244:247], a[104:107]
ds_read_b128 v[200:203], v186 offset:2048
v_mfma_f32_16x16x32_bf16 a[104:107], v[8:11], v[44:47], a[104:107]
ds_read_b128 v[204:207], v186 offset:3072
v_accvgpr_read_b32 v188, a48
v_mfma_f32_16x16x32_bf16 a[112:115], v[232:235], a[152:155], 0
v_accvgpr_read_b32 v189, a49
v_mfma_f32_16x16x32_bf16 a[112:115], a[0:3], a[176:179], a[112:115]
v_accvgpr_read_b32 v190, a50
v_mfma_f32_16x16x32_bf16 a[112:115], a[4:7], a[200:203], a[112:115]
v_accvgpr_read_b32 v191, a51
v_mfma_f32_16x16x32_bf16 a[112:115], a[8:11], a[224:227], a[112:115]
v_mul_f32 v188, v188, v26
v_mul_f32 v189, v189, v26
v_mfma_f32_16x16x32_bf16 a[112:115], v[4:7], a[248:251], a[112:115]
s_add_u32 s51, s49, 18432
ds_read_b64_tr_b16 v[0:1], v185 offset:768
v_mfma_f32_16x16x32_bf16 a[112:115], v[8:11], v[48:51], a[112:115]
ds_read_b64_tr_b16 v[2:3], v185 offset:2816
v_cvt_pk_bf16_f32 v240, v188, v189
v_mfma_f32_16x16x32_bf16 a[120:123], v[232:235], a[156:159], 0
ds_read_b64_tr_b16 v[12:13], v185 offset:4864
v_accvgpr_read_b32 v188, a52
v_mfma_f32_16x16x32_bf16 a[120:123], a[0:3], a[180:183], a[120:123]
ds_read_b64_tr_b16 v[14:15], v185 offset:6912
v_accvgpr_read_b32 v189, a53
v_mfma_f32_16x16x32_bf16 a[120:123], a[4:7], a[204:207], a[120:123]
ds_read_b64_tr_b16 a[12:13], v185 offset:8960
v_mul_f32 v190, v190, v26
v_mfma_f32_16x16x32_bf16 a[120:123], a[8:11], a[228:231], a[120:123]
ds_read_b64_tr_b16 a[14:15], v185 offset:11008
v_mul_f32 v191, v191, v26
v_mfma_f32_16x16x32_bf16 a[120:123], v[4:7], a[252:255], a[120:123]
ds_read_b64_tr_b16 a[16:17], v185 offset:13056
v_cvt_pk_bf16_f32 v241, v190, v191
v_mfma_f32_16x16x32_bf16 a[120:123], v[8:11], v[52:55], a[120:123]
ds_read_b64_tr_b16 a[18:19], v185 offset:15104
v_accvgpr_read_b32 v190, a54
v_mfma_f32_16x16x32_bf16 a[128:131], v[232:235], a[160:163], 0
ds_read_b64_tr_b16 a[20:21], v185 offset:17152
v_accvgpr_read_b32 v191, a55
v_mfma_f32_16x16x32_bf16 a[128:131], a[0:3], a[184:187], a[128:131]
s_waitcnt lgkmcnt(14)
ds_read_b64_tr_b16 a[22:23], v185 offset:19200
v_mul_f32 v188, v188, v26
v_mfma_f32_16x16x32_bf16 a[128:131], a[4:7], a[208:211], a[128:131]
s_waitcnt lgkmcnt(14)
ds_read_b64_tr_b16 a[24:25], v185 offset:21248
v_mul_f32 v189, v189, v26
v_mfma_f32_16x16x32_bf16 a[128:131], a[8:11], a[232:235], a[128:131]
s_waitcnt lgkmcnt(14)
ds_read_b64_tr_b16 a[26:27], v185 offset:23296
v_cvt_pk_bf16_f32 v242, v188, v189
v_mfma_f32_16x16x32_bf16 a[128:131], v[4:7], v[32:35], a[128:131]
s_waitcnt lgkmcnt(13)
buffer_store_dwordx4 v[200:203], v18, s[40:43], s51 offen sc1
v_mfma_f32_16x16x32_bf16 a[128:131], v[8:11], v[56:59], a[128:131]
v_mul_f32 v190, v190, v26
v_mul_f32 v191, v191, v26
v_mfma_f32_16x16x32_bf16 a[136:139], v[232:235], a[164:167], 0
s_add_u32 s51, s49, 21504
v_cvt_pk_bf16_f32 v243, v190, v191
v_accvgpr_read_b32 v188, a72
v_mfma_f32_16x16x32_bf16 a[136:139], a[0:3], a[188:191], a[136:139]
v_accvgpr_read_b32 v189, a73
v_mfma_f32_16x16x32_bf16 a[136:139], a[4:7], a[212:215], a[136:139]
v_accvgpr_read_b32 v190, a74
v_mfma_f32_16x16x32_bf16 a[136:139], a[8:11], a[236:239], a[136:139]
v_accvgpr_read_b32 v191, a75
v_mfma_f32_16x16x32_bf16 a[136:139], v[4:7], v[36:39], a[136:139]
v_mul_f32 v188, v188, v29
v_mul_f32 v189, v189, v29
v_mfma_f32_16x16x32_bf16 a[136:139], v[8:11], v[60:63], a[136:139]
s_waitcnt lgkmcnt(10)
buffer_store_dwordx4 v[204:207], v18, s[40:43], s51 offen sc1
v_mfma_f32_16x16x32_bf16 a[100:103], v[0:3], a[144:147], 0
s_waitcnt lgkmcnt(8)
v_mfma_f32_16x16x32_bf16 a[100:103], v[12:15], a[168:171], a[100:103]
s_waitcnt lgkmcnt(6)
v_cvt_pk_bf16_f32 v252, v188, v189
v_mfma_f32_16x16x32_bf16 a[100:103], a[12:15], a[192:195], a[100:103]
s_waitcnt lgkmcnt(4)
v_accvgpr_read_b32 v188, a76
v_mfma_f32_16x16x32_bf16 a[100:103], a[16:19], a[216:219], a[100:103]
s_waitcnt lgkmcnt(2)
v_accvgpr_read_b32 v189, a77
v_mul_f32 v190, v190, v29
v_mfma_f32_16x16x32_bf16 a[100:103], a[20:23], a[240:243], a[100:103]
s_waitcnt lgkmcnt(0)
v_mul_f32 v191, v191, v29
v_mfma_f32_16x16x32_bf16 a[100:103], a[24:27], v[40:43], a[100:103]
v_cvt_pk_bf16_f32 v253, v190, v191
v_mfma_f32_16x16x32_bf16 a[108:111], v[0:3], a[148:151], 0
v_accvgpr_read_b32 v190, a78
v_mfma_f32_16x16x32_bf16 a[108:111], v[12:15], a[172:175], a[108:111]
v_accvgpr_read_b32 v191, a79
v_mfma_f32_16x16x32_bf16 a[108:111], a[12:15], a[196:199], a[108:111]
v_mul_f32 v188, v188, v29
v_mul_f32 v189, v189, v29
v_mfma_f32_16x16x32_bf16 a[108:111], a[16:19], a[220:223], a[108:111]
v_cvt_pk_bf16_f32 v254, v188, v189
v_mfma_f32_16x16x32_bf16 a[108:111], a[20:23], a[244:247], a[108:111]
v_mul_f32 v190, v190, v29
v_mfma_f32_16x16x32_bf16 a[108:111], a[24:27], v[44:47], a[108:111]
v_mul_f32 v191, v191, v29
v_mfma_f32_16x16x32_bf16 a[116:119], v[0:3], a[152:155], 0
v_cvt_pk_bf16_f32 v255, v190, v191
v_mfma_f32_16x16x32_bf16 a[116:119], v[12:15], a[176:179], a[116:119]
ds_write_b64 v236, v[192:193]
v_mfma_f32_16x16x32_bf16 a[116:119], a[12:15], a[200:203], a[116:119]
ds_write_b64 v237, v[194:195]
v_mfma_f32_16x16x32_bf16 a[116:119], a[16:19], a[224:227], a[116:119]
ds_write_b64 v238, v[244:245]
v_mfma_f32_16x16x32_bf16 a[116:119], a[20:23], a[248:251], a[116:119]
ds_read_b64_tr_b16 v[8:9], v185 offset:25088
v_mfma_f32_16x16x32_bf16 a[116:119], a[24:27], v[48:51], a[116:119]
ds_read_b64_tr_b16 v[10:11], v185 offset:27136
v_mfma_f32_16x16x32_bf16 a[124:127], v[0:3], a[156:159], 0
ds_read_b64_tr_b16 v[4:5], v185 offset:29184
v_mfma_f32_16x16x32_bf16 a[124:127], v[12:15], a[180:183], a[124:127]
ds_read_b64_tr_b16 v[6:7], v185 offset:31232
v_accvgpr_read_b32 v188, a56
v_mfma_f32_16x16x32_bf16 a[124:127], a[12:15], a[204:207], a[124:127]
ds_read_b64_tr_b16 a[8:9], v185 offset:33280
v_accvgpr_read_b32 v189, a57
v_mfma_f32_16x16x32_bf16 a[124:127], a[16:19], a[228:231], a[124:127]
ds_read_b64_tr_b16 a[10:11], v185 offset:35328
v_accvgpr_read_b32 v190, a58
v_mfma_f32_16x16x32_bf16 a[124:127], a[20:23], a[252:255], a[124:127]
ds_read_b64_tr_b16 a[4:5], v185 offset:37376
v_accvgpr_read_b32 v191, a59
v_mfma_f32_16x16x32_bf16 a[124:127], a[24:27], v[52:55], a[124:127]
ds_read_b64_tr_b16 a[6:7], v185 offset:39424
ds_write_b64 v239, v[246:247]
v_mfma_f32_16x16x32_bf16 a[132:135], v[0:3], a[160:163], 0
ds_read_b64_tr_b16 a[0:1], v185 offset:41472
v_mul_f32 v188, v188, v27
v_mfma_f32_16x16x32_bf16 a[132:135], v[12:15], a[184:187], a[132:135]
ds_read_b64_tr_b16 a[2:3], v185 offset:43520
ds_read_b128 v[200:203], v186 offset:0
s_waitcnt lgkmcnt(14)
ds_read_b128 v[204:207], v186 offset:1024
v_mfma_f32_16x16x32_bf16 a[132:135], a[12:15], a[208:211], a[132:135]
s_waitcnt lgkmcnt(14)
ds_read_b64_tr_b16 v[232:233], v185 offset:45568
v_mul_f32 v189, v189, v27
v_mfma_f32_16x16x32_bf16 a[132:135], a[16:19], a[232:235], a[132:135]
s_add_u32 s51, s49, 24576
s_waitcnt lgkmcnt(14)
ds_read_b64_tr_b16 v[234:235], v185 offset:47616
v_cvt_pk_bf16_f32 v244, v188, v189
v_mfma_f32_16x16x32_bf16 a[132:135], a[20:23], v[32:35], a[132:135]
v_accvgpr_read_b32 v188, a60
v_accvgpr_read_b32 v189, a61
v_mfma_f32_16x16x32_bf16 a[132:135], a[24:27], v[56:59], a[132:135]
v_mul_f32 v190, v190, v27
v_mul_f32 v191, v191, v27
v_mfma_f32_16x16x32_bf16 a[140:143], v[0:3], a[164:167], 0
v_cvt_pk_bf16_f32 v245, v190, v191
v_mfma_f32_16x16x32_bf16 a[140:143], v[12:15], a[188:191], a[140:143]
s_waitcnt lgkmcnt(3)
buffer_store_dwordx4 v[200:203], v18, s[40:43], s51 offen sc1
v_mfma_f32_16x16x32_bf16 a[140:143], a[12:15], a[212:215], a[140:143]
v_accvgpr_read_b32 v190, a62
v_accvgpr_read_b32 v191, a63
v_mfma_f32_16x16x32_bf16 a[140:143], a[16:19], a[236:239], a[140:143]
v_mul_f32 v188, v188, v27
v_mfma_f32_16x16x32_bf16 a[140:143], a[20:23], v[36:39], a[140:143]
v_mul_f32 v189, v189, v27
v_mfma_f32_16x16x32_bf16 a[140:143], a[24:27], v[60:63], a[140:143]
v_cvt_pk_bf16_f32 v246, v188, v189
v_mfma_f32_16x16x32_bf16 a[96:99], v[8:11], v[64:67], a[96:99]
v_mul_f32 v190, v190, v27
v_mfma_f32_16x16x32_bf16 a[96:99], v[4:7], v[88:91], a[96:99]
v_mul_f32 v191, v191, v27
v_mfma_f32_16x16x32_bf16 a[96:99], a[8:11], v[112:115], a[96:99]
v_cvt_pk_bf16_f32 v247, v190, v191
v_accvgpr_read_b32 v188, a80
v_mfma_f32_16x16x32_bf16 a[96:99], a[4:7], v[136:139], a[96:99]
v_accvgpr_read_b32 v189, a81
v_mfma_f32_16x16x32_bf16 a[96:99], a[0:3], v[160:163], a[96:99]
s_waitcnt lgkmcnt(0)
v_accvgpr_read_b32 v190, a82
v_mfma_f32_16x16x32_bf16 a[96:99], v[232:235], v[208:211], a[96:99]
s_add_u32 s51, s49, 27648
v_accvgpr_read_b32 v191, a83
v_mfma_f32_16x16x32_bf16 a[104:107], v[8:11], v[68:71], a[104:107]
v_mul_f32 v188, v188, v30
v_mfma_f32_16x16x32_bf16 a[104:107], v[4:7], v[92:95], a[104:107]
v_mul_f32 v189, v189, v30
v_mfma_f32_16x16x32_bf16 a[104:107], a[8:11], v[116:119], a[104:107]
buffer_store_dwordx4 v[204:207], v18, s[40:43], s51 offen sc1
v_mfma_f32_16x16x32_bf16 a[104:107], a[4:7], v[140:143], a[104:107]
v_cvt_pk_bf16_f32 v192, v188, v189
v_mfma_f32_16x16x32_bf16 a[104:107], a[0:3], v[164:167], a[104:107]
v_accvgpr_read_b32 v188, a84
v_mfma_f32_16x16x32_bf16 a[104:107], v[232:235], v[212:215], a[104:107]
v_accvgpr_read_b32 v189, a85
v_mfma_f32_16x16x32_bf16 a[112:115], v[8:11], v[72:75], a[112:115]
v_mul_f32 v190, v190, v30
v_mul_f32 v191, v191, v30
v_mfma_f32_16x16x32_bf16 a[112:115], v[4:7], v[96:99], a[112:115]
v_cvt_pk_bf16_f32 v193, v190, v191
v_mfma_f32_16x16x32_bf16 a[112:115], a[8:11], v[120:123], a[112:115]
v_accvgpr_read_b32 v190, a86
v_mfma_f32_16x16x32_bf16 a[112:115], a[4:7], v[144:147], a[112:115]
v_accvgpr_read_b32 v191, a87
v_mfma_f32_16x16x32_bf16 a[112:115], a[0:3], v[168:171], a[112:115]
ds_read_b64_tr_b16 a[24:25], v185 offset:25344
v_mul_f32 v188, v188, v30
v_mfma_f32_16x16x32_bf16 a[112:115], v[232:235], v[216:219], a[112:115]
ds_read_b64_tr_b16 a[26:27], v185 offset:27392
v_mul_f32 v189, v189, v30
v_mfma_f32_16x16x32_bf16 a[120:123], v[8:11], v[76:79], a[120:123]
ds_read_b64_tr_b16 a[20:21], v185 offset:29440
v_cvt_pk_bf16_f32 v194, v188, v189
v_mfma_f32_16x16x32_bf16 a[120:123], v[4:7], v[100:103], a[120:123]
ds_read_b64_tr_b16 a[22:23], v185 offset:31488
v_mul_f32 v190, v190, v30
v_mfma_f32_16x16x32_bf16 a[120:123], a[8:11], v[124:127], a[120:123]
ds_read_b64_tr_b16 a[16:17], v185 offset:33536
v_mul_f32 v191, v191, v30
v_mfma_f32_16x16x32_bf16 a[120:123], a[4:7], v[148:151], a[120:123]
ds_read_b64_tr_b16 a[18:19], v185 offset:35584
v_cvt_pk_bf16_f32 v195, v190, v191
v_mfma_f32_16x16x32_bf16 a[120:123], a[0:3], v[172:175], a[120:123]
ds_read_b64_tr_b16 a[12:13], v185 offset:37632
v_mfma_f32_16x16x32_bf16 a[120:123], v[232:235], v[220:223], a[120:123]
ds_read_b64_tr_b16 a[14:15], v185 offset:39680
v_mfma_f32_16x16x32_bf16 a[128:131], v[8:11], v[80:83], a[128:131]
ds_read_b64_tr_b16 v[12:13], v185 offset:41728
v_mfma_f32_16x16x32_bf16 a[128:131], v[4:7], v[104:107], a[128:131]
ds_read_b64_tr_b16 v[14:15], v185 offset:43776
v_mfma_f32_16x16x32_bf16 a[128:131], a[8:11], v[128:131], a[128:131]
ds_read_b64_tr_b16 v[0:1], v185 offset:45824
v_mfma_f32_16x16x32_bf16 a[128:131], a[4:7], v[152:155], a[128:131]
ds_read_b64_tr_b16 v[2:3], v185 offset:47872
v_accvgpr_read_b32 v188, a64
v_mfma_f32_16x16x32_bf16 a[128:131], a[0:3], v[176:179], a[128:131]
ds_write_b64 v236, v[196:197] offset:2048
v_mfma_f32_16x16x32_bf16 a[128:131], v[232:235], v[224:227], a[128:131]
ds_write_b64 v237, v[198:199] offset:2048
v_mfma_f32_16x16x32_bf16 a[136:139], v[8:11], v[84:87], a[136:139]
ds_write_b64 v238, v[248:249] offset:2048
v_mfma_f32_16x16x32_bf16 a[136:139], v[4:7], v[108:111], a[136:139]
s_waitcnt lgkmcnt(14)
ds_write_b64 v239, v[250:251] offset:2048
v_mfma_f32_16x16x32_bf16 a[136:139], a[8:11], v[132:135], a[136:139]
s_waitcnt lgkmcnt(14)
ds_read_b128 v[200:203], v186 offset:2048
v_accvgpr_read_b32 v189, a65
v_mfma_f32_16x16x32_bf16 a[136:139], a[4:7], v[156:159], a[136:139]
s_waitcnt lgkmcnt(14)
ds_read_b128 v[204:207], v186 offset:3072
v_accvgpr_read_b32 v190, a66
v_mfma_f32_16x16x32_bf16 a[136:139], a[0:3], v[180:183], a[136:139]
v_accvgpr_read_b32 v191, a67
v_mul_f32 v188, v188, v28
v_mfma_f32_16x16x32_bf16 a[136:139], v[232:235], v[228:231], a[136:139]
v_mul_f32 v189, v189, v28
v_cvt_pk_bf16_f32 v248, v188, v189
v_mfma_f32_16x16x32_bf16 a[100:103], a[24:27], v[64:67], a[100:103]
s_waitcnt lgkmcnt(14)
v_accvgpr_read_b32 v188, a68
v_accvgpr_read_b32 v189, a69
v_mfma_f32_16x16x32_bf16 a[100:103], a[20:23], v[88:91], a[100:103]
s_waitcnt lgkmcnt(12)
v_mul_f32 v190, v190, v28
v_mul_f32 v191, v191, v28
v_mfma_f32_16x16x32_bf16 a[100:103], a[16:19], v[112:115], a[100:103]
s_waitcnt lgkmcnt(10)
v_cvt_pk_bf16_f32 v249, v190, v191
v_mfma_f32_16x16x32_bf16 a[100:103], a[12:15], v[136:139], a[100:103]
s_waitcnt lgkmcnt(8)
s_add_u32 s51, s49, 30720
s_waitcnt lgkmcnt(1)
buffer_store_dwordx4 v[200:203], v18, s[40:43], s51 offen sc1
v_mfma_f32_16x16x32_bf16 a[100:103], v[12:15], v[160:163], a[100:103]
v_accvgpr_read_b32 v190, a70
v_accvgpr_read_b32 v191, a71
v_mfma_f32_16x16x32_bf16 a[100:103], v[0:3], v[208:211], a[100:103]
v_mul_f32 v188, v188, v28
v_mfma_f32_16x16x32_bf16 a[108:111], a[24:27], v[68:71], a[108:111]
v_mul_f32 v189, v189, v28
v_mfma_f32_16x16x32_bf16 a[108:111], a[20:23], v[92:95], a[108:111]
v_cvt_pk_bf16_f32 v250, v188, v189
v_mfma_f32_16x16x32_bf16 a[108:111], a[16:19], v[116:119], a[108:111]
v_add_u32 v184, 0x18000, v184
v_mul_f32 v190, v190, v28
v_mfma_f32_16x16x32_bf16 a[108:111], a[12:15], v[140:143], a[108:111]
s_add_u32 s51, s49, 33792
v_mul_f32 v191, v191, v28
v_mfma_f32_16x16x32_bf16 a[108:111], v[12:15], v[164:167], a[108:111]
v_cvt_pk_bf16_f32 v251, v190, v191
v_mfma_f32_16x16x32_bf16 a[108:111], v[0:3], v[212:215], a[108:111]
v_accvgpr_read_b32 v188, a88
v_accvgpr_read_b32 v189, a89
v_mfma_f32_16x16x32_bf16 a[116:119], a[24:27], v[72:75], a[116:119]
v_accvgpr_read_b32 v190, a90
v_mfma_f32_16x16x32_bf16 a[116:119], a[20:23], v[96:99], a[116:119]
v_accvgpr_read_b32 v191, a91
v_mfma_f32_16x16x32_bf16 a[116:119], a[16:19], v[120:123], a[116:119]
s_waitcnt vmcnt(11)
s_barrier
v_mfma_f32_16x16x32_bf16 a[116:119], a[12:15], v[144:147], a[116:119]
v_mul_f32 v188, v188, v31
v_mul_f32 v189, v189, v31
v_mfma_f32_16x16x32_bf16 a[116:119], v[12:15], v[168:171], a[116:119]
ds_read_b64_tr_b16 v[232:233], v184 offset:0
v_mfma_f32_16x16x32_bf16 a[116:119], v[0:3], v[216:219], a[116:119]
ds_read_b64_tr_b16 v[234:235], v184 offset:2048
v_cvt_pk_bf16_f32 v196, v188, v189
v_mfma_f32_16x16x32_bf16 a[124:127], a[24:27], v[76:79], a[124:127]
ds_read_b64_tr_b16 a[0:1], v184 offset:4096
v_accvgpr_read_b32 v188, a92
v_mfma_f32_16x16x32_bf16 a[124:127], a[20:23], v[100:103], a[124:127]
ds_read_b64_tr_b16 a[2:3], v184 offset:6144
v_accvgpr_read_b32 v189, a93
v_mfma_f32_16x16x32_bf16 a[124:127], a[16:19], v[124:127], a[124:127]
ds_read_b64_tr_b16 a[4:5], v184 offset:8192
v_mul_f32 v190, v190, v31
v_mfma_f32_16x16x32_bf16 a[124:127], a[12:15], v[148:151], a[124:127]
ds_read_b64_tr_b16 a[6:7], v184 offset:10240
v_mul_f32 v191, v191, v31
v_mfma_f32_16x16x32_bf16 a[124:127], v[12:15], v[172:175], a[124:127]
ds_read_b64_tr_b16 a[8:9], v184 offset:12288
v_cvt_pk_bf16_f32 v197, v190, v191
v_mfma_f32_16x16x32_bf16 a[124:127], v[0:3], v[220:223], a[124:127]
ds_read_b64_tr_b16 a[10:11], v184 offset:14336
s_waitcnt lgkmcnt(8)
buffer_store_dwordx4 v[204:207], v18, s[40:43], s51 offen sc1
v_mfma_f32_16x16x32_bf16 a[132:135], a[24:27], v[80:83], a[132:135]
ds_read_b64_tr_b16 v[4:5], v184 offset:16384
v_accvgpr_read_b32 v190, a94
v_mfma_f32_16x16x32_bf16 a[132:135], a[20:23], v[104:107], a[132:135]
ds_read_b64_tr_b16 v[6:7], v184 offset:18432
v_accvgpr_read_b32 v191, a95
v_mfma_f32_16x16x32_bf16 a[132:135], a[16:19], v[128:131], a[132:135]
ds_read_b64_tr_b16 v[8:9], v184 offset:20480
v_mul_f32 v188, v188, v31
v_mfma_f32_16x16x32_bf16 a[132:135], a[12:15], v[152:155], a[132:135]
ds_read_b64_tr_b16 v[10:11], v184 offset:22528
v_mul_f32 v189, v189, v31
v_mfma_f32_16x16x32_bf16 a[132:135], v[12:15], v[176:179], a[132:135]
v_cvt_pk_bf16_f32 v198, v188, v189
v_mul_f32 v190, v190, v31
v_mfma_f32_16x16x32_bf16 a[132:135], v[0:3], v[224:227], a[132:135]
v_mul_f32 v191, v191, v31
v_cvt_pk_bf16_f32 v199, v190, v191
v_mfma_f32_16x16x32_bf16 a[140:143], a[24:27], v[84:87], a[140:143]
v_mfma_f32_16x16x32_bf16 a[140:143], a[20:23], v[108:111], a[140:143]
v_mfma_f32_16x16x32_bf16 a[140:143], a[16:19], v[132:135], a[140:143]
v_mfma_f32_16x16x32_bf16 a[140:143], a[12:15], v[156:159], a[140:143]
v_mfma_f32_16x16x32_bf16 a[140:143], v[12:15], v[180:183], a[140:143]
v_mfma_f32_16x16x32_bf16 a[140:143], v[0:3], v[228:231], a[140:143]
s_waitcnt lgkmcnt(10)
v_mfma_f32_16x16x32_bf16 a[48:51], v[232:235], a[144:147], 0
s_waitcnt lgkmcnt(8)
v_mfma_f32_16x16x32_bf16 a[48:51], a[0:3], a[168:171], a[48:51]
s_waitcnt lgkmcnt(6)
v_mfma_f32_16x16x32_bf16 a[48:51], a[4:7], a[192:195], a[48:51]
s_waitcnt lgkmcnt(4)
v_mfma_f32_16x16x32_bf16 a[48:51], a[8:11], a[216:219], a[48:51]
s_waitcnt lgkmcnt(2)
v_mfma_f32_16x16x32_bf16 a[48:51], v[4:7], a[240:243], a[48:51]
s_waitcnt lgkmcnt(0)
v_mfma_f32_16x16x32_bf16 a[48:51], v[8:11], v[40:43], a[48:51]
v_accvgpr_read_b32 v188, a96
v_accvgpr_read_b32 v189, a97
v_mfma_f32_16x16x32_bf16 a[56:59], v[232:235], a[148:151], 0
v_accvgpr_read_b32 v190, a98
v_mfma_f32_16x16x32_bf16 a[56:59], a[0:3], a[172:175], a[56:59]
v_accvgpr_read_b32 v191, a99
v_mfma_f32_16x16x32_bf16 a[56:59], a[4:7], a[196:199], a[56:59]
v_mul_f32 v188, v188, v26
v_mfma_f32_16x16x32_bf16 a[56:59], a[8:11], a[220:223], a[56:59]
v_mul_f32 v189, v189, v26
v_mfma_f32_16x16x32_bf16 a[56:59], v[4:7], a[244:247], a[56:59]
v_cvt_pk_bf16_f32 v22, v188, v189
v_mfma_f32_16x16x32_bf16 a[56:59], v[8:11], v[44:47], a[56:59]
ds_write_b64 v236, v[240:241]
v_mfma_f32_16x16x32_bf16 a[64:67], v[232:235], a[152:155], 0
v_accvgpr_read_b32 v188, a100
v_mfma_f32_16x16x32_bf16 a[64:67], a[0:3], a[176:179], a[64:67]
v_accvgpr_read_b32 v189, a101
v_mul_f32 v190, v190, v26
v_mfma_f32_16x16x32_bf16 a[64:67], a[4:7], a[200:203], a[64:67]
v_mul_f32 v191, v191, v26
v_mfma_f32_16x16x32_bf16 a[64:67], a[8:11], a[224:227], a[64:67]
v_cvt_pk_bf16_f32 v23, v190, v191
v_mfma_f32_16x16x32_bf16 a[64:67], v[4:7], a[248:251], a[64:67]
ds_read_b64_tr_b16 v[0:1], v184 offset:256
v_mfma_f32_16x16x32_bf16 a[64:67], v[8:11], v[48:51], a[64:67]
ds_read_b64_tr_b16 v[2:3], v184 offset:2304
v_accvgpr_read_b32 v190, a102
v_mfma_f32_16x16x32_bf16 a[72:75], v[232:235], a[156:159], 0
ds_read_b64_tr_b16 v[12:13], v184 offset:4352
v_accvgpr_read_b32 v191, a103
v_mfma_f32_16x16x32_bf16 a[72:75], a[0:3], a[180:183], a[72:75]
ds_read_b64_tr_b16 v[14:15], v184 offset:6400
v_mul_f32 v188, v188, v26
v_mfma_f32_16x16x32_bf16 a[72:75], a[4:7], a[204:207], a[72:75]
ds_read_b64_tr_b16 a[12:13], v184 offset:8448
v_mul_f32 v189, v189, v26
v_mfma_f32_16x16x32_bf16 a[72:75], a[8:11], a[228:231], a[72:75]
ds_read_b64_tr_b16 a[14:15], v184 offset:10496
v_cvt_pk_bf16_f32 v24, v188, v189
v_mfma_f32_16x16x32_bf16 a[72:75], v[4:7], a[252:255], a[72:75]
ds_read_b64_tr_b16 a[16:17], v184 offset:12544
v_mfma_f32_16x16x32_bf16 a[72:75], v[8:11], v[52:55], a[72:75]
ds_read_b64_tr_b16 a[18:19], v184 offset:14592
ds_write_b64 v238, v[22:23]
v_mfma_f32_16x16x32_bf16 a[80:83], v[232:235], a[160:163], 0
ds_read_b64_tr_b16 a[20:21], v184 offset:16640
v_mul_f32 v190, v190, v26
v_mfma_f32_16x16x32_bf16 a[80:83], a[0:3], a[184:187], a[80:83]
ds_read_b64_tr_b16 a[22:23], v184 offset:18688
v_mul_f32 v191, v191, v26
v_mfma_f32_16x16x32_bf16 a[80:83], a[4:7], a[208:211], a[80:83]
ds_read_b64_tr_b16 a[24:25], v184 offset:20736
v_cvt_pk_bf16_f32 v25, v190, v191
v_mfma_f32_16x16x32_bf16 a[80:83], a[8:11], a[232:235], a[80:83]
ds_read_b64_tr_b16 a[26:27], v184 offset:22784
v_mfma_f32_16x16x32_bf16 a[80:83], v[4:7], v[32:35], a[80:83]
ds_write_b64 v237, v[242:243]
v_mfma_f32_16x16x32_bf16 a[80:83], v[8:11], v[56:59], a[80:83]
s_waitcnt lgkmcnt(14)
ds_write_b64 v239, v[24:25]
v_mfma_f32_16x16x32_bf16 a[88:91], v[232:235], a[164:167], 0
s_waitcnt lgkmcnt(14)
ds_read_b128 v[200:203], v186 offset:0
v_accvgpr_read_b32 v188, a120
v_mfma_f32_16x16x32_bf16 a[88:91], a[0:3], a[188:191], a[88:91]
s_waitcnt lgkmcnt(14)
ds_read_b128 v[204:207], v186 offset:1024
v_accvgpr_read_b32 v189, a121
v_mfma_f32_16x16x32_bf16 a[88:91], a[4:7], a[212:215], a[88:91]
v_accvgpr_read_b32 v190, a122
v_accvgpr_read_b32 v191, a123
v_mfma_f32_16x16x32_bf16 a[88:91], a[8:11], a[236:239], a[88:91]
v_mul_f32 v188, v188, v29
v_mul_f32 v189, v189, v29
v_mfma_f32_16x16x32_bf16 a[88:91], v[4:7], v[36:39], a[88:91]
s_add_u32 s51, s49, 128
v_cvt_pk_bf16_f32 v240, v188, v189
v_accvgpr_read_b32 v188, a124
v_mfma_f32_16x16x32_bf16 a[88:91], v[8:11], v[60:63], a[88:91]
v_accvgpr_read_b32 v189, a125
v_mfma_f32_16x16x32_bf16 a[52:55], v[0:3], a[144:147], 0
s_waitcnt lgkmcnt(13)
v_mul_f32 v190, v190, v29
v_mfma_f32_16x16x32_bf16 a[52:55], v[12:15], a[168:171], a[52:55]
s_waitcnt lgkmcnt(11)
v_mul_f32 v191, v191, v29
v_mfma_f32_16x16x32_bf16 a[52:55], a[12:15], a[192:195], a[52:55]
s_waitcnt lgkmcnt(9)
v_cvt_pk_bf16_f32 v241, v190, v191
v_mfma_f32_16x16x32_bf16 a[52:55], a[16:19], a[216:219], a[52:55]
s_waitcnt lgkmcnt(6)
s_waitcnt lgkmcnt(1)
buffer_store_dwordx4 v[200:203], v18, s[40:43], s51 offen sc1
v_mfma_f32_16x16x32_bf16 a[52:55], a[20:23], a[240:243], a[52:55]
v_accvgpr_read_b32 v190, a126
v_mfma_f32_16x16x32_bf16 a[52:55], a[24:27], v[40:43], a[52:55]
v_accvgpr_read_b32 v191, a127
v_mfma_f32_16x16x32_bf16 a[60:63], v[0:3], a[148:151], 0
v_mul_f32 v188, v188, v29
v_mfma_f32_16x16x32_bf16 a[60:63], v[12:15], a[172:175], a[60:63]
v_mul_f32 v189, v189, v29
v_mfma_f32_16x16x32_bf16 a[60:63], a[12:15], a[196:199], a[60:63]
v_cvt_pk_bf16_f32 v242, v188, v189
v_mfma_f32_16x16x32_bf16 a[60:63], a[16:19], a[220:223], a[60:63]
v_mul_f32 v190, v190, v29
v_mfma_f32_16x16x32_bf16 a[60:63], a[20:23], a[244:247], a[60:63]
s_add_u32 s51, s49, 3200
v_mul_f32 v191, v191, v29
v_mfma_f32_16x16x32_bf16 a[60:63], a[24:27], v[44:47], a[60:63]
v_cvt_pk_bf16_f32 v243, v190, v191
v_mfma_f32_16x16x32_bf16 a[68:71], v[0:3], a[152:155], 0
v_accvgpr_read_b32 v188, a104
v_accvgpr_read_b32 v189, a105
v_mfma_f32_16x16x32_bf16 a[68:71], v[12:15], a[176:179], a[68:71]
v_accvgpr_read_b32 v190, a106
v_mfma_f32_16x16x32_bf16 a[68:71], a[12:15], a[200:203], a[68:71]
v_accvgpr_read_b32 v191, a107
v_mfma_f32_16x16x32_bf16 a[68:71], a[16:19], a[224:227], a[68:71]
s_waitcnt lgkmcnt(0)
buffer_store_dwordx4 v[204:207], v18, s[40:43], s51 offen sc1
v_mfma_f32_16x16x32_bf16 a[68:71], a[20:23], a[248:251], a[68:71]
ds_read_b64_tr_b16 v[8:9], v184 offset:24576
v_mfma_f32_16x16x32_bf16 a[68:71], a[24:27], v[48:51], a[68:71]
ds_read_b64_tr_b16 v[10:11], v184 offset:26624
v_mul_f32 v188, v188, v27
v_mfma_f32_16x16x32_bf16 a[76:79], v[0:3], a[156:159], 0
ds_read_b64_tr_b16 v[4:5], v184 offset:28672
v_mul_f32 v189, v189, v27
v_mfma_f32_16x16x32_bf16 a[76:79], v[12:15], a[180:183], a[76:79]
ds_read_b64_tr_b16 v[6:7], v184 offset:30720
v_cvt_pk_bf16_f32 v22, v188, v189
v_mfma_f32_16x16x32_bf16 a[76:79], a[12:15], a[204:207], a[76:79]
ds_read_b64_tr_b16 a[8:9], v184 offset:32768
v_accvgpr_read_b32 v188, a108
v_mfma_f32_16x16x32_bf16 a[76:79], a[16:19], a[228:231], a[76:79]
ds_read_b64_tr_b16 a[10:11], v184 offset:34816
v_accvgpr_read_b32 v189, a109
v_mfma_f32_16x16x32_bf16 a[76:79], a[20:23], a[252:255], a[76:79]
ds_read_b64_tr_b16 a[4:5], v184 offset:36864
v_mul_f32 v190, v190, v27
v_mfma_f32_16x16x32_bf16 a[76:79], a[24:27], v[52:55], a[76:79]
ds_read_b64_tr_b16 a[6:7], v184 offset:38912
v_mul_f32 v191, v191, v27
v_mfma_f32_16x16x32_bf16 a[84:87], v[0:3], a[160:163], 0
ds_read_b64_tr_b16 a[0:1], v184 offset:40960
v_cvt_pk_bf16_f32 v23, v190, v191
v_mfma_f32_16x16x32_bf16 a[84:87], v[12:15], a[184:187], a[84:87]
ds_read_b64_tr_b16 a[2:3], v184 offset:43008
v_mfma_f32_16x16x32_bf16 a[84:87], a[12:15], a[208:211], a[84:87]
ds_read_b64_tr_b16 v[232:233], v184 offset:45056
ds_write_b64 v236, v[244:245] offset:2048
v_mfma_f32_16x16x32_bf16 a[84:87], a[16:19], a[232:235], a[84:87]
ds_read_b64_tr_b16 v[234:235], v184 offset:47104
v_accvgpr_read_b32 v190, a110
v_mfma_f32_16x16x32_bf16 a[84:87], a[20:23], v[32:35], a[84:87]
ds_write_b64 v238, v[22:23] offset:2048
v_mfma_f32_16x16x32_bf16 a[84:87], a[24:27], v[56:59], a[84:87]
v_accvgpr_read_b32 v191, a111
v_mul_f32 v188, v188, v27
v_mfma_f32_16x16x32_bf16 a[92:95], v[0:3], a[164:167], 0
v_mul_f32 v189, v189, v27
v_cvt_pk_bf16_f32 v24, v188, v189
v_mfma_f32_16x16x32_bf16 a[92:95], v[12:15], a[188:191], a[92:95]
ds_write_b64 v237, v[246:247] offset:2048
v_mfma_f32_16x16x32_bf16 a[92:95], a[12:15], a[212:215], a[92:95]
v_mul_f32 v190, v190, v27
v_mul_f32 v191, v191, v27
v_mfma_f32_16x16x32_bf16 a[92:95], a[16:19], a[236:239], a[92:95]
v_cvt_pk_bf16_f32 v25, v190, v191
v_mfma_f32_16x16x32_bf16 a[92:95], a[20:23], v[36:39], a[92:95]
s_waitcnt lgkmcnt(14)
ds_write_b64 v239, v[24:25] offset:2048
v_mfma_f32_16x16x32_bf16 a[92:95], a[24:27], v[60:63], a[92:95]
s_waitcnt lgkmcnt(14)
ds_read_b128 v[200:203], v186 offset:2048
v_mfma_f32_16x16x32_bf16 a[48:51], v[8:11], v[64:67], a[48:51]
s_waitcnt lgkmcnt(13)
ds_read_b128 v[204:207], v186 offset:3072
v_mfma_f32_16x16x32_bf16 a[48:51], v[4:7], v[88:91], a[48:51]
s_waitcnt lgkmcnt(12)
v_accvgpr_read_b32 v188, a128
v_mfma_f32_16x16x32_bf16 a[48:51], a[8:11], v[112:115], a[48:51]
s_waitcnt lgkmcnt(10)
v_accvgpr_read_b32 v189, a129
v_mfma_f32_16x16x32_bf16 a[48:51], a[4:7], v[136:139], a[48:51]
s_waitcnt lgkmcnt(8)
v_accvgpr_read_b32 v190, a130
v_accvgpr_read_b32 v191, a131
v_mfma_f32_16x16x32_bf16 a[48:51], a[0:3], v[160:163], a[48:51]
s_waitcnt lgkmcnt(5)
v_mul_f32 v188, v188, v30
v_mfma_f32_16x16x32_bf16 a[48:51], v[232:235], v[208:211], a[48:51]
v_mul_f32 v189, v189, v30
v_mfma_f32_16x16x32_bf16 a[56:59], v[8:11], v[68:71], a[56:59]
s_add_u32 s51, s49, 6272
v_cvt_pk_bf16_f32 v244, v188, v189
v_mfma_f32_16x16x32_bf16 a[56:59], v[4:7], v[92:95], a[56:59]
v_accvgpr_read_b32 v188, a132
v_mfma_f32_16x16x32_bf16 a[56:59], a[8:11], v[116:119], a[56:59]
v_accvgpr_read_b32 v189, a133
v_mfma_f32_16x16x32_bf16 a[56:59], a[4:7], v[140:143], a[56:59]
v_mul_f32 v190, v190, v30
v_mfma_f32_16x16x32_bf16 a[56:59], a[0:3], v[164:167], a[56:59]
v_mul_f32 v191, v191, v30
v_mfma_f32_16x16x32_bf16 a[56:59], v[232:235], v[212:215], a[56:59]
v_cvt_pk_bf16_f32 v245, v190, v191
v_mfma_f32_16x16x32_bf16 a[64:67], v[8:11], v[72:75], a[64:67]
s_waitcnt lgkmcnt(1)
buffer_store_dwordx4 v[200:203], v18, s[40:43], s51 offen sc1
v_mfma_f32_16x16x32_bf16 a[64:67], v[4:7], v[96:99], a[64:67]
v_accvgpr_read_b32 v190, a134
v_mfma_f32_16x16x32_bf16 a[64:67], a[8:11], v[120:123], a[64:67]
v_accvgpr_read_b32 v191, a135
v_mfma_f32_16x16x32_bf16 a[64:67], a[4:7], v[144:147], a[64:67]
v_mul_f32 v188, v188, v30
v_mfma_f32_16x16x32_bf16 a[64:67], a[0:3], v[168:171], a[64:67]
ds_read_b64_tr_b16 a[24:25], v184 offset:24832
v_mul_f32 v189, v189, v30
v_mfma_f32_16x16x32_bf16 a[64:67], v[232:235], v[216:219], a[64:67]
ds_read_b64_tr_b16 a[26:27], v184 offset:26880
v_cvt_pk_bf16_f32 v246, v188, v189
v_mfma_f32_16x16x32_bf16 a[72:75], v[8:11], v[76:79], a[72:75]
ds_read_b64_tr_b16 a[20:21], v184 offset:28928
v_mul_f32 v190, v190, v30
v_mfma_f32_16x16x32_bf16 a[72:75], v[4:7], v[100:103], a[72:75]
s_add_u32 s51, s49, 9344
ds_read_b64_tr_b16 a[22:23], v184 offset:30976
v_mul_f32 v191, v191, v30
v_mfma_f32_16x16x32_bf16 a[72:75], a[8:11], v[124:127], a[72:75]
ds_read_b64_tr_b16 a[16:17], v184 offset:33024
v_cvt_pk_bf16_f32 v247, v190, v191
v_mfma_f32_16x16x32_bf16 a[72:75], a[4:7], v[148:151], a[72:75]
ds_read_b64_tr_b16 a[18:19], v184 offset:35072
v_accvgpr_read_b32 v188, a112
v_mfma_f32_16x16x32_bf16 a[72:75], a[0:3], v[172:175], a[72:75]
ds_read_b64_tr_b16 a[12:13], v184 offset:37120
v_accvgpr_read_b32 v189, a113
v_mfma_f32_16x16x32_bf16 a[72:75], v[232:235], v[220:223], a[72:75]
ds_read_b64_tr_b16 a[14:15], v184 offset:39168
v_accvgpr_read_b32 v190, a114
v_mfma_f32_16x16x32_bf16 a[80:83], v[8:11], v[80:83], a[80:83]
ds_read_b64_tr_b16 v[12:13], v184 offset:41216
v_accvgpr_read_b32 v191, a115
v_mfma_f32_16x16x32_bf16 a[80:83], v[4:7], v[104:107], a[80:83]
ds_read_b64_tr_b16 v[14:15], v184 offset:43264
v_mul_f32 v188, v188, v28
v_mfma_f32_16x16x32_bf16 a[80:83], a[8:11], v[128:131], a[80:83]
ds_read_b64_tr_b16 v[0:1], v184 offset:45312
v_mul_f32 v189, v189, v28
v_mfma_f32_16x16x32_bf16 a[80:83], a[4:7], v[152:155], a[80:83]
ds_read_b64_tr_b16 v[2:3], v184 offset:47360
v_cvt_pk_bf16_f32 v22, v188, v189
v_mfma_f32_16x16x32_bf16 a[80:83], a[0:3], v[176:179], a[80:83]
s_waitcnt lgkmcnt(12)
buffer_store_dwordx4 v[204:207], v18, s[40:43], s51 offen sc1
v_mfma_f32_16x16x32_bf16 a[80:83], v[232:235], v[224:227], a[80:83]
ds_write_b64 v236, v[248:249]
v_mfma_f32_16x16x32_bf16 a[88:91], v[8:11], v[84:87], a[88:91]
v_accvgpr_read_b32 v188, a116
v_accvgpr_read_b32 v189, a117
v_mfma_f32_16x16x32_bf16 a[88:91], v[4:7], v[108:111], a[88:91]
v_mul_f32 v190, v190, v28
v_mfma_f32_16x16x32_bf16 a[88:91], a[8:11], v[132:135], a[88:91]
v_mul_f32 v191, v191, v28
v_cvt_pk_bf16_f32 v23, v190, v191
v_mfma_f32_16x16x32_bf16 a[88:91], a[4:7], v[156:159], a[88:91]
ds_write_b64 v238, v[22:23]
v_mfma_f32_16x16x32_bf16 a[88:91], a[0:3], v[180:183], a[88:91]
v_mfma_f32_16x16x32_bf16 a[88:91], v[232:235], v[228:231], a[88:91]
s_waitcnt lgkmcnt(12)
v_accvgpr_read_b32 v190, a118
v_accvgpr_read_b32 v191, a119
v_mfma_f32_16x16x32_bf16 a[52:55], a[24:27], v[64:67], a[52:55]
s_waitcnt lgkmcnt(10)
v_mul_f32 v188, v188, v28
v_mfma_f32_16x16x32_bf16 a[52:55], a[20:23], v[88:91], a[52:55]
s_waitcnt lgkmcnt(8)
v_mul_f32 v189, v189, v28
v_mfma_f32_16x16x32_bf16 a[52:55], a[16:19], v[112:115], a[52:55]
s_waitcnt lgkmcnt(6)
v_cvt_pk_bf16_f32 v24, v188, v189
v_mfma_f32_16x16x32_bf16 a[52:55], a[12:15], v[136:139], a[52:55]
s_waitcnt lgkmcnt(4)
ds_write_b64 v237, v[250:251]
v_mfma_f32_16x16x32_bf16 a[52:55], v[12:15], v[160:163], a[52:55]
s_waitcnt lgkmcnt(3)
v_mul_f32 v190, v190, v28
v_mfma_f32_16x16x32_bf16 a[52:55], v[0:3], v[208:211], a[52:55]
v_mul_f32 v191, v191, v28
v_mfma_f32_16x16x32_bf16 a[60:63], a[24:27], v[68:71], a[60:63]
v_cvt_pk_bf16_f32 v25, v190, v191
v_mfma_f32_16x16x32_bf16 a[60:63], a[20:23], v[92:95], a[60:63]
ds_write_b64 v239, v[24:25]
v_mfma_f32_16x16x32_bf16 a[60:63], a[16:19], v[116:119], a[60:63]
ds_read_b128 v[200:203], v186 offset:0
v_mfma_f32_16x16x32_bf16 a[60:63], a[12:15], v[140:143], a[60:63]
ds_read_b128 v[204:207], v186 offset:1024
v_mfma_f32_16x16x32_bf16 a[60:63], v[12:15], v[164:167], a[60:63]
v_accvgpr_read_b32 v188, a136
v_accvgpr_read_b32 v189, a137
v_mfma_f32_16x16x32_bf16 a[60:63], v[0:3], v[212:215], a[60:63]
v_accvgpr_read_b32 v190, a138
v_mfma_f32_16x16x32_bf16 a[68:71], a[24:27], v[72:75], a[68:71]
v_accvgpr_read_b32 v191, a139
v_mfma_f32_16x16x32_bf16 a[68:71], a[20:23], v[96:99], a[68:71]
v_mul_f32 v188, v188, v31
v_mfma_f32_16x16x32_bf16 a[68:71], a[16:19], v[120:123], a[68:71]
v_mul_f32 v189, v189, v31
v_mfma_f32_16x16x32_bf16 a[68:71], a[12:15], v[144:147], a[68:71]
s_add_u32 s51, s49, 12416
v_cvt_pk_bf16_f32 v248, v188, v189
v_mfma_f32_16x16x32_bf16 a[68:71], v[12:15], v[168:171], a[68:71]
ds_read_b64_tr_b16 v[232:233], v184 offset:512
v_accvgpr_read_b32 v188, a140
v_mfma_f32_16x16x32_bf16 a[68:71], v[0:3], v[216:219], a[68:71]
ds_read_b64_tr_b16 v[234:235], v184 offset:2560
v_accvgpr_read_b32 v189, a141
v_mfma_f32_16x16x32_bf16 a[76:79], a[24:27], v[76:79], a[76:79]
ds_read_b64_tr_b16 a[0:1], v184 offset:4608
v_mul_f32 v190, v190, v31
v_mfma_f32_16x16x32_bf16 a[76:79], a[20:23], v[100:103], a[76:79]
ds_read_b64_tr_b16 a[2:3], v184 offset:6656
v_mul_f32 v191, v191, v31
v_mfma_f32_16x16x32_bf16 a[76:79], a[16:19], v[124:127], a[76:79]
ds_read_b64_tr_b16 a[4:5], v184 offset:8704
v_cvt_pk_bf16_f32 v249, v190, v191
v_mfma_f32_16x16x32_bf16 a[76:79], a[12:15], v[148:151], a[76:79]
ds_read_b64_tr_b16 a[6:7], v184 offset:10752
v_mfma_f32_16x16x32_bf16 a[76:79], v[12:15], v[172:175], a[76:79]
ds_read_b64_tr_b16 a[8:9], v184 offset:12800
v_accvgpr_read_b32 v190, a142
v_mfma_f32_16x16x32_bf16 a[76:79], v[0:3], v[220:223], a[76:79]
ds_read_b64_tr_b16 a[10:11], v184 offset:14848
v_accvgpr_read_b32 v191, a143
v_mfma_f32_16x16x32_bf16 a[84:87], a[24:27], v[80:83], a[84:87]
ds_read_b64_tr_b16 v[4:5], v184 offset:16896
v_mul_f32 v188, v188, v31
v_mfma_f32_16x16x32_bf16 a[84:87], a[20:23], v[104:107], a[84:87]
s_waitcnt lgkmcnt(14)
ds_read_b64_tr_b16 v[6:7], v184 offset:18944
v_mul_f32 v189, v189, v31
v_mfma_f32_16x16x32_bf16 a[84:87], a[16:19], v[128:131], a[84:87]
s_waitcnt lgkmcnt(14)
ds_read_b64_tr_b16 v[8:9], v184 offset:20992
v_cvt_pk_bf16_f32 v250, v188, v189
v_mfma_f32_16x16x32_bf16 a[84:87], a[12:15], v[152:155], a[84:87]
s_waitcnt lgkmcnt(14)
ds_read_b64_tr_b16 v[10:11], v184 offset:23040
s_waitcnt lgkmcnt(13)
buffer_store_dwordx4 v[200:203], v18, s[40:43], s51 offen sc1
v_mfma_f32_16x16x32_bf16 a[84:87], v[12:15], v[176:179], a[84:87]
v_mul_f32 v190, v190, v31
v_mul_f32 v191, v191, v31
v_mfma_f32_16x16x32_bf16 a[84:87], v[0:3], v[224:227], a[84:87]
s_add_u32 s51, s49, 15488
v_cvt_pk_bf16_f32 v251, v190, v191
v_mfma_f32_16x16x32_bf16 a[92:95], a[24:27], v[84:87], a[92:95]
v_mfma_f32_16x16x32_bf16 a[92:95], a[20:23], v[108:111], a[92:95]
v_mfma_f32_16x16x32_bf16 a[92:95], a[16:19], v[132:135], a[92:95]
v_mfma_f32_16x16x32_bf16 a[92:95], a[12:15], v[156:159], a[92:95]
s_waitcnt lgkmcnt(12)
buffer_store_dwordx4 v[204:207], v18, s[40:43], s51 offen sc1
v_mfma_f32_16x16x32_bf16 a[92:95], v[12:15], v[180:183], a[92:95]
v_mfma_f32_16x16x32_bf16 a[92:95], v[0:3], v[228:231], a[92:95]
s_waitcnt lgkmcnt(10)
v_mfma_f32_16x16x32_bf16 a[96:99], v[232:235], a[144:147], 0
s_waitcnt lgkmcnt(8)
v_mfma_f32_16x16x32_bf16 a[96:99], a[0:3], a[168:171], a[96:99]
s_waitcnt lgkmcnt(6)
v_mfma_f32_16x16x32_bf16 a[96:99], a[4:7], a[192:195], a[96:99]
s_waitcnt lgkmcnt(4)
v_mfma_f32_16x16x32_bf16 a[96:99], a[8:11], a[216:219], a[96:99]
s_waitcnt lgkmcnt(2)
v_mfma_f32_16x16x32_bf16 a[96:99], v[4:7], a[240:243], a[96:99]
s_waitcnt lgkmcnt(0)
v_mfma_f32_16x16x32_bf16 a[96:99], v[8:11], v[40:43], a[96:99]
ds_write_b64 v236, v[252:253] offset:2048
v_mfma_f32_16x16x32_bf16 a[104:107], v[232:235], a[148:151], 0
ds_write_b64 v237, v[254:255] offset:2048
v_mfma_f32_16x16x32_bf16 a[104:107], a[0:3], a[172:175], a[104:107]
ds_write_b64 v238, v[240:241] offset:2048
v_mfma_f32_16x16x32_bf16 a[104:107], a[4:7], a[196:199], a[104:107]
ds_write_b64 v239, v[242:243] offset:2048
v_mfma_f32_16x16x32_bf16 a[104:107], a[8:11], a[220:223], a[104:107]
v_mfma_f32_16x16x32_bf16 a[104:107], v[4:7], a[244:247], a[104:107]
ds_read_b128 v[200:203], v186 offset:2048
v_mfma_f32_16x16x32_bf16 a[104:107], v[8:11], v[44:47], a[104:107]
ds_read_b128 v[204:207], v186 offset:3072
v_accvgpr_read_b32 v188, a48
v_mfma_f32_16x16x32_bf16 a[112:115], v[232:235], a[152:155], 0
v_accvgpr_read_b32 v189, a49
v_mfma_f32_16x16x32_bf16 a[112:115], a[0:3], a[176:179], a[112:115]
v_accvgpr_read_b32 v190, a50
v_mfma_f32_16x16x32_bf16 a[112:115], a[4:7], a[200:203], a[112:115]
v_accvgpr_read_b32 v191, a51
v_mfma_f32_16x16x32_bf16 a[112:115], a[8:11], a[224:227], a[112:115]
v_mul_f32 v188, v188, v26
v_mul_f32 v189, v189, v26
v_mfma_f32_16x16x32_bf16 a[112:115], v[4:7], a[248:251], a[112:115]
s_add_u32 s51, s49, 18560
ds_read_b64_tr_b16 v[0:1], v184 offset:768
v_mfma_f32_16x16x32_bf16 a[112:115], v[8:11], v[48:51], a[112:115]
ds_read_b64_tr_b16 v[2:3], v184 offset:2816
v_cvt_pk_bf16_f32 v240, v188, v189
v_mfma_f32_16x16x32_bf16 a[120:123], v[232:235], a[156:159], 0
ds_read_b64_tr_b16 v[12:13], v184 offset:4864
v_accvgpr_read_b32 v188, a52
v_mfma_f32_16x16x32_bf16 a[120:123], a[0:3], a[180:183], a[120:123]
ds_read_b64_tr_b16 v[14:15], v184 offset:6912
v_accvgpr_read_b32 v189, a53
v_mfma_f32_16x16x32_bf16 a[120:123], a[4:7], a[204:207], a[120:123]
ds_read_b64_tr_b16 a[12:13], v184 offset:8960
v_mul_f32 v190, v190, v26
v_mfma_f32_16x16x32_bf16 a[120:123], a[8:11], a[228:231], a[120:123]
ds_read_b64_tr_b16 a[14:15], v184 offset:11008
v_mul_f32 v191, v191, v26
v_mfma_f32_16x16x32_bf16 a[120:123], v[4:7], a[252:255], a[120:123]
ds_read_b64_tr_b16 a[16:17], v184 offset:13056
v_cvt_pk_bf16_f32 v241, v190, v191
v_mfma_f32_16x16x32_bf16 a[120:123], v[8:11], v[52:55], a[120:123]
ds_read_b64_tr_b16 a[18:19], v184 offset:15104
v_accvgpr_read_b32 v190, a54
v_mfma_f32_16x16x32_bf16 a[128:131], v[232:235], a[160:163], 0
ds_read_b64_tr_b16 a[20:21], v184 offset:17152
v_accvgpr_read_b32 v191, a55
v_mfma_f32_16x16x32_bf16 a[128:131], a[0:3], a[184:187], a[128:131]
s_waitcnt lgkmcnt(14)
ds_read_b64_tr_b16 a[22:23], v184 offset:19200
v_mul_f32 v188, v188, v26
v_mfma_f32_16x16x32_bf16 a[128:131], a[4:7], a[208:211], a[128:131]
s_waitcnt lgkmcnt(14)
ds_read_b64_tr_b16 a[24:25], v184 offset:21248
v_mul_f32 v189, v189, v26
v_mfma_f32_16x16x32_bf16 a[128:131], a[8:11], a[232:235], a[128:131]
s_waitcnt lgkmcnt(14)
ds_read_b64_tr_b16 a[26:27], v184 offset:23296
v_cvt_pk_bf16_f32 v242, v188, v189
v_mfma_f32_16x16x32_bf16 a[128:131], v[4:7], v[32:35], a[128:131]
s_waitcnt lgkmcnt(13)
buffer_store_dwordx4 v[200:203], v18, s[40:43], s51 offen sc1
v_mfma_f32_16x16x32_bf16 a[128:131], v[8:11], v[56:59], a[128:131]
v_mul_f32 v190, v190, v26
v_mul_f32 v191, v191, v26
v_mfma_f32_16x16x32_bf16 a[136:139], v[232:235], a[164:167], 0
s_add_u32 s51, s49, 21632
v_cvt_pk_bf16_f32 v243, v190, v191
v_accvgpr_read_b32 v188, a72
v_mfma_f32_16x16x32_bf16 a[136:139], a[0:3], a[188:191], a[136:139]
v_accvgpr_read_b32 v189, a73
v_mfma_f32_16x16x32_bf16 a[136:139], a[4:7], a[212:215], a[136:139]
v_accvgpr_read_b32 v190, a74
v_mfma_f32_16x16x32_bf16 a[136:139], a[8:11], a[236:239], a[136:139]
v_accvgpr_read_b32 v191, a75
v_mfma_f32_16x16x32_bf16 a[136:139], v[4:7], v[36:39], a[136:139]
v_mul_f32 v188, v188, v29
v_mul_f32 v189, v189, v29
v_mfma_f32_16x16x32_bf16 a[136:139], v[8:11], v[60:63], a[136:139]
s_waitcnt lgkmcnt(10)
buffer_store_dwordx4 v[204:207], v18, s[40:43], s51 offen sc1
v_mfma_f32_16x16x32_bf16 a[100:103], v[0:3], a[144:147], 0
s_waitcnt lgkmcnt(8)
v_mfma_f32_16x16x32_bf16 a[100:103], v[12:15], a[168:171], a[100:103]
s_waitcnt lgkmcnt(6)
v_cvt_pk_bf16_f32 v252, v188, v189
v_mfma_f32_16x16x32_bf16 a[100:103], a[12:15], a[192:195], a[100:103]
s_waitcnt lgkmcnt(4)
v_accvgpr_read_b32 v188, a76
v_mfma_f32_16x16x32_bf16 a[100:103], a[16:19], a[216:219], a[100:103]
s_waitcnt lgkmcnt(2)
v_accvgpr_read_b32 v189, a77
v_mul_f32 v190, v190, v29
v_mfma_f32_16x16x32_bf16 a[100:103], a[20:23], a[240:243], a[100:103]
s_waitcnt lgkmcnt(0)
v_mul_f32 v191, v191, v29
v_mfma_f32_16x16x32_bf16 a[100:103], a[24:27], v[40:43], a[100:103]
v_cvt_pk_bf16_f32 v253, v190, v191
v_mfma_f32_16x16x32_bf16 a[108:111], v[0:3], a[148:151], 0
v_accvgpr_read_b32 v190, a78
v_mfma_f32_16x16x32_bf16 a[108:111], v[12:15], a[172:175], a[108:111]
v_accvgpr_read_b32 v191, a79
v_mfma_f32_16x16x32_bf16 a[108:111], a[12:15], a[196:199], a[108:111]
v_mul_f32 v188, v188, v29
v_mul_f32 v189, v189, v29
v_mfma_f32_16x16x32_bf16 a[108:111], a[16:19], a[220:223], a[108:111]
v_cvt_pk_bf16_f32 v254, v188, v189
v_mfma_f32_16x16x32_bf16 a[108:111], a[20:23], a[244:247], a[108:111]
v_mul_f32 v190, v190, v29
v_mfma_f32_16x16x32_bf16 a[108:111], a[24:27], v[44:47], a[108:111]
v_mul_f32 v191, v191, v29
v_mfma_f32_16x16x32_bf16 a[116:119], v[0:3], a[152:155], 0
v_cvt_pk_bf16_f32 v255, v190, v191
v_mfma_f32_16x16x32_bf16 a[116:119], v[12:15], a[176:179], a[116:119]
ds_write_b64 v236, v[192:193]
v_mfma_f32_16x16x32_bf16 a[116:119], a[12:15], a[200:203], a[116:119]
ds_write_b64 v237, v[194:195]
v_mfma_f32_16x16x32_bf16 a[116:119], a[16:19], a[224:227], a[116:119]
ds_write_b64 v238, v[244:245]
v_mfma_f32_16x16x32_bf16 a[116:119], a[20:23], a[248:251], a[116:119]
ds_read_b64_tr_b16 v[8:9], v184 offset:25088
v_mfma_f32_16x16x32_bf16 a[116:119], a[24:27], v[48:51], a[116:119]
ds_read_b64_tr_b16 v[10:11], v184 offset:27136
v_mfma_f32_16x16x32_bf16 a[124:127], v[0:3], a[156:159], 0
ds_read_b64_tr_b16 v[4:5], v184 offset:29184
v_mfma_f32_16x16x32_bf16 a[124:127], v[12:15], a[180:183], a[124:127]
ds_read_b64_tr_b16 v[6:7], v184 offset:31232
v_accvgpr_read_b32 v188, a56
v_mfma_f32_16x16x32_bf16 a[124:127], a[12:15], a[204:207], a[124:127]
ds_read_b64_tr_b16 a[8:9], v184 offset:33280
v_accvgpr_read_b32 v189, a57
v_mfma_f32_16x16x32_bf16 a[124:127], a[16:19], a[228:231], a[124:127]
ds_read_b64_tr_b16 a[10:11], v184 offset:35328
v_accvgpr_read_b32 v190, a58
v_mfma_f32_16x16x32_bf16 a[124:127], a[20:23], a[252:255], a[124:127]
ds_read_b64_tr_b16 a[4:5], v184 offset:37376
v_accvgpr_read_b32 v191, a59
v_mfma_f32_16x16x32_bf16 a[124:127], a[24:27], v[52:55], a[124:127]
ds_read_b64_tr_b16 a[6:7], v184 offset:39424
ds_write_b64 v239, v[246:247]
v_mfma_f32_16x16x32_bf16 a[132:135], v[0:3], a[160:163], 0
ds_read_b64_tr_b16 a[0:1], v184 offset:41472
v_mul_f32 v188, v188, v27
v_mfma_f32_16x16x32_bf16 a[132:135], v[12:15], a[184:187], a[132:135]
ds_read_b64_tr_b16 a[2:3], v184 offset:43520
ds_read_b128 v[200:203], v186 offset:0
s_waitcnt lgkmcnt(14)
ds_read_b128 v[204:207], v186 offset:1024
v_mfma_f32_16x16x32_bf16 a[132:135], a[12:15], a[208:211], a[132:135]
s_waitcnt lgkmcnt(14)
ds_read_b64_tr_b16 v[232:233], v184 offset:45568
v_mul_f32 v189, v189, v27
v_mfma_f32_16x16x32_bf16 a[132:135], a[16:19], a[232:235], a[132:135]
s_add_u32 s51, s49, 24704
s_waitcnt lgkmcnt(14)
ds_read_b64_tr_b16 v[234:235], v184 offset:47616
v_cvt_pk_bf16_f32 v244, v188, v189
v_mfma_f32_16x16x32_bf16 a[132:135], a[20:23], v[32:35], a[132:135]
v_accvgpr_read_b32 v188, a60
v_accvgpr_read_b32 v189, a61
v_mfma_f32_16x16x32_bf16 a[132:135], a[24:27], v[56:59], a[132:135]
v_mul_f32 v190, v190, v27
v_mul_f32 v191, v191, v27
v_mfma_f32_16x16x32_bf16 a[140:143], v[0:3], a[164:167], 0
v_cvt_pk_bf16_f32 v245, v190, v191
v_mfma_f32_16x16x32_bf16 a[140:143], v[12:15], a[188:191], a[140:143]
s_waitcnt lgkmcnt(3)
buffer_store_dwordx4 v[200:203], v18, s[40:43], s51 offen sc1
v_mfma_f32_16x16x32_bf16 a[140:143], a[12:15], a[212:215], a[140:143]
v_accvgpr_read_b32 v190, a62
v_accvgpr_read_b32 v191, a63
v_mfma_f32_16x16x32_bf16 a[140:143], a[16:19], a[236:239], a[140:143]
v_mul_f32 v188, v188, v27
v_mfma_f32_16x16x32_bf16 a[140:143], a[20:23], v[36:39], a[140:143]
v_mul_f32 v189, v189, v27
v_mfma_f32_16x16x32_bf16 a[140:143], a[24:27], v[60:63], a[140:143]
v_cvt_pk_bf16_f32 v246, v188, v189
v_mfma_f32_16x16x32_bf16 a[96:99], v[8:11], v[64:67], a[96:99]
v_mul_f32 v190, v190, v27
v_mfma_f32_16x16x32_bf16 a[96:99], v[4:7], v[88:91], a[96:99]
v_mul_f32 v191, v191, v27
v_mfma_f32_16x16x32_bf16 a[96:99], a[8:11], v[112:115], a[96:99]
v_cvt_pk_bf16_f32 v247, v190, v191
v_accvgpr_read_b32 v188, a80
v_mfma_f32_16x16x32_bf16 a[96:99], a[4:7], v[136:139], a[96:99]
v_accvgpr_read_b32 v189, a81
v_mfma_f32_16x16x32_bf16 a[96:99], a[0:3], v[160:163], a[96:99]
s_waitcnt lgkmcnt(0)
v_accvgpr_read_b32 v190, a82
v_mfma_f32_16x16x32_bf16 a[96:99], v[232:235], v[208:211], a[96:99]
s_add_u32 s51, s49, 27776
v_accvgpr_read_b32 v191, a83
v_mfma_f32_16x16x32_bf16 a[104:107], v[8:11], v[68:71], a[104:107]
v_mul_f32 v188, v188, v30
v_mfma_f32_16x16x32_bf16 a[104:107], v[4:7], v[92:95], a[104:107]
v_mul_f32 v189, v189, v30
v_mfma_f32_16x16x32_bf16 a[104:107], a[8:11], v[116:119], a[104:107]
buffer_store_dwordx4 v[204:207], v18, s[40:43], s51 offen sc1
v_mfma_f32_16x16x32_bf16 a[104:107], a[4:7], v[140:143], a[104:107]
v_cvt_pk_bf16_f32 v192, v188, v189
v_mfma_f32_16x16x32_bf16 a[104:107], a[0:3], v[164:167], a[104:107]
v_accvgpr_read_b32 v188, a84
v_mfma_f32_16x16x32_bf16 a[104:107], v[232:235], v[212:215], a[104:107]
v_accvgpr_read_b32 v189, a85
v_mfma_f32_16x16x32_bf16 a[112:115], v[8:11], v[72:75], a[112:115]
v_mul_f32 v190, v190, v30
v_mul_f32 v191, v191, v30
v_mfma_f32_16x16x32_bf16 a[112:115], v[4:7], v[96:99], a[112:115]
v_cvt_pk_bf16_f32 v193, v190, v191
v_mfma_f32_16x16x32_bf16 a[112:115], a[8:11], v[120:123], a[112:115]
v_accvgpr_read_b32 v190, a86
v_mfma_f32_16x16x32_bf16 a[112:115], a[4:7], v[144:147], a[112:115]
v_accvgpr_read_b32 v191, a87
v_mfma_f32_16x16x32_bf16 a[112:115], a[0:3], v[168:171], a[112:115]
ds_read_b64_tr_b16 a[24:25], v184 offset:25344
v_mul_f32 v188, v188, v30
v_mfma_f32_16x16x32_bf16 a[112:115], v[232:235], v[216:219], a[112:115]
ds_read_b64_tr_b16 a[26:27], v184 offset:27392
v_mul_f32 v189, v189, v30
v_mfma_f32_16x16x32_bf16 a[120:123], v[8:11], v[76:79], a[120:123]
ds_read_b64_tr_b16 a[20:21], v184 offset:29440
v_cvt_pk_bf16_f32 v194, v188, v189
v_mfma_f32_16x16x32_bf16 a[120:123], v[4:7], v[100:103], a[120:123]
ds_read_b64_tr_b16 a[22:23], v184 offset:31488
v_mul_f32 v190, v190, v30
v_mfma_f32_16x16x32_bf16 a[120:123], a[8:11], v[124:127], a[120:123]
ds_read_b64_tr_b16 a[16:17], v184 offset:33536
v_mul_f32 v191, v191, v30
v_mfma_f32_16x16x32_bf16 a[120:123], a[4:7], v[148:151], a[120:123]
ds_read_b64_tr_b16 a[18:19], v184 offset:35584
v_cvt_pk_bf16_f32 v195, v190, v191
v_mfma_f32_16x16x32_bf16 a[120:123], a[0:3], v[172:175], a[120:123]
ds_read_b64_tr_b16 a[12:13], v184 offset:37632
v_mfma_f32_16x16x32_bf16 a[120:123], v[232:235], v[220:223], a[120:123]
ds_read_b64_tr_b16 a[14:15], v184 offset:39680
v_mfma_f32_16x16x32_bf16 a[128:131], v[8:11], v[80:83], a[128:131]
ds_read_b64_tr_b16 v[12:13], v184 offset:41728
v_mfma_f32_16x16x32_bf16 a[128:131], v[4:7], v[104:107], a[128:131]
ds_read_b64_tr_b16 v[14:15], v184 offset:43776
v_mfma_f32_16x16x32_bf16 a[128:131], a[8:11], v[128:131], a[128:131]
ds_read_b64_tr_b16 v[0:1], v184 offset:45824
v_mfma_f32_16x16x32_bf16 a[128:131], a[4:7], v[152:155], a[128:131]
ds_read_b64_tr_b16 v[2:3], v184 offset:47872
v_accvgpr_read_b32 v188, a64
v_mfma_f32_16x16x32_bf16 a[128:131], a[0:3], v[176:179], a[128:131]
ds_write_b64 v236, v[196:197] offset:2048
v_mfma_f32_16x16x32_bf16 a[128:131], v[232:235], v[224:227], a[128:131]
ds_write_b64 v237, v[198:199] offset:2048
v_mfma_f32_16x16x32_bf16 a[136:139], v[8:11], v[84:87], a[136:139]
ds_write_b64 v238, v[248:249] offset:2048
v_mfma_f32_16x16x32_bf16 a[136:139], v[4:7], v[108:111], a[136:139]
s_waitcnt lgkmcnt(14)
ds_write_b64 v239, v[250:251] offset:2048
v_mfma_f32_16x16x32_bf16 a[136:139], a[8:11], v[132:135], a[136:139]
s_waitcnt lgkmcnt(14)
ds_read_b128 v[200:203], v186 offset:2048
v_accvgpr_read_b32 v189, a65
v_mfma_f32_16x16x32_bf16 a[136:139], a[4:7], v[156:159], a[136:139]
s_waitcnt lgkmcnt(14)
ds_read_b128 v[204:207], v186 offset:3072
v_accvgpr_read_b32 v190, a66
v_mfma_f32_16x16x32_bf16 a[136:139], a[0:3], v[180:183], a[136:139]
v_accvgpr_read_b32 v191, a67
v_mul_f32 v188, v188, v28
v_mfma_f32_16x16x32_bf16 a[136:139], v[232:235], v[228:231], a[136:139]
v_mul_f32 v189, v189, v28
v_cvt_pk_bf16_f32 v248, v188, v189
v_mfma_f32_16x16x32_bf16 a[100:103], a[24:27], v[64:67], a[100:103]
s_waitcnt lgkmcnt(14)
v_accvgpr_read_b32 v188, a68
v_accvgpr_read_b32 v189, a69
v_mfma_f32_16x16x32_bf16 a[100:103], a[20:23], v[88:91], a[100:103]
s_waitcnt lgkmcnt(12)
v_mul_f32 v190, v190, v28
v_mul_f32 v191, v191, v28
v_mfma_f32_16x16x32_bf16 a[100:103], a[16:19], v[112:115], a[100:103]
s_waitcnt lgkmcnt(10)
v_cvt_pk_bf16_f32 v249, v190, v191
v_mfma_f32_16x16x32_bf16 a[100:103], a[12:15], v[136:139], a[100:103]
s_waitcnt lgkmcnt(8)
s_add_u32 s51, s49, 30848
s_waitcnt lgkmcnt(1)
buffer_store_dwordx4 v[200:203], v18, s[40:43], s51 offen sc1
v_mfma_f32_16x16x32_bf16 a[100:103], v[12:15], v[160:163], a[100:103]
v_accvgpr_read_b32 v190, a70
v_accvgpr_read_b32 v191, a71
v_mfma_f32_16x16x32_bf16 a[100:103], v[0:3], v[208:211], a[100:103]
v_mul_f32 v188, v188, v28
v_mfma_f32_16x16x32_bf16 a[108:111], a[24:27], v[68:71], a[108:111]
v_mul_f32 v189, v189, v28
v_mfma_f32_16x16x32_bf16 a[108:111], a[20:23], v[92:95], a[108:111]
v_cvt_pk_bf16_f32 v250, v188, v189
v_mfma_f32_16x16x32_bf16 a[108:111], a[16:19], v[116:119], a[108:111]
v_mul_f32 v190, v190, v28
v_mfma_f32_16x16x32_bf16 a[108:111], a[12:15], v[140:143], a[108:111]
s_add_u32 s51, s49, 33920
v_mul_f32 v191, v191, v28
v_mfma_f32_16x16x32_bf16 a[108:111], v[12:15], v[164:167], a[108:111]
v_cvt_pk_bf16_f32 v251, v190, v191
v_mfma_f32_16x16x32_bf16 a[108:111], v[0:3], v[212:215], a[108:111]
v_accvgpr_read_b32 v188, a88
v_accvgpr_read_b32 v189, a89
v_mfma_f32_16x16x32_bf16 a[116:119], a[24:27], v[72:75], a[116:119]
v_accvgpr_read_b32 v190, a90
v_mfma_f32_16x16x32_bf16 a[116:119], a[20:23], v[96:99], a[116:119]
v_accvgpr_read_b32 v191, a91
v_mfma_f32_16x16x32_bf16 a[116:119], a[16:19], v[120:123], a[116:119]
v_mul_f32 v188, v188, v31
v_mfma_f32_16x16x32_bf16 a[116:119], a[12:15], v[144:147], a[116:119]
v_mul_f32 v189, v189, v31
v_mfma_f32_16x16x32_bf16 a[116:119], v[12:15], v[168:171], a[116:119]
s_waitcnt lgkmcnt(0)
buffer_store_dwordx4 v[204:207], v18, s[40:43], s51 offen sc1
v_mfma_f32_16x16x32_bf16 a[116:119], v[0:3], v[216:219], a[116:119]
v_cvt_pk_bf16_f32 v196, v188, v189
v_mfma_f32_16x16x32_bf16 a[124:127], a[24:27], v[76:79], a[124:127]
v_accvgpr_read_b32 v188, a92
v_mfma_f32_16x16x32_bf16 a[124:127], a[20:23], v[100:103], a[124:127]
v_accvgpr_read_b32 v189, a93
v_mfma_f32_16x16x32_bf16 a[124:127], a[16:19], v[124:127], a[124:127]
v_mul_f32 v190, v190, v31
v_mfma_f32_16x16x32_bf16 a[124:127], a[12:15], v[148:151], a[124:127]
v_mul_f32 v191, v191, v31
v_cvt_pk_bf16_f32 v197, v190, v191
v_mfma_f32_16x16x32_bf16 a[124:127], v[12:15], v[172:175], a[124:127]
v_accvgpr_read_b32 v190, a94
v_mfma_f32_16x16x32_bf16 a[124:127], v[0:3], v[220:223], a[124:127]
v_accvgpr_read_b32 v191, a95
v_mfma_f32_16x16x32_bf16 a[132:135], a[24:27], v[80:83], a[132:135]
v_mul_f32 v188, v188, v31
v_mfma_f32_16x16x32_bf16 a[132:135], a[20:23], v[104:107], a[132:135]
v_mul_f32 v189, v189, v31
v_mfma_f32_16x16x32_bf16 a[132:135], a[16:19], v[128:131], a[132:135]
v_cvt_pk_bf16_f32 v198, v188, v189
v_mul_f32 v190, v190, v31
v_mfma_f32_16x16x32_bf16 a[132:135], a[12:15], v[152:155], a[132:135]
v_mul_f32 v191, v191, v31
v_mfma_f32_16x16x32_bf16 a[132:135], v[12:15], v[176:179], a[132:135]
v_cvt_pk_bf16_f32 v199, v190, v191
v_mfma_f32_16x16x32_bf16 a[132:135], v[0:3], v[224:227], a[132:135]
v_mfma_f32_16x16x32_bf16 a[140:143], a[24:27], v[84:87], a[140:143]
v_mfma_f32_16x16x32_bf16 a[140:143], a[20:23], v[108:111], a[140:143]
v_mfma_f32_16x16x32_bf16 a[140:143], a[16:19], v[132:135], a[140:143]
v_mfma_f32_16x16x32_bf16 a[140:143], a[12:15], v[156:159], a[140:143]
v_mfma_f32_16x16x32_bf16 a[140:143], v[12:15], v[180:183], a[140:143]
v_mfma_f32_16x16x32_bf16 a[140:143], v[0:3], v[228:231], a[140:143]
v_accvgpr_read_b32 v188, a96
v_accvgpr_read_b32 v189, a97
v_accvgpr_read_b32 v190, a98
v_accvgpr_read_b32 v191, a99
v_mul_f32 v188, v188, v26
v_mul_f32 v189, v189, v26
v_cvt_pk_bf16_f32 v22, v188, v189
ds_write_b64 v236, v[240:241]
v_accvgpr_read_b32 v188, a100
v_accvgpr_read_b32 v189, a101
v_mul_f32 v190, v190, v26
v_mul_f32 v191, v191, v26
v_cvt_pk_bf16_f32 v23, v190, v191
ds_write_b64 v238, v[22:23]
v_accvgpr_read_b32 v190, a102
v_accvgpr_read_b32 v191, a103
v_mul_f32 v188, v188, v26
v_mul_f32 v189, v189, v26
v_cvt_pk_bf16_f32 v24, v188, v189
ds_write_b64 v237, v[242:243]
v_mul_f32 v190, v190, v26
v_mul_f32 v191, v191, v26
v_cvt_pk_bf16_f32 v25, v190, v191
ds_write_b64 v239, v[24:25]
ds_read_b128 v[200:203], v186 offset:0
ds_read_b128 v[204:207], v186 offset:1024
v_accvgpr_read_b32 v188, a104
v_accvgpr_read_b32 v189, a105
v_accvgpr_read_b32 v190, a106
v_accvgpr_read_b32 v191, a107
s_add_u32 s51, s49, 256
v_mul_f32 v188, v188, v27
v_mul_f32 v189, v189, v27
v_cvt_pk_bf16_f32 v22, v188, v189
ds_write_b64 v236, v[244:245] offset:2048
s_waitcnt lgkmcnt(2)
buffer_store_dwordx4 v[200:203], v18, s[40:43], s51 offen sc1
v_accvgpr_read_b32 v188, a108
v_accvgpr_read_b32 v189, a109
v_mul_f32 v190, v190, v27
v_mul_f32 v191, v191, v27
s_add_u32 s51, s49, 3328
v_cvt_pk_bf16_f32 v23, v190, v191
ds_write_b64 v238, v[22:23] offset:2048
v_accvgpr_read_b32 v190, a110
v_accvgpr_read_b32 v191, a111
s_waitcnt lgkmcnt(2)
buffer_store_dwordx4 v[204:207], v18, s[40:43], s51 offen sc1
v_mul_f32 v188, v188, v27
v_mul_f32 v189, v189, v27
v_cvt_pk_bf16_f32 v24, v188, v189
ds_write_b64 v237, v[246:247] offset:2048
v_mul_f32 v190, v190, v27
v_mul_f32 v191, v191, v27
v_cvt_pk_bf16_f32 v25, v190, v191
ds_write_b64 v239, v[24:25] offset:2048
ds_read_b128 v[200:203], v186 offset:2048
ds_read_b128 v[204:207], v186 offset:3072
v_accvgpr_read_b32 v188, a112
v_accvgpr_read_b32 v189, a113
v_accvgpr_read_b32 v190, a114
v_accvgpr_read_b32 v191, a115
s_add_u32 s51, s49, 6400
v_mul_f32 v188, v188, v28
v_mul_f32 v189, v189, v28
v_cvt_pk_bf16_f32 v22, v188, v189
ds_write_b64 v236, v[248:249]
s_waitcnt lgkmcnt(2)
buffer_store_dwordx4 v[200:203], v18, s[40:43], s51 offen sc1
v_accvgpr_read_b32 v188, a116
v_accvgpr_read_b32 v189, a117
v_mul_f32 v190, v190, v28
v_mul_f32 v191, v191, v28
s_add_u32 s51, s49, 9472
v_cvt_pk_bf16_f32 v23, v190, v191
ds_write_b64 v238, v[22:23]
v_accvgpr_read_b32 v190, a118
v_accvgpr_read_b32 v191, a119
s_waitcnt lgkmcnt(2)
buffer_store_dwordx4 v[204:207], v18, s[40:43], s51 offen sc1
v_mul_f32 v188, v188, v28
v_mul_f32 v189, v189, v28
v_cvt_pk_bf16_f32 v24, v188, v189
ds_write_b64 v237, v[250:251]
v_mul_f32 v190, v190, v28
v_mul_f32 v191, v191, v28
v_cvt_pk_bf16_f32 v25, v190, v191
ds_write_b64 v239, v[24:25]
ds_read_b128 v[200:203], v186 offset:0
ds_read_b128 v[204:207], v186 offset:1024
v_accvgpr_read_b32 v188, a120
v_accvgpr_read_b32 v189, a121
v_accvgpr_read_b32 v190, a122
v_accvgpr_read_b32 v191, a123
s_add_u32 s51, s49, 12544
v_mul_f32 v188, v188, v29
v_mul_f32 v189, v189, v29
v_cvt_pk_bf16_f32 v22, v188, v189
ds_write_b64 v236, v[252:253] offset:2048
s_waitcnt lgkmcnt(2)
buffer_store_dwordx4 v[200:203], v18, s[40:43], s51 offen sc1
v_accvgpr_read_b32 v188, a124
v_accvgpr_read_b32 v189, a125
v_mul_f32 v190, v190, v29
v_mul_f32 v191, v191, v29
s_add_u32 s51, s49, 15616
v_cvt_pk_bf16_f32 v23, v190, v191
ds_write_b64 v238, v[22:23] offset:2048
v_accvgpr_read_b32 v190, a126
v_accvgpr_read_b32 v191, a127
s_waitcnt lgkmcnt(2)
buffer_store_dwordx4 v[204:207], v18, s[40:43], s51 offen sc1
v_mul_f32 v188, v188, v29
v_mul_f32 v189, v189, v29
v_cvt_pk_bf16_f32 v24, v188, v189
ds_write_b64 v237, v[254:255] offset:2048
v_mul_f32 v190, v190, v29
v_mul_f32 v191, v191, v29
v_cvt_pk_bf16_f32 v25, v190, v191
ds_write_b64 v239, v[24:25] offset:2048
ds_read_b128 v[200:203], v186 offset:2048
ds_read_b128 v[204:207], v186 offset:3072
v_accvgpr_read_b32 v188, a128
v_accvgpr_read_b32 v189, a129
v_accvgpr_read_b32 v190, a130
v_accvgpr_read_b32 v191, a131
s_add_u32 s51, s49, 18688
v_mul_f32 v188, v188, v30
v_mul_f32 v189, v189, v30
v_cvt_pk_bf16_f32 v22, v188, v189
ds_write_b64 v236, v[192:193]
s_waitcnt lgkmcnt(2)
buffer_store_dwordx4 v[200:203], v18, s[40:43], s51 offen sc1
v_accvgpr_read_b32 v188, a132
v_accvgpr_read_b32 v189, a133
v_mul_f32 v190, v190, v30
v_mul_f32 v191, v191, v30
s_add_u32 s51, s49, 21760
v_cvt_pk_bf16_f32 v23, v190, v191
ds_write_b64 v238, v[22:23]
v_accvgpr_read_b32 v190, a134
v_accvgpr_read_b32 v191, a135
s_waitcnt lgkmcnt(2)
buffer_store_dwordx4 v[204:207], v18, s[40:43], s51 offen sc1
v_mul_f32 v188, v188, v30
v_mul_f32 v189, v189, v30
v_cvt_pk_bf16_f32 v24, v188, v189
ds_write_b64 v237, v[194:195]
v_mul_f32 v190, v190, v30
v_mul_f32 v191, v191, v30
v_cvt_pk_bf16_f32 v25, v190, v191
ds_write_b64 v239, v[24:25]
ds_read_b128 v[200:203], v186 offset:0
ds_read_b128 v[204:207], v186 offset:1024
v_accvgpr_read_b32 v188, a136
v_accvgpr_read_b32 v189, a137
v_accvgpr_read_b32 v190, a138
v_accvgpr_read_b32 v191, a139
s_add_u32 s51, s49, 24832
v_mul_f32 v188, v188, v31
v_mul_f32 v189, v189, v31
v_cvt_pk_bf16_f32 v22, v188, v189
ds_write_b64 v236, v[196:197] offset:2048
s_waitcnt lgkmcnt(2)
buffer_store_dwordx4 v[200:203], v18, s[40:43], s51 offen sc1
v_accvgpr_read_b32 v188, a140
v_accvgpr_read_b32 v189, a141
v_mul_f32 v190, v190, v31
v_mul_f32 v191, v191, v31
s_add_u32 s51, s49, 27904
v_cvt_pk_bf16_f32 v23, v190, v191
ds_write_b64 v238, v[22:23] offset:2048
v_accvgpr_read_b32 v190, a142
v_accvgpr_read_b32 v191, a143
s_waitcnt lgkmcnt(2)
buffer_store_dwordx4 v[204:207], v18, s[40:43], s51 offen sc1
v_mul_f32 v188, v188, v31
v_mul_f32 v189, v189, v31
v_cvt_pk_bf16_f32 v24, v188, v189
ds_write_b64 v237, v[198:199] offset:2048
v_mul_f32 v190, v190, v31
v_mul_f32 v191, v191, v31
v_cvt_pk_bf16_f32 v25, v190, v191
ds_write_b64 v239, v[24:25] offset:2048
ds_read_b128 v[200:203], v186 offset:2048
ds_read_b128 v[204:207], v186 offset:3072
s_add_u32 s51, s49, 30976
s_waitcnt lgkmcnt(1)
buffer_store_dwordx4 v[200:203], v18, s[40:43], s51 offen sc1
s_add_u32 s51, s49, 34048
s_waitcnt lgkmcnt(0)
buffer_store_dwordx4 v[204:207], v18, s[40:43], s51 offen sc1
s_or_b64 s[4:5], s[90:91], s[92:93]
s_or_b64 s[4:5], s[4:5], s[94:95]
s_or_b64 s[4:5], s[4:5], s[96:97]
s_or_b64 s[4:5], s[4:5], s[98:99]
s_or_b64 s[4:5], s[4:5], s[100:101]
s_cbranch_scc1 L_slow
L_end:
s_endpgm
L_slow:
s_waitcnt vmcnt(0) lgkmcnt(0)
s_nop 15
v_mbcnt_lo_u32_b32 v8, -1, 0
v_mbcnt_hi_u32_b32 v8, -1, v8
v_and_b32 v7, 31, v8
v_lshrrev_b32 v8, 5, v8
v_mul_u32_u24 v6, 384, v7
v_lshl_add_u32 v1, v8, 4, v6
v_lshl_add_u32 v6, v8, 3, v6
v_mul_u32_u24 v2, 1536, v8
v_lshl_add_u32 v2, v7, 1, v2
v_add_u32 v3, 3072, v2
v_add_u32 v4, 6144, v2
v_add_u32 v5, 9216, v2
s_cmp_eq_u64 s[90:91], 0
s_cbranch_scc1 L_sl00
s_mov_b32 s64, s12
s_mov_b32 s65, s13
s_mov_b32 s66, 147456
s_mov_b32 s67, 0x20000
s_mov_b32 s68, s16
s_mov_b32 s69, s17
s_mov_b32 s70, 147456
s_mov_b32 s71, 0x20000
s_mov_b32 s72, s20
s_mov_b32 s73, s21
s_mov_b32 s74, 147456
s_mov_b32 s75, 0x20000
s_mov_b32 s76, s24
s_mov_b32 s77, s25
s_mov_b32 s78, 147456
s_mov_b32 s79, 0x20000
s_mul_i32 s80, s3, 36864
s_add_u32 s80, s80, 0
s_call_b64 s[82:83], L_slowblk
L_sl00:
s_cmp_eq_u64 s[92:93], 0
s_cbranch_scc1 L_sl01
s_mov_b32 s64, s12
s_mov_b32 s65, s13
s_mov_b32 s66, 147456
s_mov_b32 s67, 0x20000
s_mov_b32 s68, s16
s_mov_b32 s69, s17
s_mov_b32 s70, 147456
s_mov_b32 s71, 0x20000
s_mov_b32 s72, s20
s_mov_b32 s73, s21
s_mov_b32 s74, 147456
s_mov_b32 s75, 0x20000
s_mov_b32 s76, s24
s_mov_b32 s77, s25
s_mov_b32 s78, 147456
s_mov_b32 s79, 0x20000
s_mul_i32 s80, s3, 36864
s_add_u32 s80, s80, 12288
s_call_b64 s[82:83], L_slowblk
L_sl01:
s_cmp_eq_u64 s[94:95], 0
s_cbranch_scc1 L_sl02
s_mov_b32 s64, s12
s_mov_b32 s65, s13
s_mov_b32 s66, 147456
s_mov_b32 s67, 0x20000
s_mov_b32 s68, s16
s_mov_b32 s69, s17
s_mov_b32 s70, 147456
s_mov_b32 s71, 0x20000
s_mov_b32 s72, s20
s_mov_b32 s73, s21
s_mov_b32 s74, 147456
s_mov_b32 s75, 0x20000
s_mov_b32 s76, s24
s_mov_b32 s77, s25
s_mov_b32 s78, 147456
s_mov_b32 s79, 0x20000
s_mul_i32 s80, s3, 36864
s_add_u32 s80, s80, 24576
s_call_b64 s[82:83], L_slowblk
L_sl02:
s_cmp_eq_u64 s[96:97], 0
s_cbranch_scc1 L_sl10
s_mov_b32 s64, s28
s_mov_b32 s65, s29
s_mov_b32 s66, 147456
s_mov_b32 s67, 0x20000
s_mov_b32 s68, s32
s_mov_b32 s69, s33
s_mov_b32 s70, 147456
s_mov_b32 s71, 0x20000
s_mov_b32 s72, s36
s_mov_b32 s73, s37
s_mov_b32 s74, 147456
s_mov_b32 s75, 0x20000
s_mov_b32 s76, s40
s_mov_b32 s77, s41
s_mov_b32 s78, 147456
s_mov_b32 s79, 0x20000
s_mul_i32 s80, s3, 36864
s_add_u32 s80, s80, 0
s_call_b64 s[82:83], L_slowblk
L_sl10:
s_cmp_eq_u64 s[98:99], 0
s_cbranch_scc1 L_sl11
s_mov_b32 s64, s28
s_mov_b32 s65, s29
s_mov_b32 s66, 147456
s_mov_b32 s67, 0x20000
s_mov_b32 s68, s32
s_mov_b32 s69, s33
s_mov_b32 s70, 147456
s_mov_b32 s71, 0x20000
s_mov_b32 s72, s36
s_mov_b32 s73, s37
s_mov_b32 s74, 147456
s_mov_b32 s75, 0x20000
s_mov_b32 s76, s40
s_mov_b32 s77, s41
s_mov_b32 s78, 147456
s_mov_b32 s79, 0x20000
s_mul_i32 s80, s3, 36864
s_add_u32 s80, s80, 12288
s_call_b64 s[82:83], L_slowblk
L_sl11:
s_cmp_eq_u64 s[100:101], 0
s_cbranch_scc1 L_sl12
s_mov_b32 s64, s28
s_mov_b32 s65, s29
s_mov_b32 s66, 147456
s_mov_b32 s67, 0x20000
s_mov_b32 s68, s32
s_mov_b32 s69, s33
s_mov_b32 s70, 147456
s_mov_b32 s71, 0x20000
s_mov_b32 s72, s36
s_mov_b32 s73, s37
s_mov_b32 s74, 147456
s_mov_b32 s75, 0x20000
s_mov_b32 s76, s40
s_mov_b32 s77, s41
s_mov_b32 s78, 147456
s_mov_b32 s79, 0x20000
s_mul_i32 s80, s3, 36864
s_add_u32 s80, s80, 24576
s_call_b64 s[82:83], L_slowblk
L_sl12:
s_endpgm
L_slowblk:
buffer_load_dwordx4 v[64:67], v1, s[64:67], s80 offen offset:0
buffer_load_dwordx4 v[68:71], v1, s[64:67], s80 offen offset:32
buffer_load_dwordx4 v[72:75], v1, s[64:67], s80 offen offset:64
buffer_load_dwordx4 v[76:79], v1, s[64:67], s80 offen offset:96
buffer_load_dwordx4 v[80:83], v1, s[64:67], s80 offen offset:128
buffer_load_dwordx4 v[84:87], v1, s[64:67], s80 offen offset:160
buffer_load_dwordx4 v[88:91], v1, s[64:67], s80 offen offset:192
buffer_load_dwordx4 v[92:95], v1, s[64:67], s80 offen offset:224
buffer_load_dwordx4 v[96:99], v1, s[64:67], s80 offen offset:256
buffer_load_dwordx4 v[100:103], v1, s[64:67], s80 offen offset:288
buffer_load_dwordx4 v[104:107], v1, s[64:67], s80 offen offset:320
buffer_load_dwordx4 v[108:111], v1, s[64:67], s80 offen offset:352
v_mov_b32 v9, 0xff800000
s_mov_b32 s81, 0
L_sp1:
buffer_load_dwordx4 v[112:115], v1, s[68:71], s81 offen offset:0
buffer_load_dwordx4 v[116:119], v1, s[68:71], s81 offen offset:32
buffer_load_dwordx4 v[120:123], v1, s[68:71], s81 offen offset:64
buffer_load_dwordx4 v[124:127], v1, s[68:71], s81 offen offset:96
buffer_load_dwordx4 v[128:131], v1, s[68:71], s81 offen offset:128
buffer_load_dwordx4 v[132:135], v1, s[68:71], s81 offen offset:160
buffer_load_dwordx4 v[136:139], v1, s[68:71], s81 offen offset:192
buffer_load_dwordx4 v[140:143], v1, s[68:71], s81 offen offset:224
buffer_load_dwordx4 v[144:147], v1, s[68:71], s81 offen offset:256
buffer_load_dwordx4 v[148:151], v1, s[68:71], s81 offen offset:288
buffer_load_dwordx4 v[152:155], v1, s[68:71], s81 offen offset:320
buffer_load_dwordx4 v[156:159], v1, s[68:71], s81 offen offset:352
s_waitcnt vmcnt(0)
v_mfma_f32_32x32x16_bf16 v[16:31], v[112:115], v[64:67], 0
v_mfma_f32_32x32x16_bf16 v[16:31], v[116:119], v[68:71], v[16:31]
v_mfma_f32_32x32x16_bf16 v[16:31], v[120:123], v[72:75], v[16:31]
v_mfma_f32_32x32x16_bf16 v[16:31], v[124:127], v[76:79], v[16:31]
v_mfma_f32_32x32x16_bf16 v[16:31], v[128:131], v[80:83], v[16:31]
v_mfma_f32_32x32x16_bf16 v[16:31], v[132:135], v[84:87], v[16:31]
v_mfma_f32_32x32x16_bf16 v[16:31], v[136:139], v[88:91], v[16:31]
v_mfma_f32_32x32x16_bf16 v[16:31], v[140:143], v[92:95], v[16:31]
v_mfma_f32_32x32x16_bf16 v[16:31], v[144:147], v[96:99], v[16:31]
v_mfma_f32_32x32x16_bf16 v[16:31], v[148:151], v[100:103], v[16:31]
v_mfma_f32_32x32x16_bf16 v[16:31], v[152:155], v[104:107], v[16:31]
v_mfma_f32_32x32x16_bf16 v[16:31], v[156:159], v[108:111], v[16:31]
s_nop 15
v_max3_f32 v9, v9, v16, v17
v_max3_f32 v9, v9, v18, v19
v_max3_f32 v9, v9, v20, v21
v_max3_f32 v9, v9, v22, v23
v_max3_f32 v9, v9, v24, v25
v_max3_f32 v9, v9, v26, v27
v_max3_f32 v9, v9, v28, v29
v_max3_f32 v9, v9, v30, v31
s_add_u32 s81, s81, 12288
s_cmp_lt_u32 s81, 147456
s_cbranch_scc1 L_sp1
v_mov_b32 v10, v9
s_nop 1
v_permlane32_swap_b32 v9, v10
s_nop 1
v_max_f32 v9, v9, v10
v_mov_b32 v10, 0
v_accvgpr_write_b32 a0, 0
v_accvgpr_write_b32 a1, 0
v_accvgpr_write_b32 a2, 0
v_accvgpr_write_b32 a3, 0
v_accvgpr_write_b32 a4, 0
v_accvgpr_write_b32 a5, 0
v_accvgpr_write_b32 a6, 0
v_accvgpr_write_b32 a7, 0
v_accvgpr_write_b32 a8, 0
v_accvgpr_write_b32 a9, 0
v_accvgpr_write_b32 a10, 0
v_accvgpr_write_b32 a11, 0
v_accvgpr_write_b32 a12, 0
v_accvgpr_write_b32 a13, 0
v_accvgpr_write_b32 a14, 0
v_accvgpr_write_b32 a15, 0
v_accvgpr_write_b32 a16, 0
v_accvgpr_write_b32 a17, 0
v_accvgpr_write_b32 a18, 0
v_accvgpr_write_b32 a19, 0
v_accvgpr_write_b32 a20, 0
v_accvgpr_write_b32 a21, 0
v_accvgpr_write_b32 a22, 0
v_accvgpr_write_b32 a23, 0
v_accvgpr_write_b32 a24, 0
v_accvgpr_write_b32 a25, 0
v_accvgpr_write_b32 a26, 0
v_accvgpr_write_b32 a27, 0
v_accvgpr_write_b32 a28, 0
v_accvgpr_write_b32 a29, 0
v_accvgpr_write_b32 a30, 0
v_accvgpr_write_b32 a31, 0
v_accvgpr_write_b32 a32, 0
v_accvgpr_write_b32 a33, 0
v_accvgpr_write_b32 a34, 0
v_accvgpr_write_b32 a35, 0
v_accvgpr_write_b32 a36, 0
v_accvgpr_write_b32 a37, 0
v_accvgpr_write_b32 a38, 0
v_accvgpr_write_b32 a39, 0
v_accvgpr_write_b32 a40, 0
v_accvgpr_write_b32 a41, 0
v_accvgpr_write_b32 a42, 0
v_accvgpr_write_b32 a43, 0
v_accvgpr_write_b32 a44, 0
v_accvgpr_write_b32 a45, 0
v_accvgpr_write_b32 a46, 0
v_accvgpr_write_b32 a47, 0
v_accvgpr_write_b32 a48, 0
v_accvgpr_write_b32 a49, 0
v_accvgpr_write_b32 a50, 0
v_accvgpr_write_b32 a51, 0
v_accvgpr_write_b32 a52, 0
v_accvgpr_write_b32 a53, 0
v_accvgpr_write_b32 a54, 0
v_accvgpr_write_b32 a55, 0
v_accvgpr_write_b32 a56, 0
v_accvgpr_write_b32 a57, 0
v_accvgpr_write_b32 a58, 0
v_accvgpr_write_b32 a59, 0
v_accvgpr_write_b32 a60, 0
v_accvgpr_write_b32 a61, 0
v_accvgpr_write_b32 a62, 0
v_accvgpr_write_b32 a63, 0
v_accvgpr_write_b32 a64, 0
v_accvgpr_write_b32 a65, 0
v_accvgpr_write_b32 a66, 0
v_accvgpr_write_b32 a67, 0
v_accvgpr_write_b32 a68, 0
v_accvgpr_write_b32 a69, 0
v_accvgpr_write_b32 a70, 0
v_accvgpr_write_b32 a71, 0
v_accvgpr_write_b32 a72, 0
v_accvgpr_write_b32 a73, 0
v_accvgpr_write_b32 a74, 0
v_accvgpr_write_b32 a75, 0
v_accvgpr_write_b32 a76, 0
v_accvgpr_write_b32 a77, 0
v_accvgpr_write_b32 a78, 0
v_accvgpr_write_b32 a79, 0
v_accvgpr_write_b32 a80, 0
v_accvgpr_write_b32 a81, 0
v_accvgpr_write_b32 a82, 0
v_accvgpr_write_b32 a83, 0
v_accvgpr_write_b32 a84, 0
v_accvgpr_write_b32 a85, 0
v_accvgpr_write_b32 a86, 0
v_accvgpr_write_b32 a87, 0
v_accvgpr_write_b32 a88, 0
v_accvgpr_write_b32 a89, 0
v_accvgpr_write_b32 a90, 0
v_accvgpr_write_b32 a91, 0
v_accvgpr_write_b32 a92, 0
v_accvgpr_write_b32 a93, 0
v_accvgpr_write_b32 a94, 0
v_accvgpr_write_b32 a95, 0
s_mov_b32 s81, 0
L_sp2:
buffer_load_dwordx4 v[112:115], v1, s[68:71], s81 offen offset:0
buffer_load_dwordx4 v[116:119], v1, s[68:71], s81 offen offset:32
buffer_load_dwordx4 v[120:123], v1, s[68:71], s81 offen offset:64
buffer_load_dwordx4 v[124:127], v1, s[68:71], s81 offen offset:96
buffer_load_dwordx4 v[128:131], v1, s[68:71], s81 offen offset:128
buffer_load_dwordx4 v[132:135], v1, s[68:71], s81 offen offset:160
buffer_load_dwordx4 v[136:139], v1, s[68:71], s81 offen offset:192
buffer_load_dwordx4 v[140:143], v1, s[68:71], s81 offen offset:224
buffer_load_dwordx4 v[144:147], v1, s[68:71], s81 offen offset:256
buffer_load_dwordx4 v[148:151], v1, s[68:71], s81 offen offset:288
buffer_load_dwordx4 v[152:155], v1, s[68:71], s81 offen offset:320
buffer_load_dwordx4 v[156:159], v1, s[68:71], s81 offen offset:352
s_waitcnt vmcnt(0)
v_mfma_f32_32x32x16_bf16 v[16:31], v[112:115], v[64:67], 0
v_mfma_f32_32x32x16_bf16 v[16:31], v[116:119], v[68:71], v[16:31]
v_mfma_f32_32x32x16_bf16 v[16:31], v[120:123], v[72:75], v[16:31]
v_mfma_f32_32x32x16_bf16 v[16:31], v[124:127], v[76:79], v[16:31]
v_mfma_f32_32x32x16_bf16 v[16:31], v[128:131], v[80:83], v[16:31]
v_mfma_f32_32x32x16_bf16 v[16:31], v[132:135], v[84:87], v[16:31]
v_mfma_f32_32x32x16_bf16 v[16:31], v[136:139], v[88:91], v[16:31]
v_mfma_f32_32x32x16_bf16 v[16:31], v[140:143], v[92:95], v[16:31]
v_mfma_f32_32x32x16_bf16 v[16:31], v[144:147], v[96:99], v[16:31]
v_mfma_f32_32x32x16_bf16 v[16:31], v[148:151], v[100:103], v[16:31]
v_mfma_f32_32x32x16_bf16 v[16:31], v[152:155], v[104:107], v[16:31]
v_mfma_f32_32x32x16_bf16 v[16:31], v[156:159], v[108:111], v[16:31]
s_nop 15
v_sub_f32 v16, v16, v9
v_mul_f32 v16, s44, v16
v_sub_f32 v17, v17, v9
v_mul_f32 v17, s44, v17
v_sub_f32 v18, v18, v9
v_mul_f32 v18, s44, v18
v_sub_f32 v19, v19, v9
v_mul_f32 v19, s44, v19
v_sub_f32 v20, v20, v9
v_mul_f32 v20, s44, v20
v_sub_f32 v21, v21, v9
v_mul_f32 v21, s44, v21
v_sub_f32 v22, v22, v9
v_mul_f32 v22, s44, v22
v_sub_f32 v23, v23, v9
v_mul_f32 v23, s44, v23
v_sub_f32 v24, v24, v9
v_mul_f32 v24, s44, v24
v_sub_f32 v25, v25, v9
v_mul_f32 v25, s44, v25
v_sub_f32 v26, v26, v9
v_mul_f32 v26, s44, v26
v_sub_f32 v27, v27, v9
v_mul_f32 v27, s44, v27
v_sub_f32 v28, v28, v9
v_mul_f32 v28, s44, v28
v_sub_f32 v29, v29, v9
v_mul_f32 v29, s44, v29
v_sub_f32 v30, v30, v9
v_mul_f32 v30, s44, v30
v_sub_f32 v31, v31, v9
v_mul_f32 v31, s44, v31
v_exp_f32 v16, v16
v_exp_f32 v17, v17
v_exp_f32 v18, v18
v_exp_f32 v19, v19
v_exp_f32 v20, v20
v_exp_f32 v21, v21
v_exp_f32 v22, v22
v_exp_f32 v23, v23
v_exp_f32 v24, v24
v_exp_f32 v25, v25
v_exp_f32 v26, v26
v_exp_f32 v27, v27
v_exp_f32 v28, v28
v_exp_f32 v29, v29
v_exp_f32 v30, v30
v_exp_f32 v31, v31
s_nop 0
v_add_f32 v10, v10, v16
v_add_f32 v10, v10, v17
v_add_f32 v10, v10, v18
v_add_f32 v10, v10, v19
v_add_f32 v10, v10, v20
v_add_f32 v10, v10, v21
v_add_f32 v10, v10, v22
v_add_f32 v10, v10, v23
v_add_f32 v10, v10, v24
v_add_f32 v10, v10, v25
v_add_f32 v10, v10, v26
v_add_f32 v10, v10, v27
v_add_f32 v10, v10, v28
v_add_f32 v10, v10, v29
v_add_f32 v10, v10, v30
v_add_f32 v10, v10, v31
v_cvt_pk_bf16_f32 v32, v16, v17
v_cvt_pk_bf16_f32 v33, v18, v19
v_cvt_pk_bf16_f32 v34, v20, v21
v_cvt_pk_bf16_f32 v35, v22, v23
v_cvt_pk_bf16_f32 v36, v24, v25
v_cvt_pk_bf16_f32 v37, v26, v27
v_cvt_pk_bf16_f32 v38, v28, v29
v_cvt_pk_bf16_f32 v39, v30, v31
buffer_load_ushort v192, v2, s[72:75], s81 offen offset:0
buffer_load_ushort v193, v2, s[72:75], s81 offen offset:384
buffer_load_ushort v194, v2, s[72:75], s81 offen offset:768
buffer_load_ushort v195, v2, s[72:75], s81 offen offset:1152
buffer_load_ushort v196, v3, s[72:75], s81 offen offset:0
buffer_load_ushort v197, v3, s[72:75], s81 offen offset:384
buffer_load_ushort v198, v3, s[72:75], s81 offen offset:768
buffer_load_ushort v199, v3, s[72:75], s81 offen offset:1152
buffer_load_ushort v200, v2, s[72:75], s81 offen offset:64
buffer_load_ushort v201, v2, s[72:75], s81 offen offset:448
buffer_load_ushort v202, v2, s[72:75], s81 offen offset:832
buffer_load_ushort v203, v2, s[72:75], s81 offen offset:1216
buffer_load_ushort v204, v3, s[72:75], s81 offen offset:64
buffer_load_ushort v205, v3, s[72:75], s81 offen offset:448
buffer_load_ushort v206, v3, s[72:75], s81 offen offset:832
buffer_load_ushort v207, v3, s[72:75], s81 offen offset:1216
buffer_load_ushort v208, v2, s[72:75], s81 offen offset:128
buffer_load_ushort v209, v2, s[72:75], s81 offen offset:512
buffer_load_ushort v210, v2, s[72:75], s81 offen offset:896
buffer_load_ushort v211, v2, s[72:75], s81 offen offset:1280
buffer_load_ushort v212, v3, s[72:75], s81 offen offset:128
buffer_load_ushort v213, v3, s[72:75], s81 offen offset:512
buffer_load_ushort v214, v3, s[72:75], s81 offen offset:896
buffer_load_ushort v215, v3, s[72:75], s81 offen offset:1280
buffer_load_ushort v216, v2, s[72:75], s81 offen offset:192
buffer_load_ushort v217, v2, s[72:75], s81 offen offset:576
buffer_load_ushort v218, v2, s[72:75], s81 offen offset:960
buffer_load_ushort v219, v2, s[72:75], s81 offen offset:1344
buffer_load_ushort v220, v3, s[72:75], s81 offen offset:192
buffer_load_ushort v221, v3, s[72:75], s81 offen offset:576
buffer_load_ushort v222, v3, s[72:75], s81 offen offset:960
buffer_load_ushort v223, v3, s[72:75], s81 offen offset:1344
buffer_load_ushort v224, v2, s[72:75], s81 offen offset:256
buffer_load_ushort v225, v2, s[72:75], s81 offen offset:640
buffer_load_ushort v226, v2, s[72:75], s81 offen offset:1024
buffer_load_ushort v227, v2, s[72:75], s81 offen offset:1408
buffer_load_ushort v228, v3, s[72:75], s81 offen offset:256
buffer_load_ushort v229, v3, s[72:75], s81 offen offset:640
buffer_load_ushort v230, v3, s[72:75], s81 offen offset:1024
buffer_load_ushort v231, v3, s[72:75], s81 offen offset:1408
buffer_load_ushort v232, v2, s[72:75], s81 offen offset:320
buffer_load_ushort v233, v2, s[72:75], s81 offen offset:704
buffer_load_ushort v234, v2, s[72:75], s81 offen offset:1088
buffer_load_ushort v235, v2, s[72:75], s81 offen offset:1472
buffer_load_ushort v236, v3, s[72:75], s81 offen offset:320
buffer_load_ushort v237, v3, s[72:75], s81 offen offset:704
buffer_load_ushort v238, v3, s[72:75], s81 offen offset:1088
buffer_load_ushort v239, v3, s[72:75], s81 offen offset:1472
s_waitcnt vmcnt(0)
v_lshl_or_b32 v160, v193, 16, v192
v_lshl_or_b32 v161, v195, 16, v194
v_lshl_or_b32 v162, v197, 16, v196
v_lshl_or_b32 v163, v199, 16, v198
v_lshl_or_b32 v164, v201, 16, v200
v_lshl_or_b32 v165, v203, 16, v202
v_lshl_or_b32 v166, v205, 16, v204
v_lshl_or_b32 v167, v207, 16, v206
v_lshl_or_b32 v168, v209, 16, v208
v_lshl_or_b32 v169, v211, 16, v210
v_lshl_or_b32 v170, v213, 16, v212
v_lshl_or_b32 v171, v215, 16, v214
v_lshl_or_b32 v172, v217, 16, v216
v_lshl_or_b32 v173, v219, 16, v218
v_lshl_or_b32 v174, v221, 16, v220
v_lshl_or_b32 v175, v223, 16, v222
v_lshl_or_b32 v176, v225, 16, v224
v_lshl_or_b32 v177, v227, 16, v226
v_lshl_or_b32 v178, v229, 16, v228
v_lshl_or_b32 v179, v231, 16, v230
v_lshl_or_b32 v180, v233, 16, v232
v_lshl_or_b32 v181, v235, 16, v234
v_lshl_or_b32 v182, v237, 16, v236
v_lshl_or_b32 v183, v239, 16, v238
s_nop 1
v_mfma_f32_32x32x16_bf16 a[0:15], v[160:163], v[32:35], a[0:15]
v_mfma_f32_32x32x16_bf16 a[16:31], v[164:167], v[32:35], a[16:31]
v_mfma_f32_32x32x16_bf16 a[32:47], v[168:171], v[32:35], a[32:47]
v_mfma_f32_32x32x16_bf16 a[48:63], v[172:175], v[32:35], a[48:63]
v_mfma_f32_32x32x16_bf16 a[64:79], v[176:179], v[32:35], a[64:79]
v_mfma_f32_32x32x16_bf16 a[80:95], v[180:183], v[32:35], a[80:95]
s_nop 7
buffer_load_ushort v192, v4, s[72:75], s81 offen offset:0
buffer_load_ushort v193, v4, s[72:75], s81 offen offset:384
buffer_load_ushort v194, v4, s[72:75], s81 offen offset:768
buffer_load_ushort v195, v4, s[72:75], s81 offen offset:1152
buffer_load_ushort v196, v5, s[72:75], s81 offen offset:0
buffer_load_ushort v197, v5, s[72:75], s81 offen offset:384
buffer_load_ushort v198, v5, s[72:75], s81 offen offset:768
buffer_load_ushort v199, v5, s[72:75], s81 offen offset:1152
buffer_load_ushort v200, v4, s[72:75], s81 offen offset:64
buffer_load_ushort v201, v4, s[72:75], s81 offen offset:448
buffer_load_ushort v202, v4, s[72:75], s81 offen offset:832
buffer_load_ushort v203, v4, s[72:75], s81 offen offset:1216
buffer_load_ushort v204, v5, s[72:75], s81 offen offset:64
buffer_load_ushort v205, v5, s[72:75], s81 offen offset:448
buffer_load_ushort v206, v5, s[72:75], s81 offen offset:832
buffer_load_ushort v207, v5, s[72:75], s81 offen offset:1216
buffer_load_ushort v208, v4, s[72:75], s81 offen offset:128
buffer_load_ushort v209, v4, s[72:75], s81 offen offset:512
buffer_load_ushort v210, v4, s[72:75], s81 offen offset:896
buffer_load_ushort v211, v4, s[72:75], s81 offen offset:1280
buffer_load_ushort v212, v5, s[72:75], s81 offen offset:128
buffer_load_ushort v213, v5, s[72:75], s81 offen offset:512
buffer_load_ushort v214, v5, s[72:75], s81 offen offset:896
buffer_load_ushort v215, v5, s[72:75], s81 offen offset:1280
buffer_load_ushort v216, v4, s[72:75], s81 offen offset:192
buffer_load_ushort v217, v4, s[72:75], s81 offen offset:576
buffer_load_ushort v218, v4, s[72:75], s81 offen offset:960
buffer_load_ushort v219, v4, s[72:75], s81 offen offset:1344
buffer_load_ushort v220, v5, s[72:75], s81 offen offset:192
buffer_load_ushort v221, v5, s[72:75], s81 offen offset:576
buffer_load_ushort v222, v5, s[72:75], s81 offen offset:960
buffer_load_ushort v223, v5, s[72:75], s81 offen offset:1344
buffer_load_ushort v224, v4, s[72:75], s81 offen offset:256
buffer_load_ushort v225, v4, s[72:75], s81 offen offset:640
buffer_load_ushort v226, v4, s[72:75], s81 offen offset:1024
buffer_load_ushort v227, v4, s[72:75], s81 offen offset:1408
buffer_load_ushort v228, v5, s[72:75], s81 offen offset:256
buffer_load_ushort v229, v5, s[72:75], s81 offen offset:640
buffer_load_ushort v230, v5, s[72:75], s81 offen offset:1024
buffer_load_ushort v231, v5, s[72:75], s81 offen offset:1408
buffer_load_ushort v232, v4, s[72:75], s81 offen offset:320
buffer_load_ushort v233, v4, s[72:75], s81 offen offset:704
buffer_load_ushort v234, v4, s[72:75], s81 offen offset:1088
buffer_load_ushort v235, v4, s[72:75], s81 offen offset:1472
buffer_load_ushort v236, v5, s[72:75], s81 offen offset:320
buffer_load_ushort v237, v5, s[72:75], s81 offen offset:704
buffer_load_ushort v238, v5, s[72:75], s81 offen offset:1088
buffer_load_ushort v239, v5, s[72:75], s81 offen offset:1472
s_waitcnt vmcnt(0)
v_lshl_or_b32 v160, v193, 16, v192
v_lshl_or_b32 v161, v195, 16, v194
v_lshl_or_b32 v162, v197, 16, v196
v_lshl_or_b32 v163, v199, 16, v198
v_lshl_or_b32 v164, v201, 16, v200
v_lshl_or_b32 v165, v203, 16, v202
v_lshl_or_b32 v166, v205, 16, v204
v_lshl_or_b32 v167, v207, 16, v206
v_lshl_or_b32 v168, v209, 16, v208
v_lshl_or_b32 v169, v211, 16, v210
v_lshl_or_b32 v170, v213, 16, v212
v_lshl_or_b32 v171, v215, 16, v214
v_lshl_or_b32 v172, v217, 16, v216
v_lshl_or_b32 v173, v219, 16, v218
v_lshl_or_b32 v174, v221, 16, v220
v_lshl_or_b32 v175, v223, 16, v222
v_lshl_or_b32 v176, v225, 16, v224
v_lshl_or_b32 v177, v227, 16, v226
v_lshl_or_b32 v178, v229, 16, v228
v_lshl_or_b32 v179, v231, 16, v230
v_lshl_or_b32 v180, v233, 16, v232
v_lshl_or_b32 v181, v235, 16, v234
v_lshl_or_b32 v182, v237, 16, v236
v_lshl_or_b32 v183, v239, 16, v238
s_nop 1
v_mfma_f32_32x32x16_bf16 a[0:15], v[160:163], v[36:39], a[0:15]
v_mfma_f32_32x32x16_bf16 a[16:31], v[164:167], v[36:39], a[16:31]
v_mfma_f32_32x32x16_bf16 a[32:47], v[168:171], v[36:39], a[32:47]
v_mfma_f32_32x32x16_bf16 a[48:63], v[172:175], v[36:39], a[48:63]
v_mfma_f32_32x32x16_bf16 a[64:79], v[176:179], v[36:39], a[64:79]
v_mfma_f32_32x32x16_bf16 a[80:95], v[180:183], v[36:39], a[80:95]
s_nop 7
s_add_u32 s81, s81, 12288
s_cmp_lt_u32 s81, 147456
s_cbranch_scc1 L_sp2
v_mov_b32 v11, v10
s_nop 1
v_permlane32_swap_b32 v10, v11
s_nop 1
v_add_f32 v10, v10, v11
v_rcp_f32 v10, v10
s_nop 15
v_accvgpr_read_b32 v16, a0
v_accvgpr_read_b32 v17, a1
v_accvgpr_read_b32 v18, a2
v_accvgpr_read_b32 v19, a3
v_mul_f32 v16, v16, v10
v_mul_f32 v17, v17, v10
v_mul_f32 v18, v18, v10
v_mul_f32 v19, v19, v10
v_cvt_pk_bf16_f32 v40, v16, v17
v_cvt_pk_bf16_f32 v41, v18, v19
buffer_store_dwordx2 v[40:41], v6, s[76:79], s80 offen offset:0
v_accvgpr_read_b32 v16, a4
v_accvgpr_read_b32 v17, a5
v_accvgpr_read_b32 v18, a6
v_accvgpr_read_b32 v19, a7
v_mul_f32 v16, v16, v10
v_mul_f32 v17, v17, v10
v_mul_f32 v18, v18, v10
v_mul_f32 v19, v19, v10
v_cvt_pk_bf16_f32 v42, v16, v17
v_cvt_pk_bf16_f32 v43, v18, v19
buffer_store_dwordx2 v[42:43], v6, s[76:79], s80 offen offset:16
v_accvgpr_read_b32 v16, a8
v_accvgpr_read_b32 v17, a9
v_accvgpr_read_b32 v18, a10
v_accvgpr_read_b32 v19, a11
v_mul_f32 v16, v16, v10
v_mul_f32 v17, v17, v10
v_mul_f32 v18, v18, v10
v_mul_f32 v19, v19, v10
v_cvt_pk_bf16_f32 v44, v16, v17
v_cvt_pk_bf16_f32 v45, v18, v19
buffer_store_dwordx2 v[44:45], v6, s[76:79], s80 offen offset:32
v_accvgpr_read_b32 v16, a12
v_accvgpr_read_b32 v17, a13
v_accvgpr_read_b32 v18, a14
v_accvgpr_read_b32 v19, a15
v_mul_f32 v16, v16, v10
v_mul_f32 v17, v17, v10
v_mul_f32 v18, v18, v10
v_mul_f32 v19, v19, v10
v_cvt_pk_bf16_f32 v46, v16, v17
v_cvt_pk_bf16_f32 v47, v18, v19
buffer_store_dwordx2 v[46:47], v6, s[76:79], s80 offen offset:48
v_accvgpr_read_b32 v16, a16
v_accvgpr_read_b32 v17, a17
v_accvgpr_read_b32 v18, a18
v_accvgpr_read_b32 v19, a19
v_mul_f32 v16, v16, v10
v_mul_f32 v17, v17, v10
v_mul_f32 v18, v18, v10
v_mul_f32 v19, v19, v10
v_cvt_pk_bf16_f32 v48, v16, v17
v_cvt_pk_bf16_f32 v49, v18, v19
buffer_store_dwordx2 v[48:49], v6, s[76:79], s80 offen offset:64
v_accvgpr_read_b32 v16, a20
v_accvgpr_read_b32 v17, a21
v_accvgpr_read_b32 v18, a22
v_accvgpr_read_b32 v19, a23
v_mul_f32 v16, v16, v10
v_mul_f32 v17, v17, v10
v_mul_f32 v18, v18, v10
v_mul_f32 v19, v19, v10
v_cvt_pk_bf16_f32 v50, v16, v17
v_cvt_pk_bf16_f32 v51, v18, v19
buffer_store_dwordx2 v[50:51], v6, s[76:79], s80 offen offset:80
v_accvgpr_read_b32 v16, a24
v_accvgpr_read_b32 v17, a25
v_accvgpr_read_b32 v18, a26
v_accvgpr_read_b32 v19, a27
v_mul_f32 v16, v16, v10
v_mul_f32 v17, v17, v10
v_mul_f32 v18, v18, v10
v_mul_f32 v19, v19, v10
v_cvt_pk_bf16_f32 v52, v16, v17
v_cvt_pk_bf16_f32 v53, v18, v19
buffer_store_dwordx2 v[52:53], v6, s[76:79], s80 offen offset:96
v_accvgpr_read_b32 v16, a28
v_accvgpr_read_b32 v17, a29
v_accvgpr_read_b32 v18, a30
v_accvgpr_read_b32 v19, a31
v_mul_f32 v16, v16, v10
v_mul_f32 v17, v17, v10
v_mul_f32 v18, v18, v10
v_mul_f32 v19, v19, v10
v_cvt_pk_bf16_f32 v54, v16, v17
v_cvt_pk_bf16_f32 v55, v18, v19
buffer_store_dwordx2 v[54:55], v6, s[76:79], s80 offen offset:112
v_accvgpr_read_b32 v16, a32
v_accvgpr_read_b32 v17, a33
v_accvgpr_read_b32 v18, a34
v_accvgpr_read_b32 v19, a35
v_mul_f32 v16, v16, v10
v_mul_f32 v17, v17, v10
v_mul_f32 v18, v18, v10
v_mul_f32 v19, v19, v10
v_cvt_pk_bf16_f32 v40, v16, v17
v_cvt_pk_bf16_f32 v41, v18, v19
buffer_store_dwordx2 v[40:41], v6, s[76:79], s80 offen offset:128
v_accvgpr_read_b32 v16, a36
v_accvgpr_read_b32 v17, a37
v_accvgpr_read_b32 v18, a38
v_accvgpr_read_b32 v19, a39
v_mul_f32 v16, v16, v10
v_mul_f32 v17, v17, v10
v_mul_f32 v18, v18, v10
v_mul_f32 v19, v19, v10
v_cvt_pk_bf16_f32 v42, v16, v17
v_cvt_pk_bf16_f32 v43, v18, v19
buffer_store_dwordx2 v[42:43], v6, s[76:79], s80 offen offset:144
v_accvgpr_read_b32 v16, a40
v_accvgpr_read_b32 v17, a41
v_accvgpr_read_b32 v18, a42
v_accvgpr_read_b32 v19, a43
v_mul_f32 v16, v16, v10
v_mul_f32 v17, v17, v10
v_mul_f32 v18, v18, v10
v_mul_f32 v19, v19, v10
v_cvt_pk_bf16_f32 v44, v16, v17
v_cvt_pk_bf16_f32 v45, v18, v19
buffer_store_dwordx2 v[44:45], v6, s[76:79], s80 offen offset:160
v_accvgpr_read_b32 v16, a44
v_accvgpr_read_b32 v17, a45
v_accvgpr_read_b32 v18, a46
v_accvgpr_read_b32 v19, a47
v_mul_f32 v16, v16, v10
v_mul_f32 v17, v17, v10
v_mul_f32 v18, v18, v10
v_mul_f32 v19, v19, v10
v_cvt_pk_bf16_f32 v46, v16, v17
v_cvt_pk_bf16_f32 v47, v18, v19
buffer_store_dwordx2 v[46:47], v6, s[76:79], s80 offen offset:176
v_accvgpr_read_b32 v16, a48
v_accvgpr_read_b32 v17, a49
v_accvgpr_read_b32 v18, a50
v_accvgpr_read_b32 v19, a51
v_mul_f32 v16, v16, v10
v_mul_f32 v17, v17, v10
v_mul_f32 v18, v18, v10
v_mul_f32 v19, v19, v10
v_cvt_pk_bf16_f32 v48, v16, v17
v_cvt_pk_bf16_f32 v49, v18, v19
buffer_store_dwordx2 v[48:49], v6, s[76:79], s80 offen offset:192
v_accvgpr_read_b32 v16, a52
v_accvgpr_read_b32 v17, a53
v_accvgpr_read_b32 v18, a54
v_accvgpr_read_b32 v19, a55
v_mul_f32 v16, v16, v10
v_mul_f32 v17, v17, v10
v_mul_f32 v18, v18, v10
v_mul_f32 v19, v19, v10
v_cvt_pk_bf16_f32 v50, v16, v17
v_cvt_pk_bf16_f32 v51, v18, v19
buffer_store_dwordx2 v[50:51], v6, s[76:79], s80 offen offset:208
v_accvgpr_read_b32 v16, a56
v_accvgpr_read_b32 v17, a57
v_accvgpr_read_b32 v18, a58
v_accvgpr_read_b32 v19, a59
v_mul_f32 v16, v16, v10
v_mul_f32 v17, v17, v10
v_mul_f32 v18, v18, v10
v_mul_f32 v19, v19, v10
v_cvt_pk_bf16_f32 v52, v16, v17
v_cvt_pk_bf16_f32 v53, v18, v19
buffer_store_dwordx2 v[52:53], v6, s[76:79], s80 offen offset:224
v_accvgpr_read_b32 v16, a60
v_accvgpr_read_b32 v17, a61
v_accvgpr_read_b32 v18, a62
v_accvgpr_read_b32 v19, a63
v_mul_f32 v16, v16, v10
v_mul_f32 v17, v17, v10
v_mul_f32 v18, v18, v10
v_mul_f32 v19, v19, v10
v_cvt_pk_bf16_f32 v54, v16, v17
v_cvt_pk_bf16_f32 v55, v18, v19
buffer_store_dwordx2 v[54:55], v6, s[76:79], s80 offen offset:240
v_accvgpr_read_b32 v16, a64
v_accvgpr_read_b32 v17, a65
v_accvgpr_read_b32 v18, a66
v_accvgpr_read_b32 v19, a67
v_mul_f32 v16, v16, v10
v_mul_f32 v17, v17, v10
v_mul_f32 v18, v18, v10
v_mul_f32 v19, v19, v10
v_cvt_pk_bf16_f32 v40, v16, v17
v_cvt_pk_bf16_f32 v41, v18, v19
buffer_store_dwordx2 v[40:41], v6, s[76:79], s80 offen offset:256
v_accvgpr_read_b32 v16, a68
v_accvgpr_read_b32 v17, a69
v_accvgpr_read_b32 v18, a70
v_accvgpr_read_b32 v19, a71
v_mul_f32 v16, v16, v10
v_mul_f32 v17, v17, v10
v_mul_f32 v18, v18, v10
v_mul_f32 v19, v19, v10
v_cvt_pk_bf16_f32 v42, v16, v17
v_cvt_pk_bf16_f32 v43, v18, v19
buffer_store_dwordx2 v[42:43], v6, s[76:79], s80 offen offset:272
v_accvgpr_read_b32 v16, a72
v_accvgpr_read_b32 v17, a73
v_accvgpr_read_b32 v18, a74
v_accvgpr_read_b32 v19, a75
v_mul_f32 v16, v16, v10
v_mul_f32 v17, v17, v10
v_mul_f32 v18, v18, v10
v_mul_f32 v19, v19, v10
v_cvt_pk_bf16_f32 v44, v16, v17
v_cvt_pk_bf16_f32 v45, v18, v19
buffer_store_dwordx2 v[44:45], v6, s[76:79], s80 offen offset:288
v_accvgpr_read_b32 v16, a76
v_accvgpr_read_b32 v17, a77
v_accvgpr_read_b32 v18, a78
v_accvgpr_read_b32 v19, a79
v_mul_f32 v16, v16, v10
v_mul_f32 v17, v17, v10
v_mul_f32 v18, v18, v10
v_mul_f32 v19, v19, v10
v_cvt_pk_bf16_f32 v46, v16, v17
v_cvt_pk_bf16_f32 v47, v18, v19
buffer_store_dwordx2 v[46:47], v6, s[76:79], s80 offen offset:304
v_accvgpr_read_b32 v16, a80
v_accvgpr_read_b32 v17, a81
v_accvgpr_read_b32 v18, a82
v_accvgpr_read_b32 v19, a83
v_mul_f32 v16, v16, v10
v_mul_f32 v17, v17, v10
v_mul_f32 v18, v18, v10
v_mul_f32 v19, v19, v10
v_cvt_pk_bf16_f32 v48, v16, v17
v_cvt_pk_bf16_f32 v49, v18, v19
buffer_store_dwordx2 v[48:49], v6, s[76:79], s80 offen offset:320
v_accvgpr_read_b32 v16, a84
v_accvgpr_read_b32 v17, a85
v_accvgpr_read_b32 v18, a86
v_accvgpr_read_b32 v19, a87
v_mul_f32 v16, v16, v10
v_mul_f32 v17, v17, v10
v_mul_f32 v18, v18, v10
v_mul_f32 v19, v19, v10
v_cvt_pk_bf16_f32 v50, v16, v17
v_cvt_pk_bf16_f32 v51, v18, v19
buffer_store_dwordx2 v[50:51], v6, s[76:79], s80 offen offset:336
v_accvgpr_read_b32 v16, a88
v_accvgpr_read_b32 v17, a89
v_accvgpr_read_b32 v18, a90
v_accvgpr_read_b32 v19, a91
v_mul_f32 v16, v16, v10
v_mul_f32 v17, v17, v10
v_mul_f32 v18, v18, v10
v_mul_f32 v19, v19, v10
v_cvt_pk_bf16_f32 v52, v16, v17
v_cvt_pk_bf16_f32 v53, v18, v19
buffer_store_dwordx2 v[52:53], v6, s[76:79], s80 offen offset:352
v_accvgpr_read_b32 v16, a92
v_accvgpr_read_b32 v17, a93
v_accvgpr_read_b32 v18, a94
v_accvgpr_read_b32 v19, a95
v_mul_f32 v16, v16, v10
v_mul_f32 v17, v17, v10
v_mul_f32 v18, v18, v10
v_mul_f32 v19, v19, v10
v_cvt_pk_bf16_f32 v54, v16, v17
v_cvt_pk_bf16_f32 v55, v18, v19
buffer_store_dwordx2 v[54:55], v6, s[76:79], s80 offen offset:368
s_waitcnt vmcnt(0)
s_setpc_b64 s[82:83]
.section .rodata,"a"
.p2align 6
.amdhsa_kernel standalone__gqa_softmax__near_ridge_kernel
  .amdhsa_next_free_vgpr 512
  .amdhsa_next_free_sgpr 102
  .amdhsa_accum_offset 256
  .amdhsa_group_segment_fixed_size 0
  .amdhsa_kernarg_size 48
  .amdhsa_user_sgpr_count 2
  .amdhsa_user_sgpr_kernarg_segment_ptr 1
  .amdhsa_system_sgpr_workgroup_id_x 1
.end_amdhsa_kernel
```
